```python
import torch

def _softmax(x, axis=-1):
    return torch.softmax(x, dim=axis)
def _gelu(x):
    return torch.nn.functional.gelu(x, approximate="tanh")
def _silu(x):
    return torch.nn.functional.silu(x)
def _sigmoid(x):
    return torch.sigmoid(x)
def _layernorm(x, axis=-1, eps=1e-5):
    m = x.mean(dim=axis, keepdim=True)
    v = x.var(dim=axis, keepdim=True, unbiased=False)
    return (x - m) / torch.sqrt(v + eps)
def _scatter_add(tgt, idx, src, axis=0):
    return tgt.clone().index_add_(axis, idx, src)
def _segment_sum(src, seg, n):
    out = torch.zeros((n,) + src.shape[1:], dtype=src.dtype)
    return out.index_add_(0, seg, src)
def _pad(x, pw):
    flat = tuple(v for pair in reversed(pw) for v in pair)
    return torch.nn.functional.pad(x, flat)

kernel_name = 'gated_mix__ssm_conv_s5__swiglu_ffn__prompt'

def setup_inputs():

    _w = (lambda a: (lambda t: t.to(torch.bfloat16) if t.is_floating_point() else t)(torch.as_tensor(a)))
    def _A_setup():
        B, S, D = 1, 2048, 576
        P = D
        Lambda_re = -0.5 * (lambda _x: torch.exp(torch.as_tensor(_x)))((lambda *s: torch.randn(*s, dtype=torch.bfloat16) * 0.2)(P))
        Lambda_im = (lambda *s: torch.randn(*s, dtype=torch.bfloat16) * 0.4)(P) * 1.0
        B_re = (lambda *s: torch.randn(*s, dtype=torch.bfloat16) * 0.2)(P, D) * (D ** -0.5)
        B_im = (lambda *s: torch.randn(*s, dtype=torch.bfloat16) * 0.2)(P, D) * (D ** -0.5)
        C_re = (lambda *s: torch.randn(*s, dtype=torch.bfloat16) * 0.2)(D, P) * (P ** -0.5)
        C_im = (lambda *s: torch.randn(*s, dtype=torch.bfloat16) * 0.2)(D, P) * (P ** -0.5)
        log_dt = (lambda *s: torch.randn(*s, dtype=torch.bfloat16) * 0.2)(P) * 0.3 - 2.0
        Dskip = (lambda *s: torch.randn(*s, dtype=torch.bfloat16) * 0.05)(D)
        return {
            "x": _w((lambda *s: torch.randn(*s, dtype=torch.bfloat16) * 0.05)(B, S, D)),
            "Lambda_re": _w(Lambda_re),
            "Lambda_im": _w(Lambda_im),
            "B_re": _w(B_re),
            "B_im": _w(B_im),
            "C_re": _w(C_re),
            "C_im": _w(C_im),
            "log_dt": _w(log_dt),
            "Dskip": _w(Dskip),
        }
    _A_in = _A_setup()

    def _B_setup():
        B, S, D, F = 1, 2048, 576, 4608
        return {
            "x": _w((lambda *s: torch.randn(*s, dtype=torch.bfloat16) * 0.05)(B, S, D)),
            "w_gate": _w((lambda *s: torch.randn(*s, dtype=torch.bfloat16) * 0.05)(D, F)),
            "w_up": _w((lambda *s: torch.randn(*s, dtype=torch.bfloat16) * 0.05)(D, F)),
            "w_down": _w((lambda *s: torch.randn(*s, dtype=torch.bfloat16) * 0.05)(F, D)),
        }
    _B_in = _B_setup()

    return {
        "A_x": _A_in["x"],
        "A_Lambda_re": _A_in["Lambda_re"],
        "A_Lambda_im": _A_in["Lambda_im"],
        "A_B_re": _A_in["B_re"],
        "A_B_im": _A_in["B_im"],
        "A_C_re": _A_in["C_re"],
        "A_C_im": _A_in["C_im"],
        "A_log_dt": _A_in["log_dt"],
        "A_Dskip": _A_in["Dskip"],
        "B_x": _B_in["x"],
        "B_w_gate": _B_in["w_gate"],
        "B_w_up": _B_in["w_up"],
        "B_w_down": _B_in["w_down"],
        "gate_w": _w((lambda *s: torch.randn(*s, dtype=torch.bfloat16) * 0.05)(576) * 16.0),
    }

def reference(A_x, A_Lambda_re, A_Lambda_im, A_B_re, A_B_im, A_C_re, A_C_im, A_log_dt, A_Dskip, B_x, B_w_gate, B_w_up, B_w_down, gate_w):
    def _A_ref(x, Lambda_re, Lambda_im, B_re, B_im, C_re, C_im, log_dt, Dskip):
        Bsz, L, H = x.shape
        Lam = Lambda_re + 1j * Lambda_im
        Bmat = B_re + 1j * B_im
        Cmat = C_re + 1j * C_im
        dt = torch.exp(log_dt)
        Lam_bar = torch.exp(dt * Lam)
        B_bar = ((Lam_bar - 1.0) / Lam)[:, None] * Bmat
        Bu = torch.einsum("bld,pd->blp", x + 0j, B_bar)
        h = torch.zeros_like(Bu[:, 0, :])
        hs = []
        for t in range(L):
            h = Lam_bar[None, :] * h + Bu[:, t, :]
            hs.append(h)
        hseq = torch.stack(hs, 1)
        y = 2.0 * torch.einsum("blp,dp->bld", hseq, Cmat).real + x * Dskip[None, None, :]
        return y

    def _B_ref(x, w_gate, w_up, w_down):
        g = _silu(x @ w_gate)
        u = x @ w_up
        return (g * u) @ w_down

    x = A_x
    g = _sigmoid((x * gate_w).sum(-1, keepdims=True))
    a = _A_ref(x, A_Lambda_re, A_Lambda_im, A_B_re, A_B_im, A_C_re, A_C_im, A_log_dt, A_Dskip)
    b = _B_ref(x, B_w_gate, B_w_up, B_w_down)
    return g * a + (1 - g) * b
```

```asm
; @launch grid=(256,1,1) block=(256,1,1) lds=163840
.amdgcn_target "amdgcn-amd-amdhsa--gfx950"
.text
.p2align 8
.globl gated_mix__ssm_conv_s5__swiglu_ffn__prompt_kernel
.type gated_mix__ssm_conv_s5__swiglu_ffn__prompt_kernel,@function
gated_mix__ssm_conv_s5__swiglu_ffn__prompt_kernel:
    s_cmp_ge_u32 s2, 256
    s_cbranch_scc1 gated_mix__ssm_conv_s5__swiglu_ffn__prompt_kernel_done
    s_load_dwordx16 s[56:71], s[0:1], 0
    s_load_dwordx16 s[72:87], s[0:1], 64
    s_load_dwordx2 s[88:89], s[0:1], 128
    v_lshrrev_b32 v2, 6, v0
    s_lshr_b32 s50, s2, 3
    s_lshl_b32 s50, s50, 12
    v_and_b32 v11, 7, v0
    v_lshl_add_u32 v16, v11, 7, s50
    v_lshl_add_u32 v16, v2, 10, v16
    v_min_u32 v16, gated_mix__ssm_conv_s5__swiglu_ffn__prompt_kernel_done-gated_mix__ssm_conv_s5__swiglu_ffn__prompt_kernel, v16
    s_getpc_b64 s[12:13]
gated_mix__ssm_conv_s5__swiglu_ffn__prompt_kernel_pc:
    s_sub_u32 s12, s12, gated_mix__ssm_conv_s5__swiglu_ffn__prompt_kernel_pc-gated_mix__ssm_conv_s5__swiglu_ffn__prompt_kernel
    s_subb_u32 s13, s13, 0
    global_load_dword v223, v16, s[12:13]
    v_and_b32 v0, 63, v0
    v_readfirstlane_b32 s6, v2
    s_and_b32 s4, s2, 1
    s_bfe_u32 s3, s2, 0x20001
    s_add_u32 s5, s2, 192
    s_bfe_u32 s5, s5, 0x50003
    s_lshr_b32 s7, s5, 2
    s_and_b32 s50, s5, 3
    s_lshl_b32 s90, s4, 2
    s_add_u32 s90, s90, s50
    s_lshl_b32 s91, s90, 2
    s_add_u32 s91, s91, s6
    s_add_u32 s50, s50, s7
    s_mul_i32 s49, s50, 11
    s_lshr_b32 s49, s49, 5
    s_mul_i32 s49, s49, 3
    s_sub_u32 s49, s50, s49
    s_mul_i32 s49, s49, 3
    s_cmp_eq_u32 s3, 3
    s_cselect_b32 s50, 0, s3
    s_add_u32 s49, s49, s50
    s_mul_i32 s40, s49, 589824
    s_lshl_b32 s49, s49, 7
    v_and_b32 v15, 15, v0
    s_mul_i32 s41, s3, 9
    s_add_u32 s42, s41, s41
    s_add_u32 s41, s41, s7
    s_lshl_b32 s51, s41, 4
    v_add_lshl_u32 v100, v15, s51, 1
    s_add_u32 s42, s42, s7
    s_add_u32 s42, s42, 12
    s_lshl_b32 s42, s42, 3
    v_add_lshl_u32 v101, v11, s42, 1
    v_lshrrev_b32 v10, 3, v0
    v_lshrrev_b32 v12, 4, v0
    v_xor_b32 v11, v11, v12
    v_lshlrev_b32 v11, 4, v11
    v_lshrrev_b32 v13, 5, v0
    v_and_b32 v14, 3, v10
    v_lshl_add_u32 v13, v13, 4, v14
    s_lshl_b32 s50, s91, 6
    v_add_u32 v13, s50, v13
    v_mul_u32_u24 v13, 1152, v13
    v_add_u32 v30, v13, v11
    v_xor_b32 v13, 64, v30
    v_add_u32 v31, 35840, v13
    v_add_u32 v32, 2560, v30
    v_add_u32 v33, 38400, v13
    v_add_u32 v13, s42, v10
    s_lshl_b32 s43, s6, 5
    v_xor_b32 v19, s43, v11
    v_mul_u32_u24 v13, 1152, v13
    v_add_u32 v37, v13, v19
    s_and_b32 s50, s6, 1
    s_cselect_b32 s43, 2147483632, 0
    v_or_b32 v37, s43, v37
    s_lshl_b32 s43, s6, 9
    s_add_u32 s36, s43, 135168
    s_add_u32 s37, s43, 151552
    s_add_u32 s38, s43, 157696
    s_lshl_b32 s43, s50, 6
    s_cselect_b32 s36, 159744, s36
    s_cselect_b32 s37, 159744, s37
    s_cselect_b32 s38, 159744, s38
    v_xor_b32 v11, s43, v11
    s_lshl_b32 s50, s50, 3
    s_add_u32 s51, s51, s50
    v_add_u32 v13, s51, v10
    v_mul_u32_u24 v13, 1152, v13
    v_add_u32 v36, v13, v11
    s_mov_b32 s26, 663552
    s_mov_b32 s27, 0x20000
    s_mov_b32 s10, 2359296
    s_mov_b32 s11, 0x20000
    s_sub_u32 s44, s2, 64
    s_cmp_lt_u32 s44, 12
    s_cselect_b32 s50, -1, 0
    v_mov_b32 v104, s50
    v_mov_b32 v105, s50
    v_mov_b32 v106, s50
    v_mov_b32 v107, s50
    s_lshl_b32 s50, s6, 8
    s_or_b32 s50, s50, s44
    s_cmp_lt_u32 s50, 37
    s_cselect_b32 s45, 0, 2147483632
    s_cselect_b32 s44, s44, 0
    v_lshlrev_b32 v5, 4, v0
    s_lshl_b32 s46, s44, 12
    s_add_u32 s46, s46, 23601152
    s_or_b32 s46, s46, s45
    v_or_b32 v102, s46, v5
    s_mov_b32 s22, 24014848
    s_mov_b32 s23, 0x20000
    s_waitcnt lgkmcnt(0)
    s_mov_b32 s20, s88
    s_and_b32 s21, s89, 0xffff
    s_cmp_lt_u32 s6, 2
    s_cselect_b32 s24, s62, s64
    s_cselect_b32 s25, s63, s65
    s_and_b32 s25, s25, 0xffff
    s_lshl_b32 s74, s6, 10
    s_cmp_ge_u32 s7, 6
    s_cbranch_scc1 gated_mix__ssm_conv_s5__swiglu_ffn__prompt_kernel_sk1
    s_add_u32 m0, s74, 131072
    s_nop 0
    buffer_load_dwordx4 v36, s[24:27], s49 offen  lds
    s_mov_b32 m0, s36
    s_nop 0
    buffer_load_dwordx4 v37, s[24:27], s49 offen  lds
    global_load_ushort v208, v100, s[58:59]
    global_load_ushort v211, v101, s[58:59]
    global_load_ushort v209, v100, s[60:61]
    global_load_ushort v212, v101, s[60:61]
gated_mix__ssm_conv_s5__swiglu_ffn__prompt_kernel_sk1:
    s_mov_b32 s8, s56
    s_and_b32 s9, s57, 0xffff
    s_lshl_b32 s57, s6, 13
    s_add_u32 m0, s57, 98304
    s_nop 0
    buffer_load_dwordx4 v30, s[8:11], s49 offen offset:0  lds
    buffer_load_dwordx4 v31, s[8:11], s49 offen offset:1024  lds
    buffer_load_dwordx4 v32, s[8:11], s49 offen offset:2048  lds
    buffer_load_dwordx4 v33, s[8:11], s49 offen offset:3072  lds
    s_add_u32 m0, s57, 102400
    s_add_u32 s51, s49, 9216
    buffer_load_dwordx4 v30, s[8:11], s51 offen offset:0  lds
    buffer_load_dwordx4 v31, s[8:11], s51 offen offset:1024  lds
    buffer_load_dwordx4 v32, s[8:11], s51 offen offset:2048  lds
    buffer_load_dwordx4 v33, s[8:11], s51 offen offset:3072  lds
    v_lshrrev_b32 v16, 5, v0
    v_lshl_add_u32 v16, v16, 3, v14
    s_lshl_b32 s50, s6, 4
    v_add_u32 v16, s50, v16
    v_mul_u32_u24 v16, 9216, v16
    v_and_b32 v17, 0x70, v5
    v_lshlrev_b32 v18, 5, v12
    v_xor_b32 v17, v17, v18
    s_lshl_b32 s50, s41, 8
    v_add3_u32 v2, v16, v17, s50
    s_mov_b32 s12, s76
    s_and_b32 s13, s77, 0xffff
    s_mov_b32 s14, 5308416
    s_mov_b32 s15, 0x20000
    s_mov_b32 s16, s78
    s_and_b32 s17, s79, 0xffff
    s_mov_b32 s18, 5308416
    s_mov_b32 s19, 0x20000
    s_mov_b32 s28, s82
    s_and_b32 s29, s83, 0xffff
    s_mov_b32 s30, 1152
    s_mov_b32 s31, 0x20000
    s_mul_i32 s59, s91, 36
    s_add_u32 s59, s59, s41
    s_sub_u32 s60, s59, s7
    s_lshr_b32 s50, s7, 1
    s_add_u32 s60, s60, s50
    s_lshl_b32 s59, s59, 12
    s_lshl_b32 s60, s60, 12
    s_add_u32 s59, s59, 18874368
    s_add_u32 s60, s60, 18898944
    s_and_b32 s50, s7, 1
    s_lshl_b32 s50, s50, 8
    s_add_u32 s60, s60, s50
    s_lshl_b32 s64, s91, 8
    s_add_u32 s63, s64, 23715968
    s_mul_i32 s47, s3, 6
    s_add_u32 s47, s47, s7
    s_lshl2_add_u32 s62, s47, s64
    s_add_u32 s62, s62, 23715840
    s_add_u32 s64, s64, 23592960
    s_cmp_eq_u32 s41, 6
    s_cselect_b32 s50, 8, 99
    s_cselect_b32 s48, 0, 2147483632
    v_cmp_eq_u32 vcc, s50, v15
    v_lshlrev_b32 v13, 6, v12
    v_mov_b32 v16, 2147483632
    v_cndmask_b32 v27, v16, v13, vcc
    s_lshl_b32 s47, s47, 11
    s_add_u32 s47, s47, 23601152
    s_add_u32 s32, s88, s47
    s_addc_u32 s33, s89, 0
    s_and_b32 s33, s33, 0xffff
    s_mov_b32 s34, 2048
    s_mov_b32 s35, 0x20000
    s_lshr_b32 s61, s91, 1
    s_lshl_b32 s61, s61, 2
    s_add_u32 s61, s61, s3
    s_lshl_b32 s61, s61, 7
    s_add_u32 s61, s61, s7
    s_lshl_b32 s61, s61, 1
    s_and_b32 s50, s6, 1
    s_add_u32 s61, s61, s50
    s_lshl_b32 s61, s61, 2
    s_add_u32 s61, s61, 23650304
    s_sub_u32 s50, 7, s90
    s_lshl_b32 s50, s50, 8
    v_lshlrev_b32 v13, 9, v12
    v_lshl_add_u32 v13, v15, 4, v13
    v_add_u32 v7, s50, v13
    v_cmp_eq_u32 vcc, 0, v0
    v_subrev_u32 v13, 1536, v7
    s_nop 0
    v_cndmask_b32 v6, v16, v0, vcc
    v_or_b32 v26, s48, v6
    s_cmp_eq_u32 s6, 3
    s_cselect_b32 vcc_hi, 0xffff0000, 0
    s_mov_b32 vcc_lo, 0
    v_cndmask_b32 v155, v16, v13, vcc
    s_lshl_b32 s44, s44, 2
    s_or_b32 s44, s44, s45
    v_or_b32 v28, s44, v6
    v_and_b32 v16, 32, v0
    v_lshlrev_b32 v16, 6, v16
    v_bfe_u32 v17, v0, 2, 3
    v_lshl_add_u32 v16, v17, 7, v16
    v_lshl_add_u32 v16, v14, 5, v16
    v_and_b32 v17, 3, v0
    v_lshl_add_u32 v3, v17, 3, v16
    v_xor_b32 v4, 32, v3
    s_mov_b32 s52, s86
    s_and_b32 s53, s87, 0xffff
    s_mov_b32 s54, 256
    s_mov_b32 s55, 0x20000
    s_add_u32 s41, s40, 589824
    s_cmp_lg_u32 s41, 5308416
    s_cselect_b32 s41, s41, 0
    s_add_u32 s42, s41, 589824
    s_cmp_lg_u32 s42, 5308416
    s_cselect_b32 s42, s42, 0
    s_add_u32 s43, s42, 589824
    s_cmp_lg_u32 s43, 5308416
    s_cselect_b32 s43, s43, 0
    s_add_u32 s44, s43, 589824
    s_cmp_lg_u32 s44, 5308416
    s_cselect_b32 s44, s44, 0
    s_add_u32 s45, s44, 589824
    s_cmp_lg_u32 s45, 5308416
    s_cselect_b32 s45, s45, 0
    s_add_u32 s46, s45, 589824
    s_cmp_lg_u32 s46, 5308416
    s_cselect_b32 s46, s46, 0
    s_add_u32 s47, s46, 589824
    s_cmp_lg_u32 s47, 5308416
    s_cselect_b32 s47, s47, 0
    s_add_u32 s48, s47, 589824
    s_cmp_lg_u32 s48, 5308416
    s_cselect_b32 s48, s48, 0
    s_mul_i32 s50, s91, 144
    s_mul_i32 s51, s3, 36
    s_add_u32 s50, s50, s51
    s_lshl_b32 s50, s50, 12
    s_lshl_b32 s75, s7, 14
    s_add_u32 s75, s75, s50
    s_lshl_b32 s58, s7, 13
    s_add_u32 s58, s58, s50
    s_add_u32 s58, s58, 81920
    v_lshrrev_b32 v13, 1, v15
    v_xor_b32 v13, v13, v12
    v_lshlrev_b32 v13, 4, v13
    v_lshl_add_u32 v13, v15, 7, v13
    s_add_u32 s50, s57, 65536
    v_add_u32 v34, s50, v13
    v_xor_b32 v35, 64, v34
    v_add_u32 v38, 131072, v13
    v_xor_b32 v39, 64, v38
    s_add_u32 s50, s74, 147456
    v_lshl_add_u32 v153, v0, 3, s50
    v_or_b32 v154, 384, v153
    s_mov_b32 s56, 0xbfb8aa3b
    v_cvt_f32_u32 v13, v12
    v_mul_f32 v220, 0x44000000, v13
    v_mul_f32 v222, 0x41800000, v13
    s_lshl_b32 s50, s6, 2
    v_add_lshl_u32 v13, v12, s50, 4
    v_cvt_f32_u32 v221, v13
    v_lshlrev_b32 v214, 28, v0
    v_and_b32 v214, 0x80000000, v214
    s_add_u32 s50, s74, s49
    v_add_u32 v13, s50, v5
    v_subrev_u32 v16, 1152, v13
    v_min_u32 v13, v13, v16
    s_cmp_ge_u32 s7, 6
    s_cbranch_scc0 gated_mix__ssm_conv_s5__swiglu_ffn__prompt_kernel_sk2
    s_add_u32 m0, s74, 147456
    s_nop 0
    buffer_load_dwordx4 v13, s[28:31], 0 offen lds
    s_add_u32 vcc_lo, s40, 35840
    s_lshl1_add_u32 m0, s74, 0
    s_nop 0
    buffer_load_dwordx4 v2, s[12:15], s40 offen nt lds
    buffer_load_dwordx4 v2, s[12:15], vcc_lo offen offset:1024 nt lds
    s_lshl1_add_u32 m0, s74, 8192
    s_nop 0
    buffer_load_dwordx4 v2, s[16:19], s40 offen nt lds
    buffer_load_dwordx4 v2, s[16:19], vcc_lo offen offset:1024 nt lds
    v_lshlrev_b32 v38, 4, v12
    v_add_u32 v38, 147456, v38
gated_mix__ssm_conv_s5__swiglu_ffn__prompt_kernel_sk2:
    s_cmp_ge_u32 s7, 6
    s_cselect_b32 s50, 1, 1
    s_lshl_b32 s50, s50, 7
    s_add_u32 s49, s49, s50
    s_sub_u32 s51, s49, 1152
    s_min_u32 s49, s49, s51
    s_cmp_ge_u32 s7, 6
    s_cbranch_scc1 gated_mix__ssm_conv_s5__swiglu_ffn__prompt_kernel_sk3
    buffer_store_dwordx4 v[104:107], v102, s[20:23], 0 offen offset:0 sc1
    buffer_store_dwordx4 v[104:107], v102, s[20:23], 0 offen offset:1024 sc1
    buffer_store_dwordx4 v[104:107], v102, s[20:23], 0 offen offset:2048 sc1
    buffer_store_dwordx4 v[104:107], v102, s[20:23], 0 offen offset:3072 sc1
    global_load_ushort v210, v100, s[70:71]
    global_load_ushort v213, v101, s[70:71]
    global_load_ushort v215, v100, s[72:73]
    s_add_u32 m0, s74, 147456
    s_nop 0
    buffer_load_dwordx4 v36, s[24:27], s49 offen  lds
    s_mov_b32 m0, s37
    s_nop 0
    buffer_load_dwordx4 v37, s[24:27], s49 offen  lds
gated_mix__ssm_conv_s5__swiglu_ffn__prompt_kernel_sk3:
    s_add_u32 m0, s57, 65536
    s_nop 0
    buffer_load_dwordx4 v30, s[8:11], s49 offen offset:0  lds
    buffer_load_dwordx4 v31, s[8:11], s49 offen offset:1024  lds
    buffer_load_dwordx4 v32, s[8:11], s49 offen offset:2048  lds
    buffer_load_dwordx4 v33, s[8:11], s49 offen offset:3072  lds
    s_add_u32 m0, s57, 69632
    s_add_u32 s51, s49, 9216
    buffer_load_dwordx4 v30, s[8:11], s51 offen offset:0  lds
    buffer_load_dwordx4 v31, s[8:11], s51 offen offset:1024  lds
    buffer_load_dwordx4 v32, s[8:11], s51 offen offset:2048  lds
    buffer_load_dwordx4 v33, s[8:11], s51 offen offset:3072  lds
    s_cmp_ge_u32 s7, 6
    s_cbranch_scc1 gated_mix__ssm_conv_s5__swiglu_ffn__prompt_kernel_B
gated_mix__ssm_conv_s5__swiglu_ffn__prompt_kernel_A:
    s_add_u32 s49, s49, 128
    s_cmp_lg_u32 s49, 1152
    s_cselect_b32 s49, s49, 0
    s_waitcnt vmcnt(17)
    s_barrier
    ds_read_b128 a[0:3], v34 offset:32768
    ds_read_b128 a[4:7], v34 offset:34816
    ds_read_b128 a[8:11], v34 offset:36864
    ds_read_b128 a[12:15], v34 offset:38912
    ds_read_b128 a[16:19], v35 offset:32768
    ds_read_b128 a[20:23], v35 offset:34816
    ds_read_b128 a[24:27], v35 offset:36864
    ds_read_b128 a[28:31], v35 offset:38912
    ds_read_b128 v[40:43], v38 offset:0
    ds_read_b128 v[44:47], v38 offset:2048
    ds_read_b128 v[48:51], v38 offset:4096
    ds_read_b128 v[52:55], v39 offset:0
    s_waitcnt lgkmcnt(3)
    v_mfma_f32_16x16x32_bf16 v[224:227], a[0:3], v[40:43], 0
    s_add_u32 m0, s74, 153600
    ds_read_b128 v[56:59], v39 offset:2048
    v_mov_b32 v150, 0
    v_mfma_f32_16x16x32_bf16 v[228:231], a[4:7], v[40:43], 0
    buffer_load_dwordx4 v36, s[24:27], s49 offen  lds
    v_mfma_f32_16x16x32_bf16 v[232:235], a[8:11], v[40:43], 0
    s_mov_b32 m0, s38
    v_mov_b32 v151, 0
    s_waitcnt vmcnt(11)
    v_mfma_f32_16x16x32_bf16 v[236:239], a[12:15], v[40:43], 0
    s_waitcnt lgkmcnt(3)
    v_lshlrev_b32 v208, 16, v208
    v_lshlrev_b32 v209, 16, v209
    v_mfma_f32_16x16x32_bf16 v[240:243], a[0:3], v[44:47], 0
    buffer_load_dwordx4 v37, s[24:27], s49 offen  lds
    v_mfma_f32_16x16x32_bf16 v[244:247], a[4:7], v[44:47], 0
    s_add_u32 m0, s57, 98304
    ds_read_b128 v[60:63], v39 offset:4096
    v_lshlrev_b32 v210, 16, v210
    v_mfma_f32_16x16x32_bf16 v[248:251], a[8:11], v[44:47], 0
    buffer_load_dwordx4 v30, s[8:11], s49 offen offset:0  lds
    v_mfma_f32_16x16x32_bf16 v[252:255], a[12:15], v[44:47], 0
    s_waitcnt lgkmcnt(1)
    v_mul_f32 v210, 0x3fb8aa3b, v210
    s_bitcmp1_b32 s6, 0
    s_cselect_b32 s28, s16, s12
    s_cselect_b32 s29, s17, s13
    v_mfma_f32_16x16x32_bf16 v[192:195], a[0:3], v[48:51], 0
    buffer_load_dwordx4 v31, s[8:11], s49 offen offset:1024  lds
    v_mfma_f32_16x16x32_bf16 v[196:199], a[4:7], v[48:51], 0
    buffer_load_dwordx4 v32, s[8:11], s49 offen offset:2048  lds
    v_mfma_f32_16x16x32_bf16 v[200:203], a[8:11], v[48:51], 0
    buffer_load_dwordx4 v33, s[8:11], s49 offen offset:3072  lds
    v_mfma_f32_16x16x32_bf16 v[204:207], a[12:15], v[48:51], 0
    s_add_u32 m0, s57, 102400
    v_exp_f32 v210, v210
    v_mfma_f32_16x16x32_bf16 v[224:227], a[16:19], v[52:55], v[224:227]
    s_add_u32 s51, s49, 9216
    v_cvt_pk_bf16_f32 v210, v210, v210
    v_lshlrev_b32 v210, 16, v210
    v_mfma_f32_16x16x32_bf16 v[228:231], a[20:23], v[52:55], v[228:231]
    buffer_load_dwordx4 v30, s[8:11], s51 offen offset:0  lds
    v_mfma_f32_16x16x32_bf16 v[232:235], a[24:27], v[52:55], v[232:235]
    buffer_load_dwordx4 v31, s[8:11], s51 offen offset:1024  lds
    v_mfma_f32_16x16x32_bf16 v[236:239], a[28:31], v[52:55], v[236:239]
    buffer_load_dwordx4 v32, s[8:11], s51 offen offset:2048  lds
    v_mfma_f32_16x16x32_bf16 v[240:243], a[16:19], v[56:59], v[240:243]
    buffer_load_dwordx4 v33, s[8:11], s51 offen offset:3072  lds
    v_mfma_f32_16x16x32_bf16 v[244:247], a[20:23], v[56:59], v[244:247]
    s_add_u32 s49, s49, 128
    v_mul_f32 v216, v210, v208
    s_cmp_lg_u32 s49, 1152
    s_cselect_b32 s49, s49, 0
    v_mfma_f32_16x16x32_bf16 v[248:251], a[24:27], v[56:59], v[248:251]
    s_mov_b32 s30, 5308416
    v_mul_f32 v217, v210, v209
    v_mul_f32 v216, 0x3fb8aa3b, v216
    v_mfma_f32_16x16x32_bf16 v[252:255], a[28:31], v[56:59], v[252:255]
    s_waitcnt lgkmcnt(0)
    v_mul_f32 v217, 0.15915494, v217
    v_rndne_f32 v218, v217
    v_mfma_f32_16x16x32_bf16 v[192:195], a[16:19], v[60:63], v[192:195]
    s_lshl1_add_u32 s86, s5, s4
    v_sub_f32 v217, v217, v218
    v_mul_f32 v218, 1.0, v216
    v_mfma_f32_16x16x32_bf16 v[196:199], a[20:23], v[60:63], v[196:199]
    s_lshr_b32 s87, s6, 1
    v_mul_f32 v219, 1.0, v217
    s_lshl1_add_u32 s86, s86, s87
    v_mfma_f32_16x16x32_bf16 v[200:203], a[24:27], v[60:63], v[200:203]
    s_mul_i32 s86, s86, 55296
    v_exp_f32 v218, v218
    v_mfma_f32_16x16x32_bf16 v[204:207], a[28:31], v[60:63], v[204:207]
    v_rndne_f32 v8, v219
    v_sub_f32 v219, v219, v8
    v_cos_f32 v8, v219
    v_sin_f32 v9, v219
    v_mul_f32 v8, v218, v8
    v_mul_f32 v9, v218, v9
    v_mul_f32 v218, 0x41800000, v216
    v_mul_f32 v219, 0x41800000, v217
    v_exp_f32 v218, v218
    v_rndne_f32 v128, v219
    v_sub_f32 v219, v219, v128
    v_cos_f32 v128, v219
    v_sin_f32 v129, v219
    v_mul_f32 v128, v218, v128
    v_mul_f32 v129, v218, v129
    v_mul_f32 v218, 0x42800000, v216
    v_mul_f32 v219, 0x42800000, v217
    v_exp_f32 v218, v218
    v_rndne_f32 v130, v219
    v_sub_f32 v219, v219, v130
    v_cos_f32 v130, v219
    v_sin_f32 v131, v219
    v_mul_f32 v130, v218, v130
    v_mul_f32 v131, v218, v131
    v_mul_f32 v218, v222, v216
    v_mul_f32 v219, v222, v217
    s_cmp_eq_u32 s6, 0
    s_cbranch_scc1 gated_mix__ssm_conv_s5__swiglu_ffn__prompt_kernel_A_pg0_0
    s_cmp_eq_u32 s6, 1
    s_cbranch_scc1 gated_mix__ssm_conv_s5__swiglu_ffn__prompt_kernel_A_pg0_9
    s_cmp_eq_u32 s6, 2
    s_cbranch_scc1 gated_mix__ssm_conv_s5__swiglu_ffn__prompt_kernel_A_pg0_10
    s_cmp_eq_u32 s6, 3
    s_cbranch_scc1 gated_mix__ssm_conv_s5__swiglu_ffn__prompt_kernel_A_pg0_11
gated_mix__ssm_conv_s5__swiglu_ffn__prompt_kernel_A_pr0:
    s_waitcnt vmcnt(10)
    s_barrier
    ds_read_b128 a[32:35], v34 offset:0
    ds_read_b128 a[36:39], v34 offset:2048
    ds_read_b128 a[40:43], v34 offset:4096
    ds_read_b128 a[44:47], v34 offset:6144
    ds_read_b128 a[48:51], v35 offset:0
    ds_read_b128 a[52:55], v35 offset:2048
    ds_read_b128 a[56:59], v35 offset:4096
    ds_read_b128 a[60:63], v35 offset:6144
    ds_read_b128 v[40:43], v38 offset:16384
    s_waitcnt lgkmcnt(0)
    ds_read_b128 v[44:47], v38 offset:18432
    v_mfma_f32_16x16x32_bf16 v[224:227], a[32:35], v[40:43], v[224:227]
    s_add_u32 m0, s74, 131072
    ds_read_b128 v[48:51], v38 offset:20480
    v_mfma_f32_16x16x32_bf16 v[228:231], a[36:39], v[40:43], v[228:231]
    buffer_store_dword v4, v28, s[52:55], 0 offen sc1
    v_mfma_f32_16x16x32_bf16 v[232:235], a[40:43], v[40:43], v[232:235]
    s_mul_i32 s87, s3, 2304
    ds_read_b128 v[52:55], v39 offset:16384
    v_min_u32 v29, 36, v0
    v_mfma_f32_16x16x32_bf16 v[236:239], a[44:47], v[40:43], v[236:239]
    s_waitcnt lgkmcnt(2)
    ds_read_b128 v[56:59], v39 offset:18432
    v_lshlrev_b32 v29, 2, v29
    v_mfma_f32_16x16x32_bf16 v[240:243], a[32:35], v[44:47], v[240:243]
    buffer_load_dwordx4 v36, s[24:27], s49 offen  lds
    v_mfma_f32_16x16x32_bf16 v[244:247], a[36:39], v[44:47], v[244:247]
    s_mov_b32 m0, s36
    ds_read_b128 v[60:63], v39 offset:20480
    v_mfma_f32_16x16x32_bf16 v[248:251], a[40:43], v[44:47], v[248:251]
    buffer_load_dwordx4 v37, s[24:27], s49 offen  lds
    v_mfma_f32_16x16x32_bf16 v[252:255], a[44:47], v[44:47], v[252:255]
    s_waitcnt lgkmcnt(3)
    v_exp_f32 v218, v218
    v_mfma_f32_16x16x32_bf16 v[192:195], a[32:35], v[48:51], v[192:195]
    s_add_u32 m0, s57, 65536
    v_rndne_f32 v132, v219
    v_sub_f32 v219, v219, v132
    v_mfma_f32_16x16x32_bf16 v[196:199], a[36:39], v[48:51], v[196:199]
    buffer_load_dwordx4 v30, s[8:11], s49 offen offset:0  lds
    v_mfma_f32_16x16x32_bf16 v[200:203], a[40:43], v[48:51], v[200:203]
    buffer_load_dwordx4 v31, s[8:11], s49 offen offset:1024  lds
    v_mfma_f32_16x16x32_bf16 v[204:207], a[44:47], v[48:51], v[204:207]
    s_waitcnt lgkmcnt(0)
    v_cos_f32 v132, v219
    v_mfma_f32_16x16x32_bf16 v[224:227], a[48:51], v[52:55], v[224:227]
    buffer_load_dwordx4 v32, s[8:11], s49 offen offset:2048  lds
    v_mfma_f32_16x16x32_bf16 v[228:231], a[52:55], v[52:55], v[228:231]
    buffer_load_dwordx4 v33, s[8:11], s49 offen offset:3072  lds
    v_mfma_f32_16x16x32_bf16 v[232:235], a[56:59], v[52:55], v[232:235]
    s_add_u32 m0, s57, 69632
    v_sin_f32 v133, v219
    v_mfma_f32_16x16x32_bf16 v[236:239], a[60:63], v[52:55], v[236:239]
    s_add_u32 s51, s49, 9216
    v_mul_f32 v132, v218, v132
    v_mul_f32 v133, v218, v133
    v_mfma_f32_16x16x32_bf16 v[240:243], a[48:51], v[56:59], v[240:243]
    buffer_load_dwordx4 v30, s[8:11], s51 offen offset:0  lds
    v_mfma_f32_16x16x32_bf16 v[244:247], a[52:55], v[56:59], v[244:247]
    buffer_load_dwordx4 v31, s[8:11], s51 offen offset:1024  lds
    v_mfma_f32_16x16x32_bf16 v[248:251], a[56:59], v[56:59], v[248:251]
    buffer_load_dwordx4 v32, s[8:11], s51 offen offset:2048  lds
    v_mfma_f32_16x16x32_bf16 v[252:255], a[60:63], v[56:59], v[252:255]
    buffer_load_dwordx4 v33, s[8:11], s51 offen offset:3072  lds
    v_mfma_f32_16x16x32_bf16 v[192:195], a[48:51], v[60:63], v[192:195]
    s_add_u32 s49, s49, 128
    v_mul_f32 v218, 0x43800000, v216
    s_cmp_lg_u32 s49, 1152
    s_cselect_b32 s49, s49, 0
    v_mfma_f32_16x16x32_bf16 v[196:199], a[52:55], v[60:63], v[196:199]
    s_add_u32 s86, s86, s87
    v_mul_f32 v219, 0x43800000, v217
    s_add_u32 s65, s75, 4096
    v_mfma_f32_16x16x32_bf16 v[200:203], a[56:59], v[60:63], v[200:203]
    s_add_u32 s70, s75, 8192
    v_exp_f32 v218, v218
    v_mfma_f32_16x16x32_bf16 v[204:207], a[60:63], v[60:63], v[204:207]
    v_rndne_f32 v16, v219
    v_sub_f32 v219, v219, v16
    v_cos_f32 v16, v219
    v_sin_f32 v17, v219
    v_mul_f32 v16, v218, v16
    v_mul_f32 v17, v218, v17
    v_mul_f32 v218, v220, v216
    v_mul_f32 v219, v220, v217
    v_exp_f32 v218, v218
    v_rndne_f32 v18, v219
    v_sub_f32 v219, v219, v18
    v_cos_f32 v18, v219
    v_sin_f32 v19, v219
    v_mul_f32 v18, v218, v18
    v_mul_f32 v19, v218, v19
    v_mul_f32 v218, v221, v216
    v_mul_f32 v219, v221, v217
    v_exp_f32 v218, v218
    v_rndne_f32 v20, v219
    v_sub_f32 v219, v219, v20
    v_cos_f32 v20, v219
    v_sin_f32 v21, v219
    v_mul_f32 v20, v218, v20
    v_mul_f32 v21, v218, v21
    v_add_f32 v218, -1.0, v8
    v_mul_f32 v219, v208, v208
    s_waitcnt vmcnt(11)
    s_barrier
    ds_read_b128 a[64:67], v34 offset:32768
    ds_read_b128 a[68:71], v34 offset:34816
    ds_read_b128 a[72:75], v34 offset:36864
    ds_read_b128 a[76:79], v34 offset:38912
    ds_read_b128 a[80:83], v35 offset:32768
    ds_read_b128 a[84:87], v35 offset:34816
    ds_read_b128 a[88:91], v35 offset:36864
    ds_read_b128 a[92:95], v35 offset:38912
    ds_read_b128 v[40:43], v38 offset:22528
    s_waitcnt lgkmcnt(0)
    ds_read_b128 v[44:47], v38 offset:24576
    v_fmac_f32 v219, v209, v209
    v_mfma_f32_16x16x32_bf16 v[224:227], a[64:67], v[40:43], v[224:227]
    s_add_u32 m0, s74, 147456
    ds_read_b128 v[48:51], v38 offset:26624
    v_mfma_f32_16x16x32_bf16 v[228:231], a[68:71], v[40:43], v[228:231]
    buffer_load_dwordx4 v36, s[24:27], s49 offen  lds
    v_mfma_f32_16x16x32_bf16 v[232:235], a[72:75], v[40:43], v[232:235]
    s_mov_b32 m0, s37
    ds_read_b128 v[52:55], v39 offset:22528
    v_mfma_f32_16x16x32_bf16 v[236:239], a[76:79], v[40:43], v[236:239]
    s_waitcnt lgkmcnt(2)
    ds_read_b128 v[56:59], v39 offset:24576
    v_mfma_f32_16x16x32_bf16 v[240:243], a[64:67], v[44:47], v[240:243]
    buffer_load_dwordx4 v37, s[24:27], s49 offen  lds
    v_mfma_f32_16x16x32_bf16 v[244:247], a[68:71], v[44:47], v[244:247]
    s_add_u32 m0, s57, 98304
    ds_read_b128 v[60:63], v39 offset:26624
    v_mfma_f32_16x16x32_bf16 v[248:251], a[72:75], v[44:47], v[248:251]
    buffer_load_dwordx4 v30, s[8:11], s49 offen offset:0  lds
    v_mfma_f32_16x16x32_bf16 v[252:255], a[76:79], v[44:47], v[252:255]
    s_waitcnt lgkmcnt(3)
    v_rcp_f32 v219, v219
    v_mfma_f32_16x16x32_bf16 v[192:195], a[64:67], v[48:51], v[192:195]
    buffer_load_dwordx4 v31, s[8:11], s49 offen offset:1024  lds
    v_mfma_f32_16x16x32_bf16 v[196:199], a[68:71], v[48:51], v[196:199]
    buffer_load_dwordx4 v32, s[8:11], s49 offen offset:2048  lds
    v_mfma_f32_16x16x32_bf16 v[200:203], a[72:75], v[48:51], v[200:203]
    buffer_load_dwordx4 v33, s[8:11], s49 offen offset:3072  lds
    v_mfma_f32_16x16x32_bf16 v[204:207], a[76:79], v[48:51], v[204:207]
    s_waitcnt lgkmcnt(0)
    v_mul_f32 v10, v218, v208
    s_add_u32 m0, s57, 102400
    v_mfma_f32_16x16x32_bf16 v[224:227], a[80:83], v[52:55], v[224:227]
    s_add_u32 s51, s49, 9216
    v_fmac_f32 v10, v9, v209
    v_mul_f32 v11, v9, v208
    v_mfma_f32_16x16x32_bf16 v[228:231], a[84:87], v[52:55], v[228:231]
    buffer_load_dwordx4 v30, s[8:11], s51 offen offset:0  lds
    v_mfma_f32_16x16x32_bf16 v[232:235], a[88:91], v[52:55], v[232:235]
    buffer_load_dwordx4 v31, s[8:11], s51 offen offset:1024  lds
    v_mfma_f32_16x16x32_bf16 v[236:239], a[92:95], v[52:55], v[236:239]
    buffer_load_dwordx4 v32, s[8:11], s51 offen offset:2048  lds
    v_mfma_f32_16x16x32_bf16 v[240:243], a[80:83], v[56:59], v[240:243]
    buffer_load_dwordx4 v33, s[8:11], s51 offen offset:3072  lds
    v_mfma_f32_16x16x32_bf16 v[244:247], a[84:87], v[56:59], v[244:247]
    s_add_u32 s49, s49, 128
    v_fma_f32 v11, -v218, v209, v11
    s_cmp_lg_u32 s49, 1152
    s_cselect_b32 s49, s49, 0
    v_mfma_f32_16x16x32_bf16 v[248:251], a[88:91], v[56:59], v[248:251]
    s_add_u32 s71, s75, 12288
    v_add_f32 v219, v219, v219
    v_mul_f32 v10, v10, v219
    v_mfma_f32_16x16x32_bf16 v[252:255], a[92:95], v[56:59], v[252:255]
    v_mul_f32 v11, v11, v219
    v_lshlrev_b32 v211, 16, v211
    v_mfma_f32_16x16x32_bf16 v[192:195], a[80:83], v[60:63], v[192:195]
    v_lshlrev_b32 v212, 16, v212
    v_xor_b32 v212, v214, v212
    v_mfma_f32_16x16x32_bf16 v[196:199], a[84:87], v[60:63], v[196:199]
    v_xor_b32 v212, 0x80000000, v212
    v_lshlrev_b32 v213, 16, v213
    v_mfma_f32_16x16x32_bf16 v[200:203], a[88:91], v[60:63], v[200:203]
    v_mul_f32 v213, 0x3fb8aa3b, v213
    v_mfma_f32_16x16x32_bf16 v[204:207], a[92:95], v[60:63], v[204:207]
    v_exp_f32 v213, v213
    s_nop 0
    v_cvt_pk_bf16_f32 v213, v213, v213
    v_lshlrev_b32 v213, 16, v213
    v_mul_f32 v216, v213, v211
    v_mul_f32 v217, v213, v212
    v_mul_f32 v216, 0x3fb8aa3b, v216
    v_mul_f32 v217, 0.15915494, v217
    v_rndne_f32 v218, v217
    v_sub_f32 v217, v217, v218
    v_mul_f32 v218, 1.0, v216
    v_mul_f32 v219, 1.0, v217
    v_exp_f32 v218, v218
    v_rndne_f32 v12, v219
    v_sub_f32 v219, v219, v12
    v_cos_f32 v12, v219
    v_sin_f32 v13, v219
    v_mul_f32 v12, v218, v12
    v_mul_f32 v13, v218, v13
    v_mul_f32 v218, 0x41800000, v216
    v_mul_f32 v219, 0x41800000, v217
    v_exp_f32 v218, v218
    v_rndne_f32 v134, v219
    v_sub_f32 v219, v219, v134
    v_cos_f32 v134, v219
    s_branch gated_mix__ssm_conv_s5__swiglu_ffn__prompt_kernel_A_sk0
.p2align 12
gated_mix__ssm_conv_s5__swiglu_ffn__prompt_kernel_A_pg0_0:
    s_branch gated_mix__ssm_conv_s5__swiglu_ffn__prompt_kernel_A_pr0
gated_mix__ssm_conv_s5__swiglu_ffn__prompt_kernel_A_sk0:
    v_sin_f32 v135, v219
    v_mul_f32 v134, v218, v134
    s_cmp_eq_u32 s6, 0
    s_cbranch_scc1 gated_mix__ssm_conv_s5__swiglu_ffn__prompt_kernel_A_pg1_5
    s_cmp_eq_u32 s6, 1
    s_cbranch_scc1 gated_mix__ssm_conv_s5__swiglu_ffn__prompt_kernel_A_pg1_6
    s_cmp_eq_u32 s6, 2
    s_cbranch_scc1 gated_mix__ssm_conv_s5__swiglu_ffn__prompt_kernel_A_pg1_7
    s_cmp_eq_u32 s6, 3
    s_cbranch_scc1 gated_mix__ssm_conv_s5__swiglu_ffn__prompt_kernel_A_pg1_8
gated_mix__ssm_conv_s5__swiglu_ffn__prompt_kernel_A_pr1:
    s_waitcnt vmcnt(10)
    s_barrier
    ds_read_b128 a[96:99], v34 offset:0
    ds_read_b128 a[100:103], v34 offset:2048
    ds_read_b128 a[104:107], v34 offset:4096
    ds_read_b128 a[108:111], v34 offset:6144
    ds_read_b128 a[112:115], v35 offset:0
    ds_read_b128 a[116:119], v35 offset:2048
    ds_read_b128 a[120:123], v35 offset:4096
    ds_read_b128 a[124:127], v35 offset:6144
    ds_read_b128 v[40:43], v38 offset:0
    s_waitcnt lgkmcnt(0)
    ds_read_b128 v[44:47], v38 offset:2048
    v_mul_f32 v135, v218, v135
    v_mfma_f32_16x16x32_bf16 v[224:227], a[96:99], v[40:43], v[224:227]
    s_add_u32 m0, s74, 153600
    ds_read_b128 v[48:51], v38 offset:4096
    v_mul_f32 v218, 0x42800000, v216
    v_mfma_f32_16x16x32_bf16 v[228:231], a[100:103], v[40:43], v[228:231]
    buffer_load_dwordx4 v36, s[24:27], s49 offen  lds
    v_mfma_f32_16x16x32_bf16 v[232:235], a[104:107], v[40:43], v[232:235]
    s_mov_b32 m0, s38
    ds_read_b128 v[52:55], v39 offset:0
    v_mul_f32 v219, 0x42800000, v217
    v_mfma_f32_16x16x32_bf16 v[236:239], a[108:111], v[40:43], v[236:239]
    s_waitcnt lgkmcnt(2)
    ds_read_b128 v[56:59], v39 offset:2048
    v_mfma_f32_16x16x32_bf16 v[240:243], a[96:99], v[44:47], v[240:243]
    buffer_load_dwordx4 v37, s[24:27], s49 offen  lds
    v_mfma_f32_16x16x32_bf16 v[244:247], a[100:103], v[44:47], v[244:247]
    s_add_u32 m0, s57, 65536
    ds_read_b128 v[60:63], v39 offset:4096
    v_mfma_f32_16x16x32_bf16 v[248:251], a[104:107], v[44:47], v[248:251]
    buffer_load_dwordx4 v30, s[8:11], s49 offen offset:0  lds
    v_mfma_f32_16x16x32_bf16 v[252:255], a[108:111], v[44:47], v[252:255]
    s_waitcnt lgkmcnt(3)
    v_exp_f32 v218, v218
    v_mfma_f32_16x16x32_bf16 v[192:195], a[96:99], v[48:51], v[192:195]
    buffer_load_dwordx4 v31, s[8:11], s49 offen offset:1024  lds
    v_mfma_f32_16x16x32_bf16 v[196:199], a[100:103], v[48:51], v[196:199]
    buffer_load_dwordx4 v32, s[8:11], s49 offen offset:2048  lds
    v_mfma_f32_16x16x32_bf16 v[200:203], a[104:107], v[48:51], v[200:203]
    buffer_load_dwordx4 v33, s[8:11], s49 offen offset:3072  lds
    v_mfma_f32_16x16x32_bf16 v[204:207], a[108:111], v[48:51], v[204:207]
    s_waitcnt lgkmcnt(0)
    v_rndne_f32 v136, v219
    s_add_u32 m0, s57, 69632
    v_mfma_f32_16x16x32_bf16 v[224:227], a[112:115], v[52:55], v[224:227]
    s_add_u32 s51, s49, 9216
    v_sub_f32 v219, v219, v136
    v_mfma_f32_16x16x32_bf16 v[228:231], a[116:119], v[52:55], v[228:231]
    buffer_load_dwordx4 v30, s[8:11], s51 offen offset:0  lds
    v_mfma_f32_16x16x32_bf16 v[232:235], a[120:123], v[52:55], v[232:235]
    buffer_load_dwordx4 v31, s[8:11], s51 offen offset:1024  lds
    v_mfma_f32_16x16x32_bf16 v[236:239], a[124:127], v[52:55], v[236:239]
    buffer_load_dwordx4 v32, s[8:11], s51 offen offset:2048  lds
    v_mfma_f32_16x16x32_bf16 v[240:243], a[112:115], v[56:59], v[240:243]
    buffer_load_dwordx4 v33, s[8:11], s51 offen offset:3072  lds
    v_mfma_f32_16x16x32_bf16 v[244:247], a[116:119], v[56:59], v[244:247]
    s_add_u32 s49, s49, 128
    v_cos_f32 v136, v219
    v_mfma_f32_16x16x32_bf16 v[248:251], a[120:123], v[56:59], v[248:251]
    s_cmp_lg_u32 s49, 1152
    s_cselect_b32 s49, s49, 0
    v_sin_f32 v137, v219
    v_mfma_f32_16x16x32_bf16 v[252:255], a[124:127], v[56:59], v[252:255]
    v_mul_f32 v136, v218, v136
    v_mul_f32 v137, v218, v137
    v_mfma_f32_16x16x32_bf16 v[192:195], a[112:115], v[60:63], v[192:195]
    v_mul_f32 v218, v222, v216
    v_mul_f32 v219, v222, v217
    v_mfma_f32_16x16x32_bf16 v[196:199], a[116:119], v[60:63], v[196:199]
    v_exp_f32 v218, v218
    v_mfma_f32_16x16x32_bf16 v[200:203], a[120:123], v[60:63], v[200:203]
    v_rndne_f32 v138, v219
    v_sub_f32 v219, v219, v138
    v_mfma_f32_16x16x32_bf16 v[204:207], a[124:127], v[60:63], v[204:207]
    v_cos_f32 v138, v219
    v_sin_f32 v139, v219
    v_mul_f32 v138, v218, v138
    v_mul_f32 v139, v218, v139
    v_mul_f32 v218, 0x43800000, v216
    v_mul_f32 v219, 0x43800000, v217
    v_exp_f32 v218, v218
    v_rndne_f32 v22, v219
    v_sub_f32 v219, v219, v22
    v_cos_f32 v22, v219
    v_sin_f32 v23, v219
    v_mul_f32 v22, v218, v22
    v_mul_f32 v23, v218, v23
    v_mul_f32 v218, v220, v216
    v_mul_f32 v219, v220, v217
    v_exp_f32 v218, v218
    v_rndne_f32 v24, v219
    v_sub_f32 v219, v219, v24
    v_cos_f32 v24, v219
    v_sin_f32 v25, v219
    v_mul_f32 v24, v218, v24
    v_mul_f32 v25, v218, v25
    v_mul_f32 v218, v221, v216
    v_mul_f32 v219, v221, v217
    v_exp_f32 v218, v218
    v_rndne_f32 v26, v219
    s_waitcnt vmcnt(10)
    s_barrier
    ds_read_b128 a[128:131], v34 offset:32768
    ds_read_b128 a[132:135], v34 offset:34816
    ds_read_b128 a[136:139], v34 offset:36864
    ds_read_b128 a[140:143], v34 offset:38912
    ds_read_b128 a[144:147], v35 offset:32768
    ds_read_b128 a[148:151], v35 offset:34816
    ds_read_b128 a[152:155], v35 offset:36864
    ds_read_b128 a[156:159], v35 offset:38912
    ds_read_b128 v[40:43], v38 offset:16384
    s_waitcnt lgkmcnt(0)
    ds_read_b128 v[44:47], v38 offset:18432
    v_sub_f32 v219, v219, v26
    v_mfma_f32_16x16x32_bf16 v[224:227], a[128:131], v[40:43], v[224:227]
    s_add_u32 m0, s74, 131072
    ds_read_b128 v[48:51], v38 offset:20480
    v_mfma_f32_16x16x32_bf16 v[228:231], a[132:135], v[40:43], v[228:231]
    buffer_load_dwordx4 v36, s[24:27], s49 offen  lds
    v_mfma_f32_16x16x32_bf16 v[232:235], a[136:139], v[40:43], v[232:235]
    s_mov_b32 m0, s36
    ds_read_b128 v[52:55], v39 offset:16384
    v_mfma_f32_16x16x32_bf16 v[236:239], a[140:143], v[40:43], v[236:239]
    s_waitcnt lgkmcnt(2)
    ds_read_b128 v[56:59], v39 offset:18432
    v_mfma_f32_16x16x32_bf16 v[240:243], a[128:131], v[44:47], v[240:243]
    buffer_load_dwordx4 v37, s[24:27], s49 offen  lds
    v_mfma_f32_16x16x32_bf16 v[244:247], a[132:135], v[44:47], v[244:247]
    s_add_u32 m0, s57, 98304
    ds_read_b128 v[60:63], v39 offset:20480
    v_mfma_f32_16x16x32_bf16 v[248:251], a[136:139], v[44:47], v[248:251]
    buffer_load_dwordx4 v30, s[8:11], s49 offen offset:0  lds
    v_mfma_f32_16x16x32_bf16 v[252:255], a[140:143], v[44:47], v[252:255]
    s_waitcnt lgkmcnt(3)
    v_cos_f32 v26, v219
    v_mfma_f32_16x16x32_bf16 v[192:195], a[128:131], v[48:51], v[192:195]
    buffer_load_dwordx4 v31, s[8:11], s49 offen offset:1024  lds
    v_mfma_f32_16x16x32_bf16 v[196:199], a[132:135], v[48:51], v[196:199]
    buffer_load_dwordx4 v32, s[8:11], s49 offen offset:2048  lds
    v_mfma_f32_16x16x32_bf16 v[200:203], a[136:139], v[48:51], v[200:203]
    buffer_load_dwordx4 v33, s[8:11], s49 offen offset:3072  lds
    v_mfma_f32_16x16x32_bf16 v[204:207], a[140:143], v[48:51], v[204:207]
    s_waitcnt lgkmcnt(0)
    v_sin_f32 v27, v219
    v_mfma_f32_16x16x32_bf16 v[224:227], a[144:147], v[52:55], v[224:227]
    s_add_u32 m0, s57, 102400
    v_mul_f32 v26, v218, v26
    s_add_u32 s51, s49, 9216
    v_mfma_f32_16x16x32_bf16 v[228:231], a[148:151], v[52:55], v[228:231]
    buffer_load_dwordx4 v30, s[8:11], s51 offen offset:0  lds
    v_mfma_f32_16x16x32_bf16 v[232:235], a[152:155], v[52:55], v[232:235]
    buffer_load_dwordx4 v31, s[8:11], s51 offen offset:1024  lds
    v_mfma_f32_16x16x32_bf16 v[236:239], a[156:159], v[52:55], v[236:239]
    buffer_load_dwordx4 v32, s[8:11], s51 offen offset:2048  lds
    v_mfma_f32_16x16x32_bf16 v[240:243], a[144:147], v[56:59], v[240:243]
    buffer_load_dwordx4 v33, s[8:11], s51 offen offset:3072  lds
    v_mfma_f32_16x16x32_bf16 v[244:247], a[148:151], v[56:59], v[244:247]
    s_add_u32 s49, s49, 128
    v_mul_f32 v27, v218, v27
    s_cmp_lg_u32 s49, 1152
    s_cselect_b32 s49, s49, 0
    v_mfma_f32_16x16x32_bf16 v[248:251], a[152:155], v[56:59], v[248:251]
    v_add_f32 v218, -1.0, v12
    v_mul_f32 v219, v211, v211
    v_mfma_f32_16x16x32_bf16 v[252:255], a[156:159], v[56:59], v[252:255]
    v_fmac_f32 v219, v212, v212
    v_mfma_f32_16x16x32_bf16 v[192:195], a[144:147], v[60:63], v[192:195]
    v_rcp_f32 v219, v219
    v_mfma_f32_16x16x32_bf16 v[196:199], a[148:151], v[60:63], v[196:199]
    v_mul_f32 v14, v218, v211
    v_fmac_f32 v14, v13, v212
    v_mfma_f32_16x16x32_bf16 v[200:203], a[152:155], v[60:63], v[200:203]
    v_mul_f32 v15, v13, v211
    v_fma_f32 v15, -v218, v212, v15
    v_mfma_f32_16x16x32_bf16 v[204:207], a[156:159], v[60:63], v[204:207]
    v_add_f32 v219, v219, v219
    v_xor_b32 v219, v214, v219
    v_mul_f32 v14, v14, v219
    v_mul_f32 v15, v15, v219
    s_cmp_eq_u32 s6, 0
    s_cbranch_scc1 gated_mix__ssm_conv_s5__swiglu_ffn__prompt_kernel_A_pg2_1
    s_cmp_eq_u32 s6, 1
    s_cbranch_scc1 gated_mix__ssm_conv_s5__swiglu_ffn__prompt_kernel_A_pg2_2
    s_cmp_eq_u32 s6, 2
    s_cbranch_scc1 gated_mix__ssm_conv_s5__swiglu_ffn__prompt_kernel_A_pg2_3
    s_cmp_eq_u32 s6, 3
    s_cbranch_scc1 gated_mix__ssm_conv_s5__swiglu_ffn__prompt_kernel_A_pg2_4
gated_mix__ssm_conv_s5__swiglu_ffn__prompt_kernel_A_pr2:
    s_waitcnt vmcnt(10)
    s_barrier
    ds_read_b128 a[160:163], v34 offset:0
    ds_read_b128 a[164:167], v34 offset:2048
    ds_read_b128 a[168:171], v34 offset:4096
    ds_read_b128 a[172:175], v34 offset:6144
    ds_read_b128 a[176:179], v35 offset:0
    ds_read_b128 a[180:183], v35 offset:2048
    ds_read_b128 a[184:187], v35 offset:4096
    ds_read_b128 a[188:191], v35 offset:6144
    ds_read_b128 v[40:43], v38 offset:22528
    s_waitcnt lgkmcnt(0)
    ds_read_b128 v[44:47], v38 offset:24576
    v_mfma_f32_16x16x32_bf16 v[224:227], a[160:163], v[40:43], v[224:227]
    s_add_u32 m0, s74, 147456
    ds_read_b128 v[48:51], v38 offset:26624
    v_mfma_f32_16x16x32_bf16 v[228:231], a[164:167], v[40:43], v[228:231]
    buffer_load_dwordx4 v36, s[24:27], s49 offen  lds
    v_mfma_f32_16x16x32_bf16 v[232:235], a[168:171], v[40:43], v[232:235]
    s_mov_b32 m0, s37
    ds_read_b128 v[52:55], v39 offset:22528
    v_mfma_f32_16x16x32_bf16 v[236:239], a[172:175], v[40:43], v[236:239]
    s_waitcnt lgkmcnt(2)
    ds_read_b128 v[56:59], v39 offset:24576
    v_mfma_f32_16x16x32_bf16 v[240:243], a[160:163], v[44:47], v[240:243]
    buffer_load_dwordx4 v37, s[24:27], s49 offen  lds
    v_mfma_f32_16x16x32_bf16 v[244:247], a[164:167], v[44:47], v[244:247]
    s_add_u32 m0, s57, 65536
    ds_read_b128 v[60:63], v39 offset:26624
    v_mfma_f32_16x16x32_bf16 v[248:251], a[168:171], v[44:47], v[248:251]
    buffer_load_dwordx4 v30, s[8:11], s49 offen offset:0  lds
    v_mfma_f32_16x16x32_bf16 v[252:255], a[172:175], v[44:47], v[252:255]
    s_waitcnt lgkmcnt(3)
    v_mfma_f32_16x16x32_bf16 v[192:195], a[160:163], v[48:51], v[192:195]
    buffer_load_dwordx4 v31, s[8:11], s49 offen offset:1024  lds
    v_mfma_f32_16x16x32_bf16 v[196:199], a[164:167], v[48:51], v[196:199]
    buffer_load_dwordx4 v32, s[8:11], s49 offen offset:2048  lds
    v_mfma_f32_16x16x32_bf16 v[200:203], a[168:171], v[48:51], v[200:203]
    buffer_load_dwordx4 v33, s[8:11], s49 offen offset:3072  lds
    v_mfma_f32_16x16x32_bf16 v[204:207], a[172:175], v[48:51], v[204:207]
    s_waitcnt lgkmcnt(0)
    s_add_u32 m0, s57, 69632
    s_add_u32 s51, s49, 9216
    v_mfma_f32_16x16x32_bf16 v[224:227], a[176:179], v[52:55], v[224:227]
    buffer_load_dwordx4 v30, s[8:11], s51 offen offset:0  lds
    v_mfma_f32_16x16x32_bf16 v[228:231], a[180:183], v[52:55], v[228:231]
    buffer_load_dwordx4 v31, s[8:11], s51 offen offset:1024  lds
    v_mfma_f32_16x16x32_bf16 v[232:235], a[184:187], v[52:55], v[232:235]
    buffer_load_dwordx4 v32, s[8:11], s51 offen offset:2048  lds
    v_mfma_f32_16x16x32_bf16 v[236:239], a[188:191], v[52:55], v[236:239]
    buffer_load_dwordx4 v33, s[8:11], s51 offen offset:3072  lds
    v_mfma_f32_16x16x32_bf16 v[240:243], a[176:179], v[56:59], v[240:243]
    s_add_u32 s49, s49, 128
    s_cmp_lg_u32 s49, 1152
    s_cselect_b32 s49, s49, 0
    v_mfma_f32_16x16x32_bf16 v[244:247], a[180:183], v[56:59], v[244:247]
    v_mfma_f32_16x16x32_bf16 v[248:251], a[184:187], v[56:59], v[248:251]
    v_mfma_f32_16x16x32_bf16 v[252:255], a[188:191], v[56:59], v[252:255]
    v_mfma_f32_16x16x32_bf16 v[192:195], a[176:179], v[60:63], v[192:195]
    v_mfma_f32_16x16x32_bf16 v[196:199], a[180:183], v[60:63], v[196:199]
    v_mfma_f32_16x16x32_bf16 v[200:203], a[184:187], v[60:63], v[200:203]
    v_mfma_f32_16x16x32_bf16 v[204:207], a[188:191], v[60:63], v[204:207]
    s_waitcnt vmcnt(10)
    s_barrier
    ds_read_b128 a[192:195], v34 offset:32768
    ds_read_b128 a[196:199], v34 offset:34816
    ds_read_b128 a[200:203], v34 offset:36864
    ds_read_b128 a[204:207], v34 offset:38912
    ds_read_b128 a[208:211], v35 offset:32768
    ds_read_b128 a[212:215], v35 offset:34816
    ds_read_b128 a[216:219], v35 offset:36864
    ds_read_b128 a[220:223], v35 offset:38912
    ds_read_b128 v[40:43], v38 offset:0
    s_waitcnt lgkmcnt(0)
    ds_read_b128 v[44:47], v38 offset:2048
    v_mfma_f32_16x16x32_bf16 v[224:227], a[192:195], v[40:43], v[224:227]
    s_add_u32 m0, s74, 153600
    ds_read_b128 v[48:51], v38 offset:4096
    v_mfma_f32_16x16x32_bf16 v[228:231], a[196:199], v[40:43], v[228:231]
    buffer_load_dwordx4 v36, s[24:27], s49 offen  lds
    v_mfma_f32_16x16x32_bf16 v[232:235], a[200:203], v[40:43], v[232:235]
    s_mov_b32 m0, s38
    ds_read_b128 v[52:55], v39 offset:0
    v_mfma_f32_16x16x32_bf16 v[236:239], a[204:207], v[40:43], v[236:239]
    s_waitcnt lgkmcnt(2)
    ds_read_b128 v[56:59], v39 offset:2048
    v_mfma_f32_16x16x32_bf16 v[240:243], a[192:195], v[44:47], v[240:243]
    buffer_load_dwordx4 v37, s[24:27], s49 offen  lds
    v_mfma_f32_16x16x32_bf16 v[244:247], a[196:199], v[44:47], v[244:247]
    s_add_u32 m0, s57, 98304
    ds_read_b128 v[60:63], v39 offset:4096
    v_mfma_f32_16x16x32_bf16 v[248:251], a[200:203], v[44:47], v[248:251]
    buffer_load_dwordx4 v30, s[8:11], s49 offen offset:0  lds
    v_mfma_f32_16x16x32_bf16 v[252:255], a[204:207], v[44:47], v[252:255]
    s_waitcnt lgkmcnt(3)
    v_mfma_f32_16x16x32_bf16 v[192:195], a[192:195], v[48:51], v[192:195]
    buffer_load_dwordx4 v31, s[8:11], s49 offen offset:1024  lds
    v_mfma_f32_16x16x32_bf16 v[196:199], a[196:199], v[48:51], v[196:199]
    buffer_load_dwordx4 v32, s[8:11], s49 offen offset:2048  lds
    v_mfma_f32_16x16x32_bf16 v[200:203], a[200:203], v[48:51], v[200:203]
    buffer_load_dwordx4 v33, s[8:11], s49 offen offset:3072  lds
    v_mfma_f32_16x16x32_bf16 v[204:207], a[204:207], v[48:51], v[204:207]
    s_waitcnt lgkmcnt(0)
    s_add_u32 m0, s57, 102400
    s_add_u32 s51, s49, 9216
    v_mfma_f32_16x16x32_bf16 v[224:227], a[208:211], v[52:55], v[224:227]
    buffer_load_dword v28, v29, s[52:55], 0 offen sc1
    v_mfma_f32_16x16x32_bf16 v[228:231], a[212:215], v[52:55], v[228:231]
    buffer_load_dwordx4 v30, s[8:11], s51 offen offset:0  lds
    v_mfma_f32_16x16x32_bf16 v[232:235], a[216:219], v[52:55], v[232:235]
    buffer_load_dwordx4 v31, s[8:11], s51 offen offset:1024  lds
    v_mfma_f32_16x16x32_bf16 v[236:239], a[220:223], v[52:55], v[236:239]
    buffer_load_dwordx4 v32, s[8:11], s51 offen offset:2048  lds
    v_mfma_f32_16x16x32_bf16 v[240:243], a[208:211], v[56:59], v[240:243]
    buffer_load_dwordx4 v33, s[8:11], s51 offen offset:3072  lds
    v_mfma_f32_16x16x32_bf16 v[244:247], a[212:215], v[56:59], v[244:247]
    s_add_u32 vcc_lo, s40, 35840
    s_lshl1_add_u32 m0, s74, 0
    v_mfma_f32_16x16x32_bf16 v[248:251], a[216:219], v[56:59], v[248:251]
    buffer_load_dwordx4 v2, s[12:15], s40 offen nt lds
    v_mfma_f32_16x16x32_bf16 v[252:255], a[220:223], v[56:59], v[252:255]
    buffer_load_dwordx4 v2, s[12:15], vcc_lo offen offset:1024 nt lds
    v_mfma_f32_16x16x32_bf16 v[192:195], a[208:211], v[60:63], v[192:195]
    s_lshl1_add_u32 m0, s74, 8192
    v_mfma_f32_16x16x32_bf16 v[196:199], a[212:215], v[60:63], v[196:199]
    buffer_load_dwordx4 v2, s[16:19], s40 offen nt lds
    v_mfma_f32_16x16x32_bf16 v[200:203], a[216:219], v[60:63], v[200:203]
    buffer_load_dwordx4 v2, s[16:19], vcc_lo offen offset:1024 nt lds
    v_mfma_f32_16x16x32_bf16 v[204:207], a[220:223], v[60:63], v[204:207]
    s_waitcnt vmcnt(15)
    s_barrier
    ds_read_b128 a[224:227], v34 offset:0
    ds_read_b128 a[228:231], v34 offset:2048
    ds_read_b128 a[232:235], v34 offset:4096
    ds_read_b128 a[236:239], v34 offset:6144
    ds_read_b128 a[240:243], v35 offset:0
    ds_read_b128 a[244:247], v35 offset:2048
    ds_read_b128 a[248:251], v35 offset:4096
    ds_read_b128 a[252:255], v35 offset:6144
    ds_read_b128 v[40:43], v38 offset:16384
    s_waitcnt lgkmcnt(0)
    ds_read_b128 v[44:47], v38 offset:18432
    v_mfma_f32_16x16x32_bf16 v[224:227], a[224:227], v[40:43], v[224:227]
    s_add_u32 vcc_lo, s41, 35840
    ds_read_b128 v[48:51], v38 offset:20480
    v_mfma_f32_16x16x32_bf16 v[228:231], a[228:231], v[40:43], v[228:231]
    s_lshl1_add_u32 m0, s74, 16384
    ds_read_b128 v[52:55], v39 offset:16384
    v_mfma_f32_16x16x32_bf16 v[232:235], a[232:235], v[40:43], v[232:235]
    s_barrier
    v_mfma_f32_16x16x32_bf16 v[236:239], a[236:239], v[40:43], v[236:239]
    s_waitcnt lgkmcnt(2)
    ds_read_b128 v[56:59], v39 offset:18432
    v_mfma_f32_16x16x32_bf16 v[240:243], a[224:227], v[44:47], v[240:243]
    buffer_load_dwordx4 v2, s[12:15], s41 offen nt lds
    v_mfma_f32_16x16x32_bf16 v[244:247], a[228:231], v[44:47], v[244:247]
    buffer_load_dwordx4 v2, s[12:15], vcc_lo offen offset:1024 nt lds
    v_mfma_f32_16x16x32_bf16 v[248:251], a[232:235], v[44:47], v[248:251]
    s_lshl1_add_u32 m0, s74, 24576
    ds_read_b128 v[60:63], v39 offset:20480
    v_mfma_f32_16x16x32_bf16 v[252:255], a[236:239], v[44:47], v[252:255]
    s_waitcnt lgkmcnt(2)
    v_mfma_f32_16x16x32_bf16 v[192:195], a[224:227], v[48:51], v[192:195]
    buffer_load_dwordx4 v2, s[16:19], s41 offen nt lds
    v_mfma_f32_16x16x32_bf16 v[196:199], a[228:231], v[48:51], v[196:199]
    buffer_load_dwordx4 v2, s[16:19], vcc_lo offen offset:1024 nt lds
    v_mfma_f32_16x16x32_bf16 v[200:203], a[232:235], v[48:51], v[200:203]
    s_add_u32 vcc_lo, s42, 35840
    s_lshl1_add_u32 m0, s74, 32768
    v_mfma_f32_16x16x32_bf16 v[204:207], a[236:239], v[48:51], v[204:207]
    buffer_load_dwordx4 v2, s[12:15], s42 offen nt lds
    v_mfma_f32_16x16x32_bf16 v[224:227], a[240:243], v[52:55], v[224:227]
    buffer_load_dwordx4 v2, s[12:15], vcc_lo offen offset:1024 nt lds
    v_mfma_f32_16x16x32_bf16 v[228:231], a[244:247], v[52:55], v[228:231]
    s_lshl1_add_u32 m0, s74, 40960
    v_mfma_f32_16x16x32_bf16 v[232:235], a[248:251], v[52:55], v[232:235]
    buffer_load_dwordx4 v2, s[16:19], s42 offen nt lds
    v_mfma_f32_16x16x32_bf16 v[236:239], a[252:255], v[52:55], v[236:239]
    s_waitcnt lgkmcnt(0)
    v_mfma_f32_16x16x32_bf16 v[240:243], a[240:243], v[56:59], v[240:243]
    buffer_load_dwordx4 v2, s[16:19], vcc_lo offen offset:1024 nt lds
    v_mfma_f32_16x16x32_bf16 v[244:247], a[244:247], v[56:59], v[244:247]
    s_add_u32 vcc_lo, s43, 35840
    s_lshl1_add_u32 m0, s74, 49152
    v_mfma_f32_16x16x32_bf16 v[248:251], a[248:251], v[56:59], v[248:251]
    v_mfma_f32_16x16x32_bf16 v[252:255], a[252:255], v[56:59], v[252:255]
    v_mfma_f32_16x16x32_bf16 v[192:195], a[240:243], v[60:63], v[192:195]
    v_mfma_f32_16x16x32_bf16 v[196:199], a[244:247], v[60:63], v[196:199]
    v_mfma_f32_16x16x32_bf16 v[200:203], a[248:251], v[60:63], v[200:203]
    buffer_load_dwordx4 v2, s[12:15], s43 offen  lds
    v_mfma_f32_16x16x32_bf16 v[204:207], a[252:255], v[60:63], v[204:207]
    s_waitcnt vmcnt(13)
    s_barrier
    ds_read_b128 v[64:67], v34 offset:32768
    ds_read_b128 v[68:71], v34 offset:34816
    ds_read_b128 v[72:75], v34 offset:36864
    ds_read_b128 v[76:79], v34 offset:38912
    ds_read_b128 v[80:83], v35 offset:32768
    ds_read_b128 v[84:87], v35 offset:34816
    ds_read_b128 v[88:91], v35 offset:36864
    ds_read_b128 v[92:95], v35 offset:38912
    ds_read_b128 v[40:43], v38 offset:22528
    s_waitcnt lgkmcnt(0)
    ds_read_b128 v[44:47], v38 offset:24576
    v_cmp_eq_u32 s[76:77], 0, v28
    v_mfma_f32_16x16x32_bf16 v[224:227], v[64:67], v[40:43], v[224:227]
    ds_read_b128 v[48:51], v38 offset:26624
    v_mfma_f32_16x16x32_bf16 v[228:231], v[68:71], v[40:43], v[228:231]
    s_cmp_lg_u64 s[76:77], 0
    s_cbranch_scc1 gated_mix__ssm_conv_s5__swiglu_ffn__prompt_kernel_A_rd_s
gated_mix__ssm_conv_s5__swiglu_ffn__prompt_kernel_A_rd:
    ds_read_b128 v[52:55], v39 offset:22528
    v_mfma_f32_16x16x32_bf16 v[232:235], v[72:75], v[40:43], v[232:235]
    s_barrier
    v_mfma_f32_16x16x32_bf16 v[236:239], v[76:79], v[40:43], v[236:239]
    s_waitcnt lgkmcnt(2)
    ds_read_b128 v[56:59], v39 offset:24576
    v_mfma_f32_16x16x32_bf16 v[240:243], v[64:67], v[44:47], v[240:243]
    buffer_load_dwordx4 v2, s[12:15], vcc_lo offen offset:1024  lds
    v_mfma_f32_16x16x32_bf16 v[244:247], v[68:71], v[44:47], v[244:247]
    s_lshl1_add_u32 m0, s74, 57344
    ds_read_b128 v[60:63], v39 offset:26624
    v_mfma_f32_16x16x32_bf16 v[248:251], v[72:75], v[44:47], v[248:251]
    v_mfma_f32_16x16x32_bf16 v[252:255], v[76:79], v[44:47], v[252:255]
    s_waitcnt vmcnt(10) lgkmcnt(2)
    s_barrier
    v_mfma_f32_16x16x32_bf16 v[192:195], v[64:67], v[48:51], v[192:195]
    ds_read_b64_tr_b16 v[40:41], v3 offset:0
    v_mfma_f32_16x16x32_bf16 v[196:199], v[68:71], v[48:51], v[196:199]
    ds_read_b64_tr_b16 v[42:43], v3 offset:1024
    v_mfma_f32_16x16x32_bf16 v[200:203], v[72:75], v[48:51], v[200:203]
    buffer_load_dwordx4 v2, s[16:19], s43 offen  lds
    v_mfma_f32_16x16x32_bf16 v[204:207], v[76:79], v[48:51], v[204:207]
    v_mfma_f32_16x16x32_bf16 v[224:227], v[80:83], v[52:55], v[224:227]
    ds_read_b64_tr_b16 v[44:45], v3 offset:8192
    v_mfma_f32_16x16x32_bf16 v[228:231], v[84:87], v[52:55], v[228:231]
    ds_read_b64_tr_b16 v[46:47], v3 offset:9216
    v_mfma_f32_16x16x32_bf16 v[232:235], v[88:91], v[52:55], v[232:235]
    v_mfma_f32_16x16x32_bf16 v[236:239], v[92:95], v[52:55], v[236:239]
    s_waitcnt lgkmcnt(2)
    v_mfma_f32_16x16x32_bf16 v[240:243], v[80:83], v[56:59], v[240:243]
    buffer_load_dwordx4 v2, s[16:19], vcc_lo offen offset:1024  lds
    v_mfma_f32_16x16x32_bf16 v[244:247], v[84:87], v[56:59], v[244:247]
    s_add_u32 vcc_lo, s44, 35840
    ds_read_b64_tr_b16 v[48:49], v3 offset:4096
    v_mfma_f32_16x16x32_bf16 v[248:251], v[88:91], v[56:59], v[248:251]
    s_lshl1_add_u32 m0, s74, 131072
    ds_read_b64_tr_b16 v[50:51], v3 offset:5120
    v_mfma_f32_16x16x32_bf16 v[252:255], v[92:95], v[56:59], v[252:255]
    v_mfma_f32_16x16x32_bf16 v[192:195], v[80:83], v[60:63], v[192:195]
    ds_read_b64_tr_b16 v[52:53], v3 offset:12288
    v_mfma_f32_16x16x32_bf16 v[196:199], v[84:87], v[60:63], v[196:199]
    ds_read_b64_tr_b16 v[54:55], v3 offset:13312
    v_mfma_f32_16x16x32_bf16 v[200:203], v[88:91], v[60:63], v[200:203]
    buffer_load_dwordx4 v2, s[12:15], s44 offen  lds
    v_mfma_f32_16x16x32_bf16 v[204:207], v[92:95], v[60:63], v[204:207]
    v_mfma_f32_16x16x32_bf16 v[160:163], v[40:43], a[0:3], 0
    ds_read_b64_tr_b16 v[56:57], v4 offset:0
    v_min_u32 v35, 29, v0
    v_mfma_f32_16x16x32_bf16 v[164:167], v[40:43], a[4:7], 0
    ds_read_b64_tr_b16 v[58:59], v4 offset:1024
    v_mul_u32_u24 v156, 26, v35
    v_mfma_f32_16x16x32_bf16 v[168:171], v[40:43], a[8:11], 0
    v_lshrrev_b32 v156, 8, v156
    v_mul_u32_u24 v157, 10, v156
    v_mfma_f32_16x16x32_bf16 v[172:175], v[40:43], a[12:15], 0
    s_waitcnt lgkmcnt(2)
    v_sub_u32 v35, v35, v157
    v_lshl_add_u32 v157, v35, 1, 1
    v_mfma_f32_16x16x32_bf16 v[176:179], v[44:47], a[0:3], 0
    ds_read_b64_tr_b16 v[60:61], v4 offset:8192
    v_add_u32 v35, 8, v35
    v_mfma_f32_16x16x32_bf16 v[180:183], v[44:47], a[4:7], 0
    ds_read_b64_tr_b16 v[62:63], v4 offset:9216
    v_min_u32 v35, v35, v157
    v_mfma_f32_16x16x32_bf16 v[184:187], v[44:47], a[8:11], 0
    v_mul_u32_u24 v156, 72, v156
    v_add_lshl_u32 v35, v35, v156, 7
    v_mfma_f32_16x16x32_bf16 v[188:191], v[44:47], a[12:15], 0
    v_fmac_f32 v193, v12, v192
    v_fmac_f32 v225, v8, v224
    v_mfma_f32_16x16x32_bf16 v[160:163], v[48:51], a[16:19], v[160:163]
    ds_read_b64_tr_b16 v[40:41], v4 offset:4096
    v_fmac_f32 v241, v8, v240
    v_mfma_f32_16x16x32_bf16 v[164:167], v[48:51], a[20:23], v[164:167]
    ds_read_b64_tr_b16 v[42:43], v4 offset:5120
    v_fma_f32 v225, -v9, v240, v225
    v_mfma_f32_16x16x32_bf16 v[168:171], v[48:51], a[24:27], v[168:171]
    v_fmac_f32_dpp v193, v192, v13 row_ror:8 row_mask:0xf bank_mask:0xf
    v_fmac_f32 v241, v9, v224
    v_mfma_f32_16x16x32_bf16 v[172:175], v[48:51], a[28:31], v[172:175]
    v_fmac_f32 v194, v12, v193
    v_fmac_f32 v226, v8, v225
    v_mfma_f32_16x16x32_bf16 v[176:179], v[52:55], a[16:19], v[176:179]
    ds_read_b64_tr_b16 v[44:45], v4 offset:12288
    v_fmac_f32 v242, v8, v241
    v_mfma_f32_16x16x32_bf16 v[180:183], v[52:55], a[20:23], v[180:183]
    ds_read_b64_tr_b16 v[46:47], v4 offset:13312
    v_fma_f32 v226, -v9, v241, v226
    v_mfma_f32_16x16x32_bf16 v[184:187], v[52:55], a[24:27], v[184:187]
    v_fmac_f32_dpp v194, v193, v13 row_ror:8 row_mask:0xf bank_mask:0xf
    v_fmac_f32 v242, v9, v225
    v_mfma_f32_16x16x32_bf16 v[188:191], v[52:55], a[28:31], v[188:191]
    s_waitcnt vmcnt(9) lgkmcnt(2)
    s_barrier
    v_fmac_f32 v195, v12, v194
    v_mfma_f32_16x16x32_bf16 v[96:99], v[56:59], a[0:3], 0
    s_mul_i32 s63, s5, 43
    ds_read_b64_tr_b16 v[48:49], v3 offset:16384
    v_fmac_f32 v227, v8, v226
    v_mfma_f32_16x16x32_bf16 v[100:103], v[56:59], a[4:7], 0
    s_lshr_b32 s63, s63, 7
    ds_read_b64_tr_b16 v[50:51], v3 offset:17408
    v_fmac_f32 v243, v8, v242
    v_mfma_f32_16x16x32_bf16 v[104:107], v[56:59], a[8:11], 0
    s_mul_i32 s64, s63, 3
    ds_write_b64 v153, v[150:151] offset:0
    v_fma_f32 v227, -v9, v242, v227
    v_mfma_f32_16x16x32_bf16 v[108:111], v[56:59], a[12:15], 0
    s_sub_u32 s64, s5, s64
    ds_write_b64 v153, v[150:151] offset:4096
    v_fmac_f32_dpp v195, v194, v13 row_ror:8 row_mask:0xf bank_mask:0xf
    v_mfma_f32_16x16x32_bf16 v[112:115], v[60:63], a[0:3], 0
    s_lshl_b32 s58, s4, 3
    ds_read_b64_tr_b16 v[52:53], v3 offset:24576
    v_fmac_f32 v243, v9, v226
    v_mfma_f32_16x16x32_bf16 v[116:119], v[60:63], a[4:7], 0
    s_add_u32 s63, s63, s58
    ds_read_b64_tr_b16 v[54:55], v3 offset:25600
    v_fmac_f32 v196, v12, v195
    v_mfma_f32_16x16x32_bf16 v[120:123], v[60:63], a[8:11], 0
    s_mov_b32 s24, s80
    ds_write_b32 v153, v150 offset:12288
    v_fmac_f32 v228, v8, v227
    v_mfma_f32_16x16x32_bf16 v[124:127], v[60:63], a[12:15], 0
    s_and_b32 s25, s81, 0xffff
    ds_write_b32 v153, v150 offset:4608
    v_fmac_f32 v244, v8, v243
    v_mfma_f32_16x16x32_bf16 v[96:99], v[40:43], a[16:19], v[96:99]
    s_mov_b32 s26, 5308416
    ds_read_b64_tr_b16 v[56:57], v3 offset:20480
    v_fma_f32 v228, -v9, v243, v228
    v_mfma_f32_16x16x32_bf16 v[100:103], v[40:43], a[20:23], v[100:103]
    s_mul_i32 s58, s3, 1327104
    ds_read_b64_tr_b16 v[58:59], v3 offset:21504
    v_fmac_f32_dpp v196, v195, v13 row_ror:8 row_mask:0xf bank_mask:0xf
    v_mfma_f32_16x16x32_bf16 v[104:107], v[40:43], a[24:27], v[104:107]
    s_mul_i32 s67, s64, 384
    v_fmac_f32 v244, v9, v227
    v_fmac_f32 v197, v12, v196
    v_mfma_f32_16x16x32_bf16 v[108:111], v[40:43], a[28:31], v[108:111]
    s_waitcnt lgkmcnt(4)
    v_fmac_f32 v229, v8, v228
    v_fmac_f32 v245, v8, v244
    v_mfma_f32_16x16x32_bf16 v[112:115], v[44:47], a[16:19], v[112:115]
    s_add_u32 s58, s58, s67
    ds_read_b64_tr_b16 v[60:61], v3 offset:28672
    v_fma_f32 v229, -v9, v244, v229
    v_mfma_f32_16x16x32_bf16 v[116:119], v[44:47], a[20:23], v[116:119]
    s_lshl_b32 s66, s63, 1
    ds_read_b64_tr_b16 v[62:63], v3 offset:29696
    v_fmac_f32_dpp v197, v196, v13 row_ror:8 row_mask:0xf bank_mask:0xf
    v_mfma_f32_16x16x32_bf16 v[120:123], v[44:47], a[24:27], v[120:123]
    s_lshr_b32 s67, s6, 1
    v_fmac_f32 v245, v9, v228
    v_fmac_f32 v198, v12, v197
    v_mfma_f32_16x16x32_bf16 v[124:127], v[44:47], a[28:31], v[124:127]
    s_add_u32 s66, s66, s67
    v_fmac_f32 v230, v8, v229
    v_fmac_f32 v246, v8, v245
    v_mfma_f32_16x16x32_bf16 v[160:163], v[48:51], a[32:35], v[160:163]
    s_mul_i32 s66, s66, 144
    ds_read_b64_tr_b16 v[40:41], v4 offset:16384
    v_fma_f32 v230, -v9, v245, v230
    v_mfma_f32_16x16x32_bf16 v[164:167], v[48:51], a[36:39], v[164:167]
    s_mul_i32 s67, s3, 36
    ds_read_b64_tr_b16 v[42:43], v4 offset:17408
    v_fmac_f32_dpp v198, v197, v13 row_ror:8 row_mask:0xf bank_mask:0xf
    v_mfma_f32_16x16x32_bf16 v[168:171], v[48:51], a[40:43], v[168:171]
    s_add_u32 s66, s66, s67
    v_fmac_f32 v246, v9, v229
    v_fmac_f32 v199, v12, v198
    v_mfma_f32_16x16x32_bf16 v[172:175], v[48:51], a[44:47], v[172:175]
    s_and_b32 s67, s6, 1
    v_fmac_f32 v231, v8, v230
    v_fmac_f32 v247, v8, v246
    v_mfma_f32_16x16x32_bf16 v[176:179], v[52:55], a[32:35], v[176:179]
    s_lshl1_add_u32 s66, s66, s67
    ds_read_b64_tr_b16 v[44:45], v4 offset:24576
    v_fma_f32 v231, -v9, v246, v231
    v_mfma_f32_16x16x32_bf16 v[180:183], v[52:55], a[36:39], v[180:183]
    s_lshl_b32 s66, s66, 11
    ds_read_b64_tr_b16 v[46:47], v4 offset:25600
    v_fmac_f32_dpp v199, v198, v13 row_ror:8 row_mask:0xf bank_mask:0xf
    v_mfma_f32_16x16x32_bf16 v[184:187], v[52:55], a[40:43], v[184:187]
    s_lshl_b32 s69, s63, 2
    v_fmac_f32 v247, v9, v230
    v_fmac_f32 v200, v12, v199
    v_mfma_f32_16x16x32_bf16 v[188:191], v[52:55], a[44:47], v[188:191]
    s_branch gated_mix__ssm_conv_s5__swiglu_ffn__prompt_kernel_A_sk1
.p2align 12
gated_mix__ssm_conv_s5__swiglu_ffn__prompt_kernel_A_pg2_1:
    s_branch gated_mix__ssm_conv_s5__swiglu_ffn__prompt_kernel_A_pr2
gated_mix__ssm_conv_s5__swiglu_ffn__prompt_kernel_A_sk1:
    s_waitcnt lgkmcnt(2)
    v_fmac_f32 v232, v8, v231
    v_fmac_f32 v248, v8, v247
    v_mfma_f32_16x16x32_bf16 v[160:163], v[56:59], a[48:51], v[160:163]
    s_add_u32 s69, s69, s3
    ds_read_b64_tr_b16 v[48:49], v4 offset:20480
    v_fma_f32 v232, -v9, v247, v232
    v_mfma_f32_16x16x32_bf16 v[164:167], v[56:59], a[52:55], v[164:167]
    s_lshl_b32 s69, s69, 10
    ds_read_b64_tr_b16 v[50:51], v4 offset:21504
    v_fmac_f32_dpp v200, v199, v13 row_ror:8 row_mask:0xf bank_mask:0xf
    v_mfma_f32_16x16x32_bf16 v[168:171], v[56:59], a[56:59], v[168:171]
    s_add_u32 s69, s69, 23650304
    v_fmac_f32 v248, v9, v231
    v_fmac_f32 v201, v12, v200
    v_mfma_f32_16x16x32_bf16 v[172:175], v[56:59], a[60:63], v[172:175]
    s_mul_i32 s67, s6, 9216
    v_fmac_f32 v233, v8, v232
    v_fmac_f32 v249, v8, v248
    v_mfma_f32_16x16x32_bf16 v[176:179], v[60:63], a[48:51], v[176:179]
    s_add_u32 s58, s58, s67
    ds_read_b64_tr_b16 v[52:53], v4 offset:28672
    v_fma_f32 v233, -v9, v248, v233
    v_mfma_f32_16x16x32_bf16 v[180:183], v[60:63], a[52:55], v[180:183]
    s_mul_i32 s67, s6, 3072
    ds_read_b64_tr_b16 v[54:55], v4 offset:29696
    v_fmac_f32_dpp v201, v200, v13 row_ror:8 row_mask:0xf bank_mask:0xf
    v_mfma_f32_16x16x32_bf16 v[184:187], v[60:63], a[56:59], v[184:187]
    s_lshl_b32 s68, s6, 11
    v_fmac_f32 v249, v9, v232
    v_fmac_f32 v202, v12, v201
    v_mfma_f32_16x16x32_bf16 v[188:191], v[60:63], a[60:63], v[188:191]
    s_waitcnt vmcnt(5) lgkmcnt(2)
    s_barrier
    v_fmac_f32 v234, v8, v233
    v_mfma_f32_16x16x32_bf16 v[96:99], v[40:43], a[32:35], v[96:99]
    buffer_load_dwordx4 v2, s[12:15], vcc_lo offen offset:1024  lds
    v_mfma_f32_16x16x32_bf16 v[100:103], v[40:43], a[36:39], v[100:103]
    s_lshl1_add_u32 m0, s74, 139264
    ds_read_b64_tr_b16 v[56:57], v3 offset:32768
    v_fmac_f32 v250, v8, v249
    v_mfma_f32_16x16x32_bf16 v[104:107], v[40:43], a[40:43], v[104:107]
    ds_read_b64_tr_b16 v[58:59], v3 offset:33792
    v_fma_f32 v234, -v9, v249, v234
    v_mfma_f32_16x16x32_bf16 v[108:111], v[40:43], a[44:47], v[108:111]
    v_fmac_f32_dpp v202, v201, v13 row_ror:8 row_mask:0xf bank_mask:0xf
    v_fmac_f32 v250, v9, v233
    v_mfma_f32_16x16x32_bf16 v[112:115], v[44:47], a[32:35], v[112:115]
    ds_read_b64_tr_b16 v[60:61], v3 offset:40960
    v_fmac_f32 v203, v12, v202
    v_mfma_f32_16x16x32_bf16 v[116:119], v[44:47], a[36:39], v[116:119]
    ds_read_b64_tr_b16 v[62:63], v3 offset:41984
    v_fmac_f32 v235, v8, v234
    v_mfma_f32_16x16x32_bf16 v[120:123], v[44:47], a[40:43], v[120:123]
    buffer_load_dwordx4 v2, s[16:19], s44 offen  lds
    v_mfma_f32_16x16x32_bf16 v[124:127], v[44:47], a[44:47], v[124:127]
    v_fmac_f32 v251, v8, v250
    v_fma_f32 v235, -v9, v250, v235
    v_mfma_f32_16x16x32_bf16 v[96:99], v[48:51], a[48:51], v[96:99]
    ds_read_b64_tr_b16 v[40:41], v3 offset:36864
    v_fmac_f32_dpp v203, v202, v13 row_ror:8 row_mask:0xf bank_mask:0xf
    v_mfma_f32_16x16x32_bf16 v[100:103], v[48:51], a[52:55], v[100:103]
    ds_read_b64_tr_b16 v[42:43], v3 offset:37888
    v_fmac_f32 v251, v9, v234
    v_mfma_f32_16x16x32_bf16 v[104:107], v[48:51], a[56:59], v[104:107]
    v_fmac_f32 v204, v12, v203
    v_fmac_f32 v236, v8, v235
    v_mfma_f32_16x16x32_bf16 v[108:111], v[48:51], a[60:63], v[108:111]
    s_waitcnt lgkmcnt(2)
    v_fmac_f32 v252, v8, v251
    v_fma_f32 v236, -v9, v251, v236
    v_mfma_f32_16x16x32_bf16 v[112:115], v[52:55], a[48:51], v[112:115]
    buffer_load_dwordx4 v2, s[16:19], vcc_lo offen offset:1024  lds
    v_mfma_f32_16x16x32_bf16 v[116:119], v[52:55], a[52:55], v[116:119]
    s_add_u32 vcc_lo, s45, 35840
    ds_read_b64_tr_b16 v[44:45], v3 offset:45056
    v_fmac_f32_dpp v204, v203, v13 row_ror:8 row_mask:0xf bank_mask:0xf
    v_mfma_f32_16x16x32_bf16 v[120:123], v[52:55], a[56:59], v[120:123]
    s_lshl1_add_u32 m0, s74, 65536
    ds_read_b64_tr_b16 v[46:47], v3 offset:46080
    v_fmac_f32 v252, v9, v235
    v_mfma_f32_16x16x32_bf16 v[124:127], v[52:55], a[60:63], v[124:127]
    v_fmac_f32 v205, v12, v204
    v_fmac_f32 v237, v8, v236
    v_mfma_f32_16x16x32_bf16 v[160:163], v[56:59], a[64:67], v[160:163]
    ds_read_b64_tr_b16 v[48:49], v4 offset:32768
    v_fmac_f32 v253, v8, v252
    v_mfma_f32_16x16x32_bf16 v[164:167], v[56:59], a[68:71], v[164:167]
    ds_read_b64_tr_b16 v[50:51], v4 offset:33792
    v_fma_f32 v237, -v9, v252, v237
    v_mfma_f32_16x16x32_bf16 v[168:171], v[56:59], a[72:75], v[168:171]
    v_fmac_f32_dpp v205, v204, v13 row_ror:8 row_mask:0xf bank_mask:0xf
    v_fmac_f32 v253, v9, v236
    v_mfma_f32_16x16x32_bf16 v[172:175], v[56:59], a[76:79], v[172:175]
    v_fmac_f32 v206, v12, v205
    v_fmac_f32 v238, v8, v237
    v_mfma_f32_16x16x32_bf16 v[176:179], v[60:63], a[64:67], v[176:179]
    ds_read_b64_tr_b16 v[52:53], v4 offset:40960
    v_fmac_f32 v254, v8, v253
    v_mfma_f32_16x16x32_bf16 v[180:183], v[60:63], a[68:71], v[180:183]
    ds_read_b64_tr_b16 v[54:55], v4 offset:41984
    v_fma_f32 v238, -v9, v253, v238
    v_mfma_f32_16x16x32_bf16 v[184:187], v[60:63], a[72:75], v[184:187]
    v_fmac_f32_dpp v206, v205, v13 row_ror:8 row_mask:0xf bank_mask:0xf
    v_fmac_f32 v254, v9, v237
    v_mfma_f32_16x16x32_bf16 v[188:191], v[60:63], a[76:79], v[188:191]
    s_waitcnt lgkmcnt(2)
    v_fmac_f32 v207, v12, v206
    v_fmac_f32 v239, v8, v238
    v_mfma_f32_16x16x32_bf16 v[160:163], v[40:43], a[80:83], v[160:163]
    ds_read_b64_tr_b16 v[56:57], v4 offset:36864
    v_fmac_f32 v255, v8, v254
    v_mfma_f32_16x16x32_bf16 v[164:167], v[40:43], a[84:87], v[164:167]
    ds_read_b64_tr_b16 v[58:59], v4 offset:37888
    v_fma_f32 v239, -v9, v254, v239
    v_mfma_f32_16x16x32_bf16 v[168:171], v[40:43], a[88:91], v[168:171]
    v_fmac_f32_dpp v207, v206, v13 row_ror:8 row_mask:0xf bank_mask:0xf
    v_fmac_f32 v255, v9, v238
    v_mfma_f32_16x16x32_bf16 v[172:175], v[40:43], a[92:95], v[172:175]
    v_mov_b32 v150, v239
    v_mov_b32 v151, v255
    v_mfma_f32_16x16x32_bf16 v[176:179], v[44:47], a[80:83], v[176:179]
    ds_read_b64_tr_b16 v[60:61], v4 offset:45056
    v_mov_b32 v152, v207
    v_mfma_f32_16x16x32_bf16 v[180:183], v[44:47], a[84:87], v[180:183]
    ds_read_b64_tr_b16 v[62:63], v4 offset:46080
    v_mfma_f32_16x16x32_bf16 v[184:187], v[44:47], a[88:91], v[184:187]
    buffer_load_dwordx4 v2, s[12:15], s45 offen  lds
    v_mfma_f32_16x16x32_bf16 v[188:191], v[44:47], a[92:95], v[188:191]
    s_waitcnt vmcnt(5) lgkmcnt(2)
    s_barrier
    v_mfma_f32_16x16x32_bf16 v[96:99], v[48:51], a[64:67], v[96:99]
    ds_read_b64_tr_b16 v[40:41], v3 offset:49152
    v_mfma_f32_16x16x32_bf16 v[100:103], v[48:51], a[68:71], v[100:103]
    ds_read_b64_tr_b16 v[42:43], v3 offset:50176
    v_mfma_f32_16x16x32_bf16 v[104:107], v[48:51], a[72:75], v[104:107]
    ds_write_b64 v153, v[150:151] offset:384
    v_mfma_f32_16x16x32_bf16 v[108:111], v[48:51], a[76:79], v[108:111]
    ds_write_b32 v153, v152 offset:12672
    v_mfma_f32_16x16x32_bf16 v[112:115], v[52:55], a[64:67], v[112:115]
    buffer_load_dwordx4 v2, s[12:15], vcc_lo offen offset:1024  lds
    v_mfma_f32_16x16x32_bf16 v[116:119], v[52:55], a[68:71], v[116:119]
    s_lshl1_add_u32 m0, s74, 73728
    ds_read_b64_tr_b16 v[44:45], v3 offset:57344
    v_mfma_f32_16x16x32_bf16 v[120:123], v[52:55], a[72:75], v[120:123]
    ds_read_b64_tr_b16 v[46:47], v3 offset:58368
    v_mfma_f32_16x16x32_bf16 v[124:127], v[52:55], a[76:79], v[124:127]
    ds_read_b64 v[140:141], v153 offset:0
    v_mfma_f32_16x16x32_bf16 v[96:99], v[56:59], a[80:83], v[96:99]
    ds_read_b64_tr_b16 v[48:49], v3 offset:53248
    v_mfma_f32_16x16x32_bf16 v[100:103], v[56:59], a[84:87], v[100:103]
    ds_read_b64_tr_b16 v[50:51], v3 offset:54272
    v_mfma_f32_16x16x32_bf16 v[104:107], v[56:59], a[88:91], v[104:107]
    buffer_load_dwordx4 v2, s[16:19], s45 offen  lds
    v_mfma_f32_16x16x32_bf16 v[108:111], v[56:59], a[92:95], v[108:111]
    s_waitcnt lgkmcnt(4)
    ds_read_b32 v146, v153 offset:12288
    v_mfma_f32_16x16x32_bf16 v[112:115], v[60:63], a[80:83], v[112:115]
    ds_read_b64_tr_b16 v[52:53], v3 offset:61440
    v_mfma_f32_16x16x32_bf16 v[116:119], v[60:63], a[84:87], v[116:119]
    ds_read_b64_tr_b16 v[54:55], v3 offset:62464
    v_mfma_f32_16x16x32_bf16 v[120:123], v[60:63], a[88:91], v[120:123]
    ds_read_b64 v[142:143], v153 offset:128
    v_mfma_f32_16x16x32_bf16 v[124:127], v[60:63], a[92:95], v[124:127]
    ds_read_b32 v147, v153 offset:12416
    v_mfma_f32_16x16x32_bf16 v[160:163], v[40:43], a[96:99], v[160:163]
    buffer_load_dwordx4 v2, s[16:19], vcc_lo offen offset:1024  lds
    v_mfma_f32_16x16x32_bf16 v[164:167], v[40:43], a[100:103], v[164:167]
    s_add_u32 vcc_lo, s46, 35840
    ds_read_b64_tr_b16 v[56:57], v4 offset:49152
    v_mfma_f32_16x16x32_bf16 v[168:171], v[40:43], a[104:107], v[168:171]
    s_lshl1_add_u32 m0, s74, 81920
    ds_read_b64_tr_b16 v[58:59], v4 offset:50176
    v_mfma_f32_16x16x32_bf16 v[172:175], v[40:43], a[108:111], v[172:175]
    s_waitcnt lgkmcnt(4)
    ds_read_b64 v[36:37], v153 offset:256
    v_mfma_f32_16x16x32_bf16 v[176:179], v[44:47], a[96:99], v[176:179]
    ds_read_b64_tr_b16 v[60:61], v4 offset:57344
    v_mfma_f32_16x16x32_bf16 v[180:183], v[44:47], a[100:103], v[180:183]
    ds_read_b64_tr_b16 v[62:63], v4 offset:58368
    v_mfma_f32_16x16x32_bf16 v[184:187], v[44:47], a[104:107], v[184:187]
    buffer_load_dwordx4 v2, s[12:15], s46 offen  lds
    v_mfma_f32_16x16x32_bf16 v[188:191], v[44:47], a[108:111], v[188:191]
    ds_read_b32 v38, v153 offset:12544
    v_mfma_f32_16x16x32_bf16 v[160:163], v[48:51], a[112:115], v[160:163]
    ds_read_b64_tr_b16 v[40:41], v4 offset:53248
    v_mfma_f32_16x16x32_bf16 v[164:167], v[48:51], a[116:119], v[164:167]
    ds_read_b64_tr_b16 v[42:43], v4 offset:54272
    v_mfma_f32_16x16x32_bf16 v[168:171], v[48:51], a[120:123], v[168:171]
    v_mfma_f32_16x16x32_bf16 v[172:175], v[48:51], a[124:127], v[172:175]
    s_waitcnt lgkmcnt(2)
    v_fmac_f32 v147, v134, v146
    v_fmac_f32 v142, v128, v140
    v_mfma_f32_16x16x32_bf16 v[176:179], v[52:55], a[112:115], v[176:179]
    buffer_load_dwordx4 v2, s[12:15], vcc_lo offen offset:1024  lds
    v_mfma_f32_16x16x32_bf16 v[180:183], v[52:55], a[116:119], v[180:183]
    s_lshl1_add_u32 m0, s74, 90112
    ds_read_b64_tr_b16 v[44:45], v4 offset:61440
    v_fmac_f32 v143, v128, v141
    v_mfma_f32_16x16x32_bf16 v[184:187], v[52:55], a[120:123], v[184:187]
    ds_read_b64_tr_b16 v[46:47], v4 offset:62464
    v_fma_f32 v142, -v129, v141, v142
    v_mfma_f32_16x16x32_bf16 v[188:191], v[52:55], a[124:127], v[188:191]
    s_waitcnt vmcnt(6) lgkmcnt(2)
    s_barrier
    v_fmac_f32_dpp v147, v146, v135 row_ror:8 row_mask:0xf bank_mask:0xf
    v_mfma_f32_16x16x32_bf16 v[96:99], v[56:59], a[96:99], v[96:99]
    v_add_u32 v3, 0x20000, v3
    v_fmac_f32 v143, v129, v140
    v_mfma_f32_16x16x32_bf16 v[100:103], v[56:59], a[100:103], v[100:103]
    ds_read_b64_tr_b16 v[48:49], v3 offset:0
    v_fmac_f32 v38, v134, v147
    v_mfma_f32_16x16x32_bf16 v[104:107], v[56:59], a[104:107], v[104:107]
    buffer_load_dwordx4 v2, s[16:19], s46 offen  lds
    v_mfma_f32_16x16x32_bf16 v[108:111], v[56:59], a[108:111], v[108:111]
    ds_read_b64_tr_b16 v[50:51], v3 offset:1024
    v_fmac_f32 v36, v128, v142
    v_mfma_f32_16x16x32_bf16 v[112:115], v[60:63], a[96:99], v[112:115]
    ds_read_b64_tr_b16 v[52:53], v3 offset:8192
    v_fmac_f32 v37, v128, v143
    v_mfma_f32_16x16x32_bf16 v[116:119], v[60:63], a[100:103], v[116:119]
    ds_read_b64_tr_b16 v[54:55], v3 offset:9216
    v_fma_f32 v36, -v129, v143, v36
    v_mfma_f32_16x16x32_bf16 v[120:123], v[60:63], a[104:107], v[120:123]
    v_fmac_f32_dpp v38, v147, v135 row_ror:8 row_mask:0xf bank_mask:0xf
    v_fmac_f32 v37, v129, v142
    v_mfma_f32_16x16x32_bf16 v[124:127], v[60:63], a[108:111], v[124:127]
    v_fmac_f32 v152, v134, v38
    v_fmac_f32 v150, v128, v36
    v_mfma_f32_16x16x32_bf16 v[96:99], v[40:43], a[112:115], v[96:99]
    buffer_load_dwordx4 v2, s[16:19], vcc_lo offen offset:1024  lds
    v_mfma_f32_16x16x32_bf16 v[100:103], v[40:43], a[116:119], v[100:103]
    s_add_u32 vcc_lo, s47, 35840
    ds_read_b64_tr_b16 v[56:57], v3 offset:4096
    v_fmac_f32 v151, v128, v37
    v_mfma_f32_16x16x32_bf16 v[104:107], v[40:43], a[120:123], v[104:107]
    s_lshl1_add_u32 m0, s74, 98304
    ds_read_b64_tr_b16 v[58:59], v3 offset:5120
    v_fma_f32 v150, -v129, v37, v150
    v_mfma_f32_16x16x32_bf16 v[108:111], v[40:43], a[124:127], v[108:111]
    s_waitcnt lgkmcnt(2)
    v_fmac_f32_dpp v152, v38, v135 row_ror:8 row_mask:0xf bank_mask:0xf
    v_fmac_f32 v151, v129, v36
    v_mfma_f32_16x16x32_bf16 v[112:115], v[44:47], a[112:115], v[112:115]
    ds_read_b64_tr_b16 v[60:61], v3 offset:12288
    v_mfma_f32_16x16x32_bf16 v[116:119], v[44:47], a[116:119], v[116:119]
    ds_read_b64_tr_b16 v[62:63], v3 offset:13312
    v_mfma_f32_16x16x32_bf16 v[120:123], v[44:47], a[120:123], v[120:123]
    buffer_load_dwordx4 v2, s[12:15], s47 offen  lds
    v_mfma_f32_16x16x32_bf16 v[124:127], v[44:47], a[124:127], v[124:127]
    ds_write_b64 v153, v[150:151] offset:8192
    v_mfma_f32_16x16x32_bf16 v[160:163], v[48:51], a[128:131], v[160:163]
    v_add_u32 v4, 0x20000, v4
    v_mfma_f32_16x16x32_bf16 v[164:167], v[48:51], a[132:135], v[164:167]
    ds_read_b64_tr_b16 v[40:41], v4 offset:0
    v_mfma_f32_16x16x32_bf16 v[168:171], v[48:51], a[136:139], v[168:171]
    ds_read_b64_tr_b16 v[42:43], v4 offset:1024
    v_mfma_f32_16x16x32_bf16 v[172:175], v[48:51], a[140:143], v[172:175]
    ds_write_b32 v153, v152 offset:8704
    v_mfma_f32_16x16x32_bf16 v[176:179], v[52:55], a[128:131], v[176:179]
    buffer_load_dwordx4 v2, s[12:15], vcc_lo offen offset:1024  lds
    v_mfma_f32_16x16x32_bf16 v[180:183], v[52:55], a[132:135], v[180:183]
    s_lshl1_add_u32 m0, s74, 106496
    ds_read_b64_tr_b16 v[44:45], v4 offset:8192
    v_mfma_f32_16x16x32_bf16 v[184:187], v[52:55], a[136:139], v[184:187]
    s_waitcnt lgkmcnt(1)
    ds_read_b64_tr_b16 v[46:47], v4 offset:9216
    v_mfma_f32_16x16x32_bf16 v[188:191], v[52:55], a[140:143], v[188:191]
    s_barrier
    ds_read_b64 v[140:141], v154 offset:5120
    v_mfma_f32_16x16x32_bf16 v[160:163], v[56:59], a[144:147], v[160:163]
    ds_read_b64_tr_b16 v[48:49], v4 offset:4096
    v_mfma_f32_16x16x32_bf16 v[164:167], v[56:59], a[148:151], v[164:167]
    ds_read_b64_tr_b16 v[50:51], v4 offset:5120
    v_mfma_f32_16x16x32_bf16 v[168:171], v[56:59], a[152:155], v[168:171]
    buffer_load_dwordx4 v2, s[16:19], s47 offen  lds
    v_mfma_f32_16x16x32_bf16 v[172:175], v[56:59], a[156:159], v[172:175]
    ds_read_b32 v146, v154 offset:5632
    v_mfma_f32_16x16x32_bf16 v[176:179], v[60:63], a[144:147], v[176:179]
    ds_read_b64_tr_b16 v[52:53], v4 offset:12288
    v_mfma_f32_16x16x32_bf16 v[180:183], v[60:63], a[148:151], v[180:183]
    ds_read_b64_tr_b16 v[54:55], v4 offset:13312
    v_mfma_f32_16x16x32_bf16 v[184:187], v[60:63], a[152:155], v[184:187]
    ds_read_b64 v[142:143], v154 offset:6144
    v_mfma_f32_16x16x32_bf16 v[188:191], v[60:63], a[156:159], v[188:191]
    s_waitcnt vmcnt(7) lgkmcnt(4)
    s_barrier
    v_mfma_f32_16x16x32_bf16 v[96:99], v[40:43], a[128:131], v[96:99]
    buffer_load_dwordx4 v2, s[16:19], vcc_lo offen offset:1024  lds
    v_mfma_f32_16x16x32_bf16 v[100:103], v[40:43], a[132:135], v[100:103]
    s_add_u32 vcc_lo, s48, 35840
    v_add_u32 v3, 0xffff0000, v3
    v_mfma_f32_16x16x32_bf16 v[104:107], v[40:43], a[136:139], v[104:107]
    s_lshl1_add_u32 m0, s74, 114688
    ds_read_b64_tr_b16 v[56:57], v3 offset:0
    v_mfma_f32_16x16x32_bf16 v[108:111], v[40:43], a[140:143], v[108:111]
    ds_read_b64_tr_b16 v[58:59], v3 offset:1024
    v_mfma_f32_16x16x32_bf16 v[112:115], v[44:47], a[128:131], v[112:115]
    ds_read_b64_tr_b16 v[60:61], v3 offset:8192
    v_mfma_f32_16x16x32_bf16 v[116:119], v[44:47], a[132:135], v[116:119]
    ds_read_b64_tr_b16 v[62:63], v3 offset:9216
    v_mfma_f32_16x16x32_bf16 v[120:123], v[44:47], a[136:139], v[120:123]
    buffer_load_dwordx4 v2, s[12:15], s48 offen  lds
    v_mfma_f32_16x16x32_bf16 v[124:127], v[44:47], a[140:143], v[124:127]
    ds_read_b32 v147, v154 offset:6656
    v_mfma_f32_16x16x32_bf16 v[96:99], v[48:51], a[144:147], v[96:99]
    ds_read_b64_tr_b16 v[40:41], v3 offset:4096
    v_mfma_f32_16x16x32_bf16 v[100:103], v[48:51], a[148:151], v[100:103]
    ds_read_b64_tr_b16 v[42:43], v3 offset:5120
    v_mfma_f32_16x16x32_bf16 v[104:107], v[48:51], a[152:155], v[104:107]
    ds_read_b64 v[144:145], v154 offset:7168
    v_mfma_f32_16x16x32_bf16 v[108:111], v[48:51], a[156:159], v[108:111]
    s_waitcnt lgkmcnt(4)
    ds_read_b32 v148, v154 offset:7680
    v_mfma_f32_16x16x32_bf16 v[112:115], v[52:55], a[144:147], v[112:115]
    buffer_load_dwordx4 v2, s[12:15], vcc_lo offen offset:1024  lds
    v_mfma_f32_16x16x32_bf16 v[116:119], v[52:55], a[148:151], v[116:119]
    s_lshl1_add_u32 m0, s74, 122880
    ds_read_b64_tr_b16 v[44:45], v3 offset:12288
    v_mfma_f32_16x16x32_bf16 v[120:123], v[52:55], a[152:155], v[120:123]
    ds_read_b64_tr_b16 v[46:47], v3 offset:13312
    v_mfma_f32_16x16x32_bf16 v[124:127], v[52:55], a[156:159], v[124:127]
    s_waitcnt vmcnt(6) lgkmcnt(4)
    s_barrier
    v_mfma_f32_16x16x32_bf16 v[160:163], v[56:59], a[160:163], v[160:163]
    s_waitcnt lgkmcnt(2)
    ds_read_b64_tr_b16 v[48:49], v3 offset:16384
    v_fmac_f32 v147, v136, v146
    v_mfma_f32_16x16x32_bf16 v[164:167], v[56:59], a[164:167], v[164:167]
    ds_read_b64_tr_b16 v[50:51], v3 offset:17408
    v_fmac_f32 v142, v130, v140
    v_mfma_f32_16x16x32_bf16 v[168:171], v[56:59], a[168:171], v[168:171]
    buffer_load_dwordx4 v2, s[16:19], s48 offen  lds
    v_mfma_f32_16x16x32_bf16 v[172:175], v[56:59], a[172:175], v[172:175]
    v_fmac_f32 v143, v130, v141
    v_fma_f32 v142, -v131, v141, v142
    v_mfma_f32_16x16x32_bf16 v[176:179], v[60:63], a[160:163], v[176:179]
    ds_read_b64_tr_b16 v[52:53], v3 offset:24576
    v_fmac_f32_dpp v147, v146, v137 row_ror:8 row_mask:0xf bank_mask:0xf
    v_mfma_f32_16x16x32_bf16 v[180:183], v[60:63], a[164:167], v[180:183]
    ds_read_b64_tr_b16 v[54:55], v3 offset:25600
    v_fmac_f32 v143, v131, v140
    v_mfma_f32_16x16x32_bf16 v[184:187], v[60:63], a[168:171], v[184:187]
    v_fmac_f32 v148, v136, v147
    v_fmac_f32 v144, v130, v142
    v_mfma_f32_16x16x32_bf16 v[188:191], v[60:63], a[172:175], v[188:191]
    v_fmac_f32 v145, v130, v143
    v_fma_f32 v144, -v131, v143, v144
    v_mfma_f32_16x16x32_bf16 v[160:163], v[40:43], a[176:179], v[160:163]
    buffer_load_dwordx4 v2, s[16:19], vcc_lo offen offset:1024  lds
    v_mfma_f32_16x16x32_bf16 v[164:167], v[40:43], a[180:183], v[164:167]
    ds_read_b64_tr_b16 v[56:57], v3 offset:20480
    v_add_u32 v2, 128, v2
    v_mfma_f32_16x16x32_bf16 v[168:171], v[40:43], a[184:187], v[168:171]
    s_add_u32 vcc_lo, s40, 35840
    ds_read_b64_tr_b16 v[58:59], v3 offset:21504
    v_fmac_f32_dpp v148, v147, v137 row_ror:8 row_mask:0xf bank_mask:0xf
    v_mfma_f32_16x16x32_bf16 v[172:175], v[40:43], a[188:191], v[172:175]
    s_waitcnt lgkmcnt(2)
    v_fmac_f32 v145, v131, v142
    v_fmac_f32 v152, v136, v148
    v_mfma_f32_16x16x32_bf16 v[176:179], v[44:47], a[176:179], v[176:179]
    buffer_load_dword v39, v35, s[28:31], s86 offen
    v_mfma_f32_16x16x32_bf16 v[180:183], v[44:47], a[180:183], v[180:183]
    s_add_u32 s86, s86, 27648
    ds_read_b64_tr_b16 v[60:61], v3 offset:28672
    v_fmac_f32 v150, v130, v144
    v_mfma_f32_16x16x32_bf16 v[184:187], v[44:47], a[184:187], v[184:187]
    ds_read_b64_tr_b16 v[62:63], v3 offset:29696
    v_fmac_f32 v151, v130, v145
    v_mfma_f32_16x16x32_bf16 v[188:191], v[44:47], a[188:191], v[188:191]
    s_waitcnt vmcnt(5) lgkmcnt(3)
    s_barrier
    v_fma_f32 v150, -v131, v145, v150
    v_mfma_f32_16x16x32_bf16 v[160:163], v[48:51], a[192:195], v[160:163]
    ds_read_b64_tr_b16 v[40:41], v3 offset:32768
    v_fmac_f32_dpp v152, v148, v137 row_ror:8 row_mask:0xf bank_mask:0xf
    v_mfma_f32_16x16x32_bf16 v[164:167], v[48:51], a[196:199], v[164:167]
    ds_read_b64_tr_b16 v[42:43], v3 offset:33792
    v_fmac_f32 v151, v131, v144
    v_mfma_f32_16x16x32_bf16 v[168:171], v[48:51], a[200:203], v[168:171]
    v_min_u32 v150, -2, v150
    v_min_u32 v151, -2, v151
    v_mfma_f32_16x16x32_bf16 v[172:175], v[48:51], a[204:207], v[172:175]
    v_min_u32 v152, -2, v152
    v_mfma_f32_16x16x32_bf16 v[176:179], v[52:55], a[192:195], v[176:179]
    buffer_store_dwordx3 v[150:152], v155, s[32:35], 0 offen sc1
    v_mfma_f32_16x16x32_bf16 v[180:183], v[52:55], a[196:199], v[180:183]
    ds_read_b64_tr_b16 v[44:45], v3 offset:40960
    v_fmac_f32 v38, v138, v148
    v_mfma_f32_16x16x32_bf16 v[184:187], v[52:55], a[200:203], v[184:187]
    ds_read_b64_tr_b16 v[46:47], v3 offset:41984
    v_fmac_f32 v36, v132, v144
    v_mfma_f32_16x16x32_bf16 v[188:191], v[52:55], a[204:207], v[188:191]
    s_waitcnt lgkmcnt(2)
    v_fmac_f32 v37, v132, v145
    v_fma_f32 v36, -v133, v145, v36
    v_mfma_f32_16x16x32_bf16 v[160:163], v[56:59], a[208:211], v[160:163]
    ds_read_b64_tr_b16 v[48:49], v3 offset:36864
    v_fmac_f32_dpp v38, v148, v139 row_ror:8 row_mask:0xf bank_mask:0xf
    v_mfma_f32_16x16x32_bf16 v[164:167], v[56:59], a[212:215], v[164:167]
    ds_read_b64_tr_b16 v[50:51], v3 offset:37888
    v_fmac_f32 v37, v133, v144
    v_mfma_f32_16x16x32_bf16 v[168:171], v[56:59], a[216:219], v[168:171]
    v_mfma_f32_16x16x32_bf16 v[172:175], v[56:59], a[220:223], v[172:175]
    v_mfma_f32_16x16x32_bf16 v[176:179], v[60:63], a[208:211], v[176:179]
    ds_read_b64_tr_b16 v[52:53], v3 offset:45056
    v_mfma_f32_16x16x32_bf16 v[180:183], v[60:63], a[212:215], v[180:183]
    ds_read_b64_tr_b16 v[54:55], v3 offset:46080
    v_mfma_f32_16x16x32_bf16 v[184:187], v[60:63], a[216:219], v[184:187]
    v_mfma_f32_16x16x32_bf16 v[188:191], v[60:63], a[220:223], v[188:191]
    s_waitcnt vmcnt(2) lgkmcnt(2)
    s_barrier
    v_mfma_f32_16x16x32_bf16 v[160:163], v[40:43], a[224:227], v[160:163]
    ds_read_b64_tr_b16 v[56:57], v3 offset:49152
    v_mfma_f32_16x16x32_bf16 v[164:167], v[40:43], a[228:231], v[164:167]
    ds_read_b64_tr_b16 v[58:59], v3 offset:50176
    v_mfma_f32_16x16x32_bf16 v[168:171], v[40:43], a[232:235], v[168:171]
    v_mfma_f32_16x16x32_bf16 v[172:175], v[40:43], a[236:239], v[172:175]
    v_mfma_f32_16x16x32_bf16 v[176:179], v[44:47], a[224:227], v[176:179]
    ds_read_b64_tr_b16 v[60:61], v3 offset:57344
    v_mfma_f32_16x16x32_bf16 v[180:183], v[44:47], a[228:231], v[180:183]
    ds_read_b64_tr_b16 v[62:63], v3 offset:58368
    v_mfma_f32_16x16x32_bf16 v[184:187], v[44:47], a[232:235], v[184:187]
    v_mfma_f32_16x16x32_bf16 v[188:191], v[44:47], a[236:239], v[188:191]
    v_mfma_f32_16x16x32_bf16 v[160:163], v[48:51], a[240:243], v[160:163]
    ds_read_b64_tr_b16 v[40:41], v3 offset:53248
    v_mfma_f32_16x16x32_bf16 v[164:167], v[48:51], a[244:247], v[164:167]
    ds_read_b64_tr_b16 v[42:43], v3 offset:54272
    v_mfma_f32_16x16x32_bf16 v[168:171], v[48:51], a[248:251], v[168:171]
    v_mfma_f32_16x16x32_bf16 v[172:175], v[48:51], a[252:255], v[172:175]
    s_waitcnt lgkmcnt(2)
    v_mfma_f32_16x16x32_bf16 v[176:179], v[52:55], a[240:243], v[176:179]
    ds_read_b64_tr_b16 v[44:45], v3 offset:61440
    v_mfma_f32_16x16x32_bf16 v[180:183], v[52:55], a[244:247], v[180:183]
    ds_read_b64_tr_b16 v[46:47], v3 offset:62464
    v_mfma_f32_16x16x32_bf16 v[184:187], v[52:55], a[248:251], v[184:187]
    v_mfma_f32_16x16x32_bf16 v[188:191], v[52:55], a[252:255], v[188:191]
    v_mfma_f32_16x16x32_bf16 v[160:163], v[56:59], v[64:67], v[160:163]
    v_add_u32 v4, 0xffff0000, v4
    v_mfma_f32_16x16x32_bf16 v[164:167], v[56:59], v[68:71], v[164:167]
    ds_read_b64_tr_b16 v[48:49], v4 offset:0
    v_mfma_f32_16x16x32_bf16 v[168:171], v[56:59], v[72:75], v[168:171]
    ds_read_b64_tr_b16 v[50:51], v4 offset:1024
    v_mfma_f32_16x16x32_bf16 v[172:175], v[56:59], v[76:79], v[172:175]
    v_mfma_f32_16x16x32_bf16 v[176:179], v[60:63], v[64:67], v[176:179]
    ds_read_b64_tr_b16 v[52:53], v4 offset:8192
    v_mfma_f32_16x16x32_bf16 v[180:183], v[60:63], v[68:71], v[180:183]
    ds_read_b64_tr_b16 v[54:55], v4 offset:9216
    v_mfma_f32_16x16x32_bf16 v[184:187], v[60:63], v[72:75], v[184:187]
    v_mfma_f32_16x16x32_bf16 v[188:191], v[60:63], v[76:79], v[188:191]
    s_waitcnt lgkmcnt(3)
    v_mfma_f32_16x16x32_bf16 v[160:163], v[40:43], v[80:83], v[160:163]
    ds_read_b64_tr_b16 v[56:57], v4 offset:4096
    v_mfma_f32_16x16x32_bf16 v[164:167], v[40:43], v[84:87], v[164:167]
    ds_read_b64_tr_b16 v[58:59], v4 offset:5120
    v_mfma_f32_16x16x32_bf16 v[168:171], v[40:43], v[88:91], v[168:171]
    v_mfma_f32_16x16x32_bf16 v[172:175], v[40:43], v[92:95], v[172:175]
    v_mfma_f32_16x16x32_bf16 v[176:179], v[44:47], v[80:83], v[176:179]
    ds_read_b64_tr_b16 v[60:61], v4 offset:12288
    v_mfma_f32_16x16x32_bf16 v[180:183], v[44:47], v[84:87], v[180:183]
    ds_read_b64_tr_b16 v[62:63], v4 offset:13312
    v_mfma_f32_16x16x32_bf16 v[184:187], v[44:47], v[88:91], v[184:187]
    v_mfma_f32_16x16x32_bf16 v[188:191], v[44:47], v[92:95], v[188:191]
    s_waitcnt lgkmcnt(2)
    v_mfma_f32_16x16x32_bf16 v[96:99], v[48:51], a[160:163], v[96:99]
    ds_read_b64_tr_b16 v[40:41], v4 offset:16384
    v_mfma_f32_16x16x32_bf16 v[100:103], v[48:51], a[164:167], v[100:103]
    ds_read_b64_tr_b16 v[42:43], v4 offset:17408
    v_mul_f32 v176, v160, v176
    v_mfma_f32_16x16x32_bf16 v[104:107], v[48:51], a[168:171], v[104:107]
    v_mul_f32 v160, s56, v160
    v_mul_f32 v180, v164, v180
    v_mfma_f32_16x16x32_bf16 v[108:111], v[48:51], a[172:175], v[108:111]
    v_exp_f32 v160, v160
    v_mfma_f32_16x16x32_bf16 v[112:115], v[52:55], a[160:163], v[112:115]
    ds_read_b64_tr_b16 v[44:45], v4 offset:24576
    v_add_f32 v160, 1.0, v160
    v_mfma_f32_16x16x32_bf16 v[116:119], v[52:55], a[164:167], v[116:119]
    ds_read_b64_tr_b16 v[46:47], v4 offset:25600
    v_mul_f32 v164, s56, v164
    v_mfma_f32_16x16x32_bf16 v[120:123], v[52:55], a[168:171], v[120:123]
    v_rcp_f32 v160, v160
    v_mfma_f32_16x16x32_bf16 v[124:127], v[52:55], a[172:175], v[124:127]
    v_exp_f32 v164, v164
    v_mfma_f32_16x16x32_bf16 v[96:99], v[56:59], a[176:179], v[96:99]
    ds_read_b64_tr_b16 v[48:49], v4 offset:20480
    v_mul_f32 v160, v160, v176
    v_mfma_f32_16x16x32_bf16 v[100:103], v[56:59], a[180:183], v[100:103]
    ds_read_b64_tr_b16 v[50:51], v4 offset:21504
    v_mul_f32 v177, v161, v177
    v_mfma_f32_16x16x32_bf16 v[104:107], v[56:59], a[184:187], v[104:107]
    v_mul_f32 v161, s56, v161
    v_add_f32 v164, 1.0, v164
    v_mfma_f32_16x16x32_bf16 v[108:111], v[56:59], a[188:191], v[108:111]
    s_waitcnt lgkmcnt(2)
    v_exp_f32 v161, v161
    v_mfma_f32_16x16x32_bf16 v[112:115], v[60:63], a[176:179], v[112:115]
    ds_read_b64_tr_b16 v[52:53], v4 offset:28672
    v_add_f32 v161, 1.0, v161
    v_mfma_f32_16x16x32_bf16 v[116:119], v[60:63], a[180:183], v[116:119]
    ds_read_b64_tr_b16 v[54:55], v4 offset:29696
    v_mul_f32 v184, v168, v184
    v_mfma_f32_16x16x32_bf16 v[120:123], v[60:63], a[184:187], v[120:123]
    v_rcp_f32 v161, v161
    v_mfma_f32_16x16x32_bf16 v[124:127], v[60:63], a[188:191], v[124:127]
    v_rcp_f32 v164, v164
    v_mfma_f32_16x16x32_bf16 v[96:99], v[40:43], a[192:195], v[96:99]
    buffer_load_dwordx3 v[28:30], v7, s[32:35], 0 offen offset:256 sc1
    v_mfma_f32_16x16x32_bf16 v[100:103], v[40:43], a[196:199], v[100:103]
    buffer_load_dwordx3 v[32:34], v7, s[32:35], 0 offen offset:512 sc1
    v_mfma_f32_16x16x32_bf16 v[104:107], v[40:43], a[200:203], v[104:107]
    ds_read_b64_tr_b16 v[56:57], v4 offset:32768
    v_mul_f32 v161, v161, v177
    v_mfma_f32_16x16x32_bf16 v[108:111], v[40:43], a[204:207], v[108:111]
    ds_read_b64_tr_b16 v[58:59], v4 offset:33792
    v_cvt_pk_bf16_f32 v208, v160, v161
    v_mfma_f32_16x16x32_bf16 v[112:115], v[44:47], a[192:195], v[112:115]
    ds_read_b64_tr_b16 v[60:61], v4 offset:40960
    v_mul_f32 v178, v162, v178
    v_mfma_f32_16x16x32_bf16 v[116:119], v[44:47], a[196:199], v[116:119]
    ds_read_b64_tr_b16 v[62:63], v4 offset:41984
    v_mul_f32 v162, s56, v162
    v_mfma_f32_16x16x32_bf16 v[120:123], v[44:47], a[200:203], v[120:123]
    v_exp_f32 v162, v162
    v_mfma_f32_16x16x32_bf16 v[124:127], v[44:47], a[204:207], v[124:127]
    s_waitcnt lgkmcnt(4)
    v_add_f32 v162, 1.0, v162
    v_mul_f32 v164, v164, v180
    v_mfma_f32_16x16x32_bf16 v[96:99], v[48:51], a[208:211], v[96:99]
    ds_read_b64_tr_b16 v[40:41], v4 offset:36864
    v_mul_f32 v181, v165, v181
    v_mfma_f32_16x16x32_bf16 v[100:103], v[48:51], a[212:215], v[100:103]
    ds_read_b64_tr_b16 v[42:43], v4 offset:37888
    v_mul_f32 v165, s56, v165
    v_mfma_f32_16x16x32_bf16 v[104:107], v[48:51], a[216:219], v[104:107]
    v_rcp_f32 v162, v162
    v_mfma_f32_16x16x32_bf16 v[108:111], v[48:51], a[220:223], v[108:111]
    v_exp_f32 v165, v165
    v_mfma_f32_16x16x32_bf16 v[112:115], v[52:55], a[208:211], v[112:115]
    ds_read_b64_tr_b16 v[44:45], v4 offset:45056
    v_mul_f32 v162, v162, v178
    v_mfma_f32_16x16x32_bf16 v[116:119], v[52:55], a[212:215], v[116:119]
    ds_read_b64_tr_b16 v[46:47], v4 offset:46080
    v_mul_f32 v179, v163, v179
    v_mfma_f32_16x16x32_bf16 v[120:123], v[52:55], a[216:219], v[120:123]
    v_mul_f32 v163, s56, v163
    v_add_f32 v165, 1.0, v165
    v_mfma_f32_16x16x32_bf16 v[124:127], v[52:55], a[220:223], v[124:127]
    s_waitcnt lgkmcnt(2)
    v_exp_f32 v163, v163
    v_mfma_f32_16x16x32_bf16 v[96:99], v[56:59], a[224:227], v[96:99]
    ds_read_b64_tr_b16 v[48:49], v4 offset:49152
    v_add_f32 v163, 1.0, v163
    v_mfma_f32_16x16x32_bf16 v[100:103], v[56:59], a[228:231], v[100:103]
    ds_read_b64_tr_b16 v[50:51], v4 offset:50176
    v_mul_f32 v168, s56, v168
    v_mfma_f32_16x16x32_bf16 v[104:107], v[56:59], a[232:235], v[104:107]
    v_rcp_f32 v163, v163
    v_mfma_f32_16x16x32_bf16 v[108:111], v[56:59], a[236:239], v[108:111]
    v_rcp_f32 v165, v165
    v_mfma_f32_16x16x32_bf16 v[112:115], v[60:63], a[224:227], v[112:115]
    ds_read_b64_tr_b16 v[52:53], v4 offset:57344
    v_mul_f32 v163, v163, v179
    v_mfma_f32_16x16x32_bf16 v[116:119], v[60:63], a[228:231], v[116:119]
    ds_read_b64_tr_b16 v[54:55], v4 offset:58368
    v_cvt_pk_bf16_f32 v209, v162, v163
    v_mfma_f32_16x16x32_bf16 v[120:123], v[60:63], a[232:235], v[120:123]
    buffer_load_dword v39, v35, s[28:31], s86 offen
    v_mfma_f32_16x16x32_bf16 v[124:127], v[60:63], a[236:239], v[124:127]
    v_exp_f32 v168, v168
    v_mfma_f32_16x16x32_bf16 v[96:99], v[40:43], a[240:243], v[96:99]
    ds_read_b64_tr_b16 v[56:57], v4 offset:53248
    v_min_u32 v35, 23, v0
    v_mfma_f32_16x16x32_bf16 v[100:103], v[40:43], a[244:247], v[100:103]
    ds_read_b64_tr_b16 v[58:59], v4 offset:54272
    v_lshlrev_b32 v35, 7, v35
    v_mfma_f32_16x16x32_bf16 v[104:107], v[40:43], a[248:251], v[104:107]
    s_mul_i32 s86, s4, 24
    v_mul_f32 v165, v165, v181
    s_add_u32 s86, s86, s5
    v_mfma_f32_16x16x32_bf16 v[108:111], v[40:43], a[252:255], v[108:111]
    s_branch gated_mix__ssm_conv_s5__swiglu_ffn__prompt_kernel_A_sk2
.p2align 12
gated_mix__ssm_conv_s5__swiglu_ffn__prompt_kernel_A_pg2_2:
    s_branch gated_mix__ssm_conv_s5__swiglu_ffn__prompt_kernel_A_pr2
gated_mix__ssm_conv_s5__swiglu_ffn__prompt_kernel_A_sk2:
    s_waitcnt lgkmcnt(2)
    v_cvt_pk_bf16_f32 v212, v164, v165
    s_lshl2_add_u32 s86, s86, s6
    v_mfma_f32_16x16x32_bf16 v[112:115], v[44:47], a[240:243], v[112:115]
    s_mul_i32 s87, s86, 2731
    ds_read_b64_tr_b16 v[60:61], v4 offset:61440
    v_mul_f32 v182, v166, v182
    v_mfma_f32_16x16x32_bf16 v[116:119], v[44:47], a[244:247], v[116:119]
    s_lshr_b32 s87, s87, 16
    ds_read_b64_tr_b16 v[62:63], v4 offset:62464
    v_mul_f32 v166, s56, v166
    v_mfma_f32_16x16x32_bf16 v[120:123], v[44:47], a[248:251], v[120:123]
    s_mul_i32 s86, s86, 3072
    v_exp_f32 v166, v166
    v_mfma_f32_16x16x32_bf16 v[124:127], v[44:47], a[252:255], v[124:127]
    s_mul_i32 s87, s87, 73728
    v_add_f32 v166, 1.0, v166
    s_add_u32 s86, s86, s87
    v_mfma_f32_16x16x32_bf16 v[96:99], v[48:51], v[64:67], v[96:99]
    s_mul_i32 s87, s3, 1327104
    v_xor_b32 v3, 64, v3
    v_add_f32 v168, 1.0, v168
    v_mfma_f32_16x16x32_bf16 v[100:103], v[48:51], v[68:71], v[100:103]
    s_add_u32 s86, s86, s87
    v_add_u32 v3, 0xffff0000, v3
    v_mul_f32 v188, v172, v188
    v_mfma_f32_16x16x32_bf16 v[104:107], v[48:51], v[72:75], v[104:107]
    ds_read_b64_tr_b16 v[40:41], v3 offset:0
    v_mul_f32 v172, s56, v172
    v_mfma_f32_16x16x32_bf16 v[108:111], v[48:51], v[76:79], v[108:111]
    ds_read_b64_tr_b16 v[42:43], v3 offset:1024
    v_mfma_f32_16x16x32_bf16 v[112:115], v[52:55], v[64:67], v[112:115]
    ds_read_b64_tr_b16 v[44:45], v3 offset:8192
    v_mfma_f32_16x16x32_bf16 v[116:119], v[52:55], v[68:71], v[116:119]
    ds_read_b64_tr_b16 v[46:47], v3 offset:9216
    v_mfma_f32_16x16x32_bf16 v[120:123], v[52:55], v[72:75], v[120:123]
    v_rcp_f32 v166, v166
    v_mfma_f32_16x16x32_bf16 v[124:127], v[52:55], v[76:79], v[124:127]
    s_waitcnt lgkmcnt(4)
    v_rcp_f32 v168, v168
    v_mfma_f32_16x16x32_bf16 v[96:99], v[56:59], v[80:83], v[96:99]
    ds_read_b64_tr_b16 v[48:49], v3 offset:4096
    v_mul_f32 v166, v166, v182
    v_mfma_f32_16x16x32_bf16 v[100:103], v[56:59], v[84:87], v[100:103]
    ds_read_b64_tr_b16 v[50:51], v3 offset:5120
    v_mul_f32 v183, v167, v183
    v_mfma_f32_16x16x32_bf16 v[104:107], v[56:59], v[88:91], v[104:107]
    v_exp_f32 v172, v172
    v_mfma_f32_16x16x32_bf16 v[108:111], v[56:59], v[92:95], v[108:111]
    v_mul_f32 v167, s56, v167
    v_mul_f32 v168, v168, v184
    v_mfma_f32_16x16x32_bf16 v[112:115], v[60:63], v[80:83], v[112:115]
    ds_read_b64_tr_b16 v[52:53], v3 offset:12288
    v_mul_f32 v185, v169, v185
    v_mfma_f32_16x16x32_bf16 v[116:119], v[60:63], v[84:87], v[116:119]
    ds_read_b64_tr_b16 v[54:55], v3 offset:13312
    v_mul_f32 v169, s56, v169
    v_mfma_f32_16x16x32_bf16 v[120:123], v[60:63], v[88:91], v[120:123]
    v_exp_f32 v167, v167
    v_mfma_f32_16x16x32_bf16 v[124:127], v[60:63], v[92:95], v[124:127]
    s_waitcnt lgkmcnt(2)
    v_exp_f32 v169, v169
    v_mfma_f32_16x16x32_bf16 v[128:131], v[40:43], a[0:3], 0
    ds_read_b64_tr_b16 v[56:57], v3 offset:16384
    v_add_f32 v167, 1.0, v167
    v_mfma_f32_16x16x32_bf16 v[132:135], v[40:43], a[4:7], 0
    ds_read_b64_tr_b16 v[58:59], v3 offset:17408
    v_add_f32 v169, 1.0, v169
    v_mfma_f32_16x16x32_bf16 v[136:139], v[40:43], a[8:11], 0
    v_rcp_f32 v167, v167
    v_mfma_f32_16x16x32_bf16 v[140:143], v[40:43], a[12:15], 0
    s_waitcnt vmcnt(1)
    v_rcp_f32 v169, v169
    v_mfma_f32_16x16x32_bf16 v[144:147], v[44:47], a[0:3], 0
    ds_read_b64_tr_b16 v[60:61], v3 offset:24576
    v_max3_u32 v31, v28, v29, v30
    v_mfma_f32_16x16x32_bf16 v[148:151], v[44:47], a[4:7], 0
    ds_read_b64_tr_b16 v[62:63], v3 offset:25600
    v_max3_u32 v31, v31, v32, v33
    v_mfma_f32_16x16x32_bf16 v[152:155], v[44:47], a[8:11], 0
    v_max_u32 v31, v31, v34
    v_cmp_eq_u32 s[78:79], -1, v31
    v_mfma_f32_16x16x32_bf16 v[156:159], v[44:47], a[12:15], 0
    v_mul_f32 v167, v167, v183
    v_cvt_pk_bf16_f32 v213, v166, v167
    v_mfma_f32_16x16x32_bf16 v[128:131], v[48:51], a[16:19], v[128:131]
    s_cmp_lg_u64 s[78:79], 0
    s_cbranch_scc1 gated_mix__ssm_conv_s5__swiglu_ffn__prompt_kernel_A_eS_s
gated_mix__ssm_conv_s5__swiglu_ffn__prompt_kernel_A_eS:
    ds_read_b64_tr_b16 v[40:41], v3 offset:20480
    v_fmac_f32 v30, v22, v34
    v_mfma_f32_16x16x32_bf16 v[132:135], v[48:51], a[20:23], v[132:135]
    ds_read_b64_tr_b16 v[42:43], v3 offset:21504
    v_fmac_f32 v28, v16, v32
    v_mfma_f32_16x16x32_bf16 v[136:139], v[48:51], a[24:27], v[136:139]
    v_fmac_f32 v29, v16, v33
    v_fma_f32 v28, -v17, v33, v28
    v_mfma_f32_16x16x32_bf16 v[140:143], v[48:51], a[28:31], v[140:143]
    s_waitcnt lgkmcnt(2)
    v_fmac_f32_dpp v30, v34, v23 row_ror:8 row_mask:0xf bank_mask:0xf
    v_fmac_f32 v29, v17, v32
    v_mfma_f32_16x16x32_bf16 v[144:147], v[52:55], a[16:19], v[144:147]
    ds_read_b64_tr_b16 v[44:45], v3 offset:28672
    v_mul_f32 v34, v24, v30
    v_mfma_f32_16x16x32_bf16 v[148:151], v[52:55], a[20:23], v[148:151]
    ds_read_b64_tr_b16 v[46:47], v3 offset:29696
    v_mul_f32 v32, v18, v28
    v_mfma_f32_16x16x32_bf16 v[152:155], v[52:55], a[24:27], v[152:155]
    v_mul_f32 v33, v18, v29
    v_fma_f32 v32, -v19, v29, v32
    v_mfma_f32_16x16x32_bf16 v[156:159], v[52:55], a[28:31], v[156:159]
    v_fmac_f32_dpp v34, v30, v25 row_ror:8 row_mask:0xf bank_mask:0xf
    v_fmac_f32 v33, v19, v28
    v_mfma_f32_16x16x32_bf16 v[128:131], v[56:59], a[32:35], v[128:131]
    ds_read_b64_tr_b16 v[48:49], v3 offset:32768
    v_mov_b32 v28, v32
    v_mfma_f32_16x16x32_bf16 v[132:135], v[56:59], a[36:39], v[132:135]
    ds_read_b64_tr_b16 v[50:51], v3 offset:33792
    v_mov_b32 v29, v33
    v_mfma_f32_16x16x32_bf16 v[136:139], v[56:59], a[40:43], v[136:139]
    v_mov_b32 v30, v34
    v_permlane16_swap_b32 v32, v28
    v_mfma_f32_16x16x32_bf16 v[140:143], v[56:59], a[44:47], v[140:143]
    v_permlane16_swap_b32 v33, v29
    v_permlane16_swap_b32 v34, v30
    v_mfma_f32_16x16x32_bf16 v[144:147], v[60:63], a[32:35], v[144:147]
    ds_read_b64_tr_b16 v[52:53], v3 offset:40960
    v_add_f32 v32, v32, v28
    v_mfma_f32_16x16x32_bf16 v[148:151], v[60:63], a[36:39], v[148:151]
    ds_read_b64_tr_b16 v[54:55], v3 offset:41984
    v_add_f32 v33, v33, v29
    v_mfma_f32_16x16x32_bf16 v[152:155], v[60:63], a[40:43], v[152:155]
    v_add_f32 v34, v34, v30
    v_mov_b32 v28, v32
    v_mfma_f32_16x16x32_bf16 v[156:159], v[60:63], a[44:47], v[156:159]
    s_waitcnt lgkmcnt(2)
    v_mov_b32 v29, v33
    v_mov_b32 v30, v34
    v_mfma_f32_16x16x32_bf16 v[128:131], v[40:43], a[48:51], v[128:131]
    ds_read_b64_tr_b16 v[56:57], v3 offset:36864
    v_permlane32_swap_b32 v32, v28
    v_mfma_f32_16x16x32_bf16 v[132:135], v[40:43], a[52:55], v[132:135]
    ds_read_b64_tr_b16 v[58:59], v3 offset:37888
    v_permlane32_swap_b32 v33, v29
    v_mfma_f32_16x16x32_bf16 v[136:139], v[40:43], a[56:59], v[136:139]
    v_permlane32_swap_b32 v34, v30
    v_add_f32 v32, v32, v28
    v_mfma_f32_16x16x32_bf16 v[140:143], v[40:43], a[60:63], v[140:143]
    v_add_f32 v33, v33, v29
    v_add_f32 v34, v34, v30
    v_mfma_f32_16x16x32_bf16 v[144:147], v[44:47], a[48:51], v[144:147]
    ds_read_b64_tr_b16 v[60:61], v3 offset:45056
    v_fmac_f32 v38, v26, v34
    v_mfma_f32_16x16x32_bf16 v[148:151], v[44:47], a[52:55], v[148:151]
    ds_read_b64_tr_b16 v[62:63], v3 offset:46080
    v_fmac_f32 v36, v20, v32
    v_mfma_f32_16x16x32_bf16 v[152:155], v[44:47], a[56:59], v[152:155]
    v_fmac_f32 v37, v20, v33
    v_fma_f32 v36, -v21, v33, v36
    v_mfma_f32_16x16x32_bf16 v[156:159], v[44:47], a[60:63], v[156:159]
    v_fmac_f32_dpp v38, v34, v27 row_ror:8 row_mask:0xf bank_mask:0xf
    v_fmac_f32 v37, v21, v32
    v_mfma_f32_16x16x32_bf16 v[128:131], v[48:51], a[64:67], v[128:131]
    ds_read_b64_tr_b16 v[40:41], v3 offset:49152
    v_mul_f32 v34, v14, v38
    v_mfma_f32_16x16x32_bf16 v[132:135], v[48:51], a[68:71], v[132:135]
    ds_read_b64_tr_b16 v[42:43], v3 offset:50176
    v_mul_f32 v28, v10, v36
    v_mfma_f32_16x16x32_bf16 v[136:139], v[48:51], a[72:75], v[136:139]
    v_mul_f32 v29, v10, v37
    v_fma_f32 v28, -v11, v37, v28
    v_mfma_f32_16x16x32_bf16 v[140:143], v[48:51], a[76:79], v[140:143]
    s_waitcnt lgkmcnt(2)
    v_fmac_f32_dpp v34, v38, v15 row_ror:8 row_mask:0xf bank_mask:0xf
    v_fmac_f32 v29, v11, v36
    v_mfma_f32_16x16x32_bf16 v[144:147], v[52:55], a[64:67], v[144:147]
    ds_read_b64_tr_b16 v[44:45], v3 offset:57344
    v_lshrrev_b32 v20, 3, v0
    v_mfma_f32_16x16x32_bf16 v[148:151], v[52:55], a[68:71], v[148:151]
    ds_read_b64_tr_b16 v[46:47], v3 offset:58368
    v_mul_u32_u24 v20, 1152, v20
    v_mfma_f32_16x16x32_bf16 v[152:155], v[52:55], a[72:75], v[152:155]
    v_and_b32 v21, 7, v0
    v_lshl_add_u32 v20, v21, 4, v20
    v_mfma_f32_16x16x32_bf16 v[156:159], v[52:55], a[76:79], v[156:159]
    v_and_b32 v21, 48, v0
    v_lshlrev_b32 v21, 1, v21
    v_mfma_f32_16x16x32_bf16 v[128:131], v[56:59], a[80:83], v[128:131]
    ds_read_b64_tr_b16 v[48:49], v3 offset:53248
    v_xor_b32 v22, v20, v21
    v_mfma_f32_16x16x32_bf16 v[132:135], v[56:59], a[84:87], v[132:135]
    s_add_u32 s82, s66, 0
    ds_read_b64_tr_b16 v[50:51], v3 offset:54272
    v_mul_f32 v169, v169, v185
    v_mfma_f32_16x16x32_bf16 v[136:139], v[56:59], a[88:91], v[136:139]
    v_cvt_pk_bf16_f32 v216, v168, v169
    v_mul_f32 v186, v170, v186
    v_mfma_f32_16x16x32_bf16 v[140:143], v[56:59], a[92:95], v[140:143]
    v_mul_f32 v170, s56, v170
    v_add_f32 v172, 1.0, v172
    v_mfma_f32_16x16x32_bf16 v[144:147], v[60:63], a[80:83], v[144:147]
    ds_read_b64_tr_b16 v[52:53], v3 offset:61440
    v_mul_f32 v112, v96, v112
    v_mfma_f32_16x16x32_bf16 v[148:151], v[60:63], a[84:87], v[148:151]
    ds_read_b64_tr_b16 v[54:55], v3 offset:62464
    v_mul_f32 v96, s56, v96
    v_mfma_f32_16x16x32_bf16 v[152:155], v[60:63], a[88:91], v[152:155]
    v_exp_f32 v170, v170
    v_mfma_f32_16x16x32_bf16 v[156:159], v[60:63], a[92:95], v[156:159]
    s_waitcnt lgkmcnt(2)
    v_rcp_f32 v172, v172
    v_mfma_f32_16x16x32_bf16 v[128:131], v[40:43], a[96:99], v[128:131]
    v_add_u32 v3, 0x10000, v3
    v_add_f32 v170, 1.0, v170
    v_mfma_f32_16x16x32_bf16 v[132:135], v[40:43], a[100:103], v[132:135]
    ds_read_b64_tr_b16 v[56:57], v3 offset:0
    v_mul_f32 v172, v172, v188
    v_mfma_f32_16x16x32_bf16 v[136:139], v[40:43], a[104:107], v[136:139]
    ds_read_b64_tr_b16 v[58:59], v3 offset:1024
    v_mul_f32 v189, v173, v189
    v_mfma_f32_16x16x32_bf16 v[140:143], v[40:43], a[108:111], v[140:143]
    v_rcp_f32 v170, v170
    v_mfma_f32_16x16x32_bf16 v[144:147], v[44:47], a[96:99], v[144:147]
    ds_read_b64_tr_b16 v[60:61], v3 offset:8192
    v_mul_f32 v170, v170, v186
    v_mfma_f32_16x16x32_bf16 v[148:151], v[44:47], a[100:103], v[148:151]
    ds_read_b64_tr_b16 v[62:63], v3 offset:9216
    v_mul_f32 v187, v171, v187
    v_mfma_f32_16x16x32_bf16 v[152:155], v[44:47], a[104:107], v[152:155]
    v_exp_f32 v96, v96
    v_mfma_f32_16x16x32_bf16 v[156:159], v[44:47], a[108:111], v[156:159]
    v_mul_f32 v171, s56, v171
    v_mul_f32 v173, s56, v173
    v_mfma_f32_16x16x32_bf16 v[128:131], v[48:51], a[112:115], v[128:131]
    ds_read_b64_tr_b16 v[40:41], v3 offset:4096
    v_add_f32 v96, 1.0, v96
    v_mfma_f32_16x16x32_bf16 v[132:135], v[48:51], a[116:119], v[132:135]
    ds_read_b64_tr_b16 v[42:43], v3 offset:5120
    v_mul_f32 v116, v100, v116
    v_mfma_f32_16x16x32_bf16 v[136:139], v[48:51], a[120:123], v[136:139]
    v_exp_f32 v171, v171
    v_mfma_f32_16x16x32_bf16 v[140:143], v[48:51], a[124:127], v[140:143]
    s_waitcnt lgkmcnt(2)
    v_exp_f32 v173, v173
    v_mfma_f32_16x16x32_bf16 v[144:147], v[52:55], a[112:115], v[144:147]
    ds_read_b64_tr_b16 v[44:45], v3 offset:12288
    v_add_f32 v171, 1.0, v171
    v_mfma_f32_16x16x32_bf16 v[148:151], v[52:55], a[116:119], v[148:151]
    ds_read_b64_tr_b16 v[46:47], v3 offset:13312
    v_add_f32 v173, 1.0, v173
    v_mfma_f32_16x16x32_bf16 v[152:155], v[52:55], a[120:123], v[152:155]
    v_rcp_f32 v171, v171
    v_mfma_f32_16x16x32_bf16 v[156:159], v[52:55], a[124:127], v[156:159]
    v_rcp_f32 v173, v173
    v_mfma_f32_16x16x32_bf16 v[128:131], v[56:59], a[160:163], v[128:131]
    ds_read_b64_tr_b16 v[48:49], v3 offset:16384
    v_mul_f32 v171, v171, v187
    v_mfma_f32_16x16x32_bf16 v[132:135], v[56:59], a[164:167], v[132:135]
    ds_read_b64_tr_b16 v[50:51], v3 offset:17408
    v_cvt_pk_bf16_f32 v217, v170, v171
    v_mfma_f32_16x16x32_bf16 v[136:139], v[56:59], a[168:171], v[136:139]
    buffer_load_dword v39, v35, s[24:27], s86 offen
    v_mfma_f32_16x16x32_bf16 v[140:143], v[56:59], a[172:175], v[140:143]
    s_mul_i32 s86, s4, 24
    v_rcp_f32 v96, v96
    v_mfma_f32_16x16x32_bf16 v[144:147], v[60:63], a[160:163], v[144:147]
    s_add_u32 s86, s86, s5
    ds_read_b64_tr_b16 v[52:53], v3 offset:24576
    v_mul_f32 v173, v173, v189
    v_mfma_f32_16x16x32_bf16 v[148:151], v[60:63], a[164:167], v[148:151]
    s_lshl2_add_u32 s86, s86, s6
    ds_read_b64_tr_b16 v[54:55], v3 offset:25600
    v_cvt_pk_bf16_f32 v220, v172, v173
    v_mfma_f32_16x16x32_bf16 v[152:155], v[60:63], a[168:171], v[152:155]
    s_min_u32 s86, s86, 179
    v_mul_f32 v190, v174, v190
    s_mul_i32 s87, s86, 3641
    v_mfma_f32_16x16x32_bf16 v[156:159], v[60:63], a[172:175], v[156:159]
    s_waitcnt lgkmcnt(2)
    v_mul_f32 v174, s56, v174
    s_lshr_b32 s87, s87, 16
    v_mfma_f32_16x16x32_bf16 v[128:131], v[40:43], a[176:179], v[128:131]
    s_add_u32 s87, s87, 1
    ds_read_b64_tr_b16 v[56:57], v3 offset:20480
    v_mul_f32 v96, v96, v112
    v_mfma_f32_16x16x32_bf16 v[132:135], v[40:43], a[180:183], v[132:135]
    s_min_u32 s87, s87, 8
    ds_read_b64_tr_b16 v[58:59], v3 offset:21504
    v_mul_f32 v113, v97, v113
    v_mfma_f32_16x16x32_bf16 v[136:139], v[40:43], a[184:187], v[136:139]
    s_lshl_b32 s86, s86, 12
    v_exp_f32 v174, v174
    v_mfma_f32_16x16x32_bf16 v[140:143], v[40:43], a[188:191], v[140:143]
    s_mul_i32 s87, s87, 73728
    v_add_f32 v174, 1.0, v174
    s_add_u32 s86, s86, s87
    v_mfma_f32_16x16x32_bf16 v[144:147], v[44:47], a[176:179], v[144:147]
    s_mul_i32 s87, s3, 1327104
    ds_read_b64_tr_b16 v[60:61], v3 offset:28672
    v_mul_f32 v97, s56, v97
    v_mfma_f32_16x16x32_bf16 v[148:151], v[44:47], a[180:183], v[148:151]
    s_add_u32 s86, s86, s87
    ds_read_b64_tr_b16 v[62:63], v3 offset:29696
    v_mul_f32 v100, s56, v100
    v_mfma_f32_16x16x32_bf16 v[152:155], v[44:47], a[184:187], v[152:155]
    s_mov_b32 s83, s86
    v_rcp_f32 v174, v174
    v_mfma_f32_16x16x32_bf16 v[156:159], v[44:47], a[188:191], v[156:159]
    s_lshl_b32 s87, s63, 1
    v_exp_f32 v97, v97
    v_mfma_f32_16x16x32_bf16 v[128:131], v[48:51], a[192:195], v[128:131]
    s_and_b32 s86, s6, 1
    ds_read_b64_tr_b16 v[40:41], v3 offset:32768
    v_and_b32 v37, 31, v0
    v_mfma_f32_16x16x32_bf16 v[132:135], v[48:51], a[196:199], v[132:135]
    s_add_u32 s87, s87, s86
    ds_read_b64_tr_b16 v[42:43], v3 offset:33792
    v_lshlrev_b32 v37, 7, v37
    v_mfma_f32_16x16x32_bf16 v[136:139], v[48:51], a[200:203], v[136:139]
    s_mov_b32 s32, s72
    v_exp_f32 v100, v100
    v_mfma_f32_16x16x32_bf16 v[140:143], v[48:51], a[204:207], v[140:143]
    s_waitcnt lgkmcnt(2)
    v_mul_f32 v174, v174, v190
    s_and_b32 s33, s73, 0xffff
    v_mfma_f32_16x16x32_bf16 v[144:147], v[52:55], a[192:195], v[144:147]
    s_mov_b32 s34, 1152
    ds_read_b64_tr_b16 v[44:45], v3 offset:40960
    v_mul_f32 v191, v175, v191
    v_mfma_f32_16x16x32_bf16 v[148:151], v[52:55], a[196:199], v[148:151]
    s_mov_b32 s36, s84
    ds_read_b64_tr_b16 v[46:47], v3 offset:41984
    v_mul_f32 v175, s56, v175
    v_mfma_f32_16x16x32_bf16 v[152:155], v[52:55], a[200:203], v[152:155]
    s_and_b32 s37, s85, 0xffff
    v_exp_f32 v175, v175
    v_mfma_f32_16x16x32_bf16 v[156:159], v[52:55], a[204:207], v[156:159]
    s_mov_b32 s38, 4718592
    v_add_f32 v175, 1.0, v175
    s_mov_b32 s39, 0x20000
    v_mfma_f32_16x16x32_bf16 v[128:131], v[56:59], a[208:211], v[128:131]
    s_lshr_b32 s86, s6, 1
    ds_read_b64_tr_b16 v[48:49], v3 offset:36864
    v_add_f32 v97, 1.0, v97
    v_mfma_f32_16x16x32_bf16 v[132:135], v[56:59], a[212:215], v[132:135]
    s_add_u32 s86, s86, s64
    ds_read_b64_tr_b16 v[50:51], v3 offset:37888
    v_add_f32 v100, 1.0, v100
    v_mfma_f32_16x16x32_bf16 v[136:139], v[56:59], a[216:219], v[136:139]
    s_add_u32 s86, s86, s64
    v_rcp_f32 v175, v175
    v_mfma_f32_16x16x32_bf16 v[140:143], v[56:59], a[220:223], v[140:143]
    s_mul_i32 s86, s86, 192
    v_rcp_f32 v97, v97
    v_mfma_f32_16x16x32_bf16 v[144:147], v[60:63], a[208:211], v[144:147]
    ds_read_b64_tr_b16 v[52:53], v3 offset:45056
    v_lshrrev_b32 v35, 4, v0
    v_mfma_f32_16x16x32_bf16 v[148:151], v[60:63], a[212:215], v[148:151]
    ds_read_b64_tr_b16 v[54:55], v3 offset:46080
    v_lshl_add_u32 v35, v35, 3, s86
    v_mfma_f32_16x16x32_bf16 v[152:155], v[60:63], a[216:219], v[152:155]
    v_rcp_f32 v100, v100
    v_mfma_f32_16x16x32_bf16 v[156:159], v[60:63], a[220:223], v[156:159]
    s_waitcnt lgkmcnt(2)
    v_bfe_u32 v18, v0, 2, 2
    v_lshlrev_b32 v18, 4, v18
    v_mfma_f32_16x16x32_bf16 v[128:131], v[40:43], a[224:227], v[128:131]
    ds_read_b64_tr_b16 v[56:57], v3 offset:49152
    v_and_b32 v19, 3, v0
    v_mfma_f32_16x16x32_bf16 v[132:135], v[40:43], a[228:231], v[132:135]
    s_lshl_b32 s86, s87, 4
    ds_read_b64_tr_b16 v[58:59], v3 offset:50176
    v_mul_f32 v175, v175, v191
    v_mfma_f32_16x16x32_bf16 v[136:139], v[40:43], a[232:235], v[136:139]
    s_add_u32 s86, s86, s3
    v_cvt_pk_bf16_f32 v221, v174, v175
    s_lshl_b32 s86, s86, 2
    v_mfma_f32_16x16x32_bf16 v[140:143], v[40:43], a[236:239], v[140:143]
    v_add3_u32 v18, v18, v19, s86
    v_mul_u32_u24 v19, 1152, v18
    v_mfma_f32_16x16x32_bf16 v[144:147], v[44:47], a[224:227], v[144:147]
    ds_read_b64_tr_b16 v[60:61], v3 offset:57344
    v_add_u32 v19, v19, v35
    v_mfma_f32_16x16x32_bf16 v[148:151], v[44:47], a[228:231], v[148:151]
    ds_read_b64_tr_b16 v[62:63], v3 offset:58368
    v_lshlrev_b32 v18, 2, v18
    v_mfma_f32_16x16x32_bf16 v[152:155], v[44:47], a[232:235], v[152:155]
    s_lshl_b32 s86, s87, 8
    v_mul_f32 v97, v97, v113
    s_add_u32 s86, s86, 23715968
    v_mfma_f32_16x16x32_bf16 v[156:159], v[44:47], a[236:239], v[156:159]
    v_cvt_pk_bf16_f32 v210, v96, v97
    v_mul_f32 v114, v98, v114
    v_mfma_f32_16x16x32_bf16 v[128:131], v[48:51], a[240:243], v[128:131]
    ds_read_b64_tr_b16 v[40:41], v3 offset:53248
    v_mul_f32 v98, s56, v98
    v_mfma_f32_16x16x32_bf16 v[132:135], v[48:51], a[244:247], v[132:135]
    ds_read_b64_tr_b16 v[42:43], v3 offset:54272
    v_mul_f32 v100, v100, v116
    v_mfma_f32_16x16x32_bf16 v[136:139], v[48:51], a[248:251], v[136:139]
    v_exp_f32 v98, v98
    v_mfma_f32_16x16x32_bf16 v[140:143], v[48:51], a[252:255], v[140:143]
    s_waitcnt lgkmcnt(2)
    v_add_f32 v98, 1.0, v98
    v_mul_f32 v117, v101, v117
    v_mfma_f32_16x16x32_bf16 v[144:147], v[52:55], a[240:243], v[144:147]
    ds_read_b64_tr_b16 v[44:45], v3 offset:61440
    v_mul_f32 v101, s56, v101
    v_mfma_f32_16x16x32_bf16 v[148:151], v[52:55], a[244:247], v[148:151]
    ds_read_b64_tr_b16 v[46:47], v3 offset:62464
    v_mul_f32 v120, v104, v120
    v_mfma_f32_16x16x32_bf16 v[152:155], v[52:55], a[248:251], v[152:155]
    v_rcp_f32 v98, v98
    v_mfma_f32_16x16x32_bf16 v[156:159], v[52:55], a[252:255], v[156:159]
    v_exp_f32 v101, v101
    v_mfma_f32_16x16x32_bf16 v[128:131], v[56:59], v[64:67], v[128:131]
    v_add_u32 v3, 0x10000, v3
    v_mul_f32 v98, v98, v114
    v_mfma_f32_16x16x32_bf16 v[132:135], v[56:59], v[68:71], v[132:135]
    ds_read_b64_tr_b16 v[48:49], v3 offset:0
    v_mul_f32 v115, v99, v115
    v_mfma_f32_16x16x32_bf16 v[136:139], v[56:59], v[72:75], v[136:139]
    ds_read_b64_tr_b16 v[50:51], v3 offset:1024
    v_mul_f32 v99, s56, v99
    v_mfma_f32_16x16x32_bf16 v[140:143], v[56:59], v[76:79], v[140:143]
    v_exp_f32 v99, v99
    v_mfma_f32_16x16x32_bf16 v[144:147], v[60:63], v[64:67], v[144:147]
    ds_read_b64_tr_b16 v[52:53], v3 offset:8192
    v_add_f32 v99, 1.0, v99
    v_mfma_f32_16x16x32_bf16 v[148:151], v[60:63], v[68:71], v[148:151]
    ds_read_b64_tr_b16 v[54:55], v3 offset:9216
    v_add_f32 v101, 1.0, v101
    v_mfma_f32_16x16x32_bf16 v[152:155], v[60:63], v[72:75], v[152:155]
    v_rcp_f32 v99, v99
    v_mfma_f32_16x16x32_bf16 v[156:159], v[60:63], v[76:79], v[156:159]
    s_waitcnt lgkmcnt(3)
    v_rcp_f32 v101, v101
    v_mfma_f32_16x16x32_bf16 v[128:131], v[40:43], v[80:83], v[128:131]
    ds_read_b64_tr_b16 v[56:57], v3 offset:4096
    v_mul_f32 v99, v99, v115
    v_mfma_f32_16x16x32_bf16 v[132:135], v[40:43], v[84:87], v[132:135]
    ds_read_b64_tr_b16 v[58:59], v3 offset:5120
    v_cvt_pk_bf16_f32 v211, v98, v99
    v_mfma_f32_16x16x32_bf16 v[136:139], v[40:43], v[88:91], v[136:139]
    v_mul_f32 v101, v101, v117
    v_cvt_pk_bf16_f32 v214, v100, v101
    v_mfma_f32_16x16x32_bf16 v[140:143], v[40:43], v[92:95], v[140:143]
    v_mul_f32 v118, v102, v118
    v_mul_f32 v102, s56, v102
    v_mfma_f32_16x16x32_bf16 v[144:147], v[44:47], v[80:83], v[144:147]
    ds_read_b64_tr_b16 v[60:61], v3 offset:12288
    v_mul_f32 v104, s56, v104
    v_mfma_f32_16x16x32_bf16 v[148:151], v[44:47], v[84:87], v[148:151]
    ds_read_b64_tr_b16 v[62:63], v3 offset:13312
    v_mul_f32 v124, v108, v124
    v_mfma_f32_16x16x32_bf16 v[152:155], v[44:47], v[88:91], v[152:155]
    v_exp_f32 v102, v102
    v_mfma_f32_16x16x32_bf16 v[156:159], v[44:47], v[92:95], v[156:159]
    s_waitcnt lgkmcnt(2)
    v_exp_f32 v104, v104
    v_mfma_f32_16x16x32_bf16 v[128:131], v[48:51], a[128:131], v[128:131]
    v_xor_b32 v4, 64, v4
    v_add_f32 v102, 1.0, v102
    v_mfma_f32_16x16x32_bf16 v[132:135], v[48:51], a[132:135], v[132:135]
    v_add_u32 v4, 0xffff0000, v4
    v_add_f32 v104, 1.0, v104
    v_mfma_f32_16x16x32_bf16 v[136:139], v[48:51], a[136:139], v[136:139]
    ds_read_b64_tr_b16 v[40:41], v4 offset:0
    v_mul_f32 v108, s56, v108
    v_mfma_f32_16x16x32_bf16 v[140:143], v[48:51], a[140:143], v[140:143]
    ds_read_b64_tr_b16 v[42:43], v4 offset:1024
    v_mul_f32 v30, v8, v28
    v_mfma_f32_16x16x32_bf16 v[144:147], v[52:55], a[128:131], v[144:147]
    ds_read_b64_tr_b16 v[44:45], v4 offset:8192
    v_mul_f32 v31, v8, v29
    v_mfma_f32_16x16x32_bf16 v[148:151], v[52:55], a[132:135], v[148:151]
    ds_read_b64_tr_b16 v[46:47], v4 offset:9216
    v_fma_f32 v30, -v9, v29, v30
    v_mfma_f32_16x16x32_bf16 v[152:155], v[52:55], a[136:139], v[152:155]
    v_rcp_f32 v102, v102
    v_mfma_f32_16x16x32_bf16 v[156:159], v[52:55], a[140:143], v[156:159]
    v_rcp_f32 v104, v104
    v_mfma_f32_16x16x32_bf16 v[128:131], v[56:59], a[144:147], v[128:131]
    ds_read_b64_tr_b16 v[48:49], v4 offset:4096
    v_mul_f32 v102, v102, v118
    v_mfma_f32_16x16x32_bf16 v[132:135], v[56:59], a[148:151], v[132:135]
    ds_read_b64_tr_b16 v[50:51], v4 offset:5120
    v_mul_f32 v119, v103, v119
    v_mfma_f32_16x16x32_bf16 v[136:139], v[56:59], a[152:155], v[136:139]
    v_exp_f32 v108, v108
    v_mfma_f32_16x16x32_bf16 v[140:143], v[56:59], a[156:159], v[140:143]
    s_waitcnt lgkmcnt(2)
    v_mul_f32 v103, s56, v103
    v_mul_f32 v104, v104, v120
    v_mfma_f32_16x16x32_bf16 v[144:147], v[60:63], a[144:147], v[144:147]
    ds_read_b64_tr_b16 v[52:53], v4 offset:12288
    v_mul_f32 v121, v105, v121
    v_mfma_f32_16x16x32_bf16 v[148:151], v[60:63], a[148:151], v[148:151]
    ds_read_b64_tr_b16 v[54:55], v4 offset:13312
    v_mul_f32 v105, s56, v105
    v_mfma_f32_16x16x32_bf16 v[152:155], v[60:63], a[152:155], v[152:155]
    v_exp_f32 v103, v103
    v_mfma_f32_16x16x32_bf16 v[156:159], v[60:63], a[156:159], v[156:159]
    v_exp_f32 v105, v105
    v_mfma_f32_16x16x32_bf16 v[160:163], v[40:43], a[0:3], 0
    ds_read_b64_tr_b16 v[56:57], v4 offset:16384
    v_add_f32 v103, 1.0, v103
    v_mfma_f32_16x16x32_bf16 v[164:167], v[40:43], a[4:7], 0
    ds_read_b64_tr_b16 v[58:59], v4 offset:17408
    v_add_f32 v105, 1.0, v105
    v_mfma_f32_16x16x32_bf16 v[168:171], v[40:43], a[8:11], 0
    v_rcp_f32 v103, v103
    v_mfma_f32_16x16x32_bf16 v[172:175], v[40:43], a[12:15], 0
    v_rcp_f32 v105, v105
    v_mfma_f32_16x16x32_bf16 v[176:179], v[44:47], a[0:3], 0
    ds_read_b64_tr_b16 v[60:61], v4 offset:24576
    v_mul_f32 v103, v103, v119
    v_mfma_f32_16x16x32_bf16 v[180:183], v[44:47], a[4:7], 0
    ds_read_b64_tr_b16 v[62:63], v4 offset:25600
    v_cvt_pk_bf16_f32 v215, v102, v103
    v_mfma_f32_16x16x32_bf16 v[184:187], v[44:47], a[8:11], 0
    v_mul_f32 v105, v105, v121
    v_cvt_pk_bf16_f32 v218, v104, v105
    v_mfma_f32_16x16x32_bf16 v[188:191], v[44:47], a[12:15], 0
    s_waitcnt lgkmcnt(2)
    v_mul_f32 v122, v106, v122
    v_mul_f32 v106, s56, v106
    v_mfma_f32_16x16x32_bf16 v[160:163], v[48:51], a[16:19], v[160:163]
    ds_read_b64_tr_b16 v[40:41], v4 offset:20480
    v_add_f32 v108, 1.0, v108
    v_mfma_f32_16x16x32_bf16 v[164:167], v[48:51], a[20:23], v[164:167]
    ds_read_b64_tr_b16 v[42:43], v4 offset:21504
    v_mul_f32 v144, v128, v144
    v_mfma_f32_16x16x32_bf16 v[168:171], v[48:51], a[24:27], v[168:171]
    v_exp_f32 v106, v106
    v_mfma_f32_16x16x32_bf16 v[172:175], v[48:51], a[28:31], v[172:175]
    v_rcp_f32 v108, v108
    v_mfma_f32_16x16x32_bf16 v[176:179], v[52:55], a[16:19], v[176:179]
    ds_read_b64_tr_b16 v[44:45], v4 offset:28672
    v_add_f32 v106, 1.0, v106
    v_mfma_f32_16x16x32_bf16 v[180:183], v[52:55], a[20:23], v[180:183]
    ds_read_b64_tr_b16 v[46:47], v4 offset:29696
    v_mul_f32 v108, v108, v124
    v_mfma_f32_16x16x32_bf16 v[184:187], v[52:55], a[24:27], v[184:187]
    v_rcp_f32 v106, v106
    v_mfma_f32_16x16x32_bf16 v[188:191], v[52:55], a[28:31], v[188:191]
    v_mul_f32 v106, v106, v122
    v_mul_f32 v123, v107, v123
    v_mfma_f32_16x16x32_bf16 v[160:163], v[56:59], a[32:35], v[160:163]
    ds_read_b64_tr_b16 v[48:49], v4 offset:32768
    v_mul_f32 v107, s56, v107
    v_mfma_f32_16x16x32_bf16 v[164:167], v[56:59], a[36:39], v[164:167]
    ds_read_b64_tr_b16 v[50:51], v4 offset:33792
    v_mul_f32 v125, v109, v125
    v_mfma_f32_16x16x32_bf16 v[168:171], v[56:59], a[40:43], v[168:171]
    v_exp_f32 v107, v107
    v_mfma_f32_16x16x32_bf16 v[172:175], v[56:59], a[44:47], v[172:175]
    s_waitcnt lgkmcnt(2)
    v_add_f32 v107, 1.0, v107
    v_mul_f32 v109, s56, v109
    v_mfma_f32_16x16x32_bf16 v[176:179], v[60:63], a[32:35], v[176:179]
    ds_read_b64_tr_b16 v[52:53], v4 offset:40960
    v_mul_f32 v128, s56, v128
    v_mfma_f32_16x16x32_bf16 v[180:183], v[60:63], a[36:39], v[180:183]
    ds_read_b64_tr_b16 v[54:55], v4 offset:41984
    v_mul_f32 v148, v132, v148
    v_mfma_f32_16x16x32_bf16 v[184:187], v[60:63], a[40:43], v[184:187]
    v_rcp_f32 v107, v107
    v_mfma_f32_16x16x32_bf16 v[188:191], v[60:63], a[44:47], v[188:191]
    v_exp_f32 v109, v109
    v_mfma_f32_16x16x32_bf16 v[160:163], v[40:43], a[48:51], v[160:163]
    ds_read_b64_tr_b16 v[56:57], v4 offset:36864
    v_mul_f32 v107, v107, v123
    v_mfma_f32_16x16x32_bf16 v[164:167], v[40:43], a[52:55], v[164:167]
    ds_read_b64_tr_b16 v[58:59], v4 offset:37888
    v_cvt_pk_bf16_f32 v219, v106, v107
    v_mfma_f32_16x16x32_bf16 v[168:171], v[40:43], a[56:59], v[168:171]
    v_exp_f32 v128, v128
    v_mfma_f32_16x16x32_bf16 v[172:175], v[40:43], a[60:63], v[172:175]
    v_add_f32 v109, 1.0, v109
    v_add_f32 v128, 1.0, v128
    v_mfma_f32_16x16x32_bf16 v[176:179], v[44:47], a[48:51], v[176:179]
    ds_read_b64_tr_b16 v[60:61], v4 offset:45056
    v_mul_f32 v132, s56, v132
    v_mfma_f32_16x16x32_bf16 v[180:183], v[44:47], a[52:55], v[180:183]
    ds_read_b64_tr_b16 v[62:63], v4 offset:46080
    v_mul_f32 v152, v136, v152
    v_mfma_f32_16x16x32_bf16 v[184:187], v[44:47], a[56:59], v[184:187]
    v_rcp_f32 v109, v109
    v_mfma_f32_16x16x32_bf16 v[188:191], v[44:47], a[60:63], v[188:191]
    s_waitcnt lgkmcnt(2)
    s_barrier
    v_mul_f32 v109, v109, v125
    v_mfma_f32_16x16x32_bf16 v[160:163], v[48:51], a[64:67], v[160:163]
    s_lshl1_add_u32 m0, s74, 0
    ds_read_b64_tr_b16 v[40:41], v4 offset:49152
    v_cvt_pk_bf16_f32 v222, v108, v109
    v_mfma_f32_16x16x32_bf16 v[164:167], v[48:51], a[68:71], v[164:167]
    buffer_load_dwordx4 v2, s[12:15], s40 offen  lds
    v_mfma_f32_16x16x32_bf16 v[168:171], v[48:51], a[72:75], v[168:171]
    ds_read_b64_tr_b16 v[42:43], v4 offset:50176
    v_mul_f32 v126, v110, v126
    v_mfma_f32_16x16x32_bf16 v[172:175], v[48:51], a[76:79], v[172:175]
    v_rcp_f32 v128, v128
    v_mfma_f32_16x16x32_bf16 v[176:179], v[52:55], a[64:67], v[176:179]
    ds_read_b64_tr_b16 v[44:45], v4 offset:57344
    v_mul_f32 v110, s56, v110
    v_mfma_f32_16x16x32_bf16 v[180:183], v[52:55], a[68:71], v[180:183]
    buffer_load_dwordx4 v2, s[12:15], vcc_lo offen offset:1024  lds
    v_mfma_f32_16x16x32_bf16 v[184:187], v[52:55], a[72:75], v[184:187]
    s_lshl1_add_u32 m0, s74, 8192
    ds_read_b64_tr_b16 v[46:47], v4 offset:58368
    v_mul_f32 v128, v128, v144
    v_mfma_f32_16x16x32_bf16 v[188:191], v[52:55], a[76:79], v[188:191]
    v_exp_f32 v110, v110
    v_mfma_f32_16x16x32_bf16 v[160:163], v[56:59], a[80:83], v[160:163]
    ds_read_b64_tr_b16 v[48:49], v4 offset:53248
    v_add_f32 v110, 1.0, v110
    v_mfma_f32_16x16x32_bf16 v[164:167], v[56:59], a[84:87], v[164:167]
    buffer_load_dwordx4 v2, s[16:19], s40 offen  lds
    v_mfma_f32_16x16x32_bf16 v[168:171], v[56:59], a[88:91], v[168:171]
    ds_read_b64_tr_b16 v[50:51], v4 offset:54272
    v_mul_f32 v145, v129, v145
    v_mfma_f32_16x16x32_bf16 v[172:175], v[56:59], a[92:95], v[172:175]
    s_waitcnt lgkmcnt(3)
    v_rcp_f32 v110, v110
    v_mfma_f32_16x16x32_bf16 v[176:179], v[60:63], a[80:83], v[176:179]
    ds_read_b64_tr_b16 v[52:53], v4 offset:61440
    v_mul_f32 v110, v110, v126
    v_mfma_f32_16x16x32_bf16 v[180:183], v[60:63], a[84:87], v[180:183]
    buffer_load_dwordx4 v2, s[16:19], vcc_lo offen offset:1024  lds
    v_mfma_f32_16x16x32_bf16 v[184:187], v[60:63], a[88:91], v[184:187]
    s_add_u32 vcc_lo, s41, 35840
    ds_read_b64_tr_b16 v[54:55], v4 offset:62464
    v_mul_f32 v127, v111, v127
    v_mfma_f32_16x16x32_bf16 v[188:191], v[60:63], a[92:95], v[188:191]
    s_lshl1_add_u32 m0, s74, 16384
    v_exp_f32 v132, v132
    v_mfma_f32_16x16x32_bf16 v[160:163], v[40:43], a[96:99], v[160:163]
    v_add_u32 v4, 0x10000, v4
    v_mul_f32 v111, s56, v111
    v_mfma_f32_16x16x32_bf16 v[164:167], v[40:43], a[100:103], v[164:167]
    s_branch gated_mix__ssm_conv_s5__swiglu_ffn__prompt_kernel_A_sk3
.p2align 12
gated_mix__ssm_conv_s5__swiglu_ffn__prompt_kernel_A_pg2_3:
    s_branch gated_mix__ssm_conv_s5__swiglu_ffn__prompt_kernel_A_pr2
gated_mix__ssm_conv_s5__swiglu_ffn__prompt_kernel_A_sk3:
    buffer_load_dwordx4 v2, s[12:15], s41 offen  lds
    v_mfma_f32_16x16x32_bf16 v[168:171], v[40:43], a[104:107], v[168:171]
    ds_read_b64_tr_b16 v[56:57], v4 offset:0
    v_mul_f32 v129, s56, v129
    v_mfma_f32_16x16x32_bf16 v[172:175], v[40:43], a[108:111], v[172:175]
    s_waitcnt lgkmcnt(2)
    ds_read_b64_tr_b16 v[58:59], v4 offset:1024
    v_add_f32 v132, 1.0, v132
    v_mfma_f32_16x16x32_bf16 v[176:179], v[44:47], a[96:99], v[176:179]
    ds_read_b64_tr_b16 v[60:61], v4 offset:8192
    v_mul_f32 v136, s56, v136
    v_mfma_f32_16x16x32_bf16 v[180:183], v[44:47], a[100:103], v[180:183]
    buffer_load_dwordx4 v2, s[12:15], vcc_lo offen offset:1024  lds
    v_mfma_f32_16x16x32_bf16 v[184:187], v[44:47], a[104:107], v[184:187]
    s_lshl1_add_u32 m0, s74, 24576
    ds_read_b64_tr_b16 v[62:63], v4 offset:9216
    v_mul_f32 v156, v140, v156
    v_mfma_f32_16x16x32_bf16 v[188:191], v[44:47], a[108:111], v[188:191]
    v_exp_f32 v111, v111
    v_mfma_f32_16x16x32_bf16 v[160:163], v[48:51], a[112:115], v[160:163]
    ds_read_b64_tr_b16 v[40:41], v4 offset:4096
    v_add_f32 v111, 1.0, v111
    v_mfma_f32_16x16x32_bf16 v[164:167], v[48:51], a[116:119], v[164:167]
    buffer_load_dwordx4 v2, s[16:19], s41 offen  lds
    v_mfma_f32_16x16x32_bf16 v[168:171], v[48:51], a[120:123], v[168:171]
    ds_read_b64_tr_b16 v[42:43], v4 offset:5120
    v_mul_f32 v140, s56, v140
    v_mfma_f32_16x16x32_bf16 v[172:175], v[48:51], a[124:127], v[172:175]
    s_waitcnt lgkmcnt(3)
    v_rcp_f32 v111, v111
    v_mfma_f32_16x16x32_bf16 v[176:179], v[52:55], a[112:115], v[176:179]
    ds_read_b64_tr_b16 v[44:45], v4 offset:12288
    v_mul_f32 v111, v111, v127
    v_mfma_f32_16x16x32_bf16 v[180:183], v[52:55], a[116:119], v[180:183]
    buffer_load_dwordx4 v2, s[16:19], vcc_lo offen offset:1024  lds
    v_mfma_f32_16x16x32_bf16 v[184:187], v[52:55], a[120:123], v[184:187]
    s_add_u32 vcc_lo, s42, 35840
    ds_read_b64_tr_b16 v[46:47], v4 offset:13312
    v_cvt_pk_bf16_f32 v223, v110, v111
    v_mfma_f32_16x16x32_bf16 v[188:191], v[52:55], a[124:127], v[188:191]
    s_waitcnt lgkmcnt(3)
    s_barrier
    v_fmac_f32 v31, v9, v28
    v_mfma_f32_16x16x32_bf16 v[160:163], v[56:59], a[160:163], v[160:163]
    s_lshl1_add_u32 m0, s74, 32768
    ds_read_b64_tr_b16 v[48:49], v4 offset:16384
    v_fma_f32 v32, v10, v224, v30
    v_mfma_f32_16x16x32_bf16 v[164:167], v[56:59], a[164:167], v[164:167]
    ds_read_b64_tr_b16 v[50:51], v4 offset:17408
    v_fma_f32 v32, -v11, v240, v32
    v_mfma_f32_16x16x32_bf16 v[168:171], v[56:59], a[168:171], v[168:171]
    v_exp_f32 v129, v129
    v_mfma_f32_16x16x32_bf16 v[172:175], v[56:59], a[172:175], v[172:175]
    v_rcp_f32 v132, v132
    v_mfma_f32_16x16x32_bf16 v[176:179], v[60:63], a[160:163], v[176:179]
    ds_read_b64_tr_b16 v[52:53], v4 offset:24576
    v_add_f32 v129, 1.0, v129
    v_mfma_f32_16x16x32_bf16 v[180:183], v[60:63], a[164:167], v[180:183]
    ds_read_b64_tr_b16 v[54:55], v4 offset:25600
    v_mul_f32 v132, v132, v148
    v_mfma_f32_16x16x32_bf16 v[184:187], v[60:63], a[168:171], v[184:187]
    v_rcp_f32 v129, v129
    v_mfma_f32_16x16x32_bf16 v[188:191], v[60:63], a[172:175], v[188:191]
    s_waitcnt lgkmcnt(2)
    v_exp_f32 v136, v136
    v_mfma_f32_16x16x32_bf16 v[160:163], v[40:43], a[176:179], v[160:163]
    ds_read_b64_tr_b16 v[56:57], v4 offset:20480
    v_mul_f32 v129, v129, v145
    v_mfma_f32_16x16x32_bf16 v[164:167], v[40:43], a[180:183], v[164:167]
    buffer_store_dwordx4 v[208:211], v5, s[20:23], s75 offen offset:0 sc1
    v_mfma_f32_16x16x32_bf16 v[168:171], v[40:43], a[184:187], v[168:171]
    ds_read_b64_tr_b16 v[58:59], v4 offset:21504
    v_cvt_pk_bf16_f32 v208, v128, v129
    v_mfma_f32_16x16x32_bf16 v[172:175], v[40:43], a[188:191], v[172:175]
    v_exp_f32 v140, v140
    v_mfma_f32_16x16x32_bf16 v[176:179], v[44:47], a[176:179], v[176:179]
    ds_read_b64_tr_b16 v[60:61], v4 offset:28672
    v_mul_f32 v146, v130, v146
    v_mfma_f32_16x16x32_bf16 v[180:183], v[44:47], a[180:183], v[180:183]
    buffer_store_dwordx4 v[212:215], v5, s[20:23], s75 offen offset:1024 sc1
    v_mfma_f32_16x16x32_bf16 v[184:187], v[44:47], a[184:187], v[184:187]
    ds_read_b64_tr_b16 v[62:63], v4 offset:29696
    v_mul_f32 v130, s56, v130
    v_mfma_f32_16x16x32_bf16 v[188:191], v[44:47], a[188:191], v[188:191]
    v_exp_f32 v130, v130
    v_mfma_f32_16x16x32_bf16 v[160:163], v[48:51], a[192:195], v[160:163]
    ds_read_b64_tr_b16 v[40:41], v4 offset:32768
    v_add_f32 v130, 1.0, v130
    v_mfma_f32_16x16x32_bf16 v[164:167], v[48:51], a[196:199], v[164:167]
    buffer_store_dwordx4 v[216:219], v5, s[20:23], s75 offen offset:2048 sc1
    v_mfma_f32_16x16x32_bf16 v[168:171], v[48:51], a[200:203], v[168:171]
    ds_read_b64_tr_b16 v[42:43], v4 offset:33792
    v_mul_f32 v149, v133, v149
    v_mfma_f32_16x16x32_bf16 v[172:175], v[48:51], a[204:207], v[172:175]
    s_waitcnt lgkmcnt(3)
    v_rcp_f32 v130, v130
    v_mfma_f32_16x16x32_bf16 v[176:179], v[52:55], a[192:195], v[176:179]
    ds_read_b64_tr_b16 v[44:45], v4 offset:40960
    v_mul_f32 v130, v130, v146
    v_mfma_f32_16x16x32_bf16 v[180:183], v[52:55], a[196:199], v[180:183]
    buffer_store_dwordx4 v[220:223], v5, s[20:23], s75 offen offset:3072 sc1
    v_mfma_f32_16x16x32_bf16 v[184:187], v[52:55], a[200:203], v[184:187]
    buffer_load_dwordx4 v2, s[12:15], s42 offen  lds
    v_mfma_f32_16x16x32_bf16 v[188:191], v[52:55], a[204:207], v[188:191]
    ds_read_b64_tr_b16 v[46:47], v4 offset:41984
    v_mul_f32 v147, v131, v147
    v_mfma_f32_16x16x32_bf16 v[160:163], v[56:59], a[208:211], v[160:163]
    ds_read_b64_tr_b16 v[48:49], v4 offset:36864
    v_mul_f32 v131, s56, v131
    v_mfma_f32_16x16x32_bf16 v[164:167], v[56:59], a[212:215], v[164:167]
    ds_read_b64_tr_b16 v[50:51], v4 offset:37888
    v_mul_f32 v133, s56, v133
    v_mfma_f32_16x16x32_bf16 v[168:171], v[56:59], a[216:219], v[168:171]
    buffer_load_dwordx4 v2, s[12:15], vcc_lo offen offset:1024  lds
    v_mfma_f32_16x16x32_bf16 v[172:175], v[56:59], a[220:223], v[172:175]
    s_waitcnt lgkmcnt(3)
    v_exp_f32 v131, v131
    v_mfma_f32_16x16x32_bf16 v[176:179], v[60:63], a[208:211], v[176:179]
    s_lshl1_add_u32 m0, s74, 40960
    ds_read_b64_tr_b16 v[52:53], v4 offset:45056
    v_add_f32 v131, 1.0, v131
    v_mfma_f32_16x16x32_bf16 v[180:183], v[60:63], a[212:215], v[180:183]
    ds_read_b64_tr_b16 v[54:55], v4 offset:46080
    v_add_f32 v136, 1.0, v136
    v_mfma_f32_16x16x32_bf16 v[184:187], v[60:63], a[216:219], v[184:187]
    buffer_load_dwordx4 v2, s[16:19], s42 offen  lds
    v_mfma_f32_16x16x32_bf16 v[188:191], v[60:63], a[220:223], v[188:191]
    s_waitcnt lgkmcnt(2)
    s_barrier
    v_add_f32 v140, 1.0, v140
    v_mfma_f32_16x16x32_bf16 v[160:163], v[40:43], a[224:227], v[160:163]
    ds_read_b64_tr_b16 v[56:57], v4 offset:49152
    v_fma_f32 v240, v10, v240, v31
    v_mfma_f32_16x16x32_bf16 v[164:167], v[40:43], a[228:231], v[164:167]
    ds_read_b64_tr_b16 v[58:59], v4 offset:50176
    v_fmac_f32 v240, v11, v224
    v_mfma_f32_16x16x32_bf16 v[168:171], v[40:43], a[232:235], v[168:171]
    buffer_load_dwordx4 v2, s[16:19], vcc_lo offen offset:1024  lds
    v_mfma_f32_16x16x32_bf16 v[172:175], v[40:43], a[236:239], v[172:175]
    s_add_u32 vcc_lo, s43, 35840
    v_rcp_f32 v131, v131
    v_mfma_f32_16x16x32_bf16 v[176:179], v[44:47], a[224:227], v[176:179]
    s_lshl1_add_u32 m0, s74, 49152
    ds_read_b64_tr_b16 v[60:61], v4 offset:57344
    v_mul_f32 v131, v131, v147
    v_mfma_f32_16x16x32_bf16 v[180:183], v[44:47], a[228:231], v[180:183]
    ds_read_b64_tr_b16 v[62:63], v4 offset:58368
    v_cvt_pk_bf16_f32 v209, v130, v131
    v_mfma_f32_16x16x32_bf16 v[184:187], v[44:47], a[232:235], v[184:187]
    v_exp_f32 v133, v133
    v_mfma_f32_16x16x32_bf16 v[188:191], v[44:47], a[236:239], v[188:191]
    v_rcp_f32 v136, v136
    v_mfma_f32_16x16x32_bf16 v[160:163], v[48:51], a[240:243], v[160:163]
    ds_read_b64_tr_b16 v[40:41], v4 offset:53248
    v_add_f32 v133, 1.0, v133
    v_mfma_f32_16x16x32_bf16 v[164:167], v[48:51], a[244:247], v[164:167]
    ds_read_b64_tr_b16 v[42:43], v4 offset:54272
    v_mul_f32 v136, v136, v152
    v_mfma_f32_16x16x32_bf16 v[168:171], v[48:51], a[248:251], v[168:171]
    v_rcp_f32 v133, v133
    v_mfma_f32_16x16x32_bf16 v[172:175], v[48:51], a[252:255], v[172:175]
    s_waitcnt lgkmcnt(2)
    v_rcp_f32 v140, v140
    v_mfma_f32_16x16x32_bf16 v[176:179], v[52:55], a[240:243], v[176:179]
    ds_read_b64_tr_b16 v[44:45], v4 offset:61440
    v_mul_f32 v133, v133, v149
    v_mfma_f32_16x16x32_bf16 v[180:183], v[52:55], a[244:247], v[180:183]
    ds_read_b64_tr_b16 v[46:47], v4 offset:62464
    v_cvt_pk_bf16_f32 v212, v132, v133
    v_mfma_f32_16x16x32_bf16 v[184:187], v[52:55], a[248:251], v[184:187]
    v_mul_f32 v150, v134, v150
    v_mul_f32 v134, s56, v134
    v_mfma_f32_16x16x32_bf16 v[188:191], v[52:55], a[252:255], v[188:191]
    v_exp_f32 v134, v134
    v_mfma_f32_16x16x32_bf16 v[160:163], v[56:59], v[64:67], v[160:163]
    v_add_u32 v4, 0x10000, v4
    v_add_f32 v134, 1.0, v134
    v_mfma_f32_16x16x32_bf16 v[164:167], v[56:59], v[68:71], v[164:167]
    ds_read_b64_tr_b16 v[48:49], v4 offset:0
    v_mul_f32 v153, v137, v153
    v_mfma_f32_16x16x32_bf16 v[168:171], v[56:59], v[72:75], v[168:171]
    ds_read_b64_tr_b16 v[50:51], v4 offset:1024
    v_mul_f32 v137, s56, v137
    v_mfma_f32_16x16x32_bf16 v[172:175], v[56:59], v[76:79], v[172:175]
    v_rcp_f32 v134, v134
    v_mfma_f32_16x16x32_bf16 v[176:179], v[60:63], v[64:67], v[176:179]
    ds_read_b64_tr_b16 v[52:53], v4 offset:8192
    v_mul_f32 v134, v134, v150
    v_mfma_f32_16x16x32_bf16 v[180:183], v[60:63], v[68:71], v[180:183]
    ds_read_b64_tr_b16 v[54:55], v4 offset:9216
    v_mul_f32 v151, v135, v151
    v_mfma_f32_16x16x32_bf16 v[184:187], v[60:63], v[72:75], v[184:187]
    v_exp_f32 v137, v137
    v_mfma_f32_16x16x32_bf16 v[188:191], v[60:63], v[76:79], v[188:191]
    s_waitcnt lgkmcnt(3)
    v_mul_f32 v135, s56, v135
    v_add_f32 v137, 1.0, v137
    v_mfma_f32_16x16x32_bf16 v[160:163], v[40:43], v[80:83], v[160:163]
    ds_read_b64_tr_b16 v[56:57], v4 offset:4096
    v_mul_f32 v140, v140, v156
    v_exp_f32 v135, v135
    v_mfma_f32_16x16x32_bf16 v[164:167], v[40:43], v[84:87], v[164:167]
    ds_read_b64_tr_b16 v[58:59], v4 offset:5120
    v_add_f32 v135, 1.0, v135
    v_mfma_f32_16x16x32_bf16 v[168:171], v[40:43], v[88:91], v[168:171]
    v_rcp_f32 v135, v135
    v_mfma_f32_16x16x32_bf16 v[172:175], v[40:43], v[92:95], v[172:175]
    buffer_load_dwordx4 v2, s[12:15], s43 offen  lds
    v_mfma_f32_16x16x32_bf16 v[176:179], v[44:47], v[80:83], v[176:179]
    ds_read_b64_tr_b16 v[60:61], v4 offset:12288
    v_mul_f32 v135, v135, v151
    v_mfma_f32_16x16x32_bf16 v[180:183], v[44:47], v[84:87], v[180:183]
    ds_read_b64_tr_b16 v[62:63], v4 offset:13312
    v_cvt_pk_bf16_f32 v213, v134, v135
    v_mfma_f32_16x16x32_bf16 v[184:187], v[44:47], v[88:91], v[184:187]
    v_rcp_f32 v137, v137
    s_nop 0
    v_mul_f32 v137, v137, v153
    v_mfma_f32_16x16x32_bf16 v[188:191], v[44:47], v[92:95], v[188:191]
    s_waitcnt vmcnt(13) lgkmcnt(2)
    s_barrier
    v_cvt_pk_bf16_f32 v216, v136, v137
    v_mfma_f32_16x16x32_bf16 v[160:163], v[48:51], a[128:131], v[160:163]
    buffer_load_dwordx4 v2, s[12:15], vcc_lo offen offset:1024  lds
    v_mfma_f32_16x16x32_bf16 v[164:167], v[48:51], a[132:135], v[164:167]
    s_lshl1_add_u32 m0, s74, 57344
    v_xor_b32 v3, 64, v3
    v_mul_f32 v154, v138, v154
    v_mfma_f32_16x16x32_bf16 v[168:171], v[48:51], a[136:139], v[168:171]
    v_add_u32 v3, 0xfffe0000, v3
    v_mul_f32 v138, s56, v138
    v_mfma_f32_16x16x32_bf16 v[172:175], v[48:51], a[140:143], v[172:175]
    ds_read_b64_tr_b16 v[40:41], v3 offset:0
    v_mul_f32 v157, v141, v157
    v_mfma_f32_16x16x32_bf16 v[176:179], v[52:55], a[128:131], v[176:179]
    buffer_load_dwordx4 v2, s[16:19], s43 offen  lds
    v_exp_f32 v138, v138
    v_mfma_f32_16x16x32_bf16 v[180:183], v[52:55], a[132:135], v[180:183]
    ds_read_b64_tr_b16 v[42:43], v3 offset:1024
    v_add_f32 v138, 1.0, v138
    v_mfma_f32_16x16x32_bf16 v[184:187], v[52:55], a[136:139], v[184:187]
    ds_read_b64_tr_b16 v[44:45], v3 offset:8192
    v_mul_f32 v141, s56, v141
    v_mfma_f32_16x16x32_bf16 v[188:191], v[52:55], a[140:143], v[188:191]
    ds_read_b64_tr_b16 v[46:47], v3 offset:9216
    v_mul_f32 v28, v8, v30
    v_mfma_f32_16x16x32_bf16 v[160:163], v[56:59], a[144:147], v[160:163]
    buffer_load_dwordx4 v2, s[16:19], vcc_lo offen offset:1024  lds
    v_mfma_f32_16x16x32_bf16 v[164:167], v[56:59], a[148:151], v[164:167]
    s_add_u32 vcc_lo, s44, 35840
    ds_read_b64_tr_b16 v[48:49], v3 offset:4096
    v_mul_f32 v29, v8, v31
    v_mfma_f32_16x16x32_bf16 v[168:171], v[56:59], a[152:155], v[168:171]
    s_lshl1_add_u32 m0, s74, 65536
    ds_read_b64_tr_b16 v[50:51], v3 offset:5120
    v_fma_f32 v28, -v9, v31, v28
    v_rcp_f32 v138, v138
    v_mfma_f32_16x16x32_bf16 v[172:175], v[56:59], a[156:159], v[172:175]
    s_waitcnt lgkmcnt(4)
    v_exp_f32 v141, v141
    v_mfma_f32_16x16x32_bf16 v[176:179], v[60:63], a[144:147], v[176:179]
    buffer_load_dwordx4 v2, s[12:15], s44 offen  lds
    v_mfma_f32_16x16x32_bf16 v[180:183], v[60:63], a[148:151], v[180:183]
    ds_read_b64_tr_b16 v[52:53], v3 offset:12288
    v_mul_f32 v138, v138, v154
    v_mfma_f32_16x16x32_bf16 v[184:187], v[60:63], a[152:155], v[184:187]
    ds_read_b64_tr_b16 v[54:55], v3 offset:13312
    v_mul_f32 v155, v139, v155
    v_mfma_f32_16x16x32_bf16 v[188:191], v[60:63], a[156:159], v[188:191]
    s_waitcnt vmcnt(13) lgkmcnt(3)
    s_barrier
    v_mul_f32 v139, s56, v139
    v_mfma_f32_16x16x32_bf16 v[96:99], v[40:43], a[0:3], 0
    buffer_load_dwordx4 v2, s[12:15], vcc_lo offen offset:1024  lds
    v_exp_f32 v139, v139
    v_mfma_f32_16x16x32_bf16 v[100:103], v[40:43], a[4:7], 0
    s_lshl1_add_u32 m0, s74, 73728
    ds_read_b64_tr_b16 v[56:57], v3 offset:16384
    v_add_f32 v139, 1.0, v139
    v_mfma_f32_16x16x32_bf16 v[104:107], v[40:43], a[8:11], 0
    ds_read_b64_tr_b16 v[58:59], v3 offset:17408
    v_add_f32 v141, 1.0, v141
    v_mfma_f32_16x16x32_bf16 v[108:111], v[40:43], a[12:15], 0
    v_rcp_f32 v139, v139
    v_mfma_f32_16x16x32_bf16 v[112:115], v[44:47], a[0:3], 0
    buffer_load_dwordx4 v2, s[16:19], s44 offen  lds
    v_mfma_f32_16x16x32_bf16 v[116:119], v[44:47], a[4:7], 0
    ds_read_b64_tr_b16 v[60:61], v3 offset:24576
    v_mul_f32 v139, v139, v155
    v_mfma_f32_16x16x32_bf16 v[120:123], v[44:47], a[8:11], 0
    ds_read_b64_tr_b16 v[62:63], v3 offset:25600
    v_cvt_pk_bf16_f32 v217, v138, v139
    v_rcp_f32 v141, v141
    v_mfma_f32_16x16x32_bf16 v[124:127], v[44:47], a[12:15], 0
    s_waitcnt lgkmcnt(3)
    v_mul_f32 v141, v141, v157
    v_cvt_pk_bf16_f32 v220, v140, v141
    v_mfma_f32_16x16x32_bf16 v[96:99], v[48:51], a[16:19], v[96:99]
    buffer_load_dwordx4 v2, s[16:19], vcc_lo offen offset:1024  lds
    v_mfma_f32_16x16x32_bf16 v[100:103], v[48:51], a[20:23], v[100:103]
    s_add_u32 vcc_lo, s45, 35840
    ds_read_b64_tr_b16 v[40:41], v3 offset:20480
    v_mul_f32 v158, v142, v158
    v_mfma_f32_16x16x32_bf16 v[104:107], v[48:51], a[24:27], v[104:107]
    s_lshl1_add_u32 m0, s74, 81920
    ds_read_b64_tr_b16 v[42:43], v3 offset:21504
    v_mul_f32 v142, s56, v142
    v_mfma_f32_16x16x32_bf16 v[108:111], v[48:51], a[28:31], v[108:111]
    s_waitcnt vmcnt(12)
    v_exp_f32 v142, v142
    v_mfma_f32_16x16x32_bf16 v[112:115], v[52:55], a[16:19], v[112:115]
    buffer_store_dword v4, v6, s[20:23], s61 offen offset:0 sc1
    v_add_f32 v142, 1.0, v142
    v_mfma_f32_16x16x32_bf16 v[116:119], v[52:55], a[20:23], v[116:119]
    buffer_load_dwordx4 v2, s[12:15], s45 offen  lds
    v_mfma_f32_16x16x32_bf16 v[120:123], v[52:55], a[24:27], v[120:123]
    ds_read_b64_tr_b16 v[44:45], v3 offset:28672
    v_fmac_f32 v29, v9, v30
    v_mfma_f32_16x16x32_bf16 v[124:127], v[52:55], a[28:31], v[124:127]
    s_waitcnt lgkmcnt(2)
    ds_read_b64_tr_b16 v[46:47], v3 offset:29696
    v_fma_f32 v33, v10, v225, v28
    v_mfma_f32_16x16x32_bf16 v[96:99], v[56:59], a[32:35], v[96:99]
    s_waitcnt vmcnt(10) lgkmcnt(2)
    s_barrier
    v_fma_f32 v33, -v11, v241, v33
    v_mfma_f32_16x16x32_bf16 v[100:103], v[56:59], a[36:39], v[100:103]
    buffer_load_dwordx4 v2, s[12:15], vcc_lo offen offset:1024  lds
    v_mfma_f32_16x16x32_bf16 v[104:107], v[56:59], a[40:43], v[104:107]
    s_lshl1_add_u32 m0, s74, 90112
    ds_read_b64_tr_b16 v[48:49], v3 offset:32768
    v_fma_f32 v241, v10, v241, v29
    v_rcp_f32 v142, v142
    v_mfma_f32_16x16x32_bf16 v[108:111], v[56:59], a[44:47], v[108:111]
    ds_read_b64_tr_b16 v[50:51], v3 offset:33792
    v_mul_f32 v142, v142, v158
    v_mfma_f32_16x16x32_bf16 v[112:115], v[60:63], a[32:35], v[112:115]
    ds_read_b64_tr_b16 v[52:53], v3 offset:40960
    v_mul_f32 v159, v143, v159
    v_mfma_f32_16x16x32_bf16 v[116:119], v[60:63], a[36:39], v[116:119]
    buffer_load_dwordx4 v2, s[16:19], s45 offen  lds
    v_mfma_f32_16x16x32_bf16 v[120:123], v[60:63], a[40:43], v[120:123]
    ds_read_b64_tr_b16 v[54:55], v3 offset:41984
    v_mul_f32 v143, s56, v143
    v_mfma_f32_16x16x32_bf16 v[124:127], v[60:63], a[44:47], v[124:127]
    v_exp_f32 v143, v143
    v_mfma_f32_16x16x32_bf16 v[96:99], v[40:43], a[48:51], v[96:99]
    ds_read_b64_tr_b16 v[56:57], v3 offset:36864
    v_add_f32 v143, 1.0, v143
    v_rcp_f32 v143, v143
    v_mfma_f32_16x16x32_bf16 v[100:103], v[40:43], a[52:55], v[100:103]
    buffer_load_dwordx4 v2, s[16:19], vcc_lo offen offset:1024  lds
    v_mfma_f32_16x16x32_bf16 v[104:107], v[40:43], a[56:59], v[104:107]
    s_add_u32 vcc_lo, s46, 35840
    ds_read_b64_tr_b16 v[58:59], v3 offset:37888
    v_mul_f32 v143, v143, v159
    v_mfma_f32_16x16x32_bf16 v[108:111], v[40:43], a[60:63], v[108:111]
    s_waitcnt lgkmcnt(3)
    v_cvt_pk_bf16_f32 v221, v142, v143
    s_lshl1_add_u32 m0, s74, 98304
    v_mfma_f32_16x16x32_bf16 v[112:115], v[44:47], a[48:51], v[112:115]
    ds_read_b64_tr_b16 v[60:61], v3 offset:45056
    v_fmac_f32 v241, v11, v225
    v_mfma_f32_16x16x32_bf16 v[116:119], v[44:47], a[52:55], v[116:119]
    buffer_load_dwordx4 v2, s[12:15], s46 offen  lds
    v_mfma_f32_16x16x32_bf16 v[120:123], v[44:47], a[56:59], v[120:123]
    ds_read_b64_tr_b16 v[62:63], v3 offset:46080
    v_cvt_pk_bf16_f32 v224, v32, v33
    v_cvt_pk_bf16_f32 v240, -v240, -v241
    v_mfma_f32_16x16x32_bf16 v[124:127], v[44:47], a[60:63], v[124:127]
    s_waitcnt vmcnt(10) lgkmcnt(3)
    s_barrier
    v_mul_f32 v30, v8, v28
    v_mfma_f32_16x16x32_bf16 v[96:99], v[48:51], a[64:67], v[96:99]
    ds_read_b64_tr_b16 v[40:41], v3 offset:49152
    v_mul_f32 v31, v8, v29
    v_mfma_f32_16x16x32_bf16 v[100:103], v[48:51], a[68:71], v[100:103]
    buffer_load_dwordx4 v2, s[12:15], vcc_lo offen offset:1024  lds
    v_mfma_f32_16x16x32_bf16 v[104:107], v[48:51], a[72:75], v[104:107]
    s_lshl1_add_u32 m0, s74, 106496
    ds_read_b64_tr_b16 v[42:43], v3 offset:50176
    v_fma_f32 v30, -v9, v29, v30
    v_mfma_f32_16x16x32_bf16 v[108:111], v[48:51], a[76:79], v[108:111]
    v_fmac_f32 v31, v9, v28
    v_fma_f32 v32, v10, v226, v30
    v_mfma_f32_16x16x32_bf16 v[112:115], v[52:55], a[64:67], v[112:115]
    ds_read_b64_tr_b16 v[44:45], v3 offset:57344
    v_fma_f32 v32, -v11, v242, v32
    v_fma_f32 v242, v10, v242, v31
    v_mfma_f32_16x16x32_bf16 v[116:119], v[52:55], a[68:71], v[116:119]
    buffer_load_dwordx4 v2, s[16:19], s46 offen  lds
    v_mfma_f32_16x16x32_bf16 v[120:123], v[52:55], a[72:75], v[120:123]
    ds_read_b64_tr_b16 v[46:47], v3 offset:58368
    v_fmac_f32 v242, v11, v226
    v_mfma_f32_16x16x32_bf16 v[124:127], v[52:55], a[76:79], v[124:127]
    s_waitcnt lgkmcnt(3)
    v_mul_f32 v28, v8, v30
    v_mul_f32 v29, v8, v31
    v_mfma_f32_16x16x32_bf16 v[96:99], v[56:59], a[80:83], v[96:99]
    ds_read_b64_tr_b16 v[48:49], v3 offset:53248
    v_fma_f32 v28, -v9, v31, v28
    v_mfma_f32_16x16x32_bf16 v[100:103], v[56:59], a[84:87], v[100:103]
    ds_read_b64_tr_b16 v[50:51], v3 offset:54272
    v_fmac_f32 v29, v9, v30
    v_mfma_f32_16x16x32_bf16 v[104:107], v[56:59], a[88:91], v[104:107]
    v_fma_f32 v33, v10, v227, v28
    v_fma_f32 v33, -v11, v243, v33
    v_fma_f32 v243, v10, v243, v29
    v_mfma_f32_16x16x32_bf16 v[108:111], v[56:59], a[92:95], v[108:111]
    v_fmac_f32 v243, v11, v227
    v_cvt_pk_bf16_f32 v225, v32, v33
    v_mfma_f32_16x16x32_bf16 v[112:115], v[60:63], a[80:83], v[112:115]
    ds_read_b64_tr_b16 v[52:53], v3 offset:61440
    v_cvt_pk_bf16_f32 v241, -v242, -v243
    v_mfma_f32_16x16x32_bf16 v[116:119], v[60:63], a[84:87], v[116:119]
    ds_read_b64_tr_b16 v[54:55], v3 offset:62464
    v_mul_f32 v30, v8, v28
    v_mfma_f32_16x16x32_bf16 v[120:123], v[60:63], a[88:91], v[120:123]
    v_mul_f32 v31, v8, v29
    v_fma_f32 v30, -v9, v29, v30
    v_mfma_f32_16x16x32_bf16 v[124:127], v[60:63], a[92:95], v[124:127]
    s_waitcnt lgkmcnt(2)
    v_fmac_f32 v31, v9, v28
    v_fma_f32 v32, v10, v228, v30
    v_mfma_f32_16x16x32_bf16 v[96:99], v[40:43], a[96:99], v[96:99]
    v_xor_b32 v4, 64, v4
    v_fma_f32 v32, -v11, v244, v32
    v_fma_f32 v244, v10, v244, v31
    v_mfma_f32_16x16x32_bf16 v[100:103], v[40:43], a[100:103], v[100:103]
    v_add_u32 v4, 0xfffe0000, v4
    v_fmac_f32 v244, v11, v228
    v_mfma_f32_16x16x32_bf16 v[104:107], v[40:43], a[104:107], v[104:107]
    ds_read_b64_tr_b16 v[56:57], v4 offset:0
    v_mul_f32 v28, v8, v30
    v_mfma_f32_16x16x32_bf16 v[108:111], v[40:43], a[108:111], v[108:111]
    ds_read_b64_tr_b16 v[58:59], v4 offset:1024
    v_mul_f32 v29, v8, v31
    v_mfma_f32_16x16x32_bf16 v[112:115], v[44:47], a[96:99], v[112:115]
    ds_read_b64_tr_b16 v[60:61], v4 offset:8192
    v_fma_f32 v28, -v9, v31, v28
    v_mfma_f32_16x16x32_bf16 v[116:119], v[44:47], a[100:103], v[116:119]
    ds_read_b64_tr_b16 v[62:63], v4 offset:9216
    v_fmac_f32 v29, v9, v30
    v_mfma_f32_16x16x32_bf16 v[120:123], v[44:47], a[104:107], v[120:123]
    v_fma_f32 v33, v10, v229, v28
    v_fma_f32 v33, -v11, v245, v33
    v_fma_f32 v245, v10, v245, v29
    v_mfma_f32_16x16x32_bf16 v[124:127], v[44:47], a[108:111], v[124:127]
    v_fmac_f32 v245, v11, v229
    v_cvt_pk_bf16_f32 v226, v32, v33
    v_mfma_f32_16x16x32_bf16 v[96:99], v[48:51], a[112:115], v[96:99]
    ds_read_b64_tr_b16 v[40:41], v4 offset:4096
    v_cvt_pk_bf16_f32 v242, -v244, -v245
    v_mfma_f32_16x16x32_bf16 v[100:103], v[48:51], a[116:119], v[100:103]
    ds_read_b64_tr_b16 v[42:43], v4 offset:5120
    v_mul_f32 v30, v8, v28
    v_mfma_f32_16x16x32_bf16 v[104:107], v[48:51], a[120:123], v[104:107]
    v_mul_f32 v31, v8, v29
    v_fma_f32 v30, -v9, v29, v30
    v_mfma_f32_16x16x32_bf16 v[108:111], v[48:51], a[124:127], v[108:111]
    s_waitcnt lgkmcnt(2)
    v_fmac_f32 v31, v9, v28
    v_fma_f32 v32, v10, v230, v30
    v_mfma_f32_16x16x32_bf16 v[112:115], v[52:55], a[112:115], v[112:115]
    ds_read_b64_tr_b16 v[44:45], v4 offset:12288
    v_fma_f32 v32, -v11, v246, v32
    v_fma_f32 v246, v10, v246, v31
    v_mfma_f32_16x16x32_bf16 v[116:119], v[52:55], a[116:119], v[116:119]
    ds_read_b64_tr_b16 v[46:47], v4 offset:13312
    v_fmac_f32 v246, v11, v230
    v_mfma_f32_16x16x32_bf16 v[120:123], v[52:55], a[120:123], v[120:123]
    buffer_load_dwordx4 v2, s[16:19], vcc_lo offen offset:1024  lds
    v_mfma_f32_16x16x32_bf16 v[124:127], v[52:55], a[124:127], v[124:127]
    s_add_u32 vcc_lo, s47, 35840
    v_mul_f32 v28, v8, v30
    s_lshl1_add_u32 m0, s74, 114688
    v_mfma_f32_16x16x32_bf16 v[128:131], v[56:59], a[0:3], 0
    ds_read_b64_tr_b16 v[48:49], v4 offset:16384
    v_mul_f32 v29, v8, v31
    v_mfma_f32_16x16x32_bf16 v[132:135], v[56:59], a[4:7], 0
    ds_read_b64_tr_b16 v[50:51], v4 offset:17408
    v_fma_f32 v28, -v9, v31, v28
    v_mfma_f32_16x16x32_bf16 v[136:139], v[56:59], a[8:11], 0
    buffer_load_dwordx4 v2, s[12:15], s47 offen  lds
    v_fmac_f32 v29, v9, v30
    v_mfma_f32_16x16x32_bf16 v[140:143], v[56:59], a[12:15], 0
    v_fma_f32 v33, v10, v231, v28
    v_fma_f32 v33, -v11, v247, v33
    v_mfma_f32_16x16x32_bf16 v[144:147], v[60:63], a[0:3], 0
    ds_read_b64_tr_b16 v[52:53], v4 offset:24576
    v_fma_f32 v247, v10, v247, v29
    v_mfma_f32_16x16x32_bf16 v[148:151], v[60:63], a[4:7], 0
    ds_read_b64_tr_b16 v[54:55], v4 offset:25600
    v_fmac_f32 v247, v11, v231
    v_mfma_f32_16x16x32_bf16 v[152:155], v[60:63], a[8:11], 0
    buffer_load_dwordx4 v2, s[12:15], vcc_lo offen offset:1024  lds
    v_mfma_f32_16x16x32_bf16 v[156:159], v[60:63], a[12:15], 0
    s_waitcnt lgkmcnt(2)
    v_cvt_pk_bf16_f32 v227, v32, v33
    s_lshl1_add_u32 m0, s74, 122880
    v_mfma_f32_16x16x32_bf16 v[128:131], v[40:43], a[16:19], v[128:131]
    ds_read_b64_tr_b16 v[56:57], v4 offset:20480
    v_cvt_pk_bf16_f32 v243, -v246, -v247
    v_mul_f32 v30, v8, v28
    v_mfma_f32_16x16x32_bf16 v[132:135], v[40:43], a[20:23], v[132:135]
    ds_read_b64_tr_b16 v[58:59], v4 offset:21504
    v_mul_f32 v31, v8, v29
    v_mfma_f32_16x16x32_bf16 v[136:139], v[40:43], a[24:27], v[136:139]
    buffer_load_dwordx4 v2, s[16:19], s47 offen  lds
    v_mfma_f32_16x16x32_bf16 v[140:143], v[40:43], a[28:31], v[140:143]
    v_fma_f32 v30, -v9, v29, v30
    v_fmac_f32 v31, v9, v28
    v_mfma_f32_16x16x32_bf16 v[144:147], v[44:47], a[16:19], v[144:147]
    ds_read_b64_tr_b16 v[60:61], v4 offset:28672
    v_fma_f32 v32, v10, v232, v30
    v_mfma_f32_16x16x32_bf16 v[148:151], v[44:47], a[20:23], v[148:151]
    ds_read_b64_tr_b16 v[62:63], v4 offset:29696
    v_fma_f32 v32, -v11, v248, v32
    v_mfma_f32_16x16x32_bf16 v[152:155], v[44:47], a[24:27], v[152:155]
    buffer_load_dwordx4 v2, s[16:19], vcc_lo offen offset:1024  lds
    v_fma_f32 v248, v10, v248, v31
    v_mfma_f32_16x16x32_bf16 v[156:159], v[44:47], a[28:31], v[156:159]
    s_add_u32 vcc_lo, s48, 35840
    v_fmac_f32 v248, v11, v232
    s_lshl1_add_u32 m0, s74, 131072
    v_mfma_f32_16x16x32_bf16 v[128:131], v[48:51], a[32:35], v[128:131]
    ds_read_b64_tr_b16 v[40:41], v4 offset:32768
    v_mul_f32 v28, v8, v30
    v_mfma_f32_16x16x32_bf16 v[132:135], v[48:51], a[36:39], v[132:135]
    ds_read_b64_tr_b16 v[42:43], v4 offset:33792
    v_mul_f32 v29, v8, v31
    v_mfma_f32_16x16x32_bf16 v[136:139], v[48:51], a[40:43], v[136:139]
    buffer_load_dwordx4 v2, s[12:15], s48 offen  lds
    v_mfma_f32_16x16x32_bf16 v[140:143], v[48:51], a[44:47], v[140:143]
    s_waitcnt lgkmcnt(2)
    v_fma_f32 v28, -v9, v31, v28
    v_fmac_f32 v29, v9, v30
    v_mfma_f32_16x16x32_bf16 v[144:147], v[52:55], a[32:35], v[144:147]
    ds_read_b64_tr_b16 v[44:45], v4 offset:40960
    v_fma_f32 v33, v10, v233, v28
    v_fma_f32 v33, -v11, v249, v33
    v_mfma_f32_16x16x32_bf16 v[148:151], v[52:55], a[36:39], v[148:151]
    ds_read_b64_tr_b16 v[46:47], v4 offset:41984
    v_fma_f32 v249, v10, v249, v29
    v_mfma_f32_16x16x32_bf16 v[152:155], v[52:55], a[40:43], v[152:155]
    buffer_load_dwordx4 v2, s[12:15], vcc_lo offen offset:1024  lds
    v_mfma_f32_16x16x32_bf16 v[156:159], v[52:55], a[44:47], v[156:159]
    s_lshl1_add_u32 m0, s74, 139264
    v_fmac_f32 v249, v11, v233
    v_cvt_pk_bf16_f32 v228, v32, v33
    v_mfma_f32_16x16x32_bf16 v[128:131], v[56:59], a[48:51], v[128:131]
    ds_read_b64_tr_b16 v[48:49], v4 offset:36864
    v_cvt_pk_bf16_f32 v244, -v248, -v249
    v_mfma_f32_16x16x32_bf16 v[132:135], v[56:59], a[52:55], v[132:135]
    ds_read_b64_tr_b16 v[50:51], v4 offset:37888
    v_mul_f32 v30, v8, v28
    v_mfma_f32_16x16x32_bf16 v[136:139], v[56:59], a[56:59], v[136:139]
    buffer_load_dwordx4 v2, s[16:19], s48 offen  lds
    v_mul_f32 v31, v8, v29
    v_mfma_f32_16x16x32_bf16 v[140:143], v[56:59], a[60:63], v[140:143]
    v_fma_f32 v30, -v9, v29, v30
    v_fmac_f32 v31, v9, v28
    v_mfma_f32_16x16x32_bf16 v[144:147], v[60:63], a[48:51], v[144:147]
    ds_read_b64_tr_b16 v[52:53], v4 offset:45056
    v_fma_f32 v32, v10, v234, v30
    v_mfma_f32_16x16x32_bf16 v[148:151], v[60:63], a[52:55], v[148:151]
    ds_read_b64_tr_b16 v[54:55], v4 offset:46080
    v_fma_f32 v32, -v11, v250, v32
    v_mfma_f32_16x16x32_bf16 v[152:155], v[60:63], a[56:59], v[152:155]
    buffer_load_dwordx4 v2, s[16:19], vcc_lo offen offset:1024  lds
    v_mfma_f32_16x16x32_bf16 v[156:159], v[60:63], a[60:63], v[156:159]
    s_waitcnt lgkmcnt(2)
    v_fma_f32 v250, v10, v250, v31
    v_fmac_f32 v250, v11, v234
    v_mfma_f32_16x16x32_bf16 v[128:131], v[40:43], a[64:67], v[128:131]
    ds_read_b64_tr_b16 v[56:57], v4 offset:49152
    v_mul_f32 v28, v8, v30
    v_mul_f32 v29, v8, v31
    v_mfma_f32_16x16x32_bf16 v[132:135], v[40:43], a[68:71], v[132:135]
    ds_read_b64_tr_b16 v[58:59], v4 offset:50176
    v_fma_f32 v28, -v9, v31, v28
    v_mfma_f32_16x16x32_bf16 v[136:139], v[40:43], a[72:75], v[136:139]
    v_fmac_f32 v29, v9, v30
    v_fma_f32 v33, v10, v235, v28
    v_mfma_f32_16x16x32_bf16 v[140:143], v[40:43], a[76:79], v[140:143]
    v_fma_f32 v33, -v11, v251, v33
    v_fma_f32 v251, v10, v251, v29
    v_mfma_f32_16x16x32_bf16 v[144:147], v[44:47], a[64:67], v[144:147]
    ds_read_b64_tr_b16 v[60:61], v4 offset:57344
    v_fmac_f32 v251, v11, v235
    v_mfma_f32_16x16x32_bf16 v[148:151], v[44:47], a[68:71], v[148:151]
    ds_read_b64_tr_b16 v[62:63], v4 offset:58368
    v_cvt_pk_bf16_f32 v229, v32, v33
    v_mfma_f32_16x16x32_bf16 v[152:155], v[44:47], a[72:75], v[152:155]
    s_branch gated_mix__ssm_conv_s5__swiglu_ffn__prompt_kernel_A_sk4
.p2align 12
gated_mix__ssm_conv_s5__swiglu_ffn__prompt_kernel_A_pg2_4:
    s_branch gated_mix__ssm_conv_s5__swiglu_ffn__prompt_kernel_A_pr2
gated_mix__ssm_conv_s5__swiglu_ffn__prompt_kernel_A_sk4:
    v_cvt_pk_bf16_f32 v245, -v250, -v251
    v_mul_f32 v30, v8, v28
    v_mul_f32 v31, v8, v29
    v_mfma_f32_16x16x32_bf16 v[156:159], v[44:47], a[76:79], v[156:159]
    v_fma_f32 v30, -v9, v29, v30
    v_fmac_f32 v31, v9, v28
    v_mfma_f32_16x16x32_bf16 v[128:131], v[48:51], a[80:83], v[128:131]
    ds_read_b64_tr_b16 v[40:41], v4 offset:53248
    v_fma_f32 v32, v10, v236, v30
    v_mfma_f32_16x16x32_bf16 v[132:135], v[48:51], a[84:87], v[132:135]
    ds_read_b64_tr_b16 v[42:43], v4 offset:54272
    v_fma_f32 v32, -v11, v252, v32
    v_mfma_f32_16x16x32_bf16 v[136:139], v[48:51], a[88:91], v[136:139]
    buffer_load_dword v39, v37, s[24:27], s83 offen
    v_mfma_f32_16x16x32_bf16 v[140:143], v[48:51], a[92:95], v[140:143]
    s_waitcnt lgkmcnt(2)
    v_fma_f32 v252, v10, v252, v31
    v_fmac_f32 v252, v11, v236
    v_mfma_f32_16x16x32_bf16 v[144:147], v[52:55], a[80:83], v[144:147]
    ds_read_b64_tr_b16 v[44:45], v4 offset:61440
    v_mul_f32 v28, v8, v30
    v_mul_f32 v29, v8, v31
    v_mfma_f32_16x16x32_bf16 v[148:151], v[52:55], a[84:87], v[148:151]
    ds_read_b64_tr_b16 v[46:47], v4 offset:62464
    v_fma_f32 v28, -v9, v31, v28
    v_mfma_f32_16x16x32_bf16 v[152:155], v[52:55], a[88:91], v[152:155]
    v_fmac_f32 v29, v9, v30
    v_fma_f32 v33, v10, v237, v28
    v_mfma_f32_16x16x32_bf16 v[156:159], v[52:55], a[92:95], v[156:159]
    s_waitcnt vmcnt(13) lgkmcnt(2)
    s_barrier
    v_fma_f32 v33, -v11, v253, v33
    v_mfma_f32_16x16x32_bf16 v[128:131], v[56:59], a[96:99], v[128:131]
    v_add_u32 v3, 0x10000, v3
    v_fma_f32 v253, v10, v253, v29
    v_mfma_f32_16x16x32_bf16 v[132:135], v[56:59], a[100:103], v[132:135]
    ds_read_b64_tr_b16 v[48:49], v3 offset:0
    v_fmac_f32 v253, v11, v237
    v_mfma_f32_16x16x32_bf16 v[136:139], v[56:59], a[104:107], v[136:139]
    ds_read_b64_tr_b16 v[50:51], v3 offset:1024
    v_cvt_pk_bf16_f32 v230, v32, v33
    v_cvt_pk_bf16_f32 v246, -v252, -v253
    v_mfma_f32_16x16x32_bf16 v[140:143], v[56:59], a[108:111], v[140:143]
    v_mul_f32 v30, v8, v28
    v_mul_f32 v31, v8, v29
    v_mfma_f32_16x16x32_bf16 v[144:147], v[60:63], a[96:99], v[144:147]
    ds_read_b64_tr_b16 v[52:53], v3 offset:8192
    v_fma_f32 v30, -v9, v29, v30
    v_mfma_f32_16x16x32_bf16 v[148:151], v[60:63], a[100:103], v[148:151]
    ds_read_b64_tr_b16 v[54:55], v3 offset:9216
    v_fmac_f32 v31, v9, v28
    v_mfma_f32_16x16x32_bf16 v[152:155], v[60:63], a[104:107], v[152:155]
    v_fma_f32 v32, v10, v238, v30
    v_fma_f32 v32, -v11, v254, v32
    v_mfma_f32_16x16x32_bf16 v[156:159], v[60:63], a[108:111], v[156:159]
    v_fma_f32 v254, v10, v254, v31
    v_fmac_f32 v254, v11, v238
    v_mfma_f32_16x16x32_bf16 v[128:131], v[40:43], a[112:115], v[128:131]
    ds_read_b64_tr_b16 v[56:57], v3 offset:4096
    v_mul_f32 v28, v8, v30
    v_mul_f32 v29, v8, v31
    v_mfma_f32_16x16x32_bf16 v[132:135], v[40:43], a[116:119], v[132:135]
    ds_read_b64_tr_b16 v[58:59], v3 offset:5120
    v_fma_f32 v28, -v9, v31, v28
    v_mfma_f32_16x16x32_bf16 v[136:139], v[40:43], a[120:123], v[136:139]
    v_fmac_f32 v29, v9, v30
    v_fma_f32 v33, v10, v239, v28
    v_mfma_f32_16x16x32_bf16 v[140:143], v[40:43], a[124:127], v[140:143]
    s_waitcnt lgkmcnt(2)
    v_fma_f32 v33, -v11, v255, v33
    v_fma_f32 v255, v10, v255, v29
    v_mfma_f32_16x16x32_bf16 v[144:147], v[44:47], a[112:115], v[144:147]
    ds_read_b64_tr_b16 v[60:61], v3 offset:12288
    v_fmac_f32 v255, v11, v239
    v_mfma_f32_16x16x32_bf16 v[148:151], v[44:47], a[116:119], v[148:151]
    ds_read_b64_tr_b16 v[62:63], v3 offset:13312
    v_cvt_pk_bf16_f32 v231, v32, v33
    v_mfma_f32_16x16x32_bf16 v[152:155], v[44:47], a[120:123], v[152:155]
    v_cvt_pk_bf16_f32 v247, -v254, -v255
    s_mul_i32 s57, s6, 2560
    v_mul_f32 v176, v160, v176
    v_mfma_f32_16x16x32_bf16 v[156:159], v[44:47], a[124:127], v[156:159]
    s_add_u32 s57, s57, 147456
    v_and_b32 v28, 15, v0
    v_mul_u32_u24 v28, 80, v28
    v_mfma_f32_16x16x32_bf16 v[96:99], v[48:51], a[128:131], v[96:99]
    v_add_u32 v4, 0x10000, v4
    v_and_b32 v29, 48, v0
    v_mfma_f32_16x16x32_bf16 v[100:103], v[48:51], a[132:135], v[100:103]
    ds_read_b64_tr_b16 v[40:41], v4 offset:0
    v_add3_u32 v28, v28, v29, s57
    v_mfma_f32_16x16x32_bf16 v[104:107], v[48:51], a[136:139], v[104:107]
    ds_read_b64_tr_b16 v[42:43], v4 offset:1024
    v_lshrrev_b32 v29, 1, v29
    v_mfma_f32_16x16x32_bf16 v[108:111], v[48:51], a[140:143], v[108:111]
    v_bfe_u32 v30, v0, 2, 2
    v_add_u32 v29, v29, v30
    v_mfma_f32_16x16x32_bf16 v[112:115], v[52:55], a[128:131], v[112:115]
    ds_read_b64_tr_b16 v[44:45], v4 offset:8192
    v_mul_u32_u24 v29, 80, v29
    v_and_b32 v30, 48, v5
    v_mfma_f32_16x16x32_bf16 v[116:119], v[52:55], a[132:135], v[116:119]
    ds_read_b64_tr_b16 v[46:47], v4 offset:9216
    v_add3_u32 v29, v29, v30, s57
    v_mfma_f32_16x16x32_bf16 v[120:123], v[52:55], a[136:139], v[120:123]
    ds_write_b128 v28, v[224:227] offset:0
    v_mfma_f32_16x16x32_bf16 v[124:127], v[52:55], a[140:143], v[124:127]
    s_waitcnt lgkmcnt(4)
    ds_write_b128 v28, v[240:243] offset:1280
    v_mfma_f32_16x16x32_bf16 v[96:99], v[56:59], a[144:147], v[96:99]
    ds_read_b64_tr_b16 v[48:49], v4 offset:4096
    v_mul_f32 v160, s56, v160
    v_mfma_f32_16x16x32_bf16 v[100:103], v[56:59], a[148:151], v[100:103]
    ds_read_b64_tr_b16 v[50:51], v4 offset:5120
    v_mul_f32 v180, v164, v180
    v_mfma_f32_16x16x32_bf16 v[104:107], v[56:59], a[152:155], v[104:107]
    ds_read_b64_tr_b16 v[232:233], v29 offset:0
    v_mul_f32 v164, s56, v164
    v_exp_f32 v160, v160
    v_mfma_f32_16x16x32_bf16 v[108:111], v[56:59], a[156:159], v[108:111]
    ds_read_b64_tr_b16 v[234:235], v29 offset:320
    v_add_f32 v160, 1.0, v160
    v_mfma_f32_16x16x32_bf16 v[112:115], v[60:63], a[144:147], v[112:115]
    ds_read_b64_tr_b16 v[52:53], v4 offset:12288
    v_mul_f32 v184, v168, v184
    v_mfma_f32_16x16x32_bf16 v[116:119], v[60:63], a[148:151], v[116:119]
    ds_read_b64_tr_b16 v[54:55], v4 offset:13312
    v_mul_f32 v168, s56, v168
    v_mfma_f32_16x16x32_bf16 v[120:123], v[60:63], a[152:155], v[120:123]
    ds_read_b64_tr_b16 v[236:237], v29 offset:8
    v_mul_f32 v188, v172, v188
    v_mfma_f32_16x16x32_bf16 v[124:127], v[60:63], a[156:159], v[124:127]
    s_waitcnt lgkmcnt(5)
    ds_read_b64_tr_b16 v[238:239], v29 offset:328
    v_mul_f32 v172, s56, v172
    v_mfma_f32_16x16x32_bf16 v[128:131], v[40:43], a[128:131], v[128:131]
    ds_read_b64_tr_b16 v[56:57], v3 offset:16384
    v_rcp_f32 v160, v160
    v_mfma_f32_16x16x32_bf16 v[132:135], v[40:43], a[132:135], v[132:135]
    ds_read_b64_tr_b16 v[58:59], v3 offset:17408
    v_mul_f32 v160, v160, v176
    v_mfma_f32_16x16x32_bf16 v[136:139], v[40:43], a[136:139], v[136:139]
    ds_write_b128 v28, v[228:231] offset:0
    v_mfma_f32_16x16x32_bf16 v[140:143], v[40:43], a[140:143], v[140:143]
    ds_write_b128 v28, v[244:247] offset:1280
    v_mfma_f32_16x16x32_bf16 v[144:147], v[44:47], a[128:131], v[144:147]
    ds_read_b64_tr_b16 v[60:61], v3 offset:24576
    v_mul_f32 v177, v161, v177
    v_mfma_f32_16x16x32_bf16 v[148:151], v[44:47], a[132:135], v[148:151]
    ds_read_b64_tr_b16 v[62:63], v3 offset:25600
    v_mul_f32 v161, s56, v161
    v_mfma_f32_16x16x32_bf16 v[152:155], v[44:47], a[136:139], v[152:155]
    ds_read_b64_tr_b16 v[248:249], v29 offset:0
    v_exp_f32 v161, v161
    v_mfma_f32_16x16x32_bf16 v[156:159], v[44:47], a[140:143], v[156:159]
    ds_read_b64_tr_b16 v[250:251], v29 offset:320
    v_add_f32 v161, 1.0, v161
    v_mfma_f32_16x16x32_bf16 v[128:131], v[48:51], a[144:147], v[128:131]
    ds_read_b64_tr_b16 v[40:41], v3 offset:20480
    v_mfma_f32_16x16x32_bf16 v[132:135], v[48:51], a[148:151], v[132:135]
    ds_read_b64_tr_b16 v[42:43], v3 offset:21504
    v_mfma_f32_16x16x32_bf16 v[136:139], v[48:51], a[152:155], v[136:139]
    ds_read_b64_tr_b16 v[252:253], v29 offset:8
    v_mfma_f32_16x16x32_bf16 v[140:143], v[48:51], a[156:159], v[140:143]
    s_waitcnt lgkmcnt(5)
    ds_read_b64_tr_b16 v[254:255], v29 offset:328
    v_mul_f32 v30, v12, v34
    v_mfma_f32_16x16x32_bf16 v[144:147], v[52:55], a[144:147], v[144:147]
    ds_read_b64_tr_b16 v[44:45], v3 offset:28672
    v_fmac_f32_dpp v30, v34, -v13 row_ror:8 row_mask:0xf bank_mask:0xf
    v_fma_f32 v32, v14, v192, v30
    v_mfma_f32_16x16x32_bf16 v[148:151], v[52:55], a[148:151], v[148:151]
    ds_read_b64_tr_b16 v[46:47], v3 offset:29696
    v_fmac_f32_dpp v32, v192, v15 row_ror:8 row_mask:0xf bank_mask:0xf
    v_mfma_f32_16x16x32_bf16 v[152:155], v[52:55], a[152:155], v[152:155]
    v_rcp_f32 v161, v161
    v_mfma_f32_16x16x32_bf16 v[156:159], v[52:55], a[156:159], v[156:159]
    s_waitcnt lgkmcnt(2)
    v_exp_f32 v164, v164
    v_mfma_f32_16x16x32_bf16 v[96:99], v[56:59], a[160:163], v[96:99]
    buffer_store_dwordx4 v[232:235], v5, s[20:23], s59 offen offset:0 sc1
    v_mfma_f32_16x16x32_bf16 v[100:103], v[56:59], a[164:167], v[100:103]
    ds_read_b64_tr_b16 v[48:49], v4 offset:16384
    v_mul_f32 v34, v12, v30
    v_mfma_f32_16x16x32_bf16 v[104:107], v[56:59], a[168:171], v[104:107]
    ds_read_b64_tr_b16 v[50:51], v4 offset:17408
    v_fmac_f32_dpp v34, v30, -v13 row_ror:8 row_mask:0xf bank_mask:0xf
    v_fma_f32 v33, v14, v193, v34
    v_mfma_f32_16x16x32_bf16 v[108:111], v[56:59], a[172:175], v[108:111]
    v_exp_f32 v168, v168
    v_mfma_f32_16x16x32_bf16 v[112:115], v[60:63], a[160:163], v[112:115]
    buffer_store_dwordx4 v[236:239], v5, s[20:23], s59 offen offset:1024 sc1
    v_mfma_f32_16x16x32_bf16 v[116:119], v[60:63], a[164:167], v[116:119]
    ds_read_b64_tr_b16 v[52:53], v4 offset:24576
    v_fmac_f32_dpp v33, v193, v15 row_ror:8 row_mask:0xf bank_mask:0xf
    v_mfma_f32_16x16x32_bf16 v[120:123], v[60:63], a[168:171], v[120:123]
    ds_read_b64_tr_b16 v[54:55], v4 offset:25600
    v_cvt_pk_bf16_f32 v192, v32, v33
    v_mfma_f32_16x16x32_bf16 v[124:127], v[60:63], a[172:175], v[124:127]
    v_exp_f32 v172, v172
    v_mfma_f32_16x16x32_bf16 v[96:99], v[40:43], a[176:179], v[96:99]
    buffer_store_dwordx4 v[248:251], v5, s[20:23], s59 offen offset:2048 sc1
    v_mul_f32 v30, v12, v34
    v_mfma_f32_16x16x32_bf16 v[100:103], v[40:43], a[180:183], v[100:103]
    ds_read_b64_tr_b16 v[56:57], v4 offset:20480
    v_fmac_f32_dpp v30, v34, -v13 row_ror:8 row_mask:0xf bank_mask:0xf
    v_mfma_f32_16x16x32_bf16 v[104:107], v[40:43], a[184:187], v[104:107]
    ds_read_b64_tr_b16 v[58:59], v4 offset:21504
    v_fma_f32 v32, v14, v194, v30
    v_mfma_f32_16x16x32_bf16 v[108:111], v[40:43], a[188:191], v[108:111]
    s_waitcnt lgkmcnt(3)
    v_fmac_f32_dpp v32, v194, v15 row_ror:8 row_mask:0xf bank_mask:0xf
    v_mul_f32 v34, v12, v30
    v_mfma_f32_16x16x32_bf16 v[112:115], v[44:47], a[176:179], v[112:115]
    buffer_store_dwordx4 v[252:255], v5, s[20:23], s59 offen offset:3072 sc1
    v_mfma_f32_16x16x32_bf16 v[116:119], v[44:47], a[180:183], v[116:119]
    ds_read_b64_tr_b16 v[60:61], v4 offset:28672
    v_fmac_f32_dpp v34, v30, -v13 row_ror:8 row_mask:0xf bank_mask:0xf
    v_mfma_f32_16x16x32_bf16 v[120:123], v[44:47], a[184:187], v[120:123]
    ds_read_b64_tr_b16 v[62:63], v4 offset:29696
    v_fma_f32 v33, v14, v195, v34
    v_fmac_f32_dpp v33, v195, v15 row_ror:8 row_mask:0xf bank_mask:0xf
    v_mfma_f32_16x16x32_bf16 v[124:127], v[44:47], a[188:191], v[124:127]
    s_waitcnt vmcnt(9) lgkmcnt(3)
    s_barrier
    v_cvt_pk_bf16_f32 v193, v32, v33
    v_mfma_f32_16x16x32_bf16 v[128:131], v[48:51], a[160:163], v[128:131]
    ds_read_b64_tr_b16 v[40:41], v3 offset:32768
    v_mul_f32 v30, v12, v34
    v_mfma_f32_16x16x32_bf16 v[132:135], v[48:51], a[164:167], v[132:135]
    ds_read_b64_tr_b16 v[42:43], v3 offset:33792
    v_fmac_f32_dpp v30, v34, -v13 row_ror:8 row_mask:0xf bank_mask:0xf
    v_mfma_f32_16x16x32_bf16 v[136:139], v[48:51], a[168:171], v[136:139]
    v_fma_f32 v32, v14, v196, v30
    v_fmac_f32_dpp v32, v196, v15 row_ror:8 row_mask:0xf bank_mask:0xf
    v_mfma_f32_16x16x32_bf16 v[140:143], v[48:51], a[172:175], v[140:143]
    v_mul_f32 v34, v12, v30
    v_fmac_f32_dpp v34, v30, -v13 row_ror:8 row_mask:0xf bank_mask:0xf
    v_mfma_f32_16x16x32_bf16 v[144:147], v[52:55], a[160:163], v[144:147]
    ds_read_b64_tr_b16 v[44:45], v3 offset:40960
    v_fma_f32 v33, v14, v197, v34
    v_fmac_f32_dpp v33, v197, v15 row_ror:8 row_mask:0xf bank_mask:0xf
    v_mfma_f32_16x16x32_bf16 v[148:151], v[52:55], a[164:167], v[148:151]
    ds_read_b64_tr_b16 v[46:47], v3 offset:41984
    v_cvt_pk_bf16_f32 v194, v32, v33
    v_mfma_f32_16x16x32_bf16 v[152:155], v[52:55], a[168:171], v[152:155]
    v_mul_f32 v30, v12, v34
    v_fmac_f32_dpp v30, v34, -v13 row_ror:8 row_mask:0xf bank_mask:0xf
    v_mfma_f32_16x16x32_bf16 v[156:159], v[52:55], a[172:175], v[156:159]
    s_waitcnt lgkmcnt(2)
    v_fma_f32 v32, v14, v198, v30
    v_fmac_f32_dpp v32, v198, v15 row_ror:8 row_mask:0xf bank_mask:0xf
    v_mfma_f32_16x16x32_bf16 v[128:131], v[56:59], a[176:179], v[128:131]
    ds_read_b64_tr_b16 v[48:49], v3 offset:36864
    v_mul_f32 v34, v12, v30
    v_mfma_f32_16x16x32_bf16 v[132:135], v[56:59], a[180:183], v[132:135]
    ds_read_b64_tr_b16 v[50:51], v3 offset:37888
    v_fmac_f32_dpp v34, v30, -v13 row_ror:8 row_mask:0xf bank_mask:0xf
    v_mfma_f32_16x16x32_bf16 v[136:139], v[56:59], a[184:187], v[136:139]
    v_fma_f32 v33, v14, v199, v34
    v_fmac_f32_dpp v33, v199, v15 row_ror:8 row_mask:0xf bank_mask:0xf
    v_cvt_pk_bf16_f32 v195, v32, v33
    v_mfma_f32_16x16x32_bf16 v[140:143], v[56:59], a[188:191], v[140:143]
    v_mul_f32 v30, v12, v34
    v_fmac_f32_dpp v30, v34, -v13 row_ror:8 row_mask:0xf bank_mask:0xf
    v_mfma_f32_16x16x32_bf16 v[144:147], v[60:63], a[176:179], v[144:147]
    ds_read_b64_tr_b16 v[52:53], v3 offset:45056
    v_fma_f32 v32, v14, v200, v30
    v_mfma_f32_16x16x32_bf16 v[148:151], v[60:63], a[180:183], v[148:151]
    ds_read_b64_tr_b16 v[54:55], v3 offset:46080
    v_fmac_f32_dpp v32, v200, v15 row_ror:8 row_mask:0xf bank_mask:0xf
    v_mfma_f32_16x16x32_bf16 v[152:155], v[60:63], a[184:187], v[152:155]
    v_mul_f32 v34, v12, v30
    v_fmac_f32_dpp v34, v30, -v13 row_ror:8 row_mask:0xf bank_mask:0xf
    v_mfma_f32_16x16x32_bf16 v[156:159], v[60:63], a[188:191], v[156:159]
    v_fma_f32 v33, v14, v201, v34
    v_fmac_f32_dpp v33, v201, v15 row_ror:8 row_mask:0xf bank_mask:0xf
    v_mfma_f32_16x16x32_bf16 v[96:99], v[40:43], a[192:195], v[96:99]
    ds_read_b64_tr_b16 v[56:57], v4 offset:32768
    v_cvt_pk_bf16_f32 v196, v32, v33
    v_mul_f32 v30, v12, v34
    v_mfma_f32_16x16x32_bf16 v[100:103], v[40:43], a[196:199], v[100:103]
    ds_read_b64_tr_b16 v[58:59], v4 offset:33792
    v_fmac_f32_dpp v30, v34, -v13 row_ror:8 row_mask:0xf bank_mask:0xf
    v_mfma_f32_16x16x32_bf16 v[104:107], v[40:43], a[200:203], v[104:107]
    v_fma_f32 v32, v14, v202, v30
    v_fmac_f32_dpp v32, v202, v15 row_ror:8 row_mask:0xf bank_mask:0xf
    v_mfma_f32_16x16x32_bf16 v[108:111], v[40:43], a[204:207], v[108:111]
    s_waitcnt lgkmcnt(2)
    v_mul_f32 v34, v12, v30
    v_fmac_f32_dpp v34, v30, -v13 row_ror:8 row_mask:0xf bank_mask:0xf
    v_mfma_f32_16x16x32_bf16 v[112:115], v[44:47], a[192:195], v[112:115]
    ds_read_b64_tr_b16 v[60:61], v4 offset:40960
    v_fma_f32 v33, v14, v203, v34
    v_mfma_f32_16x16x32_bf16 v[116:119], v[44:47], a[196:199], v[116:119]
    ds_read_b64_tr_b16 v[62:63], v4 offset:41984
    v_fmac_f32_dpp v33, v203, v15 row_ror:8 row_mask:0xf bank_mask:0xf
    v_mfma_f32_16x16x32_bf16 v[120:123], v[44:47], a[200:203], v[120:123]
    v_cvt_pk_bf16_f32 v197, v32, v33
    v_mul_f32 v30, v12, v34
    v_fmac_f32_dpp v30, v34, -v13 row_ror:8 row_mask:0xf bank_mask:0xf
    v_mfma_f32_16x16x32_bf16 v[124:127], v[44:47], a[204:207], v[124:127]
    v_fma_f32 v32, v14, v204, v30
    v_fmac_f32_dpp v32, v204, v15 row_ror:8 row_mask:0xf bank_mask:0xf
    v_mfma_f32_16x16x32_bf16 v[96:99], v[48:51], a[208:211], v[96:99]
    ds_read_b64_tr_b16 v[40:41], v4 offset:36864
    v_mul_f32 v34, v12, v30
    v_mfma_f32_16x16x32_bf16 v[100:103], v[48:51], a[212:215], v[100:103]
    ds_read_b64_tr_b16 v[42:43], v4 offset:37888
    v_fmac_f32_dpp v34, v30, -v13 row_ror:8 row_mask:0xf bank_mask:0xf
    v_mfma_f32_16x16x32_bf16 v[104:107], v[48:51], a[216:219], v[104:107]
    v_fma_f32 v33, v14, v205, v34
    v_fmac_f32_dpp v33, v205, v15 row_ror:8 row_mask:0xf bank_mask:0xf
    v_mfma_f32_16x16x32_bf16 v[108:111], v[48:51], a[220:223], v[108:111]
    v_cvt_pk_bf16_f32 v198, v32, v33
    v_mul_f32 v30, v12, v34
    v_mfma_f32_16x16x32_bf16 v[112:115], v[52:55], a[208:211], v[112:115]
    ds_read_b64_tr_b16 v[44:45], v4 offset:45056
    v_fmac_f32_dpp v30, v34, -v13 row_ror:8 row_mask:0xf bank_mask:0xf
    v_fma_f32 v32, v14, v206, v30
    v_mfma_f32_16x16x32_bf16 v[116:119], v[52:55], a[212:215], v[116:119]
    ds_read_b64_tr_b16 v[46:47], v4 offset:46080
    v_fmac_f32_dpp v32, v206, v15 row_ror:8 row_mask:0xf bank_mask:0xf
    v_mfma_f32_16x16x32_bf16 v[120:123], v[52:55], a[216:219], v[120:123]
    v_mul_f32 v34, v12, v30
    v_fmac_f32_dpp v34, v30, -v13 row_ror:8 row_mask:0xf bank_mask:0xf
    v_mfma_f32_16x16x32_bf16 v[124:127], v[52:55], a[220:223], v[124:127]
    s_waitcnt lgkmcnt(2)
    v_fma_f32 v33, v14, v207, v34
    v_fmac_f32_dpp v33, v207, v15 row_ror:8 row_mask:0xf bank_mask:0xf
    v_mfma_f32_16x16x32_bf16 v[128:131], v[56:59], a[192:195], v[128:131]
    ds_read_b64_tr_b16 v[48:49], v3 offset:49152
    v_cvt_pk_bf16_f32 v199, v32, v33
    v_mfma_f32_16x16x32_bf16 v[132:135], v[56:59], a[196:199], v[132:135]
    ds_read_b64_tr_b16 v[50:51], v3 offset:50176
    v_mul_f32 v161, v161, v177
    v_mfma_f32_16x16x32_bf16 v[136:139], v[56:59], a[200:203], v[136:139]
    ds_write_b128 v28, v[192:195] offset:0
    v_cvt_pk_bf16_f32 v210, v160, v161
    v_mfma_f32_16x16x32_bf16 v[140:143], v[56:59], a[204:207], v[140:143]
    ds_write_b128 v28, v[196:199] offset:1280
    v_mfma_f32_16x16x32_bf16 v[144:147], v[60:63], a[192:195], v[144:147]
    ds_read_b64_tr_b16 v[52:53], v3 offset:57344
    v_mul_f32 v178, v162, v178
    v_mfma_f32_16x16x32_bf16 v[148:151], v[60:63], a[196:199], v[148:151]
    ds_read_b64_tr_b16 v[54:55], v3 offset:58368
    v_mul_f32 v162, s56, v162
    v_mfma_f32_16x16x32_bf16 v[152:155], v[60:63], a[200:203], v[152:155]
    ds_read_b64_tr_b16 v[200:201], v29 offset:0
    v_add_f32 v164, 1.0, v164
    v_mfma_f32_16x16x32_bf16 v[156:159], v[60:63], a[204:207], v[156:159]
    ds_read_b64_tr_b16 v[202:203], v29 offset:320
    v_add_f32 v168, 1.0, v168
    v_mfma_f32_16x16x32_bf16 v[128:131], v[40:43], a[208:211], v[128:131]
    ds_read_b64_tr_b16 v[56:57], v3 offset:53248
    v_add_f32 v172, 1.0, v172
    v_exp_f32 v162, v162
    v_mfma_f32_16x16x32_bf16 v[132:135], v[40:43], a[212:215], v[132:135]
    ds_read_b64_tr_b16 v[58:59], v3 offset:54272
    v_add_f32 v162, 1.0, v162
    v_mfma_f32_16x16x32_bf16 v[136:139], v[40:43], a[216:219], v[136:139]
    ds_read_b64_tr_b16 v[204:205], v29 offset:8
    v_mfma_f32_16x16x32_bf16 v[140:143], v[40:43], a[220:223], v[140:143]
    s_waitcnt lgkmcnt(5)
    ds_read_b64_tr_b16 v[206:207], v29 offset:328
    v_and_b32 v30, 32, v0
    v_mfma_f32_16x16x32_bf16 v[144:147], v[44:47], a[208:211], v[144:147]
    ds_read_b64_tr_b16 v[60:61], v3 offset:61440
    v_and_b32 v31, 16, v0
    v_mfma_f32_16x16x32_bf16 v[148:151], v[44:47], a[212:215], v[148:151]
    ds_read_b64_tr_b16 v[62:63], v3 offset:62464
    v_mul_u32_u24 v30, 48, v30
    v_mfma_f32_16x16x32_bf16 v[152:155], v[44:47], a[216:219], v[152:155]
    v_rcp_f32 v162, v162
    v_lshl_add_u32 v30, v31, 4, v30
    v_mfma_f32_16x16x32_bf16 v[156:159], v[44:47], a[220:223], v[156:159]
    v_rcp_f32 v164, v164
    v_mfma_f32_16x16x32_bf16 v[96:99], v[48:51], a[224:227], v[96:99]
    ds_read_b64_tr_b16 v[40:41], v4 offset:49152
    v_add_u32 v30, v30, v5
    v_mfma_f32_16x16x32_bf16 v[100:103], v[48:51], a[228:231], v[100:103]
    s_waitcnt lgkmcnt(3)
    ds_read_b64_tr_b16 v[42:43], v4 offset:50176
    v_mul_f32 v162, v162, v178
    v_mfma_f32_16x16x32_bf16 v[104:107], v[48:51], a[232:235], v[104:107]
    buffer_store_dwordx4 v[200:203], v30, s[20:23], s60 offen offset:0 sc1
    v_mfma_f32_16x16x32_bf16 v[108:111], v[48:51], a[236:239], v[108:111]
    v_rcp_f32 v168, v168
    v_mfma_f32_16x16x32_bf16 v[112:115], v[52:55], a[224:227], v[112:115]
    ds_read_b64_tr_b16 v[44:45], v4 offset:57344
    v_mul_f32 v179, v163, v179
    v_mul_f32 v163, s56, v163
    v_mfma_f32_16x16x32_bf16 v[116:119], v[52:55], a[228:231], v[116:119]
    ds_read_b64_tr_b16 v[46:47], v4 offset:58368
    v_mul_f32 v164, v164, v180
    v_mfma_f32_16x16x32_bf16 v[120:123], v[52:55], a[232:235], v[120:123]
    buffer_store_dwordx4 v[204:207], v30, s[20:23], s60 offen offset:1024 sc1
    v_mfma_f32_16x16x32_bf16 v[124:127], v[52:55], a[236:239], v[124:127]
    v_exp_f32 v163, v163
    v_mfma_f32_16x16x32_bf16 v[96:99], v[56:59], a[240:243], v[96:99]
    ds_read_b64_tr_b16 v[48:49], v4 offset:53248
    v_mov_b32 v33, 0
    v_mfma_f32_16x16x32_bf16 v[100:103], v[56:59], a[244:247], v[100:103]
    buffer_load_dword v32, v33, s[20:23], s86 offen sc1
    v_mfma_f32_16x16x32_bf16 v[104:107], v[56:59], a[248:251], v[104:107]
    buffer_load_dwordx2 v[204:205], v35, s[32:35], 0 offen offset:0
    v_add_f32 v163, 1.0, v163
    v_mfma_f32_16x16x32_bf16 v[108:111], v[56:59], a[252:255], v[108:111]
    s_waitcnt lgkmcnt(1)
    ds_read_b64_tr_b16 v[50:51], v4 offset:54272
    v_mul_f32 v181, v165, v181
    v_mfma_f32_16x16x32_bf16 v[112:115], v[60:63], a[240:243], v[112:115]
    buffer_load_dwordx2 v[206:207], v35, s[32:35], 0 offen offset:32
    v_mfma_f32_16x16x32_bf16 v[116:119], v[60:63], a[244:247], v[116:119]
    buffer_load_dwordx2 v[12:13], v35, s[32:35], 0 offen offset:64
    v_mfma_f32_16x16x32_bf16 v[120:123], v[60:63], a[248:251], v[120:123]
    buffer_load_dwordx2 v[14:15], v35, s[32:35], 0 offen offset:96
    v_mfma_f32_16x16x32_bf16 v[124:127], v[60:63], a[252:255], v[124:127]
    buffer_load_dwordx2 v[28:29], v35, s[32:35], 0 offen offset:128
    v_mfma_f32_16x16x32_bf16 v[128:131], v[40:43], a[224:227], v[128:131]
    buffer_load_dwordx2 v[30:31], v35, s[32:35], 0 offen offset:160
    v_rcp_f32 v163, v163
    v_mfma_f32_16x16x32_bf16 v[132:135], v[40:43], a[228:231], v[132:135]
    ds_read_b64_tr_b16 v[52:53], v4 offset:61440
    v_mul_f32 v163, v163, v179
    v_mfma_f32_16x16x32_bf16 v[136:139], v[40:43], a[232:235], v[136:139]
    ds_read_b64_tr_b16 v[54:55], v4 offset:62464
    v_cvt_pk_bf16_f32 v211, v162, v163
    v_mfma_f32_16x16x32_bf16 v[140:143], v[40:43], a[236:239], v[140:143]
    s_waitcnt vmcnt(14) lgkmcnt(2)
    s_barrier
    v_mul_f32 v165, s56, v165
    v_mfma_f32_16x16x32_bf16 v[144:147], v[44:47], a[224:227], v[144:147]
    buffer_load_dwordx2 v[192:193], v19, s[8:11], 0 offen offset:0
    v_mfma_f32_16x16x32_bf16 v[148:151], v[44:47], a[228:231], v[148:151]
    v_add_u32 v3, 0x10000, v3
    v_mul_f32 v168, v168, v184
    v_mfma_f32_16x16x32_bf16 v[152:155], v[44:47], a[232:235], v[152:155]
    ds_read_b64_tr_b16 v[56:57], v3 offset:0
    v_mul_f32 v185, v169, v185
    v_exp_f32 v165, v165
    v_mfma_f32_16x16x32_bf16 v[156:159], v[44:47], a[236:239], v[156:159]
    ds_read_b64_tr_b16 v[58:59], v3 offset:1024
    v_add_f32 v165, 1.0, v165
    v_mfma_f32_16x16x32_bf16 v[128:131], v[48:51], a[240:243], v[128:131]
    buffer_load_dwordx2 v[194:195], v19, s[8:11], 0 offen offset:32
    v_mfma_f32_16x16x32_bf16 v[132:135], v[48:51], a[244:247], v[132:135]
    ds_read_b64_tr_b16 v[60:61], v3 offset:8192
    v_mul_f32 v169, s56, v169
    v_mfma_f32_16x16x32_bf16 v[136:139], v[48:51], a[248:251], v[136:139]
    ds_read_b64_tr_b16 v[62:63], v3 offset:9216
    v_mfma_f32_16x16x32_bf16 v[140:143], v[48:51], a[252:255], v[140:143]
    s_waitcnt lgkmcnt(4)
    ds_read_b64_tr_b16 v[40:41], v3 offset:4096
    v_mfma_f32_16x16x32_bf16 v[144:147], v[52:55], a[240:243], v[144:147]
    buffer_load_dwordx2 v[196:197], v19, s[8:11], 0 offen offset:64
    v_rcp_f32 v165, v165
    v_mfma_f32_16x16x32_bf16 v[148:151], v[52:55], a[244:247], v[148:151]
    ds_read_b64_tr_b16 v[42:43], v3 offset:5120
    v_mul_f32 v165, v165, v181
    v_mfma_f32_16x16x32_bf16 v[152:155], v[52:55], a[248:251], v[152:155]
    ds_read_b64_tr_b16 v[44:45], v3 offset:12288
    v_cvt_pk_bf16_f32 v214, v164, v165
    v_mfma_f32_16x16x32_bf16 v[156:159], v[52:55], a[252:255], v[156:159]
    s_waitcnt lgkmcnt(4)
    ds_read_b64_tr_b16 v[46:47], v3 offset:13312
    v_mul_f32 v182, v166, v182
    v_mfma_f32_16x16x32_bf16 v[96:99], v[56:59], v[64:67], v[96:99]
    buffer_load_dwordx2 v[198:199], v19, s[8:11], 0 offen offset:96
    v_mfma_f32_16x16x32_bf16 v[100:103], v[56:59], v[68:71], v[100:103]
    v_add_u32 v4, 0x10000, v4
    v_mul_f32 v166, s56, v166
    v_mfma_f32_16x16x32_bf16 v[104:107], v[56:59], v[72:75], v[104:107]
    ds_read_b64_tr_b16 v[48:49], v4 offset:0
    v_exp_f32 v166, v166
    v_mfma_f32_16x16x32_bf16 v[108:111], v[56:59], v[76:79], v[108:111]
    s_waitcnt lgkmcnt(3)
    ds_read_b64_tr_b16 v[50:51], v4 offset:1024
    v_add_f32 v166, 1.0, v166
    v_mfma_f32_16x16x32_bf16 v[112:115], v[60:63], v[64:67], v[112:115]
    ds_read_b64_tr_b16 v[52:53], v4 offset:8192
    v_mfma_f32_16x16x32_bf16 v[116:119], v[60:63], v[68:71], v[116:119]
    ds_read_b64_tr_b16 v[54:55], v4 offset:9216
    v_mfma_f32_16x16x32_bf16 v[120:123], v[60:63], v[72:75], v[120:123]
    v_rcp_f32 v166, v166
    v_mfma_f32_16x16x32_bf16 v[124:127], v[60:63], v[76:79], v[124:127]
    v_exp_f32 v169, v169
    v_mfma_f32_16x16x32_bf16 v[96:99], v[40:43], v[80:83], v[96:99]
    ds_read_b64_tr_b16 v[56:57], v4 offset:4096
    v_mul_f32 v166, v166, v182
    v_mul_f32 v183, v167, v183
    v_mfma_f32_16x16x32_bf16 v[100:103], v[40:43], v[84:87], v[100:103]
    ds_read_b64_tr_b16 v[58:59], v4 offset:5120
    v_mul_f32 v167, s56, v167
    v_mfma_f32_16x16x32_bf16 v[104:107], v[40:43], v[88:91], v[104:107]
    v_exp_f32 v167, v167
    v_mfma_f32_16x16x32_bf16 v[108:111], v[40:43], v[92:95], v[108:111]
    s_waitcnt lgkmcnt(2)
    v_rcp_f32 v172, v172
    v_mfma_f32_16x16x32_bf16 v[112:115], v[44:47], v[80:83], v[112:115]
    ds_read_b64_tr_b16 v[60:61], v4 offset:12288
    v_add_f32 v167, 1.0, v167
    v_mfma_f32_16x16x32_bf16 v[116:119], v[44:47], v[84:87], v[116:119]
    ds_read_b64_tr_b16 v[62:63], v4 offset:13312
    v_add_f32 v169, 1.0, v169
    v_mfma_f32_16x16x32_bf16 v[120:123], v[44:47], v[88:91], v[120:123]
    v_rcp_f32 v167, v167
    s_nop 0
    v_mul_f32 v167, v167, v183
    v_mfma_f32_16x16x32_bf16 v[124:127], v[44:47], v[92:95], v[124:127]
    v_rcp_f32 v169, v169
    v_mfma_f32_16x16x32_bf16 v[128:131], v[48:51], v[64:67], v[128:131]
    v_xor_b32 v3, 64, v3
    v_min_u32 v20, 15, v0
    v_mfma_f32_16x16x32_bf16 v[132:135], v[48:51], v[68:71], v[132:135]
    v_add_u32 v3, 0xfffe0000, v3
    v_lshlrev_b32 v20, 2, v20
    v_mfma_f32_16x16x32_bf16 v[136:139], v[48:51], v[72:75], v[136:139]
    ds_read_b64_tr_b16 v[40:41], v3 offset:0
    v_cvt_pk_bf16_f32 v215, v166, v167
    v_mfma_f32_16x16x32_bf16 v[140:143], v[48:51], v[76:79], v[140:143]
    ds_read_b64_tr_b16 v[42:43], v3 offset:1024
    v_mul_f32 v169, v169, v185
    v_mfma_f32_16x16x32_bf16 v[144:147], v[52:55], v[64:67], v[144:147]
    buffer_load_dword v21, v20, s[20:23], s69 offen offset:0 sc1
    v_cvt_pk_bf16_f32 v218, v168, v169
    v_mfma_f32_16x16x32_bf16 v[148:151], v[52:55], v[68:71], v[148:151]
    buffer_load_dwordx2 v[200:201], v19, s[8:11], 0 offen offset:128
    v_mfma_f32_16x16x32_bf16 v[152:155], v[52:55], v[72:75], v[152:155]
    ds_read_b64_tr_b16 v[44:45], v3 offset:8192
    v_mul_f32 v186, v170, v186
    v_mfma_f32_16x16x32_bf16 v[156:159], v[52:55], v[76:79], v[156:159]
    s_waitcnt lgkmcnt(3)
    ds_read_b64_tr_b16 v[46:47], v3 offset:9216
    v_mul_f32 v170, s56, v170
    v_mfma_f32_16x16x32_bf16 v[128:131], v[56:59], v[80:83], v[128:131]
    buffer_load_dwordx2 v[202:203], v19, s[8:11], 0 offen offset:160
    v_mfma_f32_16x16x32_bf16 v[132:135], v[56:59], v[84:87], v[132:135]
    ds_read_b64_tr_b16 v[48:49], v3 offset:4096
    v_mul_f32 v172, v172, v188
    v_mfma_f32_16x16x32_bf16 v[136:139], v[56:59], v[88:91], v[136:139]
    ds_read_b64_tr_b16 v[50:51], v3 offset:5120
    v_mul_f32 v189, v173, v189
    v_exp_f32 v170, v170
    v_mfma_f32_16x16x32_bf16 v[140:143], v[56:59], v[92:95], v[140:143]
    s_waitcnt vmcnt(13)
    v_cmp_eq_u32 s[78:79], 0, v32
    v_add_f32 v170, 1.0, v170
    v_mfma_f32_16x16x32_bf16 v[144:147], v[60:63], v[80:83], v[144:147]
    buffer_store_dword v4, v6, s[20:23], s62 offen sc1
    v_mfma_f32_16x16x32_bf16 v[148:151], v[60:63], v[84:87], v[148:151]
    s_cmp_lg_u64 s[78:79], 0
    s_cbranch_scc1 gated_mix__ssm_conv_s5__swiglu_ffn__prompt_kernel_gp_s
gated_mix__ssm_conv_s5__swiglu_ffn__prompt_kernel_gp:
    ds_read_b64_tr_b16 v[52:53], v3 offset:12288
    v_mul_f32 v173, s56, v173
    v_mfma_f32_16x16x32_bf16 v[152:155], v[60:63], v[88:91], v[152:155]
    s_mov_b32 s86, 23592960
    ds_read_b64_tr_b16 v[54:55], v3 offset:13312
    v_mul_f32 v112, v96, v112
    v_mfma_f32_16x16x32_bf16 v[156:159], v[60:63], v[92:95], v[156:159]
    s_waitcnt lgkmcnt(3)
    v_rcp_f32 v170, v170
    v_mfma_f32_16x16x32_bf16 v[224:227], v[40:43], a[0:3], 0
    buffer_load_dword v32, v18, s[20:23], s86 offen sc1
    v_lshlrev_b32 v19, 1, v19
    v_mfma_f32_16x16x32_bf16 v[228:231], v[40:43], a[4:7], 0
    s_add_u32 s49, s58, 0
    ds_read_b64_tr_b16 v[56:57], v3 offset:16384
    v_bfe_u32 v34, v0, 2, 3
    v_mfma_f32_16x16x32_bf16 v[232:235], v[40:43], a[8:11], 0
    ds_read_b64_tr_b16 v[58:59], v3 offset:17408
    v_lshlrev_b32 v34, 7, v34
    v_mfma_f32_16x16x32_bf16 v[236:239], v[40:43], a[12:15], 0
    v_exp_f32 v173, v173
    v_mfma_f32_16x16x32_bf16 v[240:243], v[44:47], a[0:3], 0
    ds_read_b64_tr_b16 v[60:61], v3 offset:24576
    v_bfe_u32 v39, v0, 3, 2
    v_mfma_f32_16x16x32_bf16 v[244:247], v[44:47], a[4:7], 0
    ds_read_b64_tr_b16 v[62:63], v3 offset:25600
    v_lshl_add_u32 v34, v39, 5, v34
    v_mfma_f32_16x16x32_bf16 v[248:251], v[44:47], a[8:11], 0
    v_and_b32 v39, 3, v0
    v_lshl_add_u32 v34, v39, 3, v34
    v_and_b32 v39, 32, v0
    v_mfma_f32_16x16x32_bf16 v[252:255], v[44:47], a[12:15], 0
    s_waitcnt lgkmcnt(3)
    v_mul_u32_u24 v39, 96, v39
    s_lshr_b32 s51, s6, 1
    v_mfma_f32_16x16x32_bf16 v[224:227], v[48:51], a[16:19], v[224:227]
    s_branch gated_mix__ssm_conv_s5__swiglu_ffn__prompt_kernel_A_sk5
.p2align 12
gated_mix__ssm_conv_s5__swiglu_ffn__prompt_kernel_A_pg1_5:
    s_branch gated_mix__ssm_conv_s5__swiglu_ffn__prompt_kernel_A_pr1
gated_mix__ssm_conv_s5__swiglu_ffn__prompt_kernel_A_sk5:
    s_mul_i32 s51, s51, 6
    ds_read_b64_tr_b16 v[40:41], v3 offset:20480
    v_mul_f32 v170, v170, v186
    v_mfma_f32_16x16x32_bf16 v[228:231], v[48:51], a[20:23], v[228:231]
    s_and_b32 s78, s51, 3
    ds_read_b64_tr_b16 v[42:43], v3 offset:21504
    v_mul_f32 v187, v171, v187
    v_mfma_f32_16x16x32_bf16 v[232:235], v[48:51], a[24:27], v[232:235]
    s_lshl_b32 s78, s78, 5
    v_mul_f32 v171, s56, v171
    s_lshr_b32 s79, s51, 2
    v_mfma_f32_16x16x32_bf16 v[236:239], v[48:51], a[28:31], v[236:239]
    s_lshl_b32 s79, s79, 10
    v_exp_f32 v171, v171
    v_mfma_f32_16x16x32_bf16 v[240:243], v[52:55], a[16:19], v[240:243]
    s_or_b32 s78, s78, s79
    ds_read_b64_tr_b16 v[44:45], v3 offset:28672
    v_xad_u32 v23, v34, s78, v39
    v_add_f32 v171, 1.0, v171
    v_mfma_f32_16x16x32_bf16 v[244:247], v[52:55], a[20:23], v[244:247]
    s_add_u32 s51, s51, 1
    ds_read_b64_tr_b16 v[46:47], v3 offset:29696
    v_add_f32 v173, 1.0, v173
    v_mfma_f32_16x16x32_bf16 v[248:251], v[52:55], a[24:27], v[248:251]
    s_and_b32 s78, s51, 3
    v_rcp_f32 v171, v171
    v_mfma_f32_16x16x32_bf16 v[252:255], v[52:55], a[28:31], v[252:255]
    s_waitcnt lgkmcnt(2)
    v_rcp_f32 v173, v173
    v_mfma_f32_16x16x32_bf16 v[224:227], v[56:59], a[32:35], v[224:227]
    s_lshl_b32 s78, s78, 5
    v_add_u32 v3, 0x10000, v3
    v_mul_f32 v171, v171, v187
    v_mfma_f32_16x16x32_bf16 v[228:231], v[56:59], a[36:39], v[228:231]
    s_lshr_b32 s79, s51, 2
    ds_read_b64_tr_b16 v[48:49], v3 offset:32768
    v_cvt_pk_bf16_f32 v219, v170, v171
    v_mfma_f32_16x16x32_bf16 v[232:235], v[56:59], a[40:43], v[232:235]
    s_lshl_b32 s79, s79, 10
    ds_read_b64_tr_b16 v[50:51], v3 offset:33792
    v_mul_f32 v173, v173, v189
    v_cvt_pk_bf16_f32 v222, v172, v173
    v_mfma_f32_16x16x32_bf16 v[236:239], v[56:59], a[44:47], v[236:239]
    s_or_b32 s78, s78, s79
    v_xad_u32 v24, v34, s78, v39
    s_add_u32 s51, s51, 1
    v_mfma_f32_16x16x32_bf16 v[240:243], v[60:63], a[32:35], v[240:243]
    s_and_b32 s78, s51, 3
    ds_read_b64_tr_b16 v[52:53], v3 offset:40960
    v_mul_f32 v190, v174, v190
    v_mfma_f32_16x16x32_bf16 v[244:247], v[60:63], a[36:39], v[244:247]
    s_lshl_b32 s78, s78, 5
    ds_read_b64_tr_b16 v[54:55], v3 offset:41984
    v_mul_f32 v174, s56, v174
    v_mfma_f32_16x16x32_bf16 v[248:251], v[60:63], a[40:43], v[248:251]
    s_lshr_b32 s79, s51, 2
    v_exp_f32 v174, v174
    v_mfma_f32_16x16x32_bf16 v[252:255], v[60:63], a[44:47], v[252:255]
    s_lshl_b32 s79, s79, 10
    v_add_f32 v174, 1.0, v174
    s_or_b32 s78, s78, s79
    v_mfma_f32_16x16x32_bf16 v[224:227], v[40:43], a[48:51], v[224:227]
    ds_read_b64_tr_b16 v[56:57], v3 offset:36864
    v_xad_u32 v25, v34, s78, v39
    v_rcp_f32 v174, v174
    v_mfma_f32_16x16x32_bf16 v[228:231], v[40:43], a[52:55], v[228:231]
    s_add_u32 s51, s51, 1
    ds_read_b64_tr_b16 v[58:59], v3 offset:37888
    v_mul_f32 v174, v174, v190
    v_mfma_f32_16x16x32_bf16 v[232:235], v[40:43], a[56:59], v[232:235]
    s_and_b32 s78, s51, 3
    v_mul_f32 v191, v175, v191
    s_lshl_b32 s78, s78, 5
    v_mfma_f32_16x16x32_bf16 v[236:239], v[40:43], a[60:63], v[236:239]
    s_waitcnt lgkmcnt(2)
    v_mul_f32 v175, s56, v175
    s_lshr_b32 s79, s51, 2
    v_mfma_f32_16x16x32_bf16 v[240:243], v[44:47], a[48:51], v[240:243]
    s_lshl_b32 s79, s79, 10
    ds_read_b64_tr_b16 v[60:61], v3 offset:45056
    v_mul_f32 v96, s56, v96
    v_mfma_f32_16x16x32_bf16 v[244:247], v[44:47], a[52:55], v[244:247]
    s_or_b32 s78, s78, s79
    ds_read_b64_tr_b16 v[62:63], v3 offset:46080
    v_xad_u32 v26, v34, s78, v39
    v_mfma_f32_16x16x32_bf16 v[248:251], v[44:47], a[56:59], v[248:251]
    s_add_u32 s51, s51, 1
    v_exp_f32 v175, v175
    s_nop 0
    v_add_f32 v175, 1.0, v175
    v_mfma_f32_16x16x32_bf16 v[252:255], v[44:47], a[60:63], v[252:255]
    s_and_b32 s78, s6, 1
    v_rcp_f32 v175, v175
    v_mfma_f32_16x16x32_bf16 v[224:227], v[48:51], a[192:195], v[224:227]
    s_lshl_b32 s78, s78, 12
    v_add_u32 v3, 0xffff0000, v3
    v_mul_f32 v175, v175, v191
    v_mfma_f32_16x16x32_bf16 v[228:231], v[48:51], a[196:199], v[228:231]
    s_add_u32 s78, s78, 98304
    ds_read_b64_tr_b16 v[40:41], v3 offset:32768
    v_cvt_pk_bf16_f32 v223, v174, v175
    v_mfma_f32_16x16x32_bf16 v[232:235], v[48:51], a[200:203], v[232:235]
    buffer_store_dwordx4 v[208:211], v5, s[20:23], s65 offen offset:0 sc1
    v_mfma_f32_16x16x32_bf16 v[236:239], v[48:51], a[204:207], v[236:239]
    s_xor_b32 s51, s3, 0
    ds_read_b64_tr_b16 v[42:43], v3 offset:33792
    v_mul_f32 v116, v100, v116
    v_mfma_f32_16x16x32_bf16 v[240:243], v[52:55], a[192:195], v[240:243]
    s_lshl_b32 s51, s51, 10
    ds_read_b64_tr_b16 v[44:45], v3 offset:40960
    v_mul_f32 v100, s56, v100
    v_exp_f32 v96, v96
    v_mfma_f32_16x16x32_bf16 v[244:247], v[52:55], a[196:199], v[244:247]
    s_add_u32 s51, s51, s78
    ds_read_b64_tr_b16 v[46:47], v3 offset:41984
    v_add_u32 v16, s51, v5
    v_mfma_f32_16x16x32_bf16 v[248:251], v[52:55], a[200:203], v[248:251]
    buffer_store_dwordx4 v[212:215], v5, s[20:23], s65 offen offset:1024 sc1
    v_mfma_f32_16x16x32_bf16 v[252:255], v[52:55], a[204:207], v[252:255]
    s_waitcnt lgkmcnt(3)
    v_exp_f32 v100, v100
    v_mfma_f32_16x16x32_bf16 v[224:227], v[56:59], a[208:211], v[224:227]
    s_xor_b32 s51, s3, 1
    ds_read_b64_tr_b16 v[48:49], v3 offset:36864
    v_add_f32 v96, 1.0, v96
    v_mfma_f32_16x16x32_bf16 v[228:231], v[56:59], a[212:215], v[228:231]
    s_lshl_b32 s51, s51, 10
    ds_read_b64_tr_b16 v[50:51], v3 offset:37888
    v_add_f32 v100, 1.0, v100
    v_mfma_f32_16x16x32_bf16 v[232:235], v[56:59], a[216:219], v[232:235]
    buffer_store_dwordx4 v[216:219], v5, s[20:23], s65 offen offset:2048 sc1
    v_rcp_f32 v96, v96
    v_mfma_f32_16x16x32_bf16 v[236:239], v[56:59], a[220:223], v[236:239]
    s_add_u32 s51, s51, s78
    v_rcp_f32 v100, v100
    v_mfma_f32_16x16x32_bf16 v[240:243], v[60:63], a[208:211], v[240:243]
    ds_read_b64_tr_b16 v[52:53], v3 offset:45056
    v_add_u32 v17, s51, v5
    v_mfma_f32_16x16x32_bf16 v[244:247], v[60:63], a[212:215], v[244:247]
    s_xor_b32 s51, s3, 2
    ds_read_b64_tr_b16 v[54:55], v3 offset:46080
    v_mul_f32 v96, v96, v112
    v_mfma_f32_16x16x32_bf16 v[248:251], v[60:63], a[216:219], v[248:251]
    buffer_store_dwordx4 v[220:223], v5, s[20:23], s65 offen offset:3072 sc1
    v_mfma_f32_16x16x32_bf16 v[252:255], v[60:63], a[220:223], v[252:255]
    s_waitcnt lgkmcnt(2)
    v_mul_f32 v113, v97, v113
    s_lshl_b32 s51, s51, 10
    v_mfma_f32_16x16x32_bf16 v[224:227], v[40:43], a[64:67], v[224:227]
    s_add_u32 s51, s51, s78
    v_xor_b32 v4, 64, v4
    v_add_u32 v27, s51, v5
    v_mul_f32 v97, s56, v97
    v_mfma_f32_16x16x32_bf16 v[228:231], v[40:43], a[68:71], v[228:231]
    s_xor_b32 s51, s3, 3
    v_add_u32 v4, 0xfffe0000, v4
    v_mul_f32 v100, v100, v116
    v_mfma_f32_16x16x32_bf16 v[232:235], v[40:43], a[72:75], v[232:235]
    s_lshl_b32 s51, s51, 10
    ds_read_b64_tr_b16 v[56:57], v4 offset:0
    v_mul_f32 v117, v101, v117
    v_mfma_f32_16x16x32_bf16 v[236:239], v[40:43], a[76:79], v[236:239]
    s_add_u32 s51, s51, s78
    ds_read_b64_tr_b16 v[58:59], v4 offset:1024
    v_add_u32 v38, s51, v5
    v_mfma_f32_16x16x32_bf16 v[240:243], v[44:47], a[64:67], v[240:243]
    ds_read_b64_tr_b16 v[60:61], v4 offset:8192
    v_add_u32 v8, 49152, v23
    v_mfma_f32_16x16x32_bf16 v[244:247], v[44:47], a[68:71], v[244:247]
    ds_read_b64_tr_b16 v[62:63], v4 offset:9216
    v_add_u32 v9, 49152, v24
    v_mfma_f32_16x16x32_bf16 v[248:251], v[44:47], a[72:75], v[248:251]
    v_exp_f32 v97, v97
    v_add_u32 v10, 49152, v25
    v_mfma_f32_16x16x32_bf16 v[252:255], v[44:47], a[76:79], v[252:255]
    v_add_u32 v11, 49152, v26
    v_add_f32 v97, 1.0, v97
    v_mfma_f32_16x16x32_bf16 v[224:227], v[48:51], a[80:83], v[224:227]
    ds_read_b64_tr_b16 v[40:41], v4 offset:4096
    v_mul_f32 v101, s56, v101
    v_mfma_f32_16x16x32_bf16 v[228:231], v[48:51], a[84:87], v[228:231]
    ds_read_b64_tr_b16 v[42:43], v4 offset:5120
    v_mul_f32 v120, v104, v120
    v_mfma_f32_16x16x32_bf16 v[232:235], v[48:51], a[88:91], v[232:235]
    v_rcp_f32 v97, v97
    v_mfma_f32_16x16x32_bf16 v[236:239], v[48:51], a[92:95], v[236:239]
    s_waitcnt lgkmcnt(2)
    v_exp_f32 v101, v101
    v_mfma_f32_16x16x32_bf16 v[240:243], v[52:55], a[80:83], v[240:243]
    ds_read_b64_tr_b16 v[44:45], v4 offset:12288
    v_mul_f32 v97, v97, v113
    v_cvt_pk_bf16_f32 v208, v96, v97
    v_mfma_f32_16x16x32_bf16 v[244:247], v[52:55], a[84:87], v[244:247]
    ds_read_b64_tr_b16 v[46:47], v4 offset:13312
    v_mul_f32 v114, v98, v114
    v_mfma_f32_16x16x32_bf16 v[248:251], v[52:55], a[88:91], v[248:251]
    v_mul_f32 v98, s56, v98
    v_add_f32 v101, 1.0, v101
    v_mfma_f32_16x16x32_bf16 v[252:255], v[52:55], a[92:95], v[252:255]
    v_exp_f32 v98, v98
    v_mfma_f32_16x16x32_bf16 v[160:163], v[56:59], a[0:3], 0
    ds_read_b64_tr_b16 v[48:49], v4 offset:16384
    v_add_f32 v98, 1.0, v98
    v_mfma_f32_16x16x32_bf16 v[164:167], v[56:59], a[4:7], 0
    ds_read_b64_tr_b16 v[50:51], v4 offset:17408
    v_mul_f32 v104, s56, v104
    v_mfma_f32_16x16x32_bf16 v[168:171], v[56:59], a[8:11], 0
    v_rcp_f32 v98, v98
    s_nop 0
    v_mul_f32 v98, v98, v114
    v_mfma_f32_16x16x32_bf16 v[172:175], v[56:59], a[12:15], 0
    v_rcp_f32 v101, v101
    v_mfma_f32_16x16x32_bf16 v[176:179], v[60:63], a[0:3], 0
    ds_read_b64_tr_b16 v[52:53], v4 offset:24576
    v_mul_f32 v115, v99, v115
    v_mfma_f32_16x16x32_bf16 v[180:183], v[60:63], a[4:7], 0
    ds_read_b64_tr_b16 v[54:55], v4 offset:25600
    v_mul_f32 v99, s56, v99
    v_mfma_f32_16x16x32_bf16 v[184:187], v[60:63], a[8:11], 0
    v_exp_f32 v99, v99
    v_mfma_f32_16x16x32_bf16 v[188:191], v[60:63], a[12:15], 0
    s_waitcnt lgkmcnt(2)
    v_exp_f32 v104, v104
    v_mfma_f32_16x16x32_bf16 v[160:163], v[40:43], a[16:19], v[160:163]
    ds_read_b64_tr_b16 v[56:57], v4 offset:20480
    v_add_f32 v99, 1.0, v99
    v_rcp_f32 v99, v99
    v_mfma_f32_16x16x32_bf16 v[164:167], v[40:43], a[20:23], v[164:167]
    ds_read_b64_tr_b16 v[58:59], v4 offset:21504
    v_mul_f32 v99, v99, v115
    v_mfma_f32_16x16x32_bf16 v[168:171], v[40:43], a[24:27], v[168:171]
    v_cvt_pk_bf16_f32 v209, v98, v99
    v_mul_f32 v101, v101, v117
    v_mfma_f32_16x16x32_bf16 v[172:175], v[40:43], a[28:31], v[172:175]
    v_cvt_pk_bf16_f32 v212, v100, v101
    v_mul_f32 v118, v102, v118
    v_mfma_f32_16x16x32_bf16 v[176:179], v[44:47], a[16:19], v[176:179]
    ds_read_b64_tr_b16 v[60:61], v4 offset:28672
    v_mul_f32 v102, s56, v102
    v_mfma_f32_16x16x32_bf16 v[180:183], v[44:47], a[20:23], v[180:183]
    ds_read_b64_tr_b16 v[62:63], v4 offset:29696
    v_add_f32 v104, 1.0, v104
    v_mfma_f32_16x16x32_bf16 v[184:187], v[44:47], a[24:27], v[184:187]
    v_exp_f32 v102, v102
    s_nop 0
    v_add_f32 v102, 1.0, v102
    v_mfma_f32_16x16x32_bf16 v[188:191], v[44:47], a[28:31], v[188:191]
    v_rcp_f32 v102, v102
    v_mfma_f32_16x16x32_bf16 v[160:163], v[48:51], a[32:35], v[160:163]
    v_add_u32 v4, 0x10000, v4
    v_mul_f32 v102, v102, v118
    v_mfma_f32_16x16x32_bf16 v[164:167], v[48:51], a[36:39], v[164:167]
    ds_read_b64_tr_b16 v[40:41], v4 offset:32768
    v_mul_f32 v119, v103, v119
    v_mfma_f32_16x16x32_bf16 v[168:171], v[48:51], a[40:43], v[168:171]
    ds_read_b64_tr_b16 v[42:43], v4 offset:33792
    v_mul_f32 v103, s56, v103
    v_mfma_f32_16x16x32_bf16 v[172:175], v[48:51], a[44:47], v[172:175]
    s_waitcnt lgkmcnt(2)
    v_exp_f32 v103, v103
    v_mfma_f32_16x16x32_bf16 v[176:179], v[52:55], a[32:35], v[176:179]
    ds_read_b64_tr_b16 v[44:45], v4 offset:40960
    v_add_f32 v103, 1.0, v103
    v_rcp_f32 v103, v103
    v_mfma_f32_16x16x32_bf16 v[180:183], v[52:55], a[36:39], v[180:183]
    ds_read_b64_tr_b16 v[46:47], v4 offset:41984
    v_mul_f32 v103, v103, v119
    v_mfma_f32_16x16x32_bf16 v[184:187], v[52:55], a[40:43], v[184:187]
    v_rcp_f32 v104, v104
    v_mfma_f32_16x16x32_bf16 v[188:191], v[52:55], a[44:47], v[188:191]
    v_cvt_pk_bf16_f32 v213, v102, v103
    v_mul_f32 v104, v104, v120
    v_mfma_f32_16x16x32_bf16 v[160:163], v[56:59], a[48:51], v[160:163]
    ds_read_b64_tr_b16 v[48:49], v4 offset:36864
    v_mul_f32 v121, v105, v121
    v_mfma_f32_16x16x32_bf16 v[164:167], v[56:59], a[52:55], v[164:167]
    ds_read_b64_tr_b16 v[50:51], v4 offset:37888
    v_mul_f32 v105, s56, v105
    v_mfma_f32_16x16x32_bf16 v[168:171], v[56:59], a[56:59], v[168:171]
    v_exp_f32 v105, v105
    s_nop 0
    v_add_f32 v105, 1.0, v105
    v_mfma_f32_16x16x32_bf16 v[172:175], v[56:59], a[60:63], v[172:175]
    v_rcp_f32 v105, v105
    v_mfma_f32_16x16x32_bf16 v[176:179], v[60:63], a[48:51], v[176:179]
    ds_read_b64_tr_b16 v[52:53], v4 offset:45056
    v_mul_f32 v105, v105, v121
    v_mfma_f32_16x16x32_bf16 v[180:183], v[60:63], a[52:55], v[180:183]
    ds_read_b64_tr_b16 v[54:55], v4 offset:46080
    v_cvt_pk_bf16_f32 v216, v104, v105
    v_mfma_f32_16x16x32_bf16 v[184:187], v[60:63], a[56:59], v[184:187]
    v_mul_f32 v122, v106, v122
    v_mul_f32 v106, s56, v106
    v_mfma_f32_16x16x32_bf16 v[188:191], v[60:63], a[60:63], v[188:191]
    s_waitcnt lgkmcnt(2)
    s_barrier
    v_mul_f32 v124, v108, v124
    v_mfma_f32_16x16x32_bf16 v[160:163], v[40:43], a[192:195], v[160:163]
    s_add_u32 m0, s67, 0
    v_add_u32 v4, 0xffff0000, v4
    v_mul_f32 v108, s56, v108
    v_exp_f32 v106, v106
    v_mfma_f32_16x16x32_bf16 v[164:167], v[40:43], a[196:199], v[164:167]
    buffer_load_dwordx4 v22, s[24:27], s49 offen offset:0 lds
    v_mfma_f32_16x16x32_bf16 v[168:171], v[40:43], a[200:203], v[168:171]
    s_waitcnt vmcnt(9)
    ds_read_b64_tr_b16 v[56:57], v4 offset:32768
    v_cmp_eq_u32 s[76:77], 0, v21
    v_mfma_f32_16x16x32_bf16 v[172:175], v[40:43], a[204:207], v[172:175]
    s_add_u32 m0, s67, 896
    ds_read_b64_tr_b16 v[58:59], v4 offset:33792
    v_add_f32 v106, 1.0, v106
    v_mfma_f32_16x16x32_bf16 v[176:179], v[44:47], a[192:195], v[176:179]
    s_cmp_lg_u64 s[76:77], 0
    s_cbranch_scc1 gated_mix__ssm_conv_s5__swiglu_ffn__prompt_kernel_hp0_s
gated_mix__ssm_conv_s5__swiglu_ffn__prompt_kernel_hp0:
    ds_read_b64_tr_b16 v[60:61], v4 offset:40960
    v_mul_f32 v144, v128, v144
    v_mfma_f32_16x16x32_bf16 v[180:183], v[44:47], a[196:199], v[180:183]
    buffer_load_dwordx4 v22, s[24:27], s49 offen offset:128 lds
    v_mfma_f32_16x16x32_bf16 v[184:187], v[44:47], a[200:203], v[184:187]
    s_add_u32 m0, s68, 147456
    ds_read_b64_tr_b16 v[62:63], v4 offset:41984
    v_mul_f32 v128, s56, v128
    v_rcp_f32 v106, v106
    v_mfma_f32_16x16x32_bf16 v[188:191], v[44:47], a[204:207], v[188:191]
    v_exp_f32 v108, v108
    v_mfma_f32_16x16x32_bf16 v[160:163], v[48:51], a[208:211], v[160:163]
    ds_read_b64_tr_b16 v[40:41], v4 offset:36864
    v_mul_f32 v106, v106, v122
    v_mfma_f32_16x16x32_bf16 v[164:167], v[48:51], a[212:215], v[164:167]
    buffer_load_dwordx4 v5, s[20:23], s82 offen offset:0 sc1  lds
    v_mfma_f32_16x16x32_bf16 v[168:171], v[48:51], a[216:219], v[168:171]
    ds_read_b64_tr_b16 v[42:43], v4 offset:37888
    v_mul_f32 v123, v107, v123
    v_mfma_f32_16x16x32_bf16 v[172:175], v[48:51], a[220:223], v[172:175]
    s_waitcnt lgkmcnt(3)
    v_exp_f32 v128, v128
    v_mfma_f32_16x16x32_bf16 v[176:179], v[52:55], a[208:211], v[176:179]
    ds_read_b64_tr_b16 v[44:45], v4 offset:45056
    v_mul_f32 v107, s56, v107
    v_exp_f32 v107, v107
    v_mfma_f32_16x16x32_bf16 v[180:183], v[52:55], a[212:215], v[180:183]
    buffer_load_dwordx4 v5, s[20:23], s82 offen offset:1024 sc1  lds
    v_mfma_f32_16x16x32_bf16 v[184:187], v[52:55], a[216:219], v[184:187]
    s_add_u32 s82, s66, 16384
    ds_read_b64_tr_b16 v[46:47], v4 offset:46080
    v_add_f32 v107, 1.0, v107
    v_mfma_f32_16x16x32_bf16 v[188:191], v[52:55], a[220:223], v[188:191]
    s_add_u32 m0, s67, 1792
    v_rcp_f32 v107, v107
    v_mfma_f32_16x16x32_bf16 v[160:163], v[56:59], a[64:67], v[160:163]
    ds_read_b64_tr_b16 v[48:49], v3 offset:49152
    v_mul_f32 v107, v107, v123
    v_mfma_f32_16x16x32_bf16 v[164:167], v[56:59], a[68:71], v[164:167]
    buffer_load_dwordx4 v22, s[24:27], s49 offen offset:256 lds
    v_mfma_f32_16x16x32_bf16 v[168:171], v[56:59], a[72:75], v[168:171]
    s_add_u32 m0, s68, 155648
    ds_read_b64_tr_b16 v[50:51], v3 offset:50176
    v_cvt_pk_bf16_f32 v217, v106, v107
    v_add_f32 v108, 1.0, v108
    v_mfma_f32_16x16x32_bf16 v[172:175], v[56:59], a[76:79], v[172:175]
    s_waitcnt lgkmcnt(3)
    v_rcp_f32 v108, v108
    v_mfma_f32_16x16x32_bf16 v[176:179], v[60:63], a[64:67], v[176:179]
    s_add_u32 s49, s58, 147456
    ds_read_b64_tr_b16 v[52:53], v3 offset:57344
    v_mul_f32 v108, v108, v124
    v_mfma_f32_16x16x32_bf16 v[180:183], v[60:63], a[68:71], v[180:183]
    buffer_load_dwordx4 v5, s[20:23], s82 offen offset:0 sc1  lds
    v_mfma_f32_16x16x32_bf16 v[184:187], v[60:63], a[72:75], v[184:187]
    s_waitcnt vmcnt(6)
    ds_read_b64_tr_b16 v[54:55], v3 offset:58368
    v_mul_f32 v125, v109, v125
    v_mfma_f32_16x16x32_bf16 v[188:191], v[60:63], a[76:79], v[188:191]
    buffer_store_dword v4, v6, s[20:23], s61 offen offset:128 sc1
    v_mfma_f32_16x16x32_bf16 v[160:163], v[40:43], a[80:83], v[160:163]
    ds_read_b64_tr_b16 v[56:57], v3 offset:53248
    v_mul_f32 v109, s56, v109
    v_exp_f32 v109, v109
    v_mfma_f32_16x16x32_bf16 v[164:167], v[40:43], a[84:87], v[164:167]
    buffer_load_dwordx4 v5, s[20:23], s82 offen offset:1024 sc1  lds
    v_mfma_f32_16x16x32_bf16 v[168:171], v[40:43], a[88:91], v[168:171]
    s_add_u32 s82, s66, 32768
    ds_read_b64_tr_b16 v[58:59], v3 offset:54272
    v_add_f32 v109, 1.0, v109
    v_mfma_f32_16x16x32_bf16 v[172:175], v[40:43], a[92:95], v[172:175]
    s_waitcnt lgkmcnt(3)
    v_rcp_f32 v109, v109
    v_mfma_f32_16x16x32_bf16 v[176:179], v[44:47], a[80:83], v[176:179]
    s_add_u32 m0, s67, 12288
    ds_read_b64_tr_b16 v[60:61], v3 offset:61440
    v_mul_f32 v109, v109, v125
    v_mfma_f32_16x16x32_bf16 v[180:183], v[44:47], a[84:87], v[180:183]
    buffer_load_dwordx4 v22, s[24:27], s49 offen offset:0 lds
    v_mfma_f32_16x16x32_bf16 v[184:187], v[44:47], a[88:91], v[184:187]
    s_add_u32 m0, s67, 13184
    ds_read_b64_tr_b16 v[62:63], v3 offset:62464
    v_cvt_pk_bf16_f32 v220, v108, v109
    v_mul_f32 v126, v110, v126
    v_mfma_f32_16x16x32_bf16 v[188:191], v[44:47], a[92:95], v[188:191]
    s_waitcnt lgkmcnt(3)
    s_barrier
    v_mul_f32 v110, s56, v110
    v_mfma_f32_16x16x32_bf16 v[224:227], v[48:51], a[96:99], v[224:227]
    ds_read_b64_tr_b16 v[40:41], v4 offset:49152
    v_add_f32 v128, 1.0, v128
    v_mfma_f32_16x16x32_bf16 v[228:231], v[48:51], a[100:103], v[228:231]
    buffer_load_dwordx4 v22, s[24:27], s49 offen offset:128 lds
    v_mfma_f32_16x16x32_bf16 v[232:235], v[48:51], a[104:107], v[232:235]
    s_add_u32 m0, s68, 98304
    ds_read_b64_tr_b16 v[42:43], v4 offset:50176
    v_mul_f32 v148, v132, v148
    v_mfma_f32_16x16x32_bf16 v[236:239], v[48:51], a[108:111], v[236:239]
    v_exp_f32 v110, v110
    v_mfma_f32_16x16x32_bf16 v[240:243], v[52:55], a[96:99], v[240:243]
    ds_read_b64_tr_b16 v[44:45], v4 offset:57344
    v_add_f32 v110, 1.0, v110
    v_rcp_f32 v110, v110
    v_mfma_f32_16x16x32_bf16 v[244:247], v[52:55], a[100:103], v[244:247]
    buffer_load_dwordx4 v5, s[20:23], s82 offen offset:0 sc1  lds
    v_mfma_f32_16x16x32_bf16 v[248:251], v[52:55], a[104:107], v[248:251]
    ds_read_b64_tr_b16 v[46:47], v4 offset:58368
    v_mul_f32 v110, v110, v126
    v_mfma_f32_16x16x32_bf16 v[252:255], v[52:55], a[108:111], v[252:255]
    s_waitcnt lgkmcnt(3)
    v_rcp_f32 v128, v128
    v_mfma_f32_16x16x32_bf16 v[224:227], v[56:59], a[112:115], v[224:227]
    ds_read_b64_tr_b16 v[48:49], v4 offset:53248
    v_mul_f32 v127, v111, v127
    v_mfma_f32_16x16x32_bf16 v[228:231], v[56:59], a[116:119], v[228:231]
    buffer_load_dwordx4 v5, s[20:23], s82 offen offset:1024 sc1  lds
    v_mfma_f32_16x16x32_bf16 v[232:235], v[56:59], a[120:123], v[232:235]
    s_add_u32 s82, s66, 49152
    ds_read_b64_tr_b16 v[50:51], v4 offset:54272
    v_mul_f32 v111, s56, v111
    v_exp_f32 v111, v111
    v_mfma_f32_16x16x32_bf16 v[236:239], v[56:59], a[124:127], v[236:239]
    s_add_u32 m0, s67, 14080
    v_add_f32 v111, 1.0, v111
    v_mul_f32 v128, v128, v144
    v_mfma_f32_16x16x32_bf16 v[240:243], v[60:63], a[112:115], v[240:243]
    ds_read_b64_tr_b16 v[52:53], v4 offset:61440
    v_mul_f32 v145, v129, v145
    v_mfma_f32_16x16x32_bf16 v[244:247], v[60:63], a[116:119], v[244:247]
    buffer_load_dwordx4 v22, s[24:27], s49 offen offset:256 lds
    v_mfma_f32_16x16x32_bf16 v[248:251], v[60:63], a[120:123], v[248:251]
    s_add_u32 m0, s68, 106496
    ds_read_b64_tr_b16 v[54:55], v4 offset:62464
    v_mul_f32 v129, s56, v129
    v_mfma_f32_16x16x32_bf16 v[252:255], v[60:63], a[124:127], v[252:255]
    s_waitcnt lgkmcnt(3)
    v_rcp_f32 v111, v111
    v_mfma_f32_16x16x32_bf16 v[160:163], v[40:43], a[96:99], v[160:163]
    s_add_u32 s49, s58, 294912
    v_add_u32 v3, 0x10000, v3
    v_mul_f32 v111, v111, v127
    v_cvt_pk_bf16_f32 v221, v110, v111
    v_mfma_f32_16x16x32_bf16 v[164:167], v[40:43], a[100:103], v[164:167]
    buffer_load_dwordx4 v5, s[20:23], s82 offen offset:0 sc1  lds
    v_mfma_f32_16x16x32_bf16 v[168:171], v[40:43], a[104:107], v[168:171]
    ds_read_b64_tr_b16 v[56:57], v3 offset:49152
    v_mul_f32 v132, s56, v132
    v_mfma_f32_16x16x32_bf16 v[172:175], v[40:43], a[108:111], v[172:175]
    ds_read_b64_tr_b16 v[58:59], v3 offset:50176
    v_mul_f32 v152, v136, v152
    v_mfma_f32_16x16x32_bf16 v[176:179], v[44:47], a[96:99], v[176:179]
    ds_read_b64_tr_b16 v[60:61], v3 offset:57344
    v_mul_f32 v136, s56, v136
    v_mfma_f32_16x16x32_bf16 v[180:183], v[44:47], a[100:103], v[180:183]
    ds_read_b64_tr_b16 v[62:63], v3 offset:58368
    v_mul_f32 v156, v140, v156
    v_mfma_f32_16x16x32_bf16 v[184:187], v[44:47], a[104:107], v[184:187]
    v_exp_f32 v129, v129
    s_nop 0
    v_add_f32 v129, 1.0, v129
    v_mfma_f32_16x16x32_bf16 v[188:191], v[44:47], a[108:111], v[188:191]
    s_waitcnt lgkmcnt(4)
    v_rcp_f32 v129, v129
    v_mfma_f32_16x16x32_bf16 v[160:163], v[48:51], a[112:115], v[160:163]
    ds_read_b64_tr_b16 v[40:41], v3 offset:53248
    v_mul_f32 v129, v129, v145
    v_mfma_f32_16x16x32_bf16 v[164:167], v[48:51], a[116:119], v[164:167]
    ds_read_b64_tr_b16 v[42:43], v3 offset:54272
    v_cvt_pk_bf16_f32 v210, v128, v129
    v_mfma_f32_16x16x32_bf16 v[168:171], v[48:51], a[120:123], v[168:171]
    v_exp_f32 v132, v132
    v_mfma_f32_16x16x32_bf16 v[172:175], v[48:51], a[124:127], v[172:175]
    v_exp_f32 v136, v136
    v_mfma_f32_16x16x32_bf16 v[176:179], v[52:55], a[112:115], v[176:179]
    ds_read_b64_tr_b16 v[44:45], v3 offset:61440
    v_mul_f32 v146, v130, v146
    v_mul_f32 v130, s56, v130
    v_mfma_f32_16x16x32_bf16 v[180:183], v[52:55], a[116:119], v[180:183]
    ds_read_b64_tr_b16 v[46:47], v3 offset:62464
    v_add_f32 v132, 1.0, v132
    v_mfma_f32_16x16x32_bf16 v[184:187], v[52:55], a[120:123], v[184:187]
    v_exp_f32 v130, v130
    v_mfma_f32_16x16x32_bf16 v[188:191], v[52:55], a[124:127], v[188:191]
    s_waitcnt lgkmcnt(2)
    v_rcp_f32 v132, v132
    v_mfma_f32_16x16x32_bf16 v[224:227], v[56:59], a[224:227], v[224:227]
    v_add_u32 v4, 0x10000, v4
    v_add_f32 v130, 1.0, v130
    v_mfma_f32_16x16x32_bf16 v[228:231], v[56:59], a[228:231], v[228:231]
    ds_read_b64_tr_b16 v[48:49], v4 offset:49152
    v_mul_f32 v132, v132, v148
    v_mfma_f32_16x16x32_bf16 v[232:235], v[56:59], a[232:235], v[232:235]
    ds_read_b64_tr_b16 v[50:51], v4 offset:50176
    v_mul_f32 v149, v133, v149
    v_rcp_f32 v130, v130
    v_mfma_f32_16x16x32_bf16 v[236:239], v[56:59], a[236:239], v[236:239]
    v_mul_f32 v130, v130, v146
    v_mul_f32 v147, v131, v147
    v_mfma_f32_16x16x32_bf16 v[240:243], v[60:63], a[224:227], v[240:243]
    ds_read_b64_tr_b16 v[52:53], v4 offset:57344
    v_mul_f32 v131, s56, v131
    v_mfma_f32_16x16x32_bf16 v[244:247], v[60:63], a[228:231], v[244:247]
    ds_read_b64_tr_b16 v[54:55], v4 offset:58368
    v_mul_f32 v133, s56, v133
    v_mfma_f32_16x16x32_bf16 v[248:251], v[60:63], a[232:235], v[248:251]
    v_exp_f32 v131, v131
    v_mfma_f32_16x16x32_bf16 v[252:255], v[60:63], a[236:239], v[252:255]
    v_exp_f32 v133, v133
    v_mfma_f32_16x16x32_bf16 v[224:227], v[40:43], a[240:243], v[224:227]
    ds_read_b64_tr_b16 v[56:57], v4 offset:53248
    v_add_f32 v131, 1.0, v131
    v_rcp_f32 v131, v131
    v_mfma_f32_16x16x32_bf16 v[228:231], v[40:43], a[244:247], v[228:231]
    buffer_load_dwordx4 v5, s[20:23], s82 offen offset:1024 sc1  lds
    v_mfma_f32_16x16x32_bf16 v[232:235], v[40:43], a[248:251], v[232:235]
    s_add_u32 s82, s66, 65536
    ds_read_b64_tr_b16 v[58:59], v4 offset:54272
    v_mul_f32 v131, v131, v147
    v_mfma_f32_16x16x32_bf16 v[236:239], v[40:43], a[252:255], v[236:239]
    s_waitcnt lgkmcnt(2)
    v_cvt_pk_bf16_f32 v211, v130, v131
    s_add_u32 m0, s67, 24576
    v_mfma_f32_16x16x32_bf16 v[240:243], v[44:47], a[240:243], v[240:243]
    ds_read_b64_tr_b16 v[60:61], v4 offset:61440
    v_add_f32 v133, 1.0, v133
    v_mfma_f32_16x16x32_bf16 v[244:247], v[44:47], a[244:247], v[244:247]
    buffer_load_dwordx4 v22, s[24:27], s49 offen offset:0 lds
    v_mfma_f32_16x16x32_bf16 v[248:251], v[44:47], a[248:251], v[248:251]
    s_add_u32 m0, s67, 25472
    ds_read_b64_tr_b16 v[62:63], v4 offset:62464
    v_add_f32 v136, 1.0, v136
    v_rcp_f32 v133, v133
    v_mfma_f32_16x16x32_bf16 v[252:255], v[44:47], a[252:255], v[252:255]
    v_rcp_f32 v136, v136
    v_mfma_f32_16x16x32_bf16 v[160:163], v[48:51], a[224:227], v[160:163]
    ds_read_b64_tr_b16 v[40:41], v3 offset:0
    v_mul_f32 v133, v133, v149
    v_mfma_f32_16x16x32_bf16 v[164:167], v[48:51], a[228:231], v[164:167]
    buffer_load_dwordx4 v22, s[24:27], s49 offen offset:128 lds
    v_mfma_f32_16x16x32_bf16 v[168:171], v[48:51], a[232:235], v[168:171]
    s_add_u32 m0, s67, 26368
    ds_read_b64_tr_b16 v[42:43], v3 offset:1024
    v_cvt_pk_bf16_f32 v214, v132, v133
    v_mfma_f32_16x16x32_bf16 v[172:175], v[48:51], a[236:239], v[172:175]
    v_mul_f32 v150, v134, v150
    v_mul_f32 v134, s56, v134
    v_mfma_f32_16x16x32_bf16 v[176:179], v[52:55], a[224:227], v[176:179]
    ds_read_b64_tr_b16 v[44:45], v3 offset:8192
    v_mul_f32 v136, v136, v152
    v_exp_f32 v134, v134
    v_mfma_f32_16x16x32_bf16 v[180:183], v[52:55], a[228:231], v[180:183]
    buffer_load_dwordx4 v22, s[24:27], s49 offen offset:256 lds
    v_mfma_f32_16x16x32_bf16 v[184:187], v[52:55], a[232:235], v[184:187]
    s_add_u32 s49, s58, 442368
    ds_read_b64_tr_b16 v[46:47], v3 offset:9216
    v_add_f32 v134, 1.0, v134
    v_mfma_f32_16x16x32_bf16 v[188:191], v[52:55], a[236:239], v[188:191]
    s_waitcnt lgkmcnt(3)
    v_rcp_f32 v134, v134
    v_mfma_f32_16x16x32_bf16 v[160:163], v[56:59], a[240:243], v[160:163]
    s_add_u32 m0, s67, 36864
    ds_read_b64_tr_b16 v[48:49], v3 offset:4096
    v_mul_f32 v134, v134, v150
    v_mfma_f32_16x16x32_bf16 v[164:167], v[56:59], a[244:247], v[164:167]
    buffer_load_dwordx4 v22, s[24:27], s49 offen offset:0 lds
    v_mfma_f32_16x16x32_bf16 v[168:171], v[56:59], a[248:251], v[168:171]
    s_add_u32 m0, s67, 37760
    ds_read_b64_tr_b16 v[50:51], v3 offset:5120
    v_mul_f32 v151, v135, v151
    v_mul_f32 v135, s56, v135
    v_mfma_f32_16x16x32_bf16 v[172:175], v[56:59], a[252:255], v[172:175]
    v_exp_f32 v135, v135
    v_mfma_f32_16x16x32_bf16 v[176:179], v[60:63], a[240:243], v[176:179]
    ds_read_b64_tr_b16 v[52:53], v3 offset:12288
    v_add_f32 v135, 1.0, v135
    v_mfma_f32_16x16x32_bf16 v[180:183], v[60:63], a[244:247], v[180:183]
    buffer_load_dwordx4 v22, s[24:27], s49 offen offset:128 lds
    v_mfma_f32_16x16x32_bf16 v[184:187], v[60:63], a[248:251], v[184:187]
    s_add_u32 m0, s67, 38656
    ds_read_b64_tr_b16 v[54:55], v3 offset:13312
    v_mul_f32 v153, v137, v153
    v_mfma_f32_16x16x32_bf16 v[188:191], v[60:63], a[252:255], v[188:191]
    s_waitcnt lgkmcnt(3)
    s_barrier
    v_mul_f32 v137, s56, v137
    v_mfma_f32_16x16x32_bf16 v[224:227], v[40:43], a[128:131], v[224:227]
    ds_read_b64_tr_b16 v[56:57], v4 offset:0
    v_mul_f32 v140, s56, v140
    v_rcp_f32 v135, v135
    v_mfma_f32_16x16x32_bf16 v[228:231], v[40:43], a[132:135], v[228:231]
    buffer_load_dwordx4 v22, s[24:27], s49 offen offset:256 lds
    v_mfma_f32_16x16x32_bf16 v[232:235], v[40:43], a[136:139], v[232:235]
    s_add_u32 m0, s68, 114688
    ds_read_b64_tr_b16 v[58:59], v4 offset:1024
    v_mul_f32 v135, v135, v151
    v_mfma_f32_16x16x32_bf16 v[236:239], v[40:43], a[140:143], v[236:239]
    s_add_u32 s49, s58, 589824
    v_exp_f32 v137, v137
    v_mfma_f32_16x16x32_bf16 v[240:243], v[44:47], a[128:131], v[240:243]
    ds_read_b64_tr_b16 v[60:61], v4 offset:8192
    v_cvt_pk_bf16_f32 v215, v134, v135
    v_mfma_f32_16x16x32_bf16 v[244:247], v[44:47], a[132:135], v[244:247]
    buffer_load_dwordx4 v5, s[20:23], s82 offen offset:0 sc1  lds
    v_mfma_f32_16x16x32_bf16 v[248:251], v[44:47], a[136:139], v[248:251]
    ds_read_b64_tr_b16 v[62:63], v4 offset:9216
    v_add_f32 v137, 1.0, v137
    v_rcp_f32 v137, v137
    v_mfma_f32_16x16x32_bf16 v[252:255], v[44:47], a[140:143], v[252:255]
    s_waitcnt lgkmcnt(3)
    v_exp_f32 v140, v140
    v_mfma_f32_16x16x32_bf16 v[224:227], v[48:51], a[144:147], v[224:227]
    ds_read_b64_tr_b16 v[40:41], v4 offset:4096
    v_mul_f32 v137, v137, v153
    v_mfma_f32_16x16x32_bf16 v[228:231], v[48:51], a[148:151], v[228:231]
    buffer_load_dwordx4 v5, s[20:23], s82 offen offset:1024 sc1  lds
    v_mfma_f32_16x16x32_bf16 v[232:235], v[48:51], a[152:155], v[232:235]
    s_add_u32 s82, s66, 81920
    ds_read_b64_tr_b16 v[42:43], v4 offset:5120
    v_cvt_pk_bf16_f32 v218, v136, v137
    v_mfma_f32_16x16x32_bf16 v[236:239], v[48:51], a[156:159], v[236:239]
    s_add_u32 m0, s67, 49152
    v_mul_f32 v154, v138, v154
    v_mul_f32 v138, s56, v138
    v_mfma_f32_16x16x32_bf16 v[240:243], v[52:55], a[144:147], v[240:243]
    s_branch gated_mix__ssm_conv_s5__swiglu_ffn__prompt_kernel_A_sk6
.p2align 12
gated_mix__ssm_conv_s5__swiglu_ffn__prompt_kernel_A_pg1_6:
    s_branch gated_mix__ssm_conv_s5__swiglu_ffn__prompt_kernel_A_pr1
gated_mix__ssm_conv_s5__swiglu_ffn__prompt_kernel_A_sk6:
    ds_read_b64_tr_b16 v[44:45], v4 offset:12288
    v_add_f32 v140, 1.0, v140
    v_exp_f32 v138, v138
    v_mfma_f32_16x16x32_bf16 v[244:247], v[52:55], a[148:151], v[244:247]
    buffer_load_dwordx4 v22, s[24:27], s49 offen offset:0 lds
    v_mfma_f32_16x16x32_bf16 v[248:251], v[52:55], a[152:155], v[248:251]
    s_add_u32 m0, s68, 122880
    ds_read_b64_tr_b16 v[46:47], v4 offset:13312
    v_add_f32 v138, 1.0, v138
    v_mfma_f32_16x16x32_bf16 v[252:255], v[52:55], a[156:159], v[252:255]
    s_waitcnt lgkmcnt(3)
    v_rcp_f32 v138, v138
    v_mfma_f32_16x16x32_bf16 v[160:163], v[56:59], a[128:131], v[160:163]
    ds_read_b64_tr_b16 v[48:49], v3 offset:16384
    v_mul_f32 v138, v138, v154
    v_mfma_f32_16x16x32_bf16 v[164:167], v[56:59], a[132:135], v[164:167]
    buffer_load_dwordx4 v5, s[20:23], s82 offen offset:0 sc1  lds
    v_mfma_f32_16x16x32_bf16 v[168:171], v[56:59], a[136:139], v[168:171]
    ds_read_b64_tr_b16 v[50:51], v3 offset:17408
    v_mul_f32 v155, v139, v155
    v_mul_f32 v139, s56, v139
    v_mfma_f32_16x16x32_bf16 v[172:175], v[56:59], a[140:143], v[172:175]
    v_exp_f32 v139, v139
    v_mfma_f32_16x16x32_bf16 v[176:179], v[60:63], a[128:131], v[176:179]
    ds_read_b64_tr_b16 v[52:53], v3 offset:24576
    v_add_f32 v139, 1.0, v139
    v_mfma_f32_16x16x32_bf16 v[180:183], v[60:63], a[132:135], v[180:183]
    buffer_load_dwordx4 v5, s[20:23], s82 offen offset:1024 sc1  lds
    v_mfma_f32_16x16x32_bf16 v[184:187], v[60:63], a[136:139], v[184:187]
    s_add_u32 s82, s66, 98304
    ds_read_b64_tr_b16 v[54:55], v3 offset:25600
    v_mfma_f32_16x16x32_bf16 v[188:191], v[60:63], a[140:143], v[188:191]
    s_waitcnt lgkmcnt(3)
    v_rcp_f32 v139, v139
    v_mfma_f32_16x16x32_bf16 v[160:163], v[40:43], a[144:147], v[160:163]
    s_add_u32 m0, s67, 50048
    ds_read_b64_tr_b16 v[56:57], v3 offset:20480
    v_mul_f32 v139, v139, v155
    v_cvt_pk_bf16_f32 v219, v138, v139
    v_mfma_f32_16x16x32_bf16 v[164:167], v[40:43], a[148:151], v[164:167]
    buffer_load_dwordx4 v22, s[24:27], s49 offen offset:128 lds
    v_mfma_f32_16x16x32_bf16 v[168:171], v[40:43], a[152:155], v[168:171]
    s_add_u32 m0, s67, 50944
    ds_read_b64_tr_b16 v[58:59], v3 offset:21504
    v_mfma_f32_16x16x32_bf16 v[172:175], v[40:43], a[156:159], v[172:175]
    v_rcp_f32 v140, v140
    v_mfma_f32_16x16x32_bf16 v[176:179], v[44:47], a[144:147], v[176:179]
    ds_read_b64_tr_b16 v[60:61], v3 offset:28672
    v_mul_f32 v140, v140, v156
    v_mfma_f32_16x16x32_bf16 v[180:183], v[44:47], a[148:151], v[180:183]
    buffer_load_dwordx4 v22, s[24:27], s49 offen offset:256 lds
    v_mfma_f32_16x16x32_bf16 v[184:187], v[44:47], a[152:155], v[184:187]
    s_add_u32 s49, s58, 737280
    ds_read_b64_tr_b16 v[62:63], v3 offset:29696
    v_mul_f32 v157, v141, v157
    v_mul_f32 v141, s56, v141
    v_mfma_f32_16x16x32_bf16 v[188:191], v[44:47], a[156:159], v[188:191]
    s_waitcnt lgkmcnt(3)
    v_exp_f32 v141, v141
    v_mfma_f32_16x16x32_bf16 v[224:227], v[48:51], a[160:163], v[224:227]
    ds_read_b64_tr_b16 v[40:41], v4 offset:16384
    v_add_f32 v141, 1.0, v141
    v_mfma_f32_16x16x32_bf16 v[228:231], v[48:51], a[164:167], v[228:231]
    ds_read_b64_tr_b16 v[42:43], v4 offset:17408
    v_mfma_f32_16x16x32_bf16 v[232:235], v[48:51], a[168:171], v[232:235]
    v_rcp_f32 v141, v141
    v_mfma_f32_16x16x32_bf16 v[236:239], v[48:51], a[172:175], v[236:239]
    v_mul_f32 v141, v141, v157
    v_cvt_pk_bf16_f32 v222, v140, v141
    v_mfma_f32_16x16x32_bf16 v[240:243], v[52:55], a[160:163], v[240:243]
    s_and_b32 s0, s6, 1
    ds_read_b64_tr_b16 v[44:45], v4 offset:24576
    v_mul_f32 v158, v142, v158
    v_mul_f32 v142, s56, v142
    v_mfma_f32_16x16x32_bf16 v[244:247], v[52:55], a[164:167], v[244:247]
    s_lshr_b32 s1, s6, 1
    ds_read_b64_tr_b16 v[46:47], v4 offset:25600
    v_mfma_f32_16x16x32_bf16 v[248:251], v[52:55], a[168:171], v[248:251]
    s_lshl1_add_u32 s0, s0, s1
    v_exp_f32 v142, v142
    v_mfma_f32_16x16x32_bf16 v[252:255], v[52:55], a[172:175], v[252:255]
    s_waitcnt lgkmcnt(2)
    v_add_f32 v142, 1.0, v142
    s_lshl_b32 s0, s0, 11
    v_mfma_f32_16x16x32_bf16 v[224:227], v[56:59], a[176:179], v[224:227]
    s_add_u32 s0, s0, 98304
    ds_read_b64_tr_b16 v[48:49], v4 offset:20480
    v_mfma_f32_16x16x32_bf16 v[228:231], v[56:59], a[180:183], v[228:231]
    s_add_u32 s1, s64, 6
    ds_read_b64_tr_b16 v[50:51], v4 offset:21504
    v_mfma_f32_16x16x32_bf16 v[232:235], v[56:59], a[184:187], v[232:235]
    s_and_b32 s1, s1, 7
    v_rcp_f32 v142, v142
    s_nop 0
    v_mul_f32 v142, v142, v158
    v_mfma_f32_16x16x32_bf16 v[236:239], v[56:59], a[188:191], v[236:239]
    s_lshl_b32 s1, s1, 13
    v_mul_f32 v159, v143, v159
    s_add_u32 s1, s1, s0
    v_mfma_f32_16x16x32_bf16 v[240:243], v[60:63], a[176:179], v[240:243]
    ds_read_b64_tr_b16 v[52:53], v4 offset:28672
    v_mul_f32 v143, s56, v143
    v_mfma_f32_16x16x32_bf16 v[244:247], v[60:63], a[180:183], v[244:247]
    ds_read_b64_tr_b16 v[54:55], v4 offset:29696
    v_mfma_f32_16x16x32_bf16 v[248:251], v[60:63], a[184:187], v[248:251]
    v_exp_f32 v143, v143
    v_mfma_f32_16x16x32_bf16 v[252:255], v[60:63], a[188:191], v[252:255]
    v_add_f32 v143, 1.0, v143
    v_mfma_f32_16x16x32_bf16 v[160:163], v[40:43], a[160:163], v[160:163]
    v_add_u32 v3, 0x10000, v3
    v_rcp_f32 v143, v143
    v_mfma_f32_16x16x32_bf16 v[164:167], v[40:43], a[164:167], v[164:167]
    ds_read_b64_tr_b16 v[56:57], v3 offset:0
    v_mul_f32 v143, v143, v159
    v_mfma_f32_16x16x32_bf16 v[168:171], v[40:43], a[168:171], v[168:171]
    ds_read_b64_tr_b16 v[58:59], v3 offset:1024
    v_cvt_pk_bf16_f32 v223, v142, v143
    v_mfma_f32_16x16x32_bf16 v[172:175], v[40:43], a[172:175], v[172:175]
    s_waitcnt lgkmcnt(2)
    v_mfma_f32_16x16x32_bf16 v[176:179], v[44:47], a[160:163], v[176:179]
    buffer_store_dwordx4 v[208:211], v5, s[20:23], s70 offen offset:0 sc1
    v_mfma_f32_16x16x32_bf16 v[180:183], v[44:47], a[164:167], v[180:183]
    ds_read_b64_tr_b16 v[60:61], v3 offset:8192
    v_mfma_f32_16x16x32_bf16 v[184:187], v[44:47], a[168:171], v[184:187]
    ds_read_b64_tr_b16 v[62:63], v3 offset:9216
    v_mfma_f32_16x16x32_bf16 v[188:191], v[44:47], a[172:175], v[188:191]
    v_mfma_f32_16x16x32_bf16 v[160:163], v[48:51], a[176:179], v[160:163]
    buffer_store_dwordx4 v[212:215], v5, s[20:23], s70 offen offset:1024 sc1
    v_mfma_f32_16x16x32_bf16 v[164:167], v[48:51], a[180:183], v[164:167]
    ds_read_b64_tr_b16 v[40:41], v3 offset:4096
    v_mfma_f32_16x16x32_bf16 v[168:171], v[48:51], a[184:187], v[168:171]
    ds_read_b64_tr_b16 v[42:43], v3 offset:5120
    v_mfma_f32_16x16x32_bf16 v[172:175], v[48:51], a[188:191], v[172:175]
    v_mfma_f32_16x16x32_bf16 v[176:179], v[52:55], a[176:179], v[176:179]
    buffer_store_dwordx4 v[216:219], v5, s[20:23], s70 offen offset:2048 sc1
    v_mfma_f32_16x16x32_bf16 v[180:183], v[52:55], a[180:183], v[180:183]
    ds_read_b64_tr_b16 v[44:45], v3 offset:12288
    v_mfma_f32_16x16x32_bf16 v[184:187], v[52:55], a[184:187], v[184:187]
    ds_read_b64_tr_b16 v[46:47], v3 offset:13312
    v_mfma_f32_16x16x32_bf16 v[188:191], v[52:55], a[188:191], v[188:191]
    s_waitcnt lgkmcnt(3)
    s_barrier
    v_mfma_f32_16x16x32_bf16 v[224:227], v[56:59], v[64:67], v[224:227]
    buffer_store_dwordx4 v[220:223], v5, s[20:23], s70 offen offset:3072 sc1
    v_mfma_f32_16x16x32_bf16 v[228:231], v[56:59], v[68:71], v[228:231]
    s_add_u32 m0, s67, 61440
    v_add_u32 v4, 0x10000, v4
    v_mfma_f32_16x16x32_bf16 v[232:235], v[56:59], v[72:75], v[232:235]
    buffer_load_dwordx4 v22, s[24:27], s49 offen offset:0 lds
    v_mfma_f32_16x16x32_bf16 v[236:239], v[56:59], v[76:79], v[236:239]
    s_add_u32 m0, s67, 62336
    ds_read_b64_tr_b16 v[48:49], v4 offset:0
    v_mfma_f32_16x16x32_bf16 v[240:243], v[60:63], v[64:67], v[240:243]
    ds_read_b64_tr_b16 v[50:51], v4 offset:1024
    v_mfma_f32_16x16x32_bf16 v[244:247], v[60:63], v[68:71], v[244:247]
    ds_read_b64_tr_b16 v[52:53], v4 offset:8192
    v_mfma_f32_16x16x32_bf16 v[248:251], v[60:63], v[72:75], v[248:251]
    buffer_load_dwordx4 v22, s[24:27], s49 offen offset:128 lds
    v_mfma_f32_16x16x32_bf16 v[252:255], v[60:63], v[76:79], v[252:255]
    s_waitcnt lgkmcnt(3)
    ds_read_b64_tr_b16 v[54:55], v4 offset:9216
    v_mfma_f32_16x16x32_bf16 v[224:227], v[40:43], v[80:83], v[224:227]
    s_add_u32 m0, s67, 63232
    ds_read_b64_tr_b16 v[56:57], v4 offset:4096
    v_mfma_f32_16x16x32_bf16 v[228:231], v[40:43], v[84:87], v[228:231]
    ds_read_b64_tr_b16 v[58:59], v4 offset:5120
    v_mfma_f32_16x16x32_bf16 v[232:235], v[40:43], v[88:91], v[232:235]
    buffer_load_dwordx4 v22, s[24:27], s49 offen offset:256 lds
    v_mfma_f32_16x16x32_bf16 v[236:239], v[40:43], v[92:95], v[236:239]
    s_add_u32 s49, s58, 884736
    s_add_u32 m0, s67, 73728
    v_mfma_f32_16x16x32_bf16 v[240:243], v[44:47], v[80:83], v[240:243]
    ds_read_b64_tr_b16 v[60:61], v4 offset:12288
    v_mfma_f32_16x16x32_bf16 v[244:247], v[44:47], v[84:87], v[244:247]
    ds_read_b64_tr_b16 v[62:63], v4 offset:13312
    v_mfma_f32_16x16x32_bf16 v[248:251], v[44:47], v[88:91], v[248:251]
    buffer_load_dwordx4 v22, s[24:27], s49 offen offset:0 lds
    v_mfma_f32_16x16x32_bf16 v[252:255], v[44:47], v[92:95], v[252:255]
    s_waitcnt lgkmcnt(2)
    s_add_u32 m0, s67, 74624
    v_mfma_f32_16x16x32_bf16 v[160:163], v[48:51], v[64:67], v[160:163]
    s_waitcnt vmcnt(31)
    s_barrier
    v_mfma_f32_16x16x32_bf16 v[164:167], v[48:51], v[68:71], v[164:167]
    ds_read_b128 a[0:3], v16 offset:49152
    v_mul_f32 v240, v224, v240
    v_mfma_f32_16x16x32_bf16 v[168:171], v[48:51], v[72:75], v[168:171]
    ds_read_b128 a[4:7], v17 offset:49152
    v_mul_f32 v224, s56, v224
    v_mfma_f32_16x16x32_bf16 v[172:175], v[48:51], v[76:79], v[172:175]
    ds_read_b128 a[8:11], v27 offset:49152
    v_mul_f32 v244, v228, v244
    v_mfma_f32_16x16x32_bf16 v[176:179], v[52:55], v[64:67], v[176:179]
    ds_read_b128 a[12:15], v38 offset:49152
    v_mul_f32 v228, s56, v228
    v_mfma_f32_16x16x32_bf16 v[180:183], v[52:55], v[68:71], v[180:183]
    ds_read_b64_tr_b16 a[48:49], v23 offset:0
    v_mul_f32 v248, v232, v248
    v_mfma_f32_16x16x32_bf16 v[184:187], v[52:55], v[72:75], v[184:187]
    ds_read_b64_tr_b16 a[50:51], v23 offset:6144
    v_mul_f32 v232, s56, v232
    v_mfma_f32_16x16x32_bf16 v[188:191], v[52:55], v[76:79], v[188:191]
    ds_read_b64_tr_b16 a[52:53], v24 offset:0
    v_mul_f32 v252, v236, v252
    v_mfma_f32_16x16x32_bf16 v[160:163], v[56:59], v[80:83], v[160:163]
    ds_read_b64_tr_b16 a[54:55], v24 offset:6144
    v_mul_f32 v236, s56, v236
    v_mfma_f32_16x16x32_bf16 v[164:167], v[56:59], v[84:87], v[164:167]
    s_waitcnt vmcnt(23) lgkmcnt(5)
    s_barrier
    v_mfma_f32_16x16x32_bf16 v[168:171], v[56:59], v[88:91], v[168:171]
    ds_read_b128 a[16:19], v16 offset:57344
    v_mfma_f32_16x16x32_bf16 v[172:175], v[56:59], v[92:95], v[172:175]
    ds_read_b64_tr_b16 a[56:57], v25 offset:0
    v_mfma_f32_16x16x32_bf16 v[176:179], v[60:63], v[80:83], v[176:179]
    ds_read_b64_tr_b16 a[58:59], v25 offset:6144
    v_min_u32 v20, 15, v0
    v_mfma_f32_16x16x32_bf16 v[180:183], v[60:63], v[84:87], v[180:183]
    ds_read_b128 a[20:23], v17 offset:57344
    v_lshlrev_b32 v20, 2, v20
    v_mfma_f32_16x16x32_bf16 v[184:187], v[60:63], v[88:91], v[184:187]
    ds_read_b64_tr_b16 a[60:61], v26 offset:0
    v_mfma_f32_16x16x32_bf16 v[188:191], v[60:63], v[92:95], v[188:191]
    s_waitcnt lgkmcnt(5)
    ds_read_b64_tr_b16 a[62:63], v26 offset:6144
    v_mfma_f32_16x16x32_bf16 v[64:67], a[48:51], a[0:3], 0
    ds_read_b128 a[24:27], v27 offset:57344
    v_add_u32 v49, s1, v5
    v_exp_f32 v224, v224
    v_mfma_f32_16x16x32_bf16 v[88:91], a[48:51], a[4:7], 0
    ds_read_b64_tr_b16 a[64:65], v23 offset:1024
    v_add_f32 v224, 1.0, v224
    v_mfma_f32_16x16x32_bf16 v[112:115], a[48:51], a[8:11], 0
    ds_read_b64_tr_b16 a[66:67], v23 offset:7168
    v_mul_f32 v176, v160, v176
    v_mfma_f32_16x16x32_bf16 v[136:139], a[48:51], a[12:15], 0
    v_rcp_f32 v224, v224
    v_mfma_f32_16x16x32_bf16 v[68:71], a[52:55], a[0:3], 0
    ds_read_b128 a[28:31], v38 offset:57344
    v_mul_f32 v224, v224, v240
    v_mul_f32 v241, v225, v241
    v_mfma_f32_16x16x32_bf16 v[92:95], a[52:55], a[4:7], 0
    ds_read_b64_tr_b16 a[68:69], v24 offset:1024
    v_mul_f32 v225, s56, v225
    v_mfma_f32_16x16x32_bf16 v[116:119], a[52:55], a[8:11], 0
    buffer_load_dword v21, v20, s[20:23], s69 offen offset:128 sc1
    v_mfma_f32_16x16x32_bf16 v[140:143], a[52:55], a[12:15], 0
    s_waitcnt lgkmcnt(3)
    ds_read_b64_tr_b16 a[70:71], v24 offset:7168
    v_mul_f32 v160, s56, v160
    v_mfma_f32_16x16x32_bf16 v[72:75], a[56:59], a[0:3], 0
    ds_read_b64_tr_b16 a[72:73], v23 offset:12288
    v_mul_f32 v180, v164, v180
    v_exp_f32 v225, v225
    v_mfma_f32_16x16x32_bf16 v[96:99], a[56:59], a[4:7], 0
    ds_read_b64_tr_b16 a[74:75], v23 offset:18432
    v_add_f32 v225, 1.0, v225
    v_mfma_f32_16x16x32_bf16 v[120:123], a[56:59], a[8:11], 0
    buffer_load_dwordx4 v22, s[24:27], s49 offen offset:128 lds
    v_mfma_f32_16x16x32_bf16 v[144:147], a[56:59], a[12:15], 0
    s_add_u32 m0, s68, 131072
    v_rcp_f32 v225, v225
    v_mfma_f32_16x16x32_bf16 v[76:79], a[60:63], a[0:3], 0
    ds_read_b64_tr_b16 a[76:77], v24 offset:12288
    v_mul_f32 v225, v225, v241
    v_cvt_pk_bf16_f32 v208, v224, v225
    v_mfma_f32_16x16x32_bf16 v[100:103], a[60:63], a[4:7], 0
    ds_read_b64_tr_b16 a[78:79], v24 offset:18432
    v_mul_f32 v242, v226, v242
    v_mfma_f32_16x16x32_bf16 v[124:127], a[60:63], a[8:11], 0
    buffer_load_dwordx4 v5, s[20:23], s82 offen offset:0 sc1  lds
    v_mfma_f32_16x16x32_bf16 v[148:151], a[60:63], a[12:15], 0
    s_waitcnt vmcnt(21) lgkmcnt(2)
    s_barrier
    v_mul_f32 v226, s56, v226
    v_mfma_f32_16x16x32_bf16 v[80:83], a[64:67], a[0:3], 0
    ds_read2st64_b64 v[60:63], v49 offset1:2
    v_mul_f32 v164, s56, v164
    v_exp_f32 v226, v226
    v_mfma_f32_16x16x32_bf16 v[104:107], a[64:67], a[4:7], 0
    ds_read_b128 a[32:35], v16 offset:0
    v_add_f32 v226, 1.0, v226
    v_mfma_f32_16x16x32_bf16 v[128:131], a[64:67], a[8:11], 0
    buffer_load_dwordx4 v5, s[20:23], s82 offen offset:1024 sc1  lds
    v_mfma_f32_16x16x32_bf16 v[152:155], a[64:67], a[12:15], 0
    s_add_u32 s82, s66, 114688
    ds_read_b64_tr_b16 a[48:49], v25 offset:12288
    v_mul_f32 v184, v168, v184
    v_mfma_f32_16x16x32_bf16 v[84:87], a[68:71], a[0:3], 0
    s_add_u32 m0, s67, 75520
    ds_read_b64_tr_b16 a[50:51], v25 offset:18432
    v_mul_f32 v168, s56, v168
    v_rcp_f32 v226, v226
    v_mfma_f32_16x16x32_bf16 v[108:111], a[68:71], a[4:7], 0
    buffer_load_dwordx4 v22, s[24:27], s49 offen offset:256 lds
    v_mfma_f32_16x16x32_bf16 v[132:135], a[68:71], a[8:11], 0
    s_add_u32 m0, s68, 139264
    ds_read_b128 a[36:39], v17 offset:0
    v_mul_f32 v226, v226, v242
    v_mfma_f32_16x16x32_bf16 v[156:159], a[68:71], a[12:15], 0
    s_add_u32 s49, s58, 1032192
    ds_read_b64_tr_b16 a[52:53], v26 offset:12288
    v_mul_f32 v243, v227, v243
    v_mfma_f32_16x16x32_bf16 v[64:67], a[72:75], a[16:19], v[64:67]
    buffer_load_dwordx4 v5, s[20:23], s82 offen offset:0 sc1  lds
    v_mul_f32 v227, s56, v227
    v_mfma_f32_16x16x32_bf16 v[88:91], a[72:75], a[20:23], v[88:91]
    s_waitcnt lgkmcnt(5)
    ds_read_b64_tr_b16 a[54:55], v26 offset:18432
    v_lshl_add_u32 v40, v61, 8, v60
    v_mfma_f32_16x16x32_bf16 v[112:115], a[72:75], a[24:27], v[112:115]
    ds_read_b128 a[40:43], v27 offset:0
    v_lshl_add_u32 v41, v63, 8, v62
    v_mfma_f32_16x16x32_bf16 v[136:139], a[72:75], a[28:31], v[136:139]
    buffer_load_dwordx4 v5, s[20:23], s82 offen offset:1024 sc1  lds
    v_mfma_f32_16x16x32_bf16 v[68:71], a[76:79], a[16:19], v[68:71]
    s_add_u32 s1, s64, 1
    ds_read_b64_tr_b16 a[56:57], v23 offset:13312
    v_mul_f32 v188, v172, v188
    v_exp_f32 v227, v227
    v_mfma_f32_16x16x32_bf16 v[92:95], a[76:79], a[20:23], v[92:95]
    s_and_b32 s1, s1, 7
    ds_read_b64_tr_b16 a[58:59], v23 offset:19456
    v_add_f32 v227, 1.0, v227
    v_mfma_f32_16x16x32_bf16 v[116:119], a[76:79], a[24:27], v[116:119]
    s_lshl_b32 s1, s1, 13
    ds_read_b128 a[44:47], v38 offset:0
    v_mul_f32 v172, s56, v172
    v_mfma_f32_16x16x32_bf16 v[140:143], a[76:79], a[28:31], v[140:143]
    s_waitcnt lgkmcnt(4)
    ds_read_b64_tr_b16 a[60:61], v24 offset:13312
    v_rcp_f32 v227, v227
    v_mfma_f32_16x16x32_bf16 v[72:75], a[48:51], a[16:19], v[72:75]
    s_add_u32 s1, s1, s0
    ds_read_b64_tr_b16 a[62:63], v24 offset:19456
    v_add_u32 v49, s1, v5
    v_mul_f32 v227, v227, v243
    v_mfma_f32_16x16x32_bf16 v[96:99], a[48:51], a[20:23], v[96:99]
    s_add_u32 s82, s66, 102400
    ds_read_b64_tr_b16 a[64:65], v23 offset:24576
    v_cvt_pk_bf16_f32 v209, v226, v227
    v_mfma_f32_16x16x32_bf16 v[120:123], a[48:51], a[24:27], v[120:123]
    s_add_u32 m0, s67, 86016
    ds_read_b64_tr_b16 a[66:67], v23 offset:30720
    v_exp_f32 v228, v228
    v_mfma_f32_16x16x32_bf16 v[144:147], a[48:51], a[28:31], v[144:147]
    buffer_load_dwordx4 v22, s[24:27], s49 offen offset:0 lds
    v_mfma_f32_16x16x32_bf16 v[76:79], a[52:55], a[16:19], v[76:79]
    s_add_u32 m0, s67, 86912
    ds_read_b64_tr_b16 a[68:69], v24 offset:24576
    v_add_f32 v228, 1.0, v228
    v_rcp_f32 v228, v228
    v_mfma_f32_16x16x32_bf16 v[100:103], a[52:55], a[20:23], v[100:103]
    ds_read_b64_tr_b16 a[70:71], v24 offset:30720
    v_mul_f32 v228, v228, v244
    v_mfma_f32_16x16x32_bf16 v[124:127], a[52:55], a[24:27], v[124:127]
    s_waitcnt vmcnt(12)
    v_exp_f32 v232, v232
    v_mfma_f32_16x16x32_bf16 v[148:151], a[52:55], a[28:31], v[148:151]
    s_waitcnt lgkmcnt(3)
    s_barrier
    v_mul_f32 v245, v229, v245
    v_mfma_f32_16x16x32_bf16 v[80:83], a[56:59], a[16:19], v[80:83]
    buffer_store_dword v4, v6, s[20:23], s61 offen offset:256 sc1
    v_mul_f32 v229, s56, v229
    v_mfma_f32_16x16x32_bf16 v[104:107], a[56:59], a[20:23], v[104:107]
    ds_read_b128 a[0:3], v16 offset:8192
    v_add_f32 v232, 1.0, v232
    v_mfma_f32_16x16x32_bf16 v[128:131], a[56:59], a[24:27], v[128:131]
    buffer_load_dwordx4 v22, s[24:27], s49 offen offset:128 lds
    v_mfma_f32_16x16x32_bf16 v[152:155], a[56:59], a[28:31], v[152:155]
    s_add_u32 m0, s68, 147456
    ds_read_b64_tr_b16 a[72:73], v25 offset:24576
    v_exp_f32 v229, v229
    v_mfma_f32_16x16x32_bf16 v[84:87], a[60:63], a[16:19], v[84:87]
    ds_read_b64_tr_b16 a[74:75], v25 offset:30720
    v_add_f32 v229, 1.0, v229
    v_rcp_f32 v229, v229
    v_mfma_f32_16x16x32_bf16 v[108:111], a[60:63], a[20:23], v[108:111]
    buffer_load_dwordx4 v5, s[20:23], s82 offen offset:0 sc1  lds
    v_mfma_f32_16x16x32_bf16 v[132:135], a[60:63], a[24:27], v[132:135]
    ds_read_b128 a[4:7], v17 offset:8192
    v_mul_f32 v229, v229, v245
    v_mfma_f32_16x16x32_bf16 v[156:159], a[60:63], a[28:31], v[156:159]
    s_waitcnt lgkmcnt(3)
    ds_read_b64_tr_b16 a[76:77], v26 offset:24576
    v_cvt_pk_bf16_f32 v212, v228, v229
    v_mfma_f32_16x16x32_bf16 v[64:67], a[64:67], a[32:35], v[64:67]
    buffer_load_dwordx4 v5, s[20:23], s82 offen offset:1024 sc1  lds
    v_mul_f32 v246, v230, v246
    v_mfma_f32_16x16x32_bf16 v[88:91], a[64:67], a[36:39], v[88:91]
    s_add_u32 s82, s66, 118784
    ds_read_b64_tr_b16 a[78:79], v26 offset:30720
    v_mul_f32 v230, s56, v230
    v_mfma_f32_16x16x32_bf16 v[112:115], a[64:67], a[40:43], v[112:115]
    s_add_u32 m0, s67, 87808
    ds_read_b128 a[8:11], v27 offset:8192
    v_exp_f32 v230, v230
    v_mfma_f32_16x16x32_bf16 v[136:139], a[64:67], a[44:47], v[136:139]
    buffer_load_dwordx4 v22, s[24:27], s49 offen offset:256 lds
    v_mfma_f32_16x16x32_bf16 v[68:71], a[68:71], a[32:35], v[68:71]
    s_add_u32 m0, s68, 155648
    ds_read_b64_tr_b16 a[48:49], v23 offset:25600
    v_add_f32 v230, 1.0, v230
    v_rcp_f32 v230, v230
    v_mfma_f32_16x16x32_bf16 v[92:95], a[68:71], a[36:39], v[92:95]
    s_add_u32 s49, s58, 921600
    ds_read_b64_tr_b16 a[50:51], v23 offset:31744
    v_mul_f32 v230, v230, v246
    v_mfma_f32_16x16x32_bf16 v[116:119], a[68:71], a[40:43], v[116:119]
    buffer_load_dwordx4 v5, s[20:23], s82 offen offset:0 sc1  lds
    v_mfma_f32_16x16x32_bf16 v[140:143], a[68:71], a[44:47], v[140:143]
    s_waitcnt lgkmcnt(3)
    ds_read_b128 a[12:15], v38 offset:8192
    v_mul_f32 v247, v231, v247
    v_mfma_f32_16x16x32_bf16 v[72:75], a[72:75], a[32:35], v[72:75]
    ds_read_b64_tr_b16 a[52:53], v24 offset:25600
    v_mul_f32 v231, s56, v231
    v_exp_f32 v231, v231
    v_mfma_f32_16x16x32_bf16 v[96:99], a[72:75], a[36:39], v[96:99]
    buffer_load_dwordx4 v5, s[20:23], s82 offen offset:1024 sc1  lds
    v_mfma_f32_16x16x32_bf16 v[120:123], a[72:75], a[40:43], v[120:123]
    s_add_u32 s82, s66, 4096
    ds_read_b64_tr_b16 a[54:55], v24 offset:31744
    v_add_f32 v231, 1.0, v231
    v_mfma_f32_16x16x32_bf16 v[144:147], a[72:75], a[44:47], v[144:147]
    s_add_u32 m0, s67, 0
    ds_read_b64_tr_b16 a[56:57], v23 offset:36864
    v_rcp_f32 v231, v231
    v_mfma_f32_16x16x32_bf16 v[76:79], a[76:79], a[32:35], v[76:79]
    s_lshl_b32 s54, s63, 8
    ds_read_b64_tr_b16 a[58:59], v23 offset:43008
    v_mul_f32 v231, v231, v247
    v_cvt_pk_bf16_f32 v213, v230, v231
    v_mfma_f32_16x16x32_bf16 v[100:103], a[76:79], a[36:39], v[100:103]
    s_add_u32 s54, s54, 23724032
    ds_read_b64_tr_b16 a[60:61], v24 offset:36864
    v_rcp_f32 v232, v232
    v_mfma_f32_16x16x32_bf16 v[124:127], a[76:79], a[40:43], v[124:127]
    s_mul_i32 s53, s3, 3
    ds_read_b64_tr_b16 a[62:63], v24 offset:43008
    v_mul_f32 v232, v232, v248
    v_mfma_f32_16x16x32_bf16 v[148:151], a[76:79], a[44:47], v[148:151]
    s_waitcnt lgkmcnt(5)
    s_barrier
    v_mul_f32 v249, v233, v249
    v_mfma_f32_16x16x32_bf16 v[80:83], a[48:51], a[32:35], v[80:83]
    buffer_load_dwordx4 v22, s[24:27], s49 offen offset:0 lds
    v_mul_f32 v233, s56, v233
    v_mfma_f32_16x16x32_bf16 v[104:107], a[48:51], a[36:39], v[104:107]
    s_add_u32 m0, s67, 896
    ds_read_b128 a[16:19], v16 offset:16384
    v_exp_f32 v233, v233
    v_mfma_f32_16x16x32_bf16 v[128:131], a[48:51], a[40:43], v[128:131]
    s_waitcnt vmcnt(15)
    ds_read_b64_tr_b16 a[64:65], v25 offset:36864
    v_cmp_eq_u32 s[76:77], 0, v21
    v_mfma_f32_16x16x32_bf16 v[152:155], a[48:51], a[44:47], v[152:155]
    s_waitcnt lgkmcnt(3)
    ds_read_b64_tr_b16 a[66:67], v25 offset:43008
    v_add_f32 v233, 1.0, v233
    v_mfma_f32_16x16x32_bf16 v[84:87], a[52:55], a[32:35], v[84:87]
    s_cmp_lg_u64 s[76:77], 0
    s_cbranch_scc1 gated_mix__ssm_conv_s5__swiglu_ffn__prompt_kernel_hp1_s
gated_mix__ssm_conv_s5__swiglu_ffn__prompt_kernel_hp1:
    ds_read_b128 a[20:23], v17 offset:16384
    v_rcp_f32 v233, v233
    s_nop 0
    v_mul_f32 v233, v233, v249
    v_mfma_f32_16x16x32_bf16 v[108:111], a[52:55], a[36:39], v[108:111]
    s_add_u32 s53, s53, s64
    ds_read_b64_tr_b16 a[68:69], v26 offset:36864
    v_cvt_pk_bf16_f32 v216, v232, v233
    v_mfma_f32_16x16x32_bf16 v[132:135], a[52:55], a[40:43], v[132:135]
    s_lshl2_add_u32 s53, s53, s54
    ds_read_b64_tr_b16 a[70:71], v26 offset:43008
    v_mul_f32 v250, v234, v250
    v_mfma_f32_16x16x32_bf16 v[156:159], a[52:55], a[44:47], v[156:159]
    s_cmp_eq_u32 s6, 0
    s_cselect_b32 s14, 0, 2147483632
    v_exp_f32 v236, v236
    v_mfma_f32_16x16x32_bf16 v[64:67], a[56:59], a[0:3], v[64:67]
    ds_read_b128 a[24:27], v27 offset:16384
    v_or_b32 v36, s14, v6
    v_min_u32 v58, 11, v0
    v_mfma_f32_16x16x32_bf16 v[88:91], a[56:59], a[4:7], v[88:91]
    ds_read_b64_tr_b16 a[72:73], v23 offset:37888
    v_lshlrev_b32 v58, 2, v58
    v_mfma_f32_16x16x32_bf16 v[112:115], a[56:59], a[8:11], v[112:115]
    ds_read_b64_tr_b16 a[74:75], v23 offset:44032
    v_add_u32 v52, 4096, v5
    v_mfma_f32_16x16x32_bf16 v[136:139], a[56:59], a[12:15], v[136:139]
    s_waitcnt lgkmcnt(4)
    v_exp_f32 v160, v160
    v_mfma_f32_16x16x32_bf16 v[68:71], a[60:63], a[0:3], v[68:71]
    s_lshr_b32 s14, s6, 1
    ds_read_b128 a[28:31], v38 offset:16384
    v_mul_f32 v234, s56, v234
    v_exp_f32 v234, v234
    v_mfma_f32_16x16x32_bf16 v[92:95], a[60:63], a[4:7], v[92:95]
    s_lshl2_add_u32 s15, s87, s3
    ds_read_b64_tr_b16 a[76:77], v24 offset:37888
    v_add_f32 v234, 1.0, v234
    v_mfma_f32_16x16x32_bf16 v[116:119], a[60:63], a[8:11], v[116:119]
    s_mul_i32 s15, s15, 36
    ds_read_b64_tr_b16 a[78:79], v24 offset:44032
    v_add_f32 v236, 1.0, v236
    v_mfma_f32_16x16x32_bf16 v[140:143], a[60:63], a[12:15], v[140:143]
    s_add_u32 s15, s15, 0
    v_rcp_f32 v234, v234
    v_mfma_f32_16x16x32_bf16 v[72:75], a[64:67], a[0:3], v[72:75]
    s_lshl2_add_u32 s40, s64, s15
    ds_read_b64_tr_b16 a[48:49], v8 offset:0
    v_mul_f32 v234, v234, v250
    v_mul_f32 v251, v235, v251
    v_mfma_f32_16x16x32_bf16 v[96:99], a[64:67], a[4:7], v[96:99]
    s_lshl1_add_u32 s40, s40, s14
    ds_read_b64_tr_b16 a[50:51], v8 offset:6144
    v_mul_f32 v235, s56, v235
    v_mfma_f32_16x16x32_bf16 v[120:123], a[64:67], a[8:11], v[120:123]
    s_lshl_b32 s40, s40, 11
    v_exp_f32 v235, v235
    v_mfma_f32_16x16x32_bf16 v[144:147], a[64:67], a[12:15], v[144:147]
    s_waitcnt lgkmcnt(3)
    v_rcp_f32 v236, v236
    v_mfma_f32_16x16x32_bf16 v[76:79], a[68:71], a[0:3], v[76:79]
    s_add_u32 s41, s40, 49152
    ds_read_b64_tr_b16 a[52:53], v9 offset:0
    v_add_f32 v235, 1.0, v235
    v_rcp_f32 v235, v235
    v_mfma_f32_16x16x32_bf16 v[100:103], a[68:71], a[4:7], v[100:103]
    s_lshl2_add_u32 s42, s14, s15
    ds_read_b64_tr_b16 a[54:55], v9 offset:6144
    v_mul_f32 v235, v235, v251
    v_mfma_f32_16x16x32_bf16 v[124:127], a[68:71], a[8:11], v[124:127]
    s_lshl2_add_u32 s42, s42, s64
    v_exp_f32 v164, v164
    v_mfma_f32_16x16x32_bf16 v[148:151], a[68:71], a[12:15], v[148:151]
    s_waitcnt lgkmcnt(2)
    s_barrier
    v_cvt_pk_bf16_f32 v217, v234, v235
    v_mfma_f32_16x16x32_bf16 v[80:83], a[72:75], a[0:3], v[80:83]
    s_lshl_b32 s42, s42, 10
    ds_read2st64_b64 v[60:63], v49 offset1:2
    v_mul_f32 v236, v236, v252
    v_mul_f32 v253, v237, v253
    v_mfma_f32_16x16x32_bf16 v[104:107], a[72:75], a[4:7], v[104:107]
    s_add_u32 s42, s42, 98304
    ds_read_b128 a[32:35], v16 offset:24576
    v_mul_f32 v237, s56, v237
    v_mfma_f32_16x16x32_bf16 v[128:131], a[72:75], a[8:11], v[128:131]
    buffer_load_dwordx4 v22, s[24:27], s49 offen offset:128 lds
    v_mfma_f32_16x16x32_bf16 v[152:155], a[72:75], a[12:15], v[152:155]
    s_add_u32 m0, s67, 1792
    ds_read_b64_tr_b16 a[56:57], v10 offset:0
    v_add_f32 v160, 1.0, v160
    v_mfma_f32_16x16x32_bf16 v[84:87], a[76:79], a[0:3], v[84:87]
    s_lshl1_add_u32 s14, s64, s14
    ds_read_b64_tr_b16 a[58:59], v10 offset:6144
    v_add_f32 v164, 1.0, v164
    v_exp_f32 v237, v237
    v_mfma_f32_16x16x32_bf16 v[108:111], a[76:79], a[4:7], v[108:111]
    buffer_load_dwordx4 v22, s[24:27], s49 offen offset:256 lds
    v_mfma_f32_16x16x32_bf16 v[132:135], a[76:79], a[8:11], v[132:135]
    s_add_u32 m0, s68, 98304
    ds_read_b128 a[36:39], v17 offset:24576
    v_add_f32 v237, 1.0, v237
    v_mfma_f32_16x16x32_bf16 v[156:159], a[76:79], a[12:15], v[156:159]
    s_add_u32 s49, s58, 1069056
    ds_read_b64_tr_b16 a[60:61], v11 offset:0
    v_rcp_f32 v237, v237
    v_mfma_f32_16x16x32_bf16 v[64:67], a[48:51], a[16:19], v[64:67]
    buffer_load_dwordx4 v5, s[20:23], s82 offen offset:0 sc1  lds
    v_mul_f32 v237, v237, v253
    v_mfma_f32_16x16x32_bf16 v[88:91], a[48:51], a[20:23], v[88:91]
    s_waitcnt lgkmcnt(5)
    ds_read_b64_tr_b16 a[62:63], v11 offset:6144
    v_lshl_add_u32 v42, v61, 8, v60
    v_mfma_f32_16x16x32_bf16 v[112:115], a[48:51], a[24:27], v[112:115]
    s_xor_b32 s16, s3, 1
    ds_read_b128 a[40:43], v27 offset:24576
    v_lshl_add_u32 v43, v63, 8, v62
    v_mfma_f32_16x16x32_bf16 v[136:139], a[48:51], a[28:31], v[136:139]
    buffer_load_dwordx4 v5, s[20:23], s82 offen offset:1024 sc1  lds
    v_mfma_f32_16x16x32_bf16 v[68:71], a[52:55], a[16:19], v[68:71]
    s_lshr_b32 s1, s6, 1
    ds_read_b64_tr_b16 a[64:65], v8 offset:1024
    v_cvt_pk_bf16_f32 v220, v236, v237
    v_mul_f32 v254, v238, v254
    v_mfma_f32_16x16x32_bf16 v[92:95], a[52:55], a[20:23], v[92:95]
    s_mul_i32 s1, s1, 6
    ds_read_b64_tr_b16 a[66:67], v8 offset:7168
    v_mul_f32 v238, s56, v238
    v_mfma_f32_16x16x32_bf16 v[116:119], a[52:55], a[24:27], v[116:119]
    s_add_u32 s1, s1, s64
    ds_read_b128 a[44:47], v38 offset:24576
    v_exp_f32 v238, v238
    v_mfma_f32_16x16x32_bf16 v[140:143], a[52:55], a[28:31], v[140:143]
    s_waitcnt lgkmcnt(4)
    ds_read_b64_tr_b16 a[68:69], v9 offset:1024
    v_add_f32 v238, 1.0, v238
    v_mfma_f32_16x16x32_bf16 v[72:75], a[56:59], a[16:19], v[72:75]
    s_lshl_b32 s1, s1, 10
    ds_read_b64_tr_b16 a[70:71], v9 offset:7168
    v_rcp_f32 v238, v238
    s_nop 0
    v_mul_f32 v238, v238, v254
    v_mfma_f32_16x16x32_bf16 v[96:99], a[56:59], a[20:23], v[96:99]
    s_add_u32 s1, s1, s0
    ds_read_b64_tr_b16 a[72:73], v8 offset:12288
    v_add_u32 v49, s1, v5
    v_mfma_f32_16x16x32_bf16 v[120:123], a[56:59], a[24:27], v[120:123]
    s_add_u32 s82, s66, 20480
    ds_read_b64_tr_b16 a[74:75], v8 offset:18432
    v_mul_f32 v255, v239, v255
    v_mfma_f32_16x16x32_bf16 v[144:147], a[56:59], a[28:31], v[144:147]
    s_add_u32 m0, s67, 12288
    v_rcp_f32 v160, v160
    v_mfma_f32_16x16x32_bf16 v[76:79], a[60:63], a[16:19], v[76:79]
    s_branch gated_mix__ssm_conv_s5__swiglu_ffn__prompt_kernel_A_sk7
.p2align 12
gated_mix__ssm_conv_s5__swiglu_ffn__prompt_kernel_A_pg1_7:
    s_branch gated_mix__ssm_conv_s5__swiglu_ffn__prompt_kernel_A_pr1
gated_mix__ssm_conv_s5__swiglu_ffn__prompt_kernel_A_sk7:
    buffer_load_dwordx4 v22, s[24:27], s49 offen offset:0 lds
    v_mul_f32 v239, s56, v239
    v_mfma_f32_16x16x32_bf16 v[100:103], a[60:63], a[20:23], v[100:103]
    s_add_u32 m0, s67, 13184
    ds_read_b64_tr_b16 a[76:77], v9 offset:12288
    v_mul_f32 v160, v160, v176
    v_mfma_f32_16x16x32_bf16 v[124:127], a[60:63], a[24:27], v[124:127]
    s_sub_u32 s16, s16, s3
    ds_read_b64_tr_b16 a[78:79], v9 offset:18432
    v_mul_f32 v177, v161, v177
    v_mfma_f32_16x16x32_bf16 v[148:151], a[60:63], a[28:31], v[148:151]
    s_waitcnt vmcnt(16) lgkmcnt(3)
    s_barrier
    v_mul_f32 v161, s56, v161
    v_mfma_f32_16x16x32_bf16 v[80:83], a[64:67], a[16:19], v[80:83]
    buffer_load_dwordx4 v22, s[24:27], s49 offen offset:128 lds
    v_exp_f32 v239, v239
    v_mfma_f32_16x16x32_bf16 v[104:107], a[64:67], a[20:23], v[104:107]
    s_add_u32 m0, s67, 14080
    ds_read_b128 a[0:3], v16 offset:32768
    v_add_f32 v239, 1.0, v239
    v_mfma_f32_16x16x32_bf16 v[128:131], a[64:67], a[24:27], v[128:131]
    s_mul_i32 s16, s16, 147456
    ds_read_b64_tr_b16 a[48:49], v10 offset:12288
    v_rcp_f32 v239, v239
    v_mfma_f32_16x16x32_bf16 v[152:155], a[64:67], a[28:31], v[152:155]
    buffer_load_dwordx4 v22, s[24:27], s49 offen offset:256 lds
    v_mfma_f32_16x16x32_bf16 v[84:87], a[68:71], a[16:19], v[84:87]
    s_add_u32 m0, s68, 106496
    ds_read_b64_tr_b16 a[50:51], v10 offset:18432
    v_mul_f32 v239, v239, v255
    v_cvt_pk_bf16_f32 v221, v238, v239
    v_mfma_f32_16x16x32_bf16 v[108:111], a[68:71], a[20:23], v[108:111]
    s_add_u32 s49, s58, 36864
    ds_read_b128 a[4:7], v17 offset:32768
    v_exp_f32 v161, v161
    v_mfma_f32_16x16x32_bf16 v[132:135], a[68:71], a[24:27], v[132:135]
    buffer_load_dwordx4 v5, s[20:23], s82 offen offset:0 sc1  lds
    v_mfma_f32_16x16x32_bf16 v[156:159], a[68:71], a[28:31], v[156:159]
    s_waitcnt lgkmcnt(3)
    ds_read_b64_tr_b16 a[52:53], v11 offset:12288
    v_add_f32 v161, 1.0, v161
    v_mfma_f32_16x16x32_bf16 v[64:67], a[72:75], a[32:35], v[64:67]
    s_add_u32 s8, s16, s40
    ds_read_b64_tr_b16 a[54:55], v11 offset:18432
    v_rcp_f32 v161, v161
    s_nop 0
    v_mul_f32 v161, v161, v177
    v_mfma_f32_16x16x32_bf16 v[88:91], a[72:75], a[36:39], v[88:91]
    buffer_load_dwordx4 v5, s[20:23], s82 offen offset:1024 sc1  lds
    v_mfma_f32_16x16x32_bf16 v[112:115], a[72:75], a[40:43], v[112:115]
    s_add_u32 s82, s66, 36864
    ds_read_b128 a[8:11], v27 offset:32768
    v_cvt_pk_bf16_f32 v210, v160, v161
    v_mfma_f32_16x16x32_bf16 v[136:139], a[72:75], a[44:47], v[136:139]
    s_add_u32 m0, s67, 24576
    ds_read_b64_tr_b16 a[56:57], v8 offset:13312
    v_mul_f32 v178, v162, v178
    v_mfma_f32_16x16x32_bf16 v[68:71], a[76:79], a[32:35], v[68:71]
    buffer_load_dwordx4 v22, s[24:27], s49 offen offset:0 lds
    v_mul_f32 v162, s56, v162
    v_mfma_f32_16x16x32_bf16 v[92:95], a[76:79], a[36:39], v[92:95]
    s_add_u32 m0, s67, 25472
    ds_read_b64_tr_b16 a[58:59], v8 offset:19456
    v_exp_f32 v162, v162
    v_mfma_f32_16x16x32_bf16 v[116:119], a[76:79], a[40:43], v[116:119]
    s_add_u32 s9, s16, s42
    ds_read_b128 a[12:15], v38 offset:32768
    v_add_f32 v162, 1.0, v162
    v_mfma_f32_16x16x32_bf16 v[140:143], a[76:79], a[44:47], v[140:143]
    s_waitcnt lgkmcnt(4)
    ds_read_b64_tr_b16 a[60:61], v9 offset:13312
    v_rcp_f32 v162, v162
    v_mfma_f32_16x16x32_bf16 v[72:75], a[48:51], a[32:35], v[72:75]
    buffer_load_dwordx4 v22, s[24:27], s49 offen offset:128 lds
    v_mul_f32 v162, v162, v178
    v_mfma_f32_16x16x32_bf16 v[96:99], a[48:51], a[36:39], v[96:99]
    s_add_u32 m0, s67, 26368
    ds_read_b64_tr_b16 a[62:63], v9 offset:19456
    v_mul_f32 v179, v163, v179
    v_mfma_f32_16x16x32_bf16 v[120:123], a[48:51], a[40:43], v[120:123]
    s_xor_b32 s16, s3, 2
    ds_read_b64_tr_b16 a[64:65], v8 offset:24576
    v_mul_f32 v163, s56, v163
    v_mfma_f32_16x16x32_bf16 v[144:147], a[48:51], a[44:47], v[144:147]
    buffer_load_dwordx4 v22, s[24:27], s49 offen offset:256 lds
    v_mfma_f32_16x16x32_bf16 v[76:79], a[52:55], a[32:35], v[76:79]
    s_add_u32 m0, s68, 114688
    ds_read_b64_tr_b16 a[66:67], v8 offset:30720
    v_exp_f32 v163, v163
    s_nop 0
    v_add_f32 v163, 1.0, v163
    v_mfma_f32_16x16x32_bf16 v[100:103], a[52:55], a[36:39], v[100:103]
    s_add_u32 s49, s58, 184320
    ds_read_b64_tr_b16 a[68:69], v9 offset:24576
    v_rcp_f32 v163, v163
    v_mfma_f32_16x16x32_bf16 v[124:127], a[52:55], a[40:43], v[124:127]
    s_sub_u32 s16, s16, s3
    ds_read_b64_tr_b16 a[70:71], v9 offset:30720
    v_mul_f32 v163, v163, v179
    v_mfma_f32_16x16x32_bf16 v[148:151], a[52:55], a[44:47], v[148:151]
    s_waitcnt vmcnt(15) lgkmcnt(4)
    s_barrier
    v_cvt_pk_bf16_f32 v211, v162, v163
    v_mfma_f32_16x16x32_bf16 v[80:83], a[56:59], a[32:35], v[80:83]
    buffer_load_dwordx4 v5, s[20:23], s82 offen offset:0 sc1  lds
    v_rcp_f32 v164, v164
    v_mfma_f32_16x16x32_bf16 v[104:107], a[56:59], a[36:39], v[104:107]
    s_mul_i32 s16, s16, 147456
    ds_read_b64 v[60:61], v49 offset:32768
    v_mul_f32 v164, v164, v180
    v_mfma_f32_16x16x32_bf16 v[128:131], a[56:59], a[40:43], v[128:131]
    s_add_u32 s10, s16, s40
    ds_read_b128 a[16:19], v16 offset:40960
    v_mul_f32 v181, v165, v181
    v_mfma_f32_16x16x32_bf16 v[152:155], a[56:59], a[44:47], v[152:155]
    s_add_u32 s11, s16, s41
    ds_read_b64_tr_b16 a[72:73], v10 offset:24576
    v_mul_f32 v165, s56, v165
    v_mfma_f32_16x16x32_bf16 v[84:87], a[60:63], a[32:35], v[84:87]
    buffer_load_dwordx4 v5, s[20:23], s82 offen offset:1024 sc1  lds
    v_exp_f32 v165, v165
    v_mfma_f32_16x16x32_bf16 v[108:111], a[60:63], a[36:39], v[108:111]
    s_add_u32 s82, s66, 53248
    ds_read_b64_tr_b16 a[74:75], v10 offset:30720
    v_add_f32 v165, 1.0, v165
    v_mfma_f32_16x16x32_bf16 v[132:135], a[60:63], a[40:43], v[132:135]
    s_add_u32 m0, s67, 36864
    ds_read_b128 a[20:23], v17 offset:40960
    v_rcp_f32 v165, v165
    v_mfma_f32_16x16x32_bf16 v[156:159], a[60:63], a[44:47], v[156:159]
    s_waitcnt lgkmcnt(4)
    ds_read_b64_tr_b16 a[76:77], v11 offset:24576
    v_lshl_add_u32 v48, v61, 8, v60
    v_mfma_f32_16x16x32_bf16 v[64:67], a[64:67], a[0:3], v[64:67]
    buffer_load_dwordx4 v22, s[24:27], s49 offen offset:0 lds
    v_mul_f32 v165, v165, v181
    v_mfma_f32_16x16x32_bf16 v[88:91], a[64:67], a[4:7], v[88:91]
    s_add_u32 s1, s64, 0
    ds_read_b64_tr_b16 a[78:79], v11 offset:30720
    v_cvt_pk_bf16_f32 v214, v164, v165
    v_mfma_f32_16x16x32_bf16 v[112:115], a[64:67], a[8:11], v[112:115]
    s_and_b32 s1, s1, 7
    ds_read_b128 a[24:27], v27 offset:40960
    v_mul_f32 v182, v166, v182
    v_mfma_f32_16x16x32_bf16 v[136:139], a[64:67], a[12:15], v[136:139]
    s_lshl_b32 s1, s1, 13
    ds_read_b64_tr_b16 a[48:49], v8 offset:25600
    v_mul_f32 v166, s56, v166
    v_mfma_f32_16x16x32_bf16 v[68:71], a[68:71], a[0:3], v[68:71]
    s_add_u32 s1, s1, s0
    ds_read_b64_tr_b16 a[50:51], v8 offset:31744
    v_add_u32 v49, s1, v5
    v_exp_f32 v166, v166
    v_mfma_f32_16x16x32_bf16 v[92:95], a[68:71], a[4:7], v[92:95]
    s_add_u32 m0, s67, 37760
    ds_read_b128 a[28:31], v38 offset:40960
    v_add_f32 v166, 1.0, v166
    v_mfma_f32_16x16x32_bf16 v[116:119], a[68:71], a[8:11], v[116:119]
    buffer_load_dwordx4 v22, s[24:27], s49 offen offset:128 lds
    v_mfma_f32_16x16x32_bf16 v[140:143], a[68:71], a[12:15], v[140:143]
    s_waitcnt lgkmcnt(4)
    ds_read_b64_tr_b16 a[52:53], v9 offset:25600
    v_rcp_f32 v166, v166
    v_mfma_f32_16x16x32_bf16 v[72:75], a[72:75], a[0:3], v[72:75]
    s_add_u32 m0, s67, 38656
    ds_read_b64_tr_b16 a[54:55], v9 offset:31744
    v_mul_f32 v166, v166, v182
    v_mul_f32 v183, v167, v183
    v_mfma_f32_16x16x32_bf16 v[96:99], a[72:75], a[4:7], v[96:99]
    buffer_load_dwordx4 v22, s[24:27], s49 offen offset:256 lds
    v_mfma_f32_16x16x32_bf16 v[120:123], a[72:75], a[8:11], v[120:123]
    s_add_u32 m0, s68, 122880
    ds_read_b64_tr_b16 a[56:57], v8 offset:36864
    v_mul_f32 v167, s56, v167
    v_mfma_f32_16x16x32_bf16 v[144:147], a[72:75], a[12:15], v[144:147]
    s_add_u32 s49, s58, 331776
    ds_read_b64_tr_b16 a[58:59], v8 offset:43008
    v_exp_f32 v167, v167
    v_mfma_f32_16x16x32_bf16 v[76:79], a[76:79], a[0:3], v[76:79]
    buffer_load_dwordx4 v5, s[20:23], s82 offen offset:0 sc1  lds
    v_add_f32 v167, 1.0, v167
    v_mfma_f32_16x16x32_bf16 v[100:103], a[76:79], a[4:7], v[100:103]
    s_xor_b32 s16, s3, 3
    ds_read_b64_tr_b16 a[60:61], v9 offset:36864
    v_rcp_f32 v167, v167
    v_mfma_f32_16x16x32_bf16 v[124:127], a[76:79], a[8:11], v[124:127]
    s_sub_u32 s16, s16, s3
    ds_read_b64_tr_b16 a[62:63], v9 offset:43008
    v_mul_f32 v167, v167, v183
    v_mfma_f32_16x16x32_bf16 v[148:151], a[76:79], a[12:15], v[148:151]
    s_waitcnt vmcnt(16) lgkmcnt(4)
    s_barrier
    v_cvt_pk_bf16_f32 v215, v166, v167
    v_mfma_f32_16x16x32_bf16 v[80:83], a[48:51], a[0:3], v[80:83]
    buffer_load_dwordx4 v5, s[20:23], s82 offen offset:1024 sc1  lds
    v_exp_f32 v168, v168
    v_mfma_f32_16x16x32_bf16 v[104:107], a[48:51], a[4:7], v[104:107]
    s_add_u32 s82, s66, 69632
    ds_read_b128 a[32:35], v16 offset:49152
    v_add_f32 v168, 1.0, v168
    v_mfma_f32_16x16x32_bf16 v[128:131], a[48:51], a[8:11], v[128:131]
    s_add_u32 m0, s67, 49152
    ds_read_b64_tr_b16 a[64:65], v10 offset:36864
    v_rcp_f32 v168, v168
    v_mfma_f32_16x16x32_bf16 v[152:155], a[48:51], a[12:15], v[152:155]
    buffer_load_dwordx4 v22, s[24:27], s49 offen offset:0 lds
    v_mfma_f32_16x16x32_bf16 v[84:87], a[52:55], a[0:3], v[84:87]
    s_add_u32 m0, s67, 50048
    ds_read_b64_tr_b16 a[66:67], v10 offset:43008
    v_mul_f32 v168, v168, v184
    v_mul_f32 v185, v169, v185
    v_mfma_f32_16x16x32_bf16 v[108:111], a[52:55], a[4:7], v[108:111]
    s_mul_i32 s16, s16, 147456
    ds_read_b128 a[36:39], v17 offset:49152
    v_mul_f32 v169, s56, v169
    v_mfma_f32_16x16x32_bf16 v[132:135], a[52:55], a[8:11], v[132:135]
    buffer_load_dwordx4 v22, s[24:27], s49 offen offset:128 lds
    v_mfma_f32_16x16x32_bf16 v[156:159], a[52:55], a[12:15], v[156:159]
    s_waitcnt lgkmcnt(3)
    ds_read_b64_tr_b16 a[68:69], v11 offset:36864
    v_exp_f32 v169, v169
    v_mfma_f32_16x16x32_bf16 v[64:67], a[56:59], a[16:19], v[64:67]
    s_add_u32 m0, s67, 50944
    ds_read_b64_tr_b16 a[70:71], v11 offset:43008
    v_add_f32 v169, 1.0, v169
    v_rcp_f32 v169, v169
    v_mfma_f32_16x16x32_bf16 v[88:91], a[56:59], a[20:23], v[88:91]
    buffer_load_dwordx4 v22, s[24:27], s49 offen offset:256 lds
    v_mfma_f32_16x16x32_bf16 v[112:115], a[56:59], a[24:27], v[112:115]
    s_add_u32 m0, s68, 131072
    ds_read_b128 a[40:43], v27 offset:49152
    v_mul_f32 v169, v169, v185
    v_mfma_f32_16x16x32_bf16 v[136:139], a[56:59], a[28:31], v[136:139]
    s_add_u32 s49, s58, 479232
    ds_read_b64_tr_b16 a[72:73], v8 offset:37888
    v_cvt_pk_bf16_f32 v218, v168, v169
    v_mfma_f32_16x16x32_bf16 v[68:71], a[60:63], a[16:19], v[68:71]
    buffer_load_dwordx4 v5, s[20:23], s82 offen offset:0 sc1  lds
    v_mul_f32 v186, v170, v186
    v_mfma_f32_16x16x32_bf16 v[92:95], a[60:63], a[20:23], v[92:95]
    s_add_u32 s17, s16, s40
    ds_read_b64_tr_b16 a[74:75], v8 offset:44032
    v_mul_f32 v170, s56, v170
    v_mfma_f32_16x16x32_bf16 v[116:119], a[60:63], a[24:27], v[116:119]
    s_add_u32 s18, s16, s41
    ds_read_b128 a[44:47], v38 offset:49152
    v_exp_f32 v170, v170
    v_mfma_f32_16x16x32_bf16 v[140:143], a[60:63], a[28:31], v[140:143]
    s_waitcnt lgkmcnt(4)
    ds_read_b64_tr_b16 a[76:77], v9 offset:37888
    v_add_f32 v170, 1.0, v170
    v_mfma_f32_16x16x32_bf16 v[72:75], a[64:67], a[16:19], v[72:75]
    s_and_b32 s15, s87, 17
    ds_read_b64_tr_b16 a[78:79], v9 offset:44032
    v_rcp_f32 v170, v170
    s_nop 0
    v_mul_f32 v170, v170, v186
    v_mfma_f32_16x16x32_bf16 v[96:99], a[64:67], a[20:23], v[96:99]
    s_and_b32 s16, s63, 1
    ds_read_b64_tr_b16 a[48:49], v23 offset:0
    v_mul_f32 v187, v171, v187
    v_mfma_f32_16x16x32_bf16 v[120:123], a[64:67], a[24:27], v[120:123]
    buffer_load_dwordx4 v5, s[20:23], s82 offen offset:1024 sc1  lds
    v_mfma_f32_16x16x32_bf16 v[144:147], a[64:67], a[28:31], v[144:147]
    s_add_u32 s82, s66, 86016
    ds_read_b64_tr_b16 a[50:51], v23 offset:6144
    v_mul_f32 v171, s56, v171
    v_mfma_f32_16x16x32_bf16 v[76:79], a[68:71], a[16:19], v[76:79]
    s_add_u32 m0, s67, 61440
    ds_read_b64_tr_b16 a[52:53], v24 offset:0
    v_exp_f32 v171, v171
    s_nop 0
    v_add_f32 v171, 1.0, v171
    v_mfma_f32_16x16x32_bf16 v[100:103], a[68:71], a[20:23], v[100:103]
    buffer_load_dwordx4 v22, s[24:27], s49 offen offset:0 lds
    v_mfma_f32_16x16x32_bf16 v[124:127], a[68:71], a[24:27], v[124:127]
    s_add_u32 m0, s67, 62336
    ds_read_b64_tr_b16 a[54:55], v24 offset:6144
    v_rcp_f32 v171, v171
    v_mfma_f32_16x16x32_bf16 v[148:151], a[68:71], a[28:31], v[148:151]
    s_waitcnt vmcnt(18) lgkmcnt(3)
    s_barrier
    v_mul_f32 v171, v171, v187
    v_mfma_f32_16x16x32_bf16 v[80:83], a[72:75], a[16:19], v[80:83]
    buffer_load_dwordx4 v22, s[24:27], s49 offen offset:128 lds
    v_cvt_pk_bf16_f32 v219, v170, v171
    v_mfma_f32_16x16x32_bf16 v[104:107], a[72:75], a[20:23], v[104:107]
    s_add_u32 m0, s67, 63232
    ds_read_b128 a[0:3], v16 offset:57344
    v_exp_f32 v172, v172
    v_mfma_f32_16x16x32_bf16 v[128:131], a[72:75], a[24:27], v[128:131]
    s_lshl3_add_u32 s15, s16, s15
    ds_read_b64_tr_b16 a[56:57], v25 offset:0
    v_add_f32 v172, 1.0, v172
    v_mfma_f32_16x16x32_bf16 v[152:155], a[72:75], a[28:31], v[152:155]
    s_bfe_u32 s16, s63, 0x20001
    ds_read_b64_tr_b16 a[58:59], v25 offset:6144
    v_rcp_f32 v172, v172
    v_mfma_f32_16x16x32_bf16 v[84:87], a[76:79], a[16:19], v[84:87]
    buffer_load_dwordx4 v22, s[24:27], s49 offen offset:256 lds
    v_mul_f32 v172, v172, v188
    v_mfma_f32_16x16x32_bf16 v[108:111], a[76:79], a[20:23], v[108:111]
    s_add_u32 m0, s68, 139264
    ds_read_b128 a[4:7], v17 offset:57344
    v_mul_f32 v189, v173, v189
    v_mfma_f32_16x16x32_bf16 v[132:135], a[76:79], a[24:27], v[132:135]
    s_add_u32 s49, s58, 626688
    ds_read_b64_tr_b16 a[60:61], v26 offset:0
    v_mul_f32 v173, s56, v173
    v_mfma_f32_16x16x32_bf16 v[156:159], a[76:79], a[28:31], v[156:159]
    s_waitcnt lgkmcnt(4)
    ds_read_b64_tr_b16 a[62:63], v26 offset:6144
    v_exp_f32 v173, v173
    v_mfma_f32_16x16x32_bf16 v[64:67], a[48:51], a[32:35], v[64:67]
    buffer_load_dwordx4 v5, s[20:23], s82 offen offset:0 sc1  lds
    v_add_f32 v173, 1.0, v173
    v_mfma_f32_16x16x32_bf16 v[88:91], a[48:51], a[36:39], v[88:91]
    s_lshl2_add_u32 s15, s15, s16
    ds_read_b128 a[8:11], v27 offset:57344
    v_rcp_f32 v173, v173
    v_mfma_f32_16x16x32_bf16 v[112:115], a[48:51], a[40:43], v[112:115]
    s_mul_i32 s15, s15, 3
    ds_read_b64_tr_b16 a[64:65], v23 offset:1024
    v_mul_f32 v173, v173, v189
    v_mfma_f32_16x16x32_bf16 v[136:139], a[48:51], a[44:47], v[136:139]
    buffer_load_dwordx4 v5, s[20:23], s82 offen offset:1024 sc1  lds
    v_mfma_f32_16x16x32_bf16 v[68:71], a[52:55], a[32:35], v[68:71]
    s_add_u32 s82, s66, 106496
    ds_read_b64_tr_b16 a[66:67], v23 offset:7168
    v_cvt_pk_bf16_f32 v222, v172, v173
    v_mul_f32 v190, v174, v190
    v_mfma_f32_16x16x32_bf16 v[92:95], a[52:55], a[36:39], v[92:95]
    s_add_u32 m0, s67, 73728
    ds_read_b128 a[12:15], v38 offset:57344
    v_mul_f32 v174, s56, v174
    v_mfma_f32_16x16x32_bf16 v[116:119], a[52:55], a[40:43], v[116:119]
    buffer_load_dwordx4 v22, s[24:27], s49 offen offset:0 lds
    v_mfma_f32_16x16x32_bf16 v[140:143], a[52:55], a[44:47], v[140:143]
    s_waitcnt lgkmcnt(3)
    ds_read_b64_tr_b16 a[68:69], v24 offset:1024
    v_exp_f32 v174, v174
    v_mfma_f32_16x16x32_bf16 v[72:75], a[56:59], a[32:35], v[72:75]
    s_add_u32 m0, s67, 74624
    ds_read_b64_tr_b16 a[70:71], v24 offset:7168
    v_add_f32 v174, 1.0, v174
    v_rcp_f32 v174, v174
    v_mfma_f32_16x16x32_bf16 v[96:99], a[56:59], a[36:39], v[96:99]
    buffer_load_dwordx4 v22, s[24:27], s49 offen offset:128 lds
    v_mfma_f32_16x16x32_bf16 v[120:123], a[56:59], a[40:43], v[120:123]
    s_add_u32 m0, s67, 75520
    ds_read_b64_tr_b16 a[72:73], v23 offset:12288
    v_mul_f32 v174, v174, v190
    v_mfma_f32_16x16x32_bf16 v[144:147], a[56:59], a[44:47], v[144:147]
    s_lshr_b32 s16, s3, 1
    ds_read_b64_tr_b16 a[74:75], v23 offset:18432
    v_mul_f32 v191, v175, v191
    v_mfma_f32_16x16x32_bf16 v[76:79], a[60:63], a[32:35], v[76:79]
    s_add_u32 s15, s15, s16
    ds_read_b64_tr_b16 a[76:77], v24 offset:12288
    v_mul_f32 v175, s56, v175
    v_exp_f32 v175, v175
    v_mfma_f32_16x16x32_bf16 v[100:103], a[60:63], a[36:39], v[100:103]
    s_mul_i32 s15, s15, 24
    ds_read_b64_tr_b16 a[78:79], v24 offset:18432
    v_add_f32 v175, 1.0, v175
    v_mfma_f32_16x16x32_bf16 v[124:127], a[60:63], a[40:43], v[124:127]
    buffer_load_dwordx4 v22, s[24:27], s49 offen offset:256 lds
    v_mfma_f32_16x16x32_bf16 v[148:151], a[60:63], a[44:47], v[148:151]
    s_waitcnt vmcnt(20) lgkmcnt(4)
    s_barrier
    v_mfma_f32_16x16x32_bf16 v[80:83], a[64:67], a[32:35], v[80:83]
    s_add_u32 m0, s68, 147456
    ds_read_b128 a[16:19], v16 offset:0
    v_rcp_f32 v175, v175
    s_nop 0
    v_mul_f32 v175, v175, v191
    v_mfma_f32_16x16x32_bf16 v[104:107], a[64:67], a[36:39], v[104:107]
    buffer_load_dwordx4 v5, s[20:23], s82 offen offset:0 sc1  lds
    v_mfma_f32_16x16x32_bf16 v[128:131], a[64:67], a[40:43], v[128:131]
    s_add_u32 s49, s58, 774144
    ds_read_b64_tr_b16 a[48:49], v25 offset:12288
    v_cvt_pk_bf16_f32 v223, v174, v175
    v_mfma_f32_16x16x32_bf16 v[152:155], a[64:67], a[44:47], v[152:155]
    s_and_b32 s16, s3, 1
    ds_read_b64_tr_b16 a[50:51], v25 offset:18432
    v_mfma_f32_16x16x32_bf16 v[84:87], a[68:71], a[32:35], v[84:87]
    s_add_u32 s15, s15, s16
    ds_read_b128 a[20:23], v17 offset:0
    v_mfma_f32_16x16x32_bf16 v[108:111], a[68:71], a[36:39], v[108:111]
    s_lshl4_add_u32 s15, s14, s15
    ds_read_b64_tr_b16 a[52:53], v26 offset:12288
    v_mfma_f32_16x16x32_bf16 v[132:135], a[68:71], a[40:43], v[132:135]
    s_lshl_b32 s15, s15, 11
    ds_read_b64_tr_b16 a[54:55], v26 offset:18432
    v_mfma_f32_16x16x32_bf16 v[156:159], a[68:71], a[44:47], v[156:159]
    s_waitcnt lgkmcnt(5)
    s_and_b32 s52, s63, 1
    s_mul_i32 s52, s52, 768
    v_mfma_f32_16x16x32_bf16 v[64:67], a[72:75], a[0:3], v[64:67]
    s_bfe_u32 s16, s63, 0x20001
    ds_read_b128 a[24:27], v27 offset:0
    v_mfma_f32_16x16x32_bf16 v[88:91], a[72:75], a[4:7], v[88:91]
    s_mul_i32 s16, s16, -500
    ds_read_b64_tr_b16 a[56:57], v23 offset:13312
    v_mfma_f32_16x16x32_bf16 v[112:115], a[72:75], a[8:11], v[112:115]
    s_add_u32 s52, s52, s16
    ds_read_b64_tr_b16 a[58:59], v23 offset:19456
    v_mfma_f32_16x16x32_bf16 v[136:139], a[72:75], a[12:15], v[136:139]
    s_add_u32 s52, s52, 2176
    s_sub_u32 s54, s54, 2048
    v_mfma_f32_16x16x32_bf16 v[68:71], a[76:79], a[0:3], v[68:71]
    ds_read_b128 a[28:31], v38 offset:0
    v_add_u32 v58, 2048, v58
    v_mfma_f32_16x16x32_bf16 v[92:95], a[76:79], a[4:7], v[92:95]
    s_mul_i32 s16, s14, 22
    ds_read_b64_tr_b16 a[60:61], v24 offset:13312
    v_min_u32 v20, 15, v0
    v_mfma_f32_16x16x32_bf16 v[116:119], a[76:79], a[8:11], v[116:119]
    s_add_u32 s16, s16, 0
    ds_read_b64_tr_b16 a[62:63], v24 offset:19456
    v_lshlrev_b32 v20, 2, v20
    v_mfma_f32_16x16x32_bf16 v[140:143], a[76:79], a[12:15], v[140:143]
    s_waitcnt lgkmcnt(4)
    s_lshr_b32 s16, s16, 5
    s_lshl_b32 s43, s16, 8
    v_mfma_f32_16x16x32_bf16 v[72:75], a[48:51], a[0:3], v[72:75]
    buffer_store_dwordx4 v[208:211], v5, s[20:23], s71 offen offset:0 sc1
    v_mfma_f32_16x16x32_bf16 v[96:99], a[48:51], a[4:7], v[96:99]
    buffer_load_dword v21, v20, s[20:23], s69 offen offset:256 sc1
    v_mfma_f32_16x16x32_bf16 v[120:123], a[48:51], a[8:11], v[120:123]
    s_add_u32 s43, s43, s52
    ds_read_b64_tr_b16 a[64:65], v23 offset:24576
    v_writelane_b32 v58, s43, 12
    v_mfma_f32_16x16x32_bf16 v[144:147], a[48:51], a[12:15], v[144:147]
    s_mul_i32 s16, s16, 1130496
    ds_read_b64_tr_b16 a[66:67], v23 offset:30720
    v_mfma_f32_16x16x32_bf16 v[76:79], a[52:55], a[0:3], v[76:79]
    buffer_store_dwordx4 v[212:215], v5, s[20:23], s71 offen offset:1024 sc1
    v_mfma_f32_16x16x32_bf16 v[100:103], a[52:55], a[4:7], v[100:103]
    s_add_u32 s16, s16, 8192
    ds_read_b64_tr_b16 a[68:69], v24 offset:24576
    v_mfma_f32_16x16x32_bf16 v[124:127], a[52:55], a[8:11], v[124:127]
    s_add_u32 s12, s15, s16
    ds_read_b64_tr_b16 a[70:71], v24 offset:30720
    v_mfma_f32_16x16x32_bf16 v[148:151], a[52:55], a[12:15], v[148:151]
    s_waitcnt vmcnt(19) lgkmcnt(4)
    s_barrier
    v_mfma_f32_16x16x32_bf16 v[80:83], a[56:59], a[0:3], v[80:83]
    s_cmp_eq_u32 s6, 0
    s_cbranch_scc1 gated_mix__ssm_conv_s5__swiglu_ffn__prompt_kernel_A_pg3_8
    s_cmp_eq_u32 s6, 1
    s_cbranch_scc1 gated_mix__ssm_conv_s5__swiglu_ffn__prompt_kernel_A_pg3_9
    s_cmp_eq_u32 s6, 2
    s_cbranch_scc1 gated_mix__ssm_conv_s5__swiglu_ffn__prompt_kernel_A_pg3_10
    s_cmp_eq_u32 s6, 3
    s_cbranch_scc1 gated_mix__ssm_conv_s5__swiglu_ffn__prompt_kernel_A_pg3_11
gated_mix__ssm_conv_s5__swiglu_ffn__prompt_kernel_A_pr3:
    ds_read_b128 a[32:35], v16 offset:8192
    v_mfma_f32_16x16x32_bf16 v[104:107], a[56:59], a[4:7], v[104:107]
    buffer_store_dwordx4 v[216:219], v5, s[20:23], s71 offen offset:2048 sc1
    v_mfma_f32_16x16x32_bf16 v[128:131], a[56:59], a[8:11], v[128:131]
    s_mul_i32 s16, s14, 22
    ds_read_b64_tr_b16 a[72:73], v25 offset:24576
    v_mfma_f32_16x16x32_bf16 v[152:155], a[56:59], a[12:15], v[152:155]
    s_add_u32 s16, s16, 11
    ds_read_b64_tr_b16 a[74:75], v25 offset:30720
    v_mfma_f32_16x16x32_bf16 v[84:87], a[60:63], a[0:3], v[84:87]
    s_lshr_b32 s16, s16, 5
    ds_read_b128 a[36:39], v17 offset:8192
    v_mfma_f32_16x16x32_bf16 v[108:111], a[60:63], a[4:7], v[108:111]
    buffer_store_dwordx4 v[220:223], v5, s[20:23], s71 offen offset:3072 sc1
    v_mfma_f32_16x16x32_bf16 v[132:135], a[60:63], a[8:11], v[132:135]
    buffer_load_dwordx4 v5, s[20:23], s82 offen offset:1024 sc1  lds
    v_mfma_f32_16x16x32_bf16 v[156:159], a[60:63], a[12:15], v[156:159]
    s_waitcnt lgkmcnt(3)
    ds_read_b64_tr_b16 a[76:77], v26 offset:24576
    v_cvt_pk_bf16_f32 v32, v32, v32
    v_mfma_f32_16x16x32_bf16 v[64:67], a[64:67], a[16:19], v[64:67]
    s_add_u32 s82, s66, 122880
    ds_read_b64_tr_b16 a[78:79], v26 offset:30720
    v_lshlrev_b32 v32, 16, v32
    v_mfma_f32_16x16x32_bf16 v[88:91], a[64:67], a[20:23], v[88:91]
    s_add_u32 m0, s67, 86016
    ds_read_b128 a[40:43], v27 offset:8192
    v_mul_f32 v32, s56, v32
    v_mfma_f32_16x16x32_bf16 v[112:115], a[64:67], a[24:27], v[112:115]
    buffer_load_dwordx4 v22, s[24:27], s49 offen offset:0 lds
    v_mfma_f32_16x16x32_bf16 v[136:139], a[64:67], a[28:31], v[136:139]
    s_add_u32 m0, s67, 86912
    ds_read_b64_tr_b16 a[48:49], v23 offset:25600
    v_exp_f32 v32, v32
    v_mfma_f32_16x16x32_bf16 v[68:71], a[68:71], a[16:19], v[68:71]
    s_lshl_b32 s43, s16, 8
    ds_read_b64_tr_b16 a[50:51], v23 offset:31744
    v_add_f32 v32, 1.0, v32
    v_mfma_f32_16x16x32_bf16 v[92:95], a[68:71], a[20:23], v[92:95]
    buffer_load_dwordx4 v22, s[24:27], s49 offen offset:128 lds
    v_mfma_f32_16x16x32_bf16 v[116:119], a[68:71], a[24:27], v[116:119]
    s_add_u32 m0, s67, 87808
    ds_read_b128 a[44:47], v38 offset:8192
    v_rcp_f32 v32, v32
    v_mfma_f32_16x16x32_bf16 v[140:143], a[68:71], a[28:31], v[140:143]
    s_waitcnt lgkmcnt(3)
    ds_read_b64_tr_b16 a[52:53], v24 offset:25600
    v_cvt_pk_bf16_f32 v32, v32, v32
    v_mfma_f32_16x16x32_bf16 v[72:75], a[72:75], a[16:19], v[72:75]
    s_add_u32 s43, s43, s52
    ds_read_b64_tr_b16 a[54:55], v24 offset:31744
    v_writelane_b32 v58, s43, 13
    v_mfma_f32_16x16x32_bf16 v[96:99], a[72:75], a[20:23], v[96:99]
    s_mul_i32 s16, s16, 1130496
    ds_read_b64_tr_b16 a[56:57], v23 offset:36864
    v_lshlrev_b32 v32, 16, v32
    v_mfma_f32_16x16x32_bf16 v[120:123], a[72:75], a[24:27], v[120:123]
    s_add_u32 s16, s16, 24576
    ds_read_b64_tr_b16 a[58:59], v23 offset:43008
    v_sub_f32 v33, 1.0, v32
    v_mfma_f32_16x16x32_bf16 v[144:147], a[72:75], a[28:31], v[144:147]
    s_add_u32 s13, s15, s16
    v_cvt_pk_bf16_f32 v33, v33, v33
    s_mov_b64 s[44:45], -1
    v_mfma_f32_16x16x32_bf16 v[76:79], a[76:79], a[16:19], v[76:79]
    s_mul_i32 s19, s4, 24
    ds_read_b64_tr_b16 a[60:61], v24 offset:36864
    v_lshlrev_b32 v33, 16, v33
    v_mfma_f32_16x16x32_bf16 v[100:103], a[76:79], a[20:23], v[100:103]
    s_add_u32 s19, s19, s5
    ds_read_b64_tr_b16 a[62:63], v24 offset:43008
    v_lshrrev_b32 v54, 16, v32
    v_mfma_f32_16x16x32_bf16 v[124:127], a[76:79], a[24:27], v[124:127]
    s_lshl4_add_u32 s19, s19, s6
    v_lshrrev_b32 v55, 16, v33
    s_lshl_b32 s19, s19, 5
    v_mfma_f32_16x16x32_bf16 v[148:151], a[76:79], a[28:31], v[148:151]
    s_waitcnt vmcnt(19) lgkmcnt(3)
    s_barrier
    v_lshlrev_b32 v160, 16, v192
    v_mfma_f32_16x16x32_bf16 v[80:83], a[48:51], a[16:19], v[80:83]
    s_add_u32 s19, s19, 23728128
    ds_read2st64_b64 v[60:63], v49 offset1:2
    v_lshlrev_b32 v161, 16, v204
    v_mfma_f32_16x16x32_bf16 v[104:107], a[48:51], a[20:23], v[104:107]
    s_lshl_b32 s55, s3, 7
    ds_read_b128 a[0:3], v16 offset:16384
    v_mul_f32 v160, v160, v161
    v_mfma_f32_16x16x32_bf16 v[128:131], a[48:51], a[24:27], v[128:131]
    s_add_u32 s55, s55, s19
    ds_read_b64_tr_b16 a[64:65], v25 offset:36864
    v_min_u32 v50, 2, v0
    v_mfma_f32_16x16x32_bf16 v[152:155], a[48:51], a[28:31], v[152:155]
    ds_read_b64_tr_b16 a[66:67], v25 offset:43008
    v_add_u32 v50, 1, v50
    v_mfma_f32_16x16x32_bf16 v[84:87], a[52:55], a[16:19], v[84:87]
    ds_read_b128 a[4:7], v17 offset:16384
    v_xor_b32 v50, s3, v50
    v_mfma_f32_16x16x32_bf16 v[108:111], a[52:55], a[20:23], v[108:111]
    ds_read_b64_tr_b16 a[68:69], v26 offset:36864
    v_lshlrev_b32 v50, 7, v50
    v_mfma_f32_16x16x32_bf16 v[132:135], a[52:55], a[24:27], v[132:135]
    ds_read_b64_tr_b16 a[70:71], v26 offset:43008
    v_mov_b32 v51, 0
    v_mfma_f32_16x16x32_bf16 v[156:159], a[52:55], a[28:31], v[156:159]
    s_waitcnt lgkmcnt(5)
    v_lshl_add_u32 v44, v61, 8, v60
    v_lshl_add_u32 v45, v63, 8, v62
    v_mfma_f32_16x16x32_bf16 v[64:67], a[56:59], a[32:35], v[64:67]
    s_add_u32 s1, s64, 3
    ds_read_b128 a[8:11], v27 offset:16384
    v_and_b32 v192, 0xffff0000, v192
    v_mfma_f32_16x16x32_bf16 v[88:91], a[56:59], a[36:39], v[88:91]
    s_and_b32 s1, s1, 7
    ds_read_b64_tr_b16 a[72:73], v23 offset:37888
    v_and_b32 v204, 0xffff0000, v204
    v_mfma_f32_16x16x32_bf16 v[112:115], a[56:59], a[40:43], v[112:115]
    s_lshl_b32 s1, s1, 13
    ds_read_b64_tr_b16 a[74:75], v23 offset:44032
    v_mul_f32 v192, v192, v204
    v_mfma_f32_16x16x32_bf16 v[136:139], a[56:59], a[44:47], v[136:139]
    s_add_u32 s1, s1, s0
    v_add_u32 v49, s1, v5
    v_cvt_pk_bf16_f32 v192, v160, v192
    v_mfma_f32_16x16x32_bf16 v[68:71], a[60:63], a[32:35], v[68:71]
    ds_read_b128 a[12:15], v38 offset:16384
    v_lshlrev_b32 v160, 16, v192
    v_mfma_f32_16x16x32_bf16 v[92:95], a[60:63], a[36:39], v[92:95]
    ds_read_b64_tr_b16 a[76:77], v24 offset:37888
    v_and_b32 v161, 0xffff0000, v192
    v_mfma_f32_16x16x32_bf16 v[116:119], a[60:63], a[40:43], v[116:119]
    ds_read_b64_tr_b16 a[78:79], v24 offset:44032
    v_mul_f32 v160, v32, v160
    v_mfma_f32_16x16x32_bf16 v[140:143], a[60:63], a[44:47], v[140:143]
    s_waitcnt lgkmcnt(4)
    v_mul_f32 v161, v32, v161
    v_lshlrev_b32 v162, 16, v193
    v_mfma_f32_16x16x32_bf16 v[72:75], a[64:67], a[32:35], v[72:75]
    ds_read_b64_tr_b16 a[48:49], v8 offset:0
    v_lshlrev_b32 v163, 16, v205
    v_mfma_f32_16x16x32_bf16 v[96:99], a[64:67], a[36:39], v[96:99]
    ds_read_b64_tr_b16 a[50:51], v8 offset:6144
    v_mul_f32 v162, v162, v163
    v_mfma_f32_16x16x32_bf16 v[120:123], a[64:67], a[40:43], v[120:123]
    buffer_load_dwordx4 v22, s[24:27], s49 offen offset:256 lds
    v_mfma_f32_16x16x32_bf16 v[144:147], a[64:67], a[44:47], v[144:147]
    s_add_u32 m0, s68, 155648
    v_and_b32 v193, 0xffff0000, v193
    s_add_u32 s49, s58, 958464
    v_mfma_f32_16x16x32_bf16 v[76:79], a[68:71], a[32:35], v[76:79]
    ds_read_b64_tr_b16 a[52:53], v9 offset:0
    v_and_b32 v205, 0xffff0000, v205
    v_mfma_f32_16x16x32_bf16 v[100:103], a[68:71], a[36:39], v[100:103]
    buffer_load_dwordx4 v5, s[20:23], s82 offen offset:0 sc1  lds
    v_mfma_f32_16x16x32_bf16 v[124:127], a[68:71], a[40:43], v[124:127]
    ds_read_b64_tr_b16 a[54:55], v9 offset:6144
    v_mul_f32 v193, v193, v205
    v_mfma_f32_16x16x32_bf16 v[148:151], a[68:71], a[44:47], v[148:151]
    s_branch gated_mix__ssm_conv_s5__swiglu_ffn__prompt_kernel_A_sk8
.p2align 12
gated_mix__ssm_conv_s5__swiglu_ffn__prompt_kernel_A_pg1_8:
    s_branch gated_mix__ssm_conv_s5__swiglu_ffn__prompt_kernel_A_pr1
gated_mix__ssm_conv_s5__swiglu_ffn__prompt_kernel_A_pg3_8:
    s_branch gated_mix__ssm_conv_s5__swiglu_ffn__prompt_kernel_A_pr3
gated_mix__ssm_conv_s5__swiglu_ffn__prompt_kernel_A_sk8:
    s_waitcnt vmcnt(16) lgkmcnt(2)
    s_barrier
    v_cvt_pk_bf16_f32 v193, v162, v193
    v_mfma_f32_16x16x32_bf16 v[80:83], a[72:75], a[32:35], v[80:83]
    buffer_load_dwordx4 v5, s[20:23], s82 offen offset:1024 sc1  lds
    v_mfma_f32_16x16x32_bf16 v[104:107], a[72:75], a[36:39], v[104:107]
    s_add_u32 s82, s66, 8192
    ds_read_b128 a[16:19], v16 offset:24576
    v_lshlrev_b32 v162, 16, v193
    v_mfma_f32_16x16x32_bf16 v[128:131], a[72:75], a[40:43], v[128:131]
    s_add_u32 m0, s67, 0
    ds_read_b64_tr_b16 a[56:57], v10 offset:0
    v_and_b32 v163, 0xffff0000, v193
    v_mfma_f32_16x16x32_bf16 v[152:155], a[72:75], a[44:47], v[152:155]
    buffer_load_dwordx4 v22, s[24:27], s49 offen offset:0 lds
    v_mfma_f32_16x16x32_bf16 v[84:87], a[76:79], a[32:35], v[84:87]
    s_add_u32 m0, s67, 896
    ds_read_b64_tr_b16 a[58:59], v10 offset:6144
    v_mul_f32 v162, v32, v162
    v_mfma_f32_16x16x32_bf16 v[108:111], a[76:79], a[36:39], v[108:111]
    s_waitcnt vmcnt(10)
    ds_read_b128 a[20:23], v17 offset:24576
    v_cmp_eq_u32 s[76:77], 0, v21
    v_mfma_f32_16x16x32_bf16 v[132:135], a[76:79], a[40:43], v[132:135]
    ds_read_b64_tr_b16 a[60:61], v11 offset:0
    v_mul_f32 v163, v32, v163
    v_mfma_f32_16x16x32_bf16 v[156:159], a[76:79], a[44:47], v[156:159]
    buffer_load_dwordx4 v22, s[24:27], s49 offen offset:128 lds
    v_mfma_f32_16x16x32_bf16 v[64:67], a[48:51], a[0:3], v[64:67]
    s_cmp_lg_u64 s[76:77], 0
    s_cbranch_scc1 gated_mix__ssm_conv_s5__swiglu_ffn__prompt_kernel_hp2_s
gated_mix__ssm_conv_s5__swiglu_ffn__prompt_kernel_hp2:
    ds_read_b64_tr_b16 a[62:63], v11 offset:6144
    v_lshlrev_b32 v164, 16, v194
    v_mfma_f32_16x16x32_bf16 v[88:91], a[48:51], a[4:7], v[88:91]
    s_add_u32 m0, s67, 1792
    ds_read_b128 a[24:27], v27 offset:24576
    v_lshlrev_b32 v165, 16, v206
    v_mfma_f32_16x16x32_bf16 v[112:115], a[48:51], a[8:11], v[112:115]
    buffer_load_dwordx4 v22, s[24:27], s49 offen offset:256 lds
    v_mfma_f32_16x16x32_bf16 v[136:139], a[48:51], a[12:15], v[136:139]
    s_waitcnt lgkmcnt(3)
    ds_read_b64_tr_b16 a[64:65], v8 offset:1024
    v_mul_f32 v164, v164, v165
    v_mfma_f32_16x16x32_bf16 v[68:71], a[52:55], a[0:3], v[68:71]
    s_add_u32 m0, s68, 98304
    ds_read_b64_tr_b16 a[66:67], v8 offset:7168
    v_and_b32 v194, 0xffff0000, v194
    v_mfma_f32_16x16x32_bf16 v[92:95], a[52:55], a[4:7], v[92:95]
    buffer_load_dwordx4 v5, s[20:23], s82 offen offset:0 sc1  lds
    v_mfma_f32_16x16x32_bf16 v[116:119], a[52:55], a[8:11], v[116:119]
    s_add_u32 s49, s58, 1105920
    ds_read_b128 a[28:31], v38 offset:24576
    v_and_b32 v206, 0xffff0000, v206
    v_mfma_f32_16x16x32_bf16 v[140:143], a[52:55], a[12:15], v[140:143]
    ds_read_b64_tr_b16 a[68:69], v9 offset:1024
    v_mul_f32 v194, v194, v206
    v_mfma_f32_16x16x32_bf16 v[72:75], a[56:59], a[0:3], v[72:75]
    buffer_load_dwordx4 v5, s[20:23], s82 offen offset:1024 sc1  lds
    v_mfma_f32_16x16x32_bf16 v[96:99], a[56:59], a[4:7], v[96:99]
    s_add_u32 s82, s66, 24576
    ds_read_b64_tr_b16 a[70:71], v9 offset:7168
    v_cvt_pk_bf16_f32 v194, v164, v194
    v_mfma_f32_16x16x32_bf16 v[120:123], a[56:59], a[8:11], v[120:123]
    s_add_u32 m0, s67, 12288
    ds_read_b64_tr_b16 a[72:73], v8 offset:12288
    v_lshlrev_b32 v164, 16, v194
    v_mfma_f32_16x16x32_bf16 v[144:147], a[56:59], a[12:15], v[144:147]
    s_waitcnt lgkmcnt(4)
    ds_read_b64_tr_b16 a[74:75], v8 offset:18432
    v_and_b32 v165, 0xffff0000, v194
    v_mfma_f32_16x16x32_bf16 v[76:79], a[60:63], a[0:3], v[76:79]
    ds_read_b64_tr_b16 a[76:77], v9 offset:12288
    v_mul_f32 v164, v32, v164
    v_mfma_f32_16x16x32_bf16 v[100:103], a[60:63], a[4:7], v[100:103]
    ds_read_b64_tr_b16 a[78:79], v9 offset:18432
    v_mul_f32 v165, v32, v165
    v_mfma_f32_16x16x32_bf16 v[124:127], a[60:63], a[8:11], v[124:127]
    buffer_load_dwordx4 v22, s[24:27], s49 offen offset:0 lds
    v_mfma_f32_16x16x32_bf16 v[148:151], a[60:63], a[12:15], v[148:151]
    s_waitcnt lgkmcnt(4)
    s_barrier
    v_lshlrev_b32 v166, 16, v195
    v_mfma_f32_16x16x32_bf16 v[80:83], a[64:67], a[0:3], v[80:83]
    s_add_u32 m0, s67, 13184
    ds_read_b128 a[32:35], v16 offset:32768
    v_lshlrev_b32 v167, 16, v207
    v_mfma_f32_16x16x32_bf16 v[104:107], a[64:67], a[4:7], v[104:107]
    buffer_load_dwordx4 v22, s[24:27], s49 offen offset:128 lds
    v_mfma_f32_16x16x32_bf16 v[128:131], a[64:67], a[8:11], v[128:131]
    s_add_u32 m0, s67, 14080
    ds_read_b64_tr_b16 a[48:49], v10 offset:12288
    v_mul_f32 v166, v166, v167
    v_mfma_f32_16x16x32_bf16 v[152:155], a[64:67], a[12:15], v[152:155]
    s_waitcnt vmcnt(13)
    ds_read_b64_tr_b16 a[50:51], v10 offset:18432
    v_and_b32 v195, 0xffff0000, v195
    v_mfma_f32_16x16x32_bf16 v[84:87], a[68:71], a[0:3], v[84:87]
    buffer_store_dword v4, v6, s[20:23], s61 offen offset:384 sc1
    v_mfma_f32_16x16x32_bf16 v[108:111], a[68:71], a[4:7], v[108:111]
    ds_read_b128 a[36:39], v17 offset:32768
    v_and_b32 v207, 0xffff0000, v207
    v_mfma_f32_16x16x32_bf16 v[132:135], a[68:71], a[8:11], v[132:135]
    ds_read_b64_tr_b16 a[52:53], v11 offset:12288
    v_mul_f32 v195, v195, v207
    v_mfma_f32_16x16x32_bf16 v[156:159], a[68:71], a[12:15], v[156:159]
    s_waitcnt lgkmcnt(4)
    ds_read_b64_tr_b16 a[54:55], v11 offset:18432
    v_cvt_pk_bf16_f32 v195, v166, v195
    v_mfma_f32_16x16x32_bf16 v[64:67], a[72:75], a[16:19], v[64:67]
    buffer_load_dwordx4 v22, s[24:27], s49 offen offset:256 lds
    v_mfma_f32_16x16x32_bf16 v[88:91], a[72:75], a[20:23], v[88:91]
    s_add_u32 m0, s68, 106496
    ds_read_b128 a[40:43], v27 offset:32768
    v_lshlrev_b32 v166, 16, v195
    v_mfma_f32_16x16x32_bf16 v[112:115], a[72:75], a[24:27], v[112:115]
    s_add_u32 s49, s58, 73728
    ds_read_b64_tr_b16 a[56:57], v8 offset:13312
    v_and_b32 v167, 0xffff0000, v195
    v_mfma_f32_16x16x32_bf16 v[136:139], a[72:75], a[28:31], v[136:139]
    buffer_load_dwordx4 v5, s[20:23], s82 offen offset:0 sc1  lds
    v_mfma_f32_16x16x32_bf16 v[68:71], a[76:79], a[16:19], v[68:71]
    ds_read_b64_tr_b16 a[58:59], v8 offset:19456
    v_mul_f32 v166, v32, v166
    v_mfma_f32_16x16x32_bf16 v[92:95], a[76:79], a[20:23], v[92:95]
    ds_read_b128 a[44:47], v38 offset:32768
    v_mul_f32 v167, v32, v167
    v_mfma_f32_16x16x32_bf16 v[116:119], a[76:79], a[24:27], v[116:119]
    buffer_load_dwordx4 v5, s[20:23], s82 offen offset:1024 sc1  lds
    v_mfma_f32_16x16x32_bf16 v[140:143], a[76:79], a[28:31], v[140:143]
    s_waitcnt lgkmcnt(3)
    ds_read_b64_tr_b16 a[60:61], v9 offset:13312
    v_lshlrev_b32 v168, 16, v196
    v_mfma_f32_16x16x32_bf16 v[72:75], a[48:51], a[16:19], v[72:75]
    s_add_u32 s82, s66, 40960
    ds_read_b64_tr_b16 a[62:63], v9 offset:19456
    v_lshlrev_b32 v169, 16, v12
    v_mfma_f32_16x16x32_bf16 v[96:99], a[48:51], a[20:23], v[96:99]
    s_add_u32 m0, s67, 24576
    ds_read_b64_tr_b16 a[64:65], v8 offset:24576
    v_mul_f32 v168, v168, v169
    v_mfma_f32_16x16x32_bf16 v[120:123], a[48:51], a[24:27], v[120:123]
    buffer_load_dwordx4 v22, s[24:27], s49 offen offset:0 lds
    v_mfma_f32_16x16x32_bf16 v[144:147], a[48:51], a[28:31], v[144:147]
    s_add_u32 m0, s67, 25472
    ds_read_b64_tr_b16 a[66:67], v8 offset:30720
    v_and_b32 v196, 0xffff0000, v196
    v_mfma_f32_16x16x32_bf16 v[76:79], a[52:55], a[16:19], v[76:79]
    ds_read_b64_tr_b16 a[68:69], v9 offset:24576
    v_and_b32 v12, 0xffff0000, v12
    v_mfma_f32_16x16x32_bf16 v[100:103], a[52:55], a[20:23], v[100:103]
    buffer_load_dwordx4 v22, s[24:27], s49 offen offset:128 lds
    v_mfma_f32_16x16x32_bf16 v[124:127], a[52:55], a[24:27], v[124:127]
    s_add_u32 m0, s67, 26368
    ds_read_b64_tr_b16 a[70:71], v9 offset:30720
    v_mul_f32 v196, v196, v12
    v_mfma_f32_16x16x32_bf16 v[148:151], a[52:55], a[28:31], v[148:151]
    s_waitcnt vmcnt(15) lgkmcnt(3)
    s_barrier
    v_cvt_pk_bf16_f32 v196, v168, v196
    v_mfma_f32_16x16x32_bf16 v[80:83], a[56:59], a[16:19], v[80:83]
    buffer_store_dword v4, v36, s[20:23], s53 offen offset:0 sc1
    v_mfma_f32_16x16x32_bf16 v[104:107], a[56:59], a[20:23], v[104:107]
    ds_read2st64_b64 v[60:63], v49 offset1:2
    v_lshlrev_b32 v168, 16, v196
    v_mfma_f32_16x16x32_bf16 v[128:131], a[56:59], a[24:27], v[128:131]
    buffer_load_dwordx4 v22, s[24:27], s49 offen offset:256 lds
    v_mfma_f32_16x16x32_bf16 v[152:155], a[56:59], a[28:31], v[152:155]
    s_add_u32 m0, s68, 114688
    ds_read_b128 a[0:3], v16 offset:40960
    v_and_b32 v169, 0xffff0000, v196
    v_mfma_f32_16x16x32_bf16 v[84:87], a[60:63], a[16:19], v[84:87]
    s_add_u32 s49, s58, 221184
    ds_read_b64_tr_b16 a[72:73], v10 offset:24576
    v_mul_f32 v168, v32, v168
    v_mfma_f32_16x16x32_bf16 v[108:111], a[60:63], a[20:23], v[108:111]
    buffer_load_dwordx4 v5, s[20:23], s82 offen offset:0 sc1  lds
    v_mfma_f32_16x16x32_bf16 v[132:135], a[60:63], a[24:27], v[132:135]
    ds_read_b64_tr_b16 a[74:75], v10 offset:30720
    v_mul_f32 v169, v32, v169
    v_mfma_f32_16x16x32_bf16 v[156:159], a[60:63], a[28:31], v[156:159]
    s_waitcnt lgkmcnt(3)
    ds_read_b128 a[4:7], v17 offset:40960
    v_lshl_add_u32 v46, v61, 8, v60
    v_mfma_f32_16x16x32_bf16 v[64:67], a[64:67], a[32:35], v[64:67]
    ds_read_b64_tr_b16 a[76:77], v11 offset:24576
    v_lshl_add_u32 v47, v63, 8, v62
    v_mfma_f32_16x16x32_bf16 v[88:91], a[64:67], a[36:39], v[88:91]
    ds_read_b64_tr_b16 a[78:79], v11 offset:30720
    v_lshlrev_b32 v170, 16, v197
    v_mfma_f32_16x16x32_bf16 v[112:115], a[64:67], a[40:43], v[112:115]
    ds_read_b128 a[8:11], v27 offset:40960
    v_lshlrev_b32 v171, 16, v13
    v_mfma_f32_16x16x32_bf16 v[136:139], a[64:67], a[44:47], v[136:139]
    ds_read_b64_tr_b16 a[48:49], v8 offset:25600
    v_mul_f32 v170, v170, v171
    v_mfma_f32_16x16x32_bf16 v[68:71], a[68:71], a[32:35], v[68:71]
    ds_read_b64_tr_b16 a[50:51], v8 offset:31744
    v_and_b32 v197, 0xffff0000, v197
    v_mfma_f32_16x16x32_bf16 v[92:95], a[68:71], a[36:39], v[92:95]
    ds_read_b128 a[12:15], v38 offset:40960
    v_and_b32 v13, 0xffff0000, v13
    v_mfma_f32_16x16x32_bf16 v[116:119], a[68:71], a[40:43], v[116:119]
    ds_read_b64_tr_b16 a[52:53], v9 offset:25600
    v_mul_f32 v197, v197, v13
    v_mfma_f32_16x16x32_bf16 v[140:143], a[68:71], a[44:47], v[140:143]
    s_waitcnt lgkmcnt(5)
    ds_read_b64_tr_b16 a[54:55], v9 offset:31744
    v_cvt_pk_bf16_f32 v197, v170, v197
    v_mfma_f32_16x16x32_bf16 v[72:75], a[72:75], a[32:35], v[72:75]
    ds_read_b64_tr_b16 a[56:57], v8 offset:36864
    v_lshlrev_b32 v170, 16, v197
    v_mfma_f32_16x16x32_bf16 v[96:99], a[72:75], a[36:39], v[96:99]
    ds_read_b64_tr_b16 a[58:59], v8 offset:43008
    v_and_b32 v171, 0xffff0000, v197
    v_mfma_f32_16x16x32_bf16 v[120:123], a[72:75], a[40:43], v[120:123]
    v_mul_f32 v170, v32, v170
    v_mul_f32 v171, v32, v171
    v_mfma_f32_16x16x32_bf16 v[144:147], a[72:75], a[44:47], v[144:147]
    v_lshlrev_b32 v172, 16, v198
    v_lshlrev_b32 v173, 16, v14
    v_mfma_f32_16x16x32_bf16 v[76:79], a[76:79], a[32:35], v[76:79]
    ds_read_b64_tr_b16 a[60:61], v9 offset:36864
    v_mul_f32 v172, v172, v173
    v_mfma_f32_16x16x32_bf16 v[100:103], a[76:79], a[36:39], v[100:103]
    ds_read_b64_tr_b16 a[62:63], v9 offset:43008
    v_and_b32 v198, 0xffff0000, v198
    v_mfma_f32_16x16x32_bf16 v[124:127], a[76:79], a[40:43], v[124:127]
    v_and_b32 v14, 0xffff0000, v14
    v_mul_f32 v198, v198, v14
    v_mfma_f32_16x16x32_bf16 v[148:151], a[76:79], a[44:47], v[148:151]
    s_waitcnt vmcnt(13) lgkmcnt(2)
    s_barrier
    v_cvt_pk_bf16_f32 v198, v172, v198
    v_mfma_f32_16x16x32_bf16 v[80:83], a[48:51], a[32:35], v[80:83]
    ds_read_b128 a[16:19], v16 offset:49152
    v_lshlrev_b32 v172, 16, v198
    v_mfma_f32_16x16x32_bf16 v[104:107], a[48:51], a[36:39], v[104:107]
    ds_read_b64_tr_b16 a[64:65], v10 offset:36864
    v_and_b32 v173, 0xffff0000, v198
    v_mfma_f32_16x16x32_bf16 v[128:131], a[48:51], a[40:43], v[128:131]
    ds_read_b64_tr_b16 a[66:67], v10 offset:43008
    v_mul_f32 v172, v32, v172
    v_mfma_f32_16x16x32_bf16 v[152:155], a[48:51], a[44:47], v[152:155]
    v_mul_f32 v173, v32, v173
    v_lshlrev_b32 v174, 16, v199
    v_mfma_f32_16x16x32_bf16 v[84:87], a[52:55], a[32:35], v[84:87]
    ds_read_b128 a[20:23], v17 offset:49152
    v_lshlrev_b32 v175, 16, v15
    v_mfma_f32_16x16x32_bf16 v[108:111], a[52:55], a[36:39], v[108:111]
    ds_read_b64_tr_b16 a[68:69], v11 offset:36864
    v_mul_f32 v174, v174, v175
    v_mfma_f32_16x16x32_bf16 v[132:135], a[52:55], a[40:43], v[132:135]
    buffer_load_dwordx4 v5, s[20:23], s82 offen offset:1024 sc1  lds
    v_mfma_f32_16x16x32_bf16 v[156:159], a[52:55], a[44:47], v[156:159]
    s_add_u32 s82, s66, 57344
    ds_read_b64_tr_b16 a[70:71], v11 offset:43008
    v_and_b32 v199, 0xffff0000, v199
    v_mfma_f32_16x16x32_bf16 v[64:67], a[56:59], a[0:3], v[64:67]
    s_add_u32 m0, s67, 36864
    ds_read_b128 a[24:27], v27 offset:49152
    v_and_b32 v15, 0xffff0000, v15
    v_mfma_f32_16x16x32_bf16 v[88:91], a[56:59], a[4:7], v[88:91]
    buffer_load_dwordx4 v22, s[24:27], s49 offen offset:0 lds
    v_mfma_f32_16x16x32_bf16 v[112:115], a[56:59], a[8:11], v[112:115]
    s_add_u32 m0, s67, 37760
    ds_read_b64_tr_b16 a[72:73], v8 offset:37888
    v_mul_f32 v199, v199, v15
    v_mfma_f32_16x16x32_bf16 v[136:139], a[56:59], a[12:15], v[136:139]
    s_waitcnt lgkmcnt(3)
    ds_read_b64_tr_b16 a[74:75], v8 offset:44032
    v_cvt_pk_bf16_f32 v199, v174, v199
    v_mfma_f32_16x16x32_bf16 v[68:71], a[60:63], a[0:3], v[68:71]
    buffer_load_dwordx4 v22, s[24:27], s49 offen offset:128 lds
    v_mfma_f32_16x16x32_bf16 v[92:95], a[60:63], a[4:7], v[92:95]
    s_add_u32 m0, s67, 38656
    ds_read_b128 a[28:31], v38 offset:49152
    v_lshlrev_b32 v174, 16, v199
    v_mfma_f32_16x16x32_bf16 v[116:119], a[60:63], a[8:11], v[116:119]
    ds_read_b64_tr_b16 a[76:77], v9 offset:37888
    v_and_b32 v175, 0xffff0000, v199
    v_mfma_f32_16x16x32_bf16 v[140:143], a[60:63], a[12:15], v[140:143]
    buffer_load_dwordx4 v22, s[24:27], s49 offen offset:256 lds
    v_mfma_f32_16x16x32_bf16 v[72:75], a[64:67], a[0:3], v[72:75]
    s_add_u32 m0, s68, 122880
    ds_read_b64_tr_b16 a[78:79], v9 offset:44032
    v_mul_f32 v174, v32, v174
    v_mfma_f32_16x16x32_bf16 v[96:99], a[64:67], a[4:7], v[96:99]
    s_add_u32 s49, s58, 368640
    ds_read_b64_tr_b16 a[48:49], v23 offset:0
    v_mul_f32 v175, v32, v175
    v_mfma_f32_16x16x32_bf16 v[120:123], a[64:67], a[8:11], v[120:123]
    buffer_load_dwordx4 v5, s[20:23], s82 offen offset:0 sc1  lds
    v_mfma_f32_16x16x32_bf16 v[144:147], a[64:67], a[12:15], v[144:147]
    s_waitcnt lgkmcnt(3)
    ds_read_b64_tr_b16 a[50:51], v23 offset:6144
    v_lshlrev_b32 v176, 16, v200
    v_mfma_f32_16x16x32_bf16 v[76:79], a[68:71], a[0:3], v[76:79]
    ds_read_b64_tr_b16 a[52:53], v24 offset:0
    v_lshlrev_b32 v177, 16, v28
    v_mfma_f32_16x16x32_bf16 v[100:103], a[68:71], a[4:7], v[100:103]
    ds_read_b64_tr_b16 a[54:55], v24 offset:6144
    v_mul_f32 v176, v176, v177
    v_mfma_f32_16x16x32_bf16 v[124:127], a[68:71], a[8:11], v[124:127]
    v_and_b32 v200, 0xffff0000, v200
    v_and_b32 v28, 0xffff0000, v28
    v_mfma_f32_16x16x32_bf16 v[148:151], a[68:71], a[12:15], v[148:151]
    s_waitcnt vmcnt(12) lgkmcnt(3)
    s_barrier
    v_mul_f32 v200, v200, v28
    v_mfma_f32_16x16x32_bf16 v[80:83], a[72:75], a[0:3], v[80:83]
    ds_read_b128 a[32:35], v16 offset:57344
    v_cvt_pk_bf16_f32 v200, v176, v200
    v_mfma_f32_16x16x32_bf16 v[104:107], a[72:75], a[4:7], v[104:107]
    ds_read_b64_tr_b16 a[56:57], v25 offset:0
    v_lshlrev_b32 v176, 16, v200
    v_mfma_f32_16x16x32_bf16 v[128:131], a[72:75], a[8:11], v[128:131]
    buffer_load_dwordx4 v5, s[20:23], s82 offen offset:1024 sc1  lds
    v_mfma_f32_16x16x32_bf16 v[152:155], a[72:75], a[12:15], v[152:155]
    s_add_u32 s82, s66, 73728
    ds_read_b64_tr_b16 a[58:59], v25 offset:6144
    v_and_b32 v177, 0xffff0000, v200
    v_mfma_f32_16x16x32_bf16 v[84:87], a[76:79], a[0:3], v[84:87]
    s_add_u32 m0, s67, 49152
    ds_read_b128 a[36:39], v17 offset:57344
    v_mul_f32 v176, v32, v176
    v_mfma_f32_16x16x32_bf16 v[108:111], a[76:79], a[4:7], v[108:111]
    buffer_load_dwordx4 v22, s[24:27], s49 offen offset:0 lds
    v_mfma_f32_16x16x32_bf16 v[132:135], a[76:79], a[8:11], v[132:135]
    s_add_u32 m0, s67, 50048
    ds_read_b64_tr_b16 a[60:61], v26 offset:0
    v_mul_f32 v177, v32, v177
    v_mfma_f32_16x16x32_bf16 v[156:159], a[76:79], a[12:15], v[156:159]
    s_waitcnt lgkmcnt(3)
    ds_read_b64_tr_b16 a[62:63], v26 offset:6144
    v_lshlrev_b32 v178, 16, v201
    v_mfma_f32_16x16x32_bf16 v[64:67], a[48:51], a[16:19], v[64:67]
    buffer_load_dwordx4 v22, s[24:27], s49 offen offset:128 lds
    v_mfma_f32_16x16x32_bf16 v[88:91], a[48:51], a[20:23], v[88:91]
    s_add_u32 m0, s67, 50944
    ds_read_b128 a[40:43], v27 offset:57344
    v_lshlrev_b32 v179, 16, v29
    v_mfma_f32_16x16x32_bf16 v[112:115], a[48:51], a[24:27], v[112:115]
    ds_read_b64_tr_b16 a[64:65], v23 offset:1024
    v_mul_f32 v178, v178, v179
    v_mfma_f32_16x16x32_bf16 v[136:139], a[48:51], a[28:31], v[136:139]
    buffer_load_dwordx4 v22, s[24:27], s49 offen offset:256 lds
    v_mfma_f32_16x16x32_bf16 v[68:71], a[52:55], a[16:19], v[68:71]
    s_add_u32 m0, s68, 131072
    ds_read_b64_tr_b16 a[66:67], v23 offset:7168
    v_and_b32 v201, 0xffff0000, v201
    v_mfma_f32_16x16x32_bf16 v[92:95], a[52:55], a[20:23], v[92:95]
    s_add_u32 s49, s58, 516096
    ds_read_b128 a[44:47], v38 offset:57344
    v_and_b32 v29, 0xffff0000, v29
    v_mfma_f32_16x16x32_bf16 v[116:119], a[52:55], a[24:27], v[116:119]
    buffer_load_dwordx4 v5, s[20:23], s82 offen offset:0 sc1  lds
    v_mfma_f32_16x16x32_bf16 v[140:143], a[52:55], a[28:31], v[140:143]
    s_waitcnt lgkmcnt(3)
    ds_read_b64_tr_b16 a[68:69], v24 offset:1024
    v_mul_f32 v201, v201, v29
    v_mfma_f32_16x16x32_bf16 v[72:75], a[56:59], a[16:19], v[72:75]
    ds_read_b64_tr_b16 a[70:71], v24 offset:7168
    v_cvt_pk_bf16_f32 v201, v178, v201
    v_mfma_f32_16x16x32_bf16 v[96:99], a[56:59], a[20:23], v[96:99]
    buffer_load_dwordx4 v5, s[20:23], s82 offen offset:1024 sc1  lds
    v_mfma_f32_16x16x32_bf16 v[120:123], a[56:59], a[24:27], v[120:123]
    s_add_u32 s82, s66, 90112
    ds_read_b64_tr_b16 a[72:73], v23 offset:12288
    v_lshlrev_b32 v178, 16, v201
    v_mfma_f32_16x16x32_bf16 v[144:147], a[56:59], a[28:31], v[144:147]
    s_add_u32 m0, s67, 61440
    ds_read_b64_tr_b16 a[74:75], v23 offset:18432
    v_and_b32 v179, 0xffff0000, v201
    v_mfma_f32_16x16x32_bf16 v[76:79], a[60:63], a[16:19], v[76:79]
    buffer_load_dwordx4 v22, s[24:27], s49 offen offset:0 lds
    v_mfma_f32_16x16x32_bf16 v[100:103], a[60:63], a[20:23], v[100:103]
    s_add_u32 m0, s67, 62336
    ds_read_b64_tr_b16 a[76:77], v24 offset:12288
    v_mul_f32 v178, v32, v178
    v_mfma_f32_16x16x32_bf16 v[124:127], a[60:63], a[24:27], v[124:127]
    ds_read_b64_tr_b16 a[78:79], v24 offset:18432
    v_mul_f32 v179, v32, v179
    v_mfma_f32_16x16x32_bf16 v[148:151], a[60:63], a[28:31], v[148:151]
    s_waitcnt vmcnt(13) lgkmcnt(4)
    s_barrier
    v_lshlrev_b32 v180, 16, v202
    v_mfma_f32_16x16x32_bf16 v[80:83], a[64:67], a[16:19], v[80:83]
    buffer_load_dwordx4 v22, s[24:27], s49 offen offset:128 lds
    v_mfma_f32_16x16x32_bf16 v[104:107], a[64:67], a[20:23], v[104:107]
    s_add_u32 m0, s67, 63232
    ds_read_b128 a[0:3], v16 offset:0
    v_lshlrev_b32 v181, 16, v30
    v_mfma_f32_16x16x32_bf16 v[128:131], a[64:67], a[24:27], v[128:131]
    ds_read_b64_tr_b16 a[48:49], v25 offset:12288
    v_mul_f32 v180, v180, v181
    v_mfma_f32_16x16x32_bf16 v[152:155], a[64:67], a[28:31], v[152:155]
    ds_read_b64_tr_b16 a[50:51], v25 offset:18432
    v_and_b32 v202, 0xffff0000, v202
    v_mfma_f32_16x16x32_bf16 v[84:87], a[68:71], a[16:19], v[84:87]
    ds_read_b128 a[4:7], v17 offset:0
    v_and_b32 v30, 0xffff0000, v30
    v_mfma_f32_16x16x32_bf16 v[108:111], a[68:71], a[20:23], v[108:111]
    ds_read_b64_tr_b16 a[52:53], v26 offset:12288
    v_mul_f32 v202, v202, v30
    v_mfma_f32_16x16x32_bf16 v[132:135], a[68:71], a[24:27], v[132:135]
    buffer_load_dwordx4 v22, s[24:27], s49 offen offset:256 lds
    v_mfma_f32_16x16x32_bf16 v[156:159], a[68:71], a[28:31], v[156:159]
    s_waitcnt lgkmcnt(4)
    ds_read_b64_tr_b16 a[54:55], v26 offset:18432
    v_cvt_pk_bf16_f32 v202, v180, v202
    v_mfma_f32_16x16x32_bf16 v[64:67], a[72:75], a[32:35], v[64:67]
    s_add_u32 m0, s68, 139264
    ds_read_b128 a[8:11], v27 offset:0
    v_lshlrev_b32 v180, 16, v202
    v_mfma_f32_16x16x32_bf16 v[88:91], a[72:75], a[36:39], v[88:91]
    buffer_load_dwordx4 v5, s[20:23], s82 offen offset:0 sc1  lds
    v_mfma_f32_16x16x32_bf16 v[112:115], a[72:75], a[40:43], v[112:115]
    s_add_u32 s49, s58, 663552
    ds_read_b64_tr_b16 a[56:57], v23 offset:13312
    v_and_b32 v181, 0xffff0000, v202
    v_mfma_f32_16x16x32_bf16 v[136:139], a[72:75], a[44:47], v[136:139]
    ds_read_b64_tr_b16 a[58:59], v23 offset:19456
    v_mul_f32 v180, v32, v180
    v_mfma_f32_16x16x32_bf16 v[68:71], a[76:79], a[32:35], v[68:71]
    buffer_load_dwordx4 v5, s[20:23], s82 offen offset:1024 sc1  lds
    v_mfma_f32_16x16x32_bf16 v[92:95], a[76:79], a[36:39], v[92:95]
    s_add_u32 s82, s66, 110592
    ds_read_b128 a[12:15], v38 offset:0
    v_mul_f32 v181, v32, v181
    v_mfma_f32_16x16x32_bf16 v[116:119], a[76:79], a[40:43], v[116:119]
    s_add_u32 m0, s67, 73728
    ds_read_b64_tr_b16 a[60:61], v24 offset:13312
    v_lshlrev_b32 v182, 16, v203
    v_mfma_f32_16x16x32_bf16 v[140:143], a[76:79], a[44:47], v[140:143]
    s_waitcnt lgkmcnt(4)
    ds_read_b64_tr_b16 a[62:63], v24 offset:19456
    v_lshlrev_b32 v183, 16, v31
    v_mfma_f32_16x16x32_bf16 v[72:75], a[48:51], a[32:35], v[72:75]
    buffer_load_dwordx4 v22, s[24:27], s49 offen offset:0 lds
    v_mfma_f32_16x16x32_bf16 v[96:99], a[48:51], a[36:39], v[96:99]
    s_add_u32 m0, s67, 74624
    ds_read_b64_tr_b16 a[64:65], v23 offset:24576
    v_mul_f32 v182, v182, v183
    v_mfma_f32_16x16x32_bf16 v[120:123], a[48:51], a[40:43], v[120:123]
    ds_read_b64_tr_b16 a[66:67], v23 offset:30720
    v_and_b32 v203, 0xffff0000, v203
    v_mfma_f32_16x16x32_bf16 v[144:147], a[48:51], a[44:47], v[144:147]
    buffer_load_dwordx4 v22, s[24:27], s49 offen offset:128 lds
    v_mfma_f32_16x16x32_bf16 v[76:79], a[52:55], a[32:35], v[76:79]
    s_add_u32 m0, s67, 75520
    ds_read_b64_tr_b16 a[68:69], v24 offset:24576
    v_and_b32 v31, 0xffff0000, v31
    v_mfma_f32_16x16x32_bf16 v[100:103], a[52:55], a[36:39], v[100:103]
    ds_read_b64_tr_b16 a[70:71], v24 offset:30720
    v_min_u32 v20, 15, v0
    v_mfma_f32_16x16x32_bf16 v[124:127], a[52:55], a[40:43], v[124:127]
    buffer_load_dwordx4 v22, s[24:27], s49 offen offset:256 lds
    v_mfma_f32_16x16x32_bf16 v[148:151], a[52:55], a[44:47], v[148:151]
    s_waitcnt vmcnt(15) lgkmcnt(3)
    s_barrier
    v_lshlrev_b32 v20, 2, v20
    v_mfma_f32_16x16x32_bf16 v[80:83], a[56:59], a[32:35], v[80:83]
    s_add_u32 m0, s68, 147456
    ds_read_b128 a[16:19], v16 offset:8192
    v_mul_f32 v203, v203, v31
    v_mfma_f32_16x16x32_bf16 v[104:107], a[56:59], a[36:39], v[104:107]
    buffer_load_dword v21, v20, s[20:23], s69 offen offset:384 sc1
    v_mfma_f32_16x16x32_bf16 v[128:131], a[56:59], a[40:43], v[128:131]
    s_add_u32 s49, s58, 811008
    ds_read_b64_tr_b16 a[72:73], v25 offset:24576
    v_cvt_pk_bf16_f32 v203, v182, v203
    v_mfma_f32_16x16x32_bf16 v[152:155], a[56:59], a[44:47], v[152:155]
    ds_read_b64_tr_b16 a[74:75], v25 offset:30720
    v_lshlrev_b32 v182, 16, v203
    v_mfma_f32_16x16x32_bf16 v[84:87], a[60:63], a[32:35], v[84:87]
    buffer_load_dwordx4 v5, s[20:23], s82 offen offset:0 sc1  lds
    v_mfma_f32_16x16x32_bf16 v[108:111], a[60:63], a[36:39], v[108:111]
    ds_read_b128 a[20:23], v17 offset:8192
    v_and_b32 v183, 0xffff0000, v203
    v_mfma_f32_16x16x32_bf16 v[132:135], a[60:63], a[40:43], v[132:135]
    ds_read_b64_tr_b16 a[76:77], v26 offset:24576
    v_mul_f32 v182, v32, v182
    v_mfma_f32_16x16x32_bf16 v[156:159], a[60:63], a[44:47], v[156:159]
    s_waitcnt lgkmcnt(4)
    ds_read_b64_tr_b16 a[78:79], v26 offset:30720
    v_mul_f32 v183, v32, v183
    v_mfma_f32_16x16x32_bf16 v[64:67], a[64:67], a[0:3], v[64:67]
    ds_read_b128 a[24:27], v27 offset:8192
    v_mfma_f32_16x16x32_bf16 v[88:91], a[64:67], a[4:7], v[88:91]
    ds_read_b64_tr_b16 a[48:49], v23 offset:25600
    v_mfma_f32_16x16x32_bf16 v[112:115], a[64:67], a[8:11], v[112:115]
    buffer_load_dwordx4 v5, s[20:23], s82 offen offset:1024 sc1  lds
    v_mfma_f32_16x16x32_bf16 v[136:139], a[64:67], a[12:15], v[136:139]
    s_add_u32 s82, s66, 126976
    ds_read_b64_tr_b16 a[50:51], v23 offset:31744
    v_mfma_f32_16x16x32_bf16 v[68:71], a[68:71], a[0:3], v[68:71]
    s_add_u32 m0, s67, 86016
    ds_read_b128 a[28:31], v38 offset:8192
    v_mfma_f32_16x16x32_bf16 v[92:95], a[68:71], a[4:7], v[92:95]
    buffer_load_dwordx4 v22, s[24:27], s49 offen offset:0 lds
    v_mfma_f32_16x16x32_bf16 v[116:119], a[68:71], a[8:11], v[116:119]
    s_add_u32 m0, s67, 86912
    ds_read_b64_tr_b16 a[52:53], v24 offset:25600
    v_mfma_f32_16x16x32_bf16 v[140:143], a[68:71], a[12:15], v[140:143]
    s_waitcnt lgkmcnt(3)
    ds_read_b64_tr_b16 a[54:55], v24 offset:31744
    v_mfma_f32_16x16x32_bf16 v[72:75], a[72:75], a[0:3], v[72:75]
    buffer_load_dwordx4 v22, s[24:27], s49 offen offset:128 lds
    v_mfma_f32_16x16x32_bf16 v[96:99], a[72:75], a[4:7], v[96:99]
    s_add_u32 m0, s67, 87808
    ds_read_b64_tr_b16 a[56:57], v23 offset:36864
    v_mfma_f32_16x16x32_bf16 v[120:123], a[72:75], a[8:11], v[120:123]
    ds_read_b64_tr_b16 a[58:59], v23 offset:43008
    v_mfma_f32_16x16x32_bf16 v[144:147], a[72:75], a[12:15], v[144:147]
    v_mfma_f32_16x16x32_bf16 v[76:79], a[76:79], a[0:3], v[76:79]
    buffer_load_dwordx4 v22, s[24:27], s49 offen offset:256 lds
    v_mfma_f32_16x16x32_bf16 v[100:103], a[76:79], a[4:7], v[100:103]
    s_add_u32 m0, s68, 155648
    ds_read_b64_tr_b16 a[60:61], v24 offset:36864
    v_mfma_f32_16x16x32_bf16 v[124:127], a[76:79], a[8:11], v[124:127]
    s_add_u32 s49, s58, 995328
    ds_read_b64_tr_b16 a[62:63], v24 offset:43008
    v_mfma_f32_16x16x32_bf16 v[148:151], a[76:79], a[12:15], v[148:151]
    s_waitcnt vmcnt(16) lgkmcnt(3)
    s_barrier
    v_mfma_f32_16x16x32_bf16 v[80:83], a[48:51], a[0:3], v[80:83]
    buffer_load_dwordx4 v5, s[20:23], s82 offen offset:0 sc1  lds
    v_mfma_f32_16x16x32_bf16 v[104:107], a[48:51], a[4:7], v[104:107]
    ds_read_b128 a[32:35], v16 offset:16384
    v_mfma_f32_16x16x32_bf16 v[128:131], a[48:51], a[8:11], v[128:131]
    ds_read_b64_tr_b16 a[64:65], v25 offset:36864
    v_mfma_f32_16x16x32_bf16 v[152:155], a[48:51], a[12:15], v[152:155]
    buffer_load_dwordx4 v5, s[20:23], s82 offen offset:1024 sc1  lds
    v_mfma_f32_16x16x32_bf16 v[84:87], a[52:55], a[0:3], v[84:87]
    s_add_u32 s82, s66, 12288
    ds_read_b64_tr_b16 a[66:67], v25 offset:43008
    v_mfma_f32_16x16x32_bf16 v[108:111], a[52:55], a[4:7], v[108:111]
    s_add_u32 m0, s67, 0
    ds_read_b128 a[36:39], v17 offset:16384
    v_mfma_f32_16x16x32_bf16 v[132:135], a[52:55], a[8:11], v[132:135]
    ds_read_b64_tr_b16 a[68:69], v26 offset:36864
    v_mfma_f32_16x16x32_bf16 v[156:159], a[52:55], a[12:15], v[156:159]
    s_waitcnt lgkmcnt(4)
    ds_read_b64_tr_b16 a[70:71], v26 offset:43008
    v_mfma_f32_16x16x32_bf16 v[64:67], a[56:59], a[16:19], v[64:67]
    ds_read_b128 a[40:43], v27 offset:16384
    v_mfma_f32_16x16x32_bf16 v[88:91], a[56:59], a[20:23], v[88:91]
    ds_read_b64_tr_b16 a[72:73], v23 offset:37888
    v_mfma_f32_16x16x32_bf16 v[112:115], a[56:59], a[24:27], v[112:115]
    ds_read_b64_tr_b16 a[74:75], v23 offset:44032
    v_mfma_f32_16x16x32_bf16 v[136:139], a[56:59], a[28:31], v[136:139]
    v_mfma_f32_16x16x32_bf16 v[68:71], a[60:63], a[16:19], v[68:71]
    ds_read_b128 a[44:47], v38 offset:16384
    v_mfma_f32_16x16x32_bf16 v[92:95], a[60:63], a[20:23], v[92:95]
    buffer_load_dwordx4 v22, s[24:27], s49 offen offset:0 lds
    v_mfma_f32_16x16x32_bf16 v[116:119], a[60:63], a[24:27], v[116:119]
    s_add_u32 m0, s67, 896
    ds_read_b64_tr_b16 a[76:77], v24 offset:37888
    v_mfma_f32_16x16x32_bf16 v[140:143], a[60:63], a[28:31], v[140:143]
    s_waitcnt lgkmcnt(3)
    ds_read_b64_tr_b16 a[78:79], v24 offset:44032
    v_mfma_f32_16x16x32_bf16 v[72:75], a[64:67], a[16:19], v[72:75]
    buffer_load_dwordx4 v22, s[24:27], s49 offen offset:128 lds
    v_mfma_f32_16x16x32_bf16 v[96:99], a[64:67], a[20:23], v[96:99]
    s_add_u32 m0, s67, 1792
    ds_read_b64_tr_b16 a[48:49], v8 offset:0
    v_mfma_f32_16x16x32_bf16 v[120:123], a[64:67], a[24:27], v[120:123]
    s_branch gated_mix__ssm_conv_s5__swiglu_ffn__prompt_kernel_A_sk9
.p2align 12
gated_mix__ssm_conv_s5__swiglu_ffn__prompt_kernel_A_pg0_9:
    s_branch gated_mix__ssm_conv_s5__swiglu_ffn__prompt_kernel_A_pr0
gated_mix__ssm_conv_s5__swiglu_ffn__prompt_kernel_A_pg3_9:
    s_branch gated_mix__ssm_conv_s5__swiglu_ffn__prompt_kernel_A_pr3
gated_mix__ssm_conv_s5__swiglu_ffn__prompt_kernel_A_sk9:
    ds_read_b64_tr_b16 a[50:51], v8 offset:6144
    v_mfma_f32_16x16x32_bf16 v[144:147], a[64:67], a[28:31], v[144:147]
    buffer_load_dwordx4 v22, s[24:27], s49 offen offset:256 lds
    v_mfma_f32_16x16x32_bf16 v[76:79], a[68:71], a[16:19], v[76:79]
    s_add_u32 s49, s58, 1142784
    ds_read_b64_tr_b16 a[52:53], v9 offset:0
    v_mfma_f32_16x16x32_bf16 v[100:103], a[68:71], a[20:23], v[100:103]
    s_add_u32 m0, s67, 12288
    ds_read_b64_tr_b16 a[54:55], v9 offset:6144
    v_mfma_f32_16x16x32_bf16 v[124:127], a[68:71], a[24:27], v[124:127]
    buffer_load_dwordx4 v22, s[24:27], s49 offen offset:0 lds
    v_mfma_f32_16x16x32_bf16 v[148:151], a[68:71], a[28:31], v[148:151]
    s_waitcnt vmcnt(17) lgkmcnt(3)
    s_barrier
    v_mfma_f32_16x16x32_bf16 v[80:83], a[72:75], a[16:19], v[80:83]
    s_add_u32 m0, s67, 13184
    ds_read_b128 a[0:3], v16 offset:24576
    v_mfma_f32_16x16x32_bf16 v[104:107], a[72:75], a[20:23], v[104:107]
    buffer_load_dwordx4 v22, s[24:27], s49 offen offset:128 lds
    v_mfma_f32_16x16x32_bf16 v[128:131], a[72:75], a[24:27], v[128:131]
    s_add_u32 m0, s67, 14080
    ds_read_b64_tr_b16 a[56:57], v10 offset:0
    v_mfma_f32_16x16x32_bf16 v[152:155], a[72:75], a[28:31], v[152:155]
    ds_read_b64_tr_b16 a[58:59], v10 offset:6144
    v_mfma_f32_16x16x32_bf16 v[84:87], a[76:79], a[16:19], v[84:87]
    buffer_load_dwordx4 v22, s[24:27], s49 offen offset:256 lds
    v_mfma_f32_16x16x32_bf16 v[108:111], a[76:79], a[20:23], v[108:111]
    s_add_u32 s49, s58, 110592
    ds_read_b128 a[4:7], v17 offset:24576
    v_mfma_f32_16x16x32_bf16 v[132:135], a[76:79], a[24:27], v[132:135]
    s_add_u32 m0, s67, 24576
    ds_read_b64_tr_b16 a[60:61], v11 offset:0
    v_mfma_f32_16x16x32_bf16 v[156:159], a[76:79], a[28:31], v[156:159]
    s_waitcnt lgkmcnt(4)
    ds_read_b64_tr_b16 a[62:63], v11 offset:6144
    v_mfma_f32_16x16x32_bf16 v[64:67], a[48:51], a[32:35], v[64:67]
    buffer_load_dwordx4 v22, s[24:27], s49 offen offset:0 lds
    v_mfma_f32_16x16x32_bf16 v[88:91], a[48:51], a[36:39], v[88:91]
    s_add_u32 m0, s67, 25472
    ds_read_b128 a[8:11], v27 offset:24576
    v_mfma_f32_16x16x32_bf16 v[112:115], a[48:51], a[40:43], v[112:115]
    ds_read_b64_tr_b16 a[64:65], v8 offset:1024
    v_mfma_f32_16x16x32_bf16 v[136:139], a[48:51], a[44:47], v[136:139]
    buffer_load_dwordx4 v22, s[24:27], s49 offen offset:128 lds
    v_mfma_f32_16x16x32_bf16 v[68:71], a[52:55], a[32:35], v[68:71]
    s_add_u32 m0, s67, 26368
    ds_read_b64_tr_b16 a[66:67], v8 offset:7168
    v_mfma_f32_16x16x32_bf16 v[92:95], a[52:55], a[36:39], v[92:95]
    s_waitcnt vmcnt(15)
    ds_read_b128 a[12:15], v38 offset:24576
    v_cmp_eq_u32 s[76:77], 0, v21
    v_mfma_f32_16x16x32_bf16 v[116:119], a[52:55], a[40:43], v[116:119]
    ds_read_b64_tr_b16 a[68:69], v9 offset:1024
    v_mfma_f32_16x16x32_bf16 v[140:143], a[52:55], a[44:47], v[140:143]
    s_waitcnt lgkmcnt(4)
    ds_read_b64_tr_b16 a[70:71], v9 offset:7168
    v_mfma_f32_16x16x32_bf16 v[72:75], a[56:59], a[32:35], v[72:75]
    s_cmp_lg_u64 s[76:77], 0
    s_cbranch_scc1 gated_mix__ssm_conv_s5__swiglu_ffn__prompt_kernel_hp3_s
gated_mix__ssm_conv_s5__swiglu_ffn__prompt_kernel_hp3:
    ds_read_b64_tr_b16 a[72:73], v8 offset:12288
    v_mfma_f32_16x16x32_bf16 v[96:99], a[56:59], a[36:39], v[96:99]
    buffer_load_dwordx4 v22, s[24:27], s49 offen offset:256 lds
    v_mfma_f32_16x16x32_bf16 v[120:123], a[56:59], a[40:43], v[120:123]
    s_add_u32 m0, s68, 98304
    ds_read_b64_tr_b16 a[74:75], v8 offset:18432
    v_mfma_f32_16x16x32_bf16 v[144:147], a[56:59], a[44:47], v[144:147]
    s_add_u32 s49, s58, 258048
    v_mfma_f32_16x16x32_bf16 v[76:79], a[60:63], a[32:35], v[76:79]
    buffer_load_dwordx4 v5, s[20:23], s82 offen offset:0 sc1  lds
    v_mfma_f32_16x16x32_bf16 v[100:103], a[60:63], a[36:39], v[100:103]
    ds_read_b64_tr_b16 a[76:77], v9 offset:12288
    v_mfma_f32_16x16x32_bf16 v[124:127], a[60:63], a[40:43], v[124:127]
    ds_read_b64_tr_b16 a[78:79], v9 offset:18432
    v_mfma_f32_16x16x32_bf16 v[148:151], a[60:63], a[44:47], v[148:151]
    s_waitcnt lgkmcnt(3)
    s_barrier
    v_mfma_f32_16x16x32_bf16 v[80:83], a[64:67], a[32:35], v[80:83]
    buffer_load_dwordx4 v5, s[20:23], s82 offen offset:1024 sc1  lds
    v_mfma_f32_16x16x32_bf16 v[104:107], a[64:67], a[36:39], v[104:107]
    s_add_u32 s82, s66, 28672
    ds_read_b128 a[16:19], v16 offset:32768
    v_mfma_f32_16x16x32_bf16 v[128:131], a[64:67], a[40:43], v[128:131]
    s_add_u32 m0, s67, 36864
    ds_read_b64_tr_b16 a[48:49], v10 offset:12288
    v_mfma_f32_16x16x32_bf16 v[152:155], a[64:67], a[44:47], v[152:155]
    buffer_load_dwordx4 v22, s[24:27], s49 offen offset:0 lds
    v_mfma_f32_16x16x32_bf16 v[84:87], a[68:71], a[32:35], v[84:87]
    s_add_u32 m0, s68, 106496
    ds_read_b64_tr_b16 a[50:51], v10 offset:18432
    v_mfma_f32_16x16x32_bf16 v[108:111], a[68:71], a[36:39], v[108:111]
    ds_read_b128 a[20:23], v17 offset:32768
    v_mfma_f32_16x16x32_bf16 v[132:135], a[68:71], a[40:43], v[132:135]
    buffer_load_dwordx4 v5, s[20:23], s82 offen offset:0 sc1  lds
    v_mfma_f32_16x16x32_bf16 v[156:159], a[68:71], a[44:47], v[156:159]
    s_waitcnt lgkmcnt(3)
    ds_read_b64_tr_b16 a[52:53], v11 offset:12288
    v_mfma_f32_16x16x32_bf16 v[64:67], a[72:75], a[0:3], v[64:67]
    ds_read_b64_tr_b16 a[54:55], v11 offset:18432
    v_mfma_f32_16x16x32_bf16 v[88:91], a[72:75], a[4:7], v[88:91]
    buffer_load_dwordx4 v5, s[20:23], s82 offen offset:1024 sc1  lds
    v_mfma_f32_16x16x32_bf16 v[112:115], a[72:75], a[8:11], v[112:115]
    s_add_u32 s82, s66, 45056
    ds_read_b128 a[24:27], v27 offset:32768
    v_mfma_f32_16x16x32_bf16 v[136:139], a[72:75], a[12:15], v[136:139]
    s_add_u32 m0, s67, 37760
    ds_read_b64_tr_b16 a[56:57], v8 offset:13312
    v_mfma_f32_16x16x32_bf16 v[68:71], a[76:79], a[0:3], v[68:71]
    buffer_load_dwordx4 v22, s[24:27], s49 offen offset:128 lds
    v_mfma_f32_16x16x32_bf16 v[92:95], a[76:79], a[4:7], v[92:95]
    s_add_u32 m0, s68, 114688
    ds_read_b64_tr_b16 a[58:59], v8 offset:19456
    v_mfma_f32_16x16x32_bf16 v[116:119], a[76:79], a[8:11], v[116:119]
    ds_read_b128 a[28:31], v38 offset:32768
    v_mfma_f32_16x16x32_bf16 v[140:143], a[76:79], a[12:15], v[140:143]
    s_waitcnt lgkmcnt(4)
    ds_read_b64_tr_b16 a[60:61], v9 offset:13312
    v_mfma_f32_16x16x32_bf16 v[72:75], a[48:51], a[0:3], v[72:75]
    buffer_load_dwordx4 v5, s[20:23], s82 offen offset:0 sc1  lds
    v_mfma_f32_16x16x32_bf16 v[96:99], a[48:51], a[4:7], v[96:99]
    ds_read_b64_tr_b16 a[62:63], v9 offset:19456
    v_mfma_f32_16x16x32_bf16 v[120:123], a[48:51], a[8:11], v[120:123]
    ds_read_b64_tr_b16 a[64:65], v8 offset:24576
    v_mfma_f32_16x16x32_bf16 v[144:147], a[48:51], a[12:15], v[144:147]
    ds_read_b64_tr_b16 a[66:67], v8 offset:30720
    v_mfma_f32_16x16x32_bf16 v[76:79], a[52:55], a[0:3], v[76:79]
    ds_read_b64_tr_b16 a[68:69], v9 offset:24576
    v_mfma_f32_16x16x32_bf16 v[100:103], a[52:55], a[4:7], v[100:103]
    buffer_load_dwordx4 v5, s[20:23], s82 offen offset:1024 sc1  lds
    v_mfma_f32_16x16x32_bf16 v[124:127], a[52:55], a[8:11], v[124:127]
    s_add_u32 s82, s66, 61440
    ds_read_b64_tr_b16 a[70:71], v9 offset:30720
    v_mfma_f32_16x16x32_bf16 v[148:151], a[52:55], a[12:15], v[148:151]
    s_waitcnt lgkmcnt(4)
    s_add_u32 m0, s67, 38656
    v_mfma_f32_16x16x32_bf16 v[80:83], a[56:59], a[0:3], v[80:83]
    buffer_load_dwordx4 v22, s[24:27], s49 offen offset:256 lds
    v_mfma_f32_16x16x32_bf16 v[104:107], a[56:59], a[4:7], v[104:107]
    s_add_u32 m0, s68, 122880
    ds_read_b64_tr_b16 a[72:73], v10 offset:24576
    v_mfma_f32_16x16x32_bf16 v[128:131], a[56:59], a[8:11], v[128:131]
    s_add_u32 s49, s58, 405504
    ds_read_b64_tr_b16 a[74:75], v10 offset:30720
    v_mfma_f32_16x16x32_bf16 v[152:155], a[56:59], a[12:15], v[152:155]
    v_mfma_f32_16x16x32_bf16 v[84:87], a[60:63], a[0:3], v[84:87]
    buffer_load_dwordx4 v5, s[20:23], s82 offen offset:0 sc1  lds
    v_mfma_f32_16x16x32_bf16 v[108:111], a[60:63], a[4:7], v[108:111]
    ds_read_b64_tr_b16 a[76:77], v11 offset:24576
    v_mfma_f32_16x16x32_bf16 v[132:135], a[60:63], a[8:11], v[132:135]
    ds_read_b64_tr_b16 a[78:79], v11 offset:30720
    v_mfma_f32_16x16x32_bf16 v[156:159], a[60:63], a[12:15], v[156:159]
    s_waitcnt vmcnt(21) lgkmcnt(3)
    s_barrier
    v_mfma_f32_16x16x32_bf16 v[64:67], a[64:67], a[16:19], v[64:67]
    buffer_load_dwordx4 v5, s[20:23], s82 offen offset:1024 sc1  lds
    v_mfma_f32_16x16x32_bf16 v[88:91], a[64:67], a[20:23], v[88:91]
    s_add_u32 s82, s66, 77824
    ds_read_b64_tr_b16 a[48:49], v8 offset:25600
    v_mfma_f32_16x16x32_bf16 v[112:115], a[64:67], a[24:27], v[112:115]
    s_add_u32 m0, s67, 49152
    ds_read_b64_tr_b16 a[50:51], v8 offset:31744
    v_mfma_f32_16x16x32_bf16 v[136:139], a[64:67], a[28:31], v[136:139]
    buffer_load_dwordx4 v22, s[24:27], s49 offen offset:0 lds
    v_mfma_f32_16x16x32_bf16 v[68:71], a[68:71], a[16:19], v[68:71]
    s_add_u32 m0, s67, 50048
    ds_read_b128 a[80:83], v17 offset:40960
    ds_read_b128 a[84:87], v27 offset:40960
    v_mfma_f32_16x16x32_bf16 v[92:95], a[68:71], a[20:23], v[92:95]
    ds_read_b128 a[88:91], v38 offset:40960
    v_mfma_f32_16x16x32_bf16 v[116:119], a[68:71], a[24:27], v[116:119]
    buffer_load_dwordx4 v22, s[24:27], s49 offen offset:128 lds
    v_mfma_f32_16x16x32_bf16 v[140:143], a[68:71], a[28:31], v[140:143]
    s_waitcnt lgkmcnt(4)
    ds_read_b64_tr_b16 a[52:53], v9 offset:25600
    ds_read_b64_tr_b16 a[54:55], v9 offset:31744
    v_mfma_f32_16x16x32_bf16 v[72:75], a[72:75], a[16:19], v[72:75]
    s_add_u32 m0, s67, 50944
    ds_read_b64_tr_b16 a[92:93], v8 offset:36864
    v_mfma_f32_16x16x32_bf16 v[96:99], a[72:75], a[20:23], v[96:99]
    buffer_load_dwordx4 v22, s[24:27], s49 offen offset:256 lds
    v_mfma_f32_16x16x32_bf16 v[120:123], a[72:75], a[24:27], v[120:123]
    s_add_u32 m0, s68, 131072
    ds_read_b64_tr_b16 a[94:95], v8 offset:43008
    v_mfma_f32_16x16x32_bf16 v[144:147], a[72:75], a[28:31], v[144:147]
    s_add_u32 s49, s58, 552960
    ds_read_b64_tr_b16 a[96:97], v9 offset:36864
    v_mfma_f32_16x16x32_bf16 v[76:79], a[76:79], a[16:19], v[76:79]
    buffer_load_dwordx4 v5, s[20:23], s82 offen offset:0 sc1  lds
    v_mfma_f32_16x16x32_bf16 v[100:103], a[76:79], a[20:23], v[100:103]
    ds_read_b64_tr_b16 a[98:99], v9 offset:43008
    v_mfma_f32_16x16x32_bf16 v[124:127], a[76:79], a[24:27], v[124:127]
    ds_read_b64_tr_b16 a[100:101], v10 offset:36864
    v_mfma_f32_16x16x32_bf16 v[148:151], a[76:79], a[28:31], v[148:151]
    s_waitcnt lgkmcnt(4)
    ds_read_b64_tr_b16 a[102:103], v10 offset:43008
    v_mfma_f32_16x16x32_bf16 v[80:83], a[48:51], a[16:19], v[80:83]
    ds_read_b128 a[104:107], v16 offset:40960
    v_mfma_f32_16x16x32_bf16 v[104:107], a[48:51], a[20:23], v[104:107]
    buffer_load_dwordx4 v5, s[20:23], s82 offen offset:1024 sc1  lds
    v_mfma_f32_16x16x32_bf16 v[128:131], a[48:51], a[24:27], v[128:131]
    s_add_u32 s82, s66, 94208
    ds_read_b64_tr_b16 a[108:109], v11 offset:36864
    v_min_u32 v20, 3, v0
    v_mfma_f32_16x16x32_bf16 v[152:155], a[48:51], a[28:31], v[152:155]
    s_add_u32 m0, s67, 61440
    ds_read_b64_tr_b16 a[110:111], v11 offset:43008
    v_lshlrev_b32 v20, 2, v20
    v_mfma_f32_16x16x32_bf16 v[84:87], a[52:55], a[16:19], v[84:87]
    s_waitcnt vmcnt(22) lgkmcnt(4)
    s_barrier
    v_mfma_f32_16x16x32_bf16 v[108:111], a[52:55], a[20:23], v[108:111]
    buffer_store_dword v4, v36, s[20:23], s53 offen offset:128 sc1
    v_mfma_f32_16x16x32_bf16 v[132:135], a[52:55], a[24:27], v[132:135]
    buffer_load_dword v21, v20, s[20:23], s69 offen offset:560 sc1
    v_mfma_f32_16x16x32_bf16 v[156:159], a[52:55], a[28:31], v[156:159]
    ds_read_b128 a[112:115], v17 offset:49152
    ds_read_b128 a[116:119], v27 offset:49152
    v_mfma_f32_16x16x32_bf16 v[88:91], a[92:95], a[80:83], v[88:91]
    buffer_load_dwordx4 v22, s[24:27], s49 offen offset:0 lds
    v_mfma_f32_16x16x32_bf16 v[112:115], a[92:95], a[84:87], v[112:115]
    s_add_u32 m0, s67, 62336
    ds_read_b128 a[120:123], v38 offset:49152
    ds_read_b64_tr_b16 a[124:125], v8 offset:37888
    v_mfma_f32_16x16x32_bf16 v[136:139], a[92:95], a[88:91], v[136:139]
    ds_read_b64_tr_b16 a[126:127], v8 offset:44032
    ds_read_b64_tr_b16 a[128:129], v9 offset:37888
    v_mfma_f32_16x16x32_bf16 v[92:95], a[96:99], a[80:83], v[92:95]
    ds_read_b64_tr_b16 a[130:131], v9 offset:44032
    v_mfma_f32_16x16x32_bf16 v[116:119], a[96:99], a[84:87], v[116:119]
    buffer_load_dwordx4 v22, s[24:27], s49 offen offset:128 lds
    v_mfma_f32_16x16x32_bf16 v[140:143], a[96:99], a[88:91], v[140:143]
    s_waitcnt lgkmcnt(5)
    ds_read_b64_tr_b16 a[132:133], v23 offset:0
    ds_read_b64_tr_b16 a[134:135], v23 offset:6144
    v_mfma_f32_16x16x32_bf16 v[96:99], a[100:103], a[80:83], v[96:99]
    s_add_u32 m0, s67, 63232
    ds_read_b64_tr_b16 a[136:137], v24 offset:0
    v_mfma_f32_16x16x32_bf16 v[120:123], a[100:103], a[84:87], v[120:123]
    buffer_load_dwordx4 v22, s[24:27], s49 offen offset:256 lds
    v_mfma_f32_16x16x32_bf16 v[144:147], a[100:103], a[88:91], v[144:147]
    s_add_u32 s49, s58, 700416
    ds_read_b64_tr_b16 a[138:139], v24 offset:6144
    v_mfma_f32_16x16x32_bf16 v[100:103], a[108:111], a[80:83], v[100:103]
    s_add_u32 m0, s67, 73728
    ds_read_b64_tr_b16 a[140:141], v25 offset:0
    v_mfma_f32_16x16x32_bf16 v[124:127], a[108:111], a[84:87], v[124:127]
    buffer_load_dwordx4 v22, s[24:27], s49 offen offset:0 lds
    v_mfma_f32_16x16x32_bf16 v[148:151], a[108:111], a[88:91], v[148:151]
    s_waitcnt lgkmcnt(3)
    ds_read_b64_tr_b16 a[142:143], v25 offset:6144
    v_mfma_f32_16x16x32_bf16 v[104:107], a[124:127], a[80:83], v[104:107]
    s_add_u32 m0, s67, 74624
    ds_read_b128 a[144:147], v16 offset:49152
    v_mfma_f32_16x16x32_bf16 v[128:131], a[124:127], a[84:87], v[128:131]
    buffer_load_dwordx4 v22, s[24:27], s49 offen offset:128 lds
    v_mfma_f32_16x16x32_bf16 v[152:155], a[124:127], a[88:91], v[152:155]
    s_add_u32 m0, s67, 75520
    ds_read_b64_tr_b16 a[148:149], v26 offset:0
    ds_read_b64_tr_b16 a[150:151], v26 offset:6144
    v_mfma_f32_16x16x32_bf16 v[108:111], a[128:131], a[80:83], v[108:111]
    s_waitcnt vmcnt(26) lgkmcnt(4)
    s_barrier
    v_mfma_f32_16x16x32_bf16 v[132:135], a[128:131], a[84:87], v[132:135]
    buffer_load_dwordx4 v22, s[24:27], s49 offen offset:256 lds
    v_mfma_f32_16x16x32_bf16 v[156:159], a[128:131], a[88:91], v[156:159]
    s_add_u32 m0, s68, 139264
    ds_read_b128 a[152:155], v17 offset:57344
    ds_read_b128 a[156:159], v27 offset:57344
    v_mfma_f32_16x16x32_bf16 v[88:91], a[132:135], a[112:115], v[88:91]
    s_add_u32 s49, s58, 847872
    ds_read_b128 a[160:163], v38 offset:57344
    ds_read_b64_tr_b16 a[164:165], v23 offset:1024
    v_mfma_f32_16x16x32_bf16 v[112:115], a[132:135], a[116:119], v[112:115]
    ds_read_b64_tr_b16 a[166:167], v23 offset:7168
    v_mfma_f32_16x16x32_bf16 v[136:139], a[132:135], a[120:123], v[136:139]
    ds_read_b64_tr_b16 a[168:169], v24 offset:1024
    ds_read_b64_tr_b16 a[170:171], v24 offset:7168
    v_mfma_f32_16x16x32_bf16 v[92:95], a[136:139], a[112:115], v[92:95]
    buffer_load_dwordx4 v5, s[20:23], s82 offen offset:0 sc1  lds
    v_mfma_f32_16x16x32_bf16 v[116:119], a[136:139], a[116:119], v[116:119]
    ds_read_b64_tr_b16 a[172:173], v23 offset:12288
    v_mfma_f32_16x16x32_bf16 v[140:143], a[136:139], a[120:123], v[140:143]
    s_waitcnt lgkmcnt(6)
    ds_read_b64_tr_b16 a[174:175], v23 offset:18432
    v_mfma_f32_16x16x32_bf16 v[96:99], a[140:143], a[112:115], v[96:99]
    ds_read_b64_tr_b16 a[176:177], v24 offset:12288
    v_mfma_f32_16x16x32_bf16 v[120:123], a[140:143], a[116:119], v[120:123]
    ds_read_b64_tr_b16 a[178:179], v24 offset:18432
    v_mfma_f32_16x16x32_bf16 v[144:147], a[140:143], a[120:123], v[144:147]
    ds_read_b64_tr_b16 a[180:181], v25 offset:12288
    v_mfma_f32_16x16x32_bf16 v[100:103], a[148:151], a[112:115], v[100:103]
    ds_read_b64_tr_b16 a[182:183], v25 offset:18432
    v_mfma_f32_16x16x32_bf16 v[124:127], a[148:151], a[116:119], v[124:127]
    ds_read_b128 a[184:187], v16 offset:57344
    v_mfma_f32_16x16x32_bf16 v[148:151], a[148:151], a[120:123], v[148:151]
    s_waitcnt lgkmcnt(5)
    ds_read_b64_tr_b16 a[188:189], v26 offset:12288
    v_mfma_f32_16x16x32_bf16 v[104:107], a[164:167], a[112:115], v[104:107]
    ds_read_b64_tr_b16 a[190:191], v26 offset:18432
    v_mfma_f32_16x16x32_bf16 v[128:131], a[164:167], a[116:119], v[128:131]
    s_waitcnt vmcnt(23) lgkmcnt(5)
    s_barrier
    v_mfma_f32_16x16x32_bf16 v[152:155], a[164:167], a[120:123], v[152:155]
    ds_read_b128 a[192:195], v17 offset:0
    v_mfma_f32_16x16x32_bf16 v[108:111], a[168:171], a[112:115], v[108:111]
    ds_read_b128 a[196:199], v27 offset:0
    v_mfma_f32_16x16x32_bf16 v[132:135], a[168:171], a[116:119], v[132:135]
    ds_read_b128 a[200:203], v38 offset:0
    v_mfma_f32_16x16x32_bf16 v[156:159], a[168:171], a[120:123], v[156:159]
    ds_read_b64_tr_b16 a[204:205], v23 offset:13312
    ds_read_b64_tr_b16 a[206:207], v23 offset:19456
    v_mfma_f32_16x16x32_bf16 v[88:91], a[172:175], a[152:155], v[88:91]
    ds_read_b64_tr_b16 a[208:209], v24 offset:13312
    v_mfma_f32_16x16x32_bf16 v[112:115], a[172:175], a[156:159], v[112:115]
    ds_read_b64_tr_b16 a[210:211], v24 offset:19456
    v_mfma_f32_16x16x32_bf16 v[136:139], a[172:175], a[160:163], v[136:139]
    ds_read_b64_tr_b16 a[212:213], v23 offset:24576
    v_mfma_f32_16x16x32_bf16 v[92:95], a[176:179], a[152:155], v[92:95]
    ds_read_b64_tr_b16 a[214:215], v23 offset:30720
    v_mfma_f32_16x16x32_bf16 v[116:119], a[176:179], a[156:159], v[116:119]
    v_mfma_f32_16x16x32_bf16 v[140:143], a[176:179], a[160:163], v[140:143]
    s_waitcnt lgkmcnt(4)
    ds_read_b64_tr_b16 a[216:217], v24 offset:24576
    v_mfma_f32_16x16x32_bf16 v[96:99], a[180:183], a[152:155], v[96:99]
    ds_read_b64_tr_b16 a[218:219], v24 offset:30720
    v_mfma_f32_16x16x32_bf16 v[120:123], a[180:183], a[156:159], v[120:123]
    v_mfma_f32_16x16x32_bf16 v[144:147], a[180:183], a[160:163], v[144:147]
    ds_read_b64_tr_b16 a[220:221], v25 offset:24576
    v_mfma_f32_16x16x32_bf16 v[100:103], a[188:191], a[152:155], v[100:103]
    ds_read_b64_tr_b16 a[222:223], v25 offset:30720
    v_mfma_f32_16x16x32_bf16 v[124:127], a[188:191], a[156:159], v[124:127]
    ds_read_b128 a[224:227], v16 offset:0
    v_mfma_f32_16x16x32_bf16 v[148:151], a[188:191], a[160:163], v[148:151]
    buffer_load_dwordx4 v5, s[20:23], s82 offen offset:1024 sc1  lds
    v_mfma_f32_16x16x32_bf16 v[104:107], a[204:207], a[152:155], v[104:107]
    s_add_u32 s82, s66, 131072
    ds_read_b64_tr_b16 a[228:229], v26 offset:24576
    v_mfma_f32_16x16x32_bf16 v[128:131], a[204:207], a[156:159], v[128:131]
    s_add_u32 m0, s67, 86016
    ds_read_b64_tr_b16 a[230:231], v26 offset:30720
    v_mfma_f32_16x16x32_bf16 v[152:155], a[204:207], a[160:163], v[152:155]
    s_waitcnt vmcnt(17) lgkmcnt(4)
    s_barrier
    v_mfma_f32_16x16x32_bf16 v[108:111], a[208:211], a[152:155], v[108:111]
    buffer_load_dwordx4 v22, s[24:27], s49 offen offset:0 lds
    v_mfma_f32_16x16x32_bf16 v[132:135], a[208:211], a[156:159], v[132:135]
    s_add_u32 m0, s68, 147456
    ds_read_b128 a[232:235], v17 offset:8192
    ds_read_b128 a[236:239], v27 offset:8192
    v_mfma_f32_16x16x32_bf16 v[156:159], a[208:211], a[160:163], v[156:159]
    ds_read_b128 a[240:243], v38 offset:8192
    ds_read_b64_tr_b16 a[244:245], v23 offset:25600
    v_mfma_f32_16x16x32_bf16 v[88:91], a[212:215], a[192:195], v[88:91]
    buffer_load_dwordx4 v5, s[20:23], s82 offen offset:0 sc1  lds
    v_mfma_f32_16x16x32_bf16 v[112:115], a[212:215], a[196:199], v[112:115]
    ds_read_b64_tr_b16 a[246:247], v23 offset:31744
    v_mfma_f32_16x16x32_bf16 v[136:139], a[212:215], a[200:203], v[136:139]
    ds_read_b64_tr_b16 a[248:249], v24 offset:25600
    ds_read_b64_tr_b16 a[250:251], v24 offset:31744
    v_mfma_f32_16x16x32_bf16 v[92:95], a[216:219], a[192:195], v[92:95]
    buffer_load_dwordx4 v5, s[20:23], s82 offen offset:1024 sc1  lds
    v_mfma_f32_16x16x32_bf16 v[116:119], a[216:219], a[196:199], v[116:119]
    s_waitcnt vmcnt(11)
    ds_read_b64_tr_b16 a[252:253], v23 offset:36864
    v_cmp_eq_u32 s[76:77], 0, v21
    v_mfma_f32_16x16x32_bf16 v[140:143], a[216:219], a[200:203], v[140:143]
    s_waitcnt lgkmcnt(4)
    ds_read_b64_tr_b16 a[254:255], v23 offset:43008
    v_mfma_f32_16x16x32_bf16 v[96:99], a[220:223], a[192:195], v[96:99]
    s_cmp_lg_u64 s[76:77], 0
    s_cbranch_scc1 gated_mix__ssm_conv_s5__swiglu_ffn__prompt_kernel_hp4_s
gated_mix__ssm_conv_s5__swiglu_ffn__prompt_kernel_hp4:
    ds_read_b64_tr_b16 a[32:33], v24 offset:36864
    v_mfma_f32_16x16x32_bf16 v[120:123], a[220:223], a[196:199], v[120:123]
    s_add_u32 s82, s66, 139264
    ds_read_b64_tr_b16 a[34:35], v24 offset:43008
    v_mfma_f32_16x16x32_bf16 v[144:147], a[220:223], a[200:203], v[144:147]
    s_add_u32 m0, s67, 86912
    ds_read_b64_tr_b16 a[36:37], v25 offset:36864
    v_mfma_f32_16x16x32_bf16 v[100:103], a[228:231], a[192:195], v[100:103]
    buffer_load_dwordx4 v22, s[24:27], s49 offen offset:128 lds
    v_mfma_f32_16x16x32_bf16 v[124:127], a[228:231], a[196:199], v[124:127]
    s_add_u32 m0, s67, 87808
    ds_read_b64_tr_b16 a[38:39], v25 offset:43008
    v_mfma_f32_16x16x32_bf16 v[148:151], a[228:231], a[200:203], v[148:151]
    s_waitcnt lgkmcnt(4)
    ds_read_b128 a[40:43], v16 offset:8192
    v_mfma_f32_16x16x32_bf16 v[104:107], a[244:247], a[192:195], v[104:107]
    buffer_load_dwordx4 v22, s[24:27], s49 offen offset:256 lds
    v_mfma_f32_16x16x32_bf16 v[128:131], a[244:247], a[196:199], v[128:131]
    s_add_u32 m0, s68, 155648
    ds_read_b64_tr_b16 a[44:45], v26 offset:36864
    v_mfma_f32_16x16x32_bf16 v[152:155], a[244:247], a[200:203], v[152:155]
    s_add_u32 s49, s58, 1179648
    ds_read_b64_tr_b16 a[46:47], v26 offset:43008
    v_mfma_f32_16x16x32_bf16 v[108:111], a[248:251], a[192:195], v[108:111]
    s_waitcnt lgkmcnt(4)
    s_barrier
    v_mfma_f32_16x16x32_bf16 v[132:135], a[248:251], a[196:199], v[132:135]
    buffer_load_dwordx4 v5, s[20:23], s82 offen offset:0 sc1  lds
    v_mfma_f32_16x16x32_bf16 v[156:159], a[248:251], a[200:203], v[156:159]
    ds_read_b128 a[56:59], v17 offset:16384
    ds_read_b128 a[0:3], v27 offset:16384
    v_mfma_f32_16x16x32_bf16 v[88:91], a[252:255], a[232:235], v[88:91]
    ds_read_b128 a[4:7], v38 offset:16384
    ds_read_b64_tr_b16 a[8:9], v23 offset:37888
    v_mfma_f32_16x16x32_bf16 v[112:115], a[252:255], a[236:239], v[112:115]
    buffer_load_dwordx4 v5, s[20:23], s82 offen offset:1024 sc1  lds
    v_mfma_f32_16x16x32_bf16 v[136:139], a[252:255], a[240:243], v[136:139]
    s_add_u32 s82, s66, 135168
    ds_read_b64_tr_b16 a[10:11], v23 offset:44032
    ds_read_b64_tr_b16 a[12:13], v24 offset:37888
    v_mfma_f32_16x16x32_bf16 v[92:95], a[32:35], a[232:235], v[92:95]
    s_add_u32 m0, s67, 0
    ds_read_b64_tr_b16 a[14:15], v24 offset:44032
    v_mfma_f32_16x16x32_bf16 v[116:119], a[32:35], a[236:239], v[116:119]
    buffer_load_dwordx4 v22, s[24:27], s49 offen offset:0 lds
    v_mfma_f32_16x16x32_bf16 v[140:143], a[32:35], a[240:243], v[140:143]
    s_waitcnt lgkmcnt(5)
    ds_read_b64_tr_b16 a[60:61], v8 offset:0
    ds_read_b64_tr_b16 a[62:63], v8 offset:6144
    v_mfma_f32_16x16x32_bf16 v[96:99], a[36:39], a[232:235], v[96:99]
    s_add_u32 m0, s67, 896
    ds_read_b64_tr_b16 a[64:65], v9 offset:0
    v_mfma_f32_16x16x32_bf16 v[120:123], a[36:39], a[236:239], v[120:123]
    buffer_load_dwordx4 v22, s[24:27], s49 offen offset:128 lds
    v_mfma_f32_16x16x32_bf16 v[144:147], a[36:39], a[240:243], v[144:147]
    s_add_u32 m0, s67, 1792
    ds_read_b64_tr_b16 a[66:67], v9 offset:6144
    v_mfma_f32_16x16x32_bf16 v[100:103], a[44:47], a[232:235], v[100:103]
    ds_read_b64_tr_b16 a[68:69], v10 offset:0
    v_mfma_f32_16x16x32_bf16 v[124:127], a[44:47], a[236:239], v[124:127]
    buffer_load_dwordx4 v22, s[24:27], s49 offen offset:256 lds
    v_mfma_f32_16x16x32_bf16 v[148:151], a[44:47], a[240:243], v[148:151]
    s_waitcnt lgkmcnt(3)
    ds_read_b64_tr_b16 a[70:71], v10 offset:6144
    v_mfma_f32_16x16x32_bf16 v[104:107], a[8:11], a[232:235], v[104:107]
    s_add_u32 m0, s68, 98304
    ds_read_b64_tr_b16 a[72:73], v11 offset:0
    v_mfma_f32_16x16x32_bf16 v[128:131], a[8:11], a[236:239], v[128:131]
    buffer_load_dwordx4 v5, s[20:23], s82 offen offset:0 sc1  lds
    v_mfma_f32_16x16x32_bf16 v[152:155], a[8:11], a[240:243], v[152:155]
    s_add_u32 s49, s58, 1253376
    ds_read_b64_tr_b16 a[74:75], v11 offset:6144
    v_mfma_f32_16x16x32_bf16 v[108:111], a[12:15], a[232:235], v[108:111]
    s_waitcnt vmcnt(16) lgkmcnt(3)
    s_barrier
    v_mfma_f32_16x16x32_bf16 v[132:135], a[12:15], a[236:239], v[132:135]
    ds_read_b128 a[76:79], v17 offset:24576
    ds_read_b128 a[48:51], v27 offset:24576
    v_mfma_f32_16x16x32_bf16 v[156:159], a[12:15], a[240:243], v[156:159]
    ds_read_b128 a[16:19], v38 offset:24576
    ds_read_b64_tr_b16 a[20:21], v8 offset:1024
    v_mfma_f32_16x16x32_bf16 v[88:91], a[60:63], a[56:59], v[88:91]
    ds_read_b64_tr_b16 a[22:23], v8 offset:7168
    v_mfma_f32_16x16x32_bf16 v[112:115], a[60:63], a[0:3], v[112:115]
    buffer_load_dwordx4 v5, s[20:23], s82 offen offset:1024 sc1  lds
    v_mfma_f32_16x16x32_bf16 v[136:139], a[60:63], a[4:7], v[136:139]
    s_add_u32 s82, s66, 143360
    ds_read_b64_tr_b16 a[24:25], v9 offset:1024
    ds_read_b64_tr_b16 a[26:27], v9 offset:7168
    v_mfma_f32_16x16x32_bf16 v[92:95], a[64:67], a[56:59], v[92:95]
    s_add_u32 m0, s67, 12288
    ds_read_b64_tr_b16 a[28:29], v8 offset:12288
    v_mfma_f32_16x16x32_bf16 v[116:119], a[64:67], a[0:3], v[116:119]
    buffer_load_dwordx4 v22, s[24:27], s49 offen offset:0 lds
    v_mfma_f32_16x16x32_bf16 v[140:143], a[64:67], a[4:7], v[140:143]
    s_waitcnt lgkmcnt(4)
    ds_read_b64_tr_b16 a[30:31], v8 offset:18432
    v_mfma_f32_16x16x32_bf16 v[96:99], a[68:71], a[56:59], v[96:99]
    s_add_u32 m0, s67, 13184
    ds_read_b64_tr_b16 a[52:53], v9 offset:12288
    v_mfma_f32_16x16x32_bf16 v[120:123], a[68:71], a[0:3], v[120:123]
    ds_read_b64_tr_b16 a[54:55], v9 offset:18432
    v_mfma_f32_16x16x32_bf16 v[144:147], a[68:71], a[4:7], v[144:147]
    buffer_load_dwordx4 v22, s[24:27], s49 offen offset:128 lds
    v_mfma_f32_16x16x32_bf16 v[100:103], a[72:75], a[56:59], v[100:103]
    s_add_u32 m0, s67, 14080
    ds_read_b64_tr_b16 a[80:81], v10 offset:12288
    v_mfma_f32_16x16x32_bf16 v[124:127], a[72:75], a[0:3], v[124:127]
    ds_read_b64_tr_b16 a[82:83], v10 offset:18432
    v_mfma_f32_16x16x32_bf16 v[148:151], a[72:75], a[4:7], v[148:151]
    s_waitcnt lgkmcnt(4)
    ds_read_b64_tr_b16 a[84:85], v11 offset:12288
    v_mfma_f32_16x16x32_bf16 v[104:107], a[20:23], a[56:59], v[104:107]
    buffer_load_dwordx4 v22, s[24:27], s49 offen offset:256 lds
    v_mfma_f32_16x16x32_bf16 v[128:131], a[20:23], a[0:3], v[128:131]
    s_add_u32 m0, s68, 106496
    ds_read_b64_tr_b16 a[86:87], v11 offset:18432
    v_mfma_f32_16x16x32_bf16 v[152:155], a[20:23], a[4:7], v[152:155]
    s_waitcnt vmcnt(17) lgkmcnt(4)
    s_barrier
    v_mfma_f32_16x16x32_bf16 v[108:111], a[24:27], a[56:59], v[108:111]
    buffer_load_dwordx4 v5, s[20:23], s82 offen offset:0 sc1  lds
    v_mfma_f32_16x16x32_bf16 v[132:135], a[24:27], a[0:3], v[132:135]
    s_add_u32 s49, s58, 1216512
    ds_read_b128 a[88:91], v17 offset:32768
    ds_read_b128 a[112:115], v27 offset:32768
    v_mfma_f32_16x16x32_bf16 v[156:159], a[24:27], a[4:7], v[156:159]
    ds_read_b128 a[116:119], v38 offset:32768
    ds_read_b64_tr_b16 a[120:121], v8 offset:13312
    v_mfma_f32_16x16x32_bf16 v[88:91], a[28:31], a[76:79], v[88:91]
    buffer_load_dwordx4 v5, s[20:23], s82 offen offset:1024 sc1  lds
    v_mfma_f32_16x16x32_bf16 v[112:115], a[28:31], a[48:51], v[112:115]
    s_add_u32 m0, s67, 24576
    ds_read_b64_tr_b16 a[122:123], v8 offset:19456
    v_mfma_f32_16x16x32_bf16 v[136:139], a[28:31], a[16:19], v[136:139]
    ds_read_b64_tr_b16 a[152:153], v9 offset:13312
    ds_read_b64_tr_b16 a[154:155], v9 offset:19456
    v_mfma_f32_16x16x32_bf16 v[92:95], a[52:55], a[76:79], v[92:95]
    buffer_load_dwordx4 v22, s[24:27], s49 offen offset:0 lds
    v_mfma_f32_16x16x32_bf16 v[116:119], a[52:55], a[48:51], v[116:119]
    s_add_u32 m0, s67, 25472
    ds_read_b64_tr_b16 a[156:157], v8 offset:24576
    v_mfma_f32_16x16x32_bf16 v[140:143], a[52:55], a[16:19], v[140:143]
    s_waitcnt lgkmcnt(4)
    ds_read_b64_tr_b16 a[158:159], v8 offset:30720
    v_mfma_f32_16x16x32_bf16 v[96:99], a[80:83], a[76:79], v[96:99]
    buffer_load_dwordx4 v22, s[24:27], s49 offen offset:128 lds
    v_mfma_f32_16x16x32_bf16 v[120:123], a[80:83], a[48:51], v[120:123]
    s_add_u32 m0, s67, 26368
    ds_read_b64_tr_b16 a[160:161], v9 offset:24576
    v_mfma_f32_16x16x32_bf16 v[144:147], a[80:83], a[16:19], v[144:147]
    ds_read_b64_tr_b16 a[162:163], v9 offset:30720
    v_mfma_f32_16x16x32_bf16 v[100:103], a[84:87], a[76:79], v[100:103]
    ds_read_b64_tr_b16 a[192:193], v10 offset:24576
    v_mfma_f32_16x16x32_bf16 v[124:127], a[84:87], a[48:51], v[124:127]
    ds_read_b64_tr_b16 a[194:195], v10 offset:30720
    v_mfma_f32_16x16x32_bf16 v[148:151], a[84:87], a[16:19], v[148:151]
    s_waitcnt lgkmcnt(4)
    ds_read_b64_tr_b16 a[196:197], v11 offset:24576
    v_mfma_f32_16x16x32_bf16 v[104:107], a[120:123], a[76:79], v[104:107]
    buffer_load_dwordx4 v22, s[24:27], s49 offen offset:256 lds
    v_mfma_f32_16x16x32_bf16 v[128:131], a[120:123], a[48:51], v[128:131]
    s_add_u32 s49, s58, 1290240
    ds_read_b64_tr_b16 a[198:199], v11 offset:30720
    v_mfma_f32_16x16x32_bf16 v[152:155], a[120:123], a[16:19], v[152:155]
    s_branch gated_mix__ssm_conv_s5__swiglu_ffn__prompt_kernel_A_sk10
.p2align 12
gated_mix__ssm_conv_s5__swiglu_ffn__prompt_kernel_A_pg0_10:
    s_branch gated_mix__ssm_conv_s5__swiglu_ffn__prompt_kernel_A_pr0
gated_mix__ssm_conv_s5__swiglu_ffn__prompt_kernel_A_pg3_10:
    s_branch gated_mix__ssm_conv_s5__swiglu_ffn__prompt_kernel_A_pr3
gated_mix__ssm_conv_s5__swiglu_ffn__prompt_kernel_A_sk10:
    s_waitcnt vmcnt(15) lgkmcnt(4)
    s_barrier
    v_mfma_f32_16x16x32_bf16 v[108:111], a[152:155], a[76:79], v[108:111]
    s_add_u32 m0, s67, 36864
    ds_read_b128 a[200:203], v17 offset:40960
    v_mfma_f32_16x16x32_bf16 v[132:135], a[152:155], a[48:51], v[132:135]
    buffer_load_dwordx4 v22, s[24:27], s49 offen offset:0 lds
    v_mfma_f32_16x16x32_bf16 v[156:159], a[152:155], a[16:19], v[156:159]
    s_add_u32 m0, s67, 37760
    ds_read_b128 a[232:235], v27 offset:40960
    ds_read_b128 a[236:239], v38 offset:40960
    v_mfma_f32_16x16x32_bf16 v[88:91], a[156:159], a[88:91], v[88:91]
    ds_read_b64_tr_b16 a[240:241], v8 offset:25600
    ds_read_b64_tr_b16 a[242:243], v8 offset:31744
    v_mfma_f32_16x16x32_bf16 v[112:115], a[156:159], a[112:115], v[112:115]
    buffer_load_dwordx4 v22, s[24:27], s49 offen offset:128 lds
    v_mfma_f32_16x16x32_bf16 v[136:139], a[156:159], a[116:119], v[136:139]
    s_add_u32 m0, s67, 38656
    ds_read_b64_tr_b16 a[56:57], v9 offset:25600
    ds_read_b64_tr_b16 a[58:59], v9 offset:31744
    v_mfma_f32_16x16x32_bf16 v[92:95], a[160:163], a[88:91], v[92:95]
    ds_read_b64_tr_b16 a[0:1], v8 offset:36864
    v_mfma_f32_16x16x32_bf16 v[116:119], a[160:163], a[112:115], v[116:119]
    buffer_load_dwordx4 v22, s[24:27], s49 offen offset:256 lds
    v_mfma_f32_16x16x32_bf16 v[140:143], a[160:163], a[116:119], v[140:143]
    s_waitcnt lgkmcnt(5)
    ds_read_b64_tr_b16 a[2:3], v8 offset:43008
    v_mfma_f32_16x16x32_bf16 v[96:99], a[192:195], a[88:91], v[96:99]
    ds_read_b64_tr_b16 a[4:5], v9 offset:36864
    v_mfma_f32_16x16x32_bf16 v[120:123], a[192:195], a[112:115], v[120:123]
    ds_read_b64_tr_b16 a[6:7], v9 offset:43008
    v_mfma_f32_16x16x32_bf16 v[144:147], a[192:195], a[116:119], v[144:147]
    ds_read_b64_tr_b16 a[76:77], v10 offset:36864
    v_mfma_f32_16x16x32_bf16 v[100:103], a[196:199], a[88:91], v[100:103]
    ds_read_b64_tr_b16 a[78:79], v10 offset:43008
    v_mfma_f32_16x16x32_bf16 v[124:127], a[196:199], a[112:115], v[124:127]
    v_mfma_f32_16x16x32_bf16 v[148:151], a[196:199], a[116:119], v[148:151]
    s_waitcnt lgkmcnt(4)
    ds_read_b64_tr_b16 a[48:49], v11 offset:36864
    v_mfma_f32_16x16x32_bf16 v[104:107], a[240:243], a[88:91], v[104:107]
    ds_read_b64_tr_b16 a[50:51], v11 offset:43008
    v_mfma_f32_16x16x32_bf16 v[128:131], a[240:243], a[112:115], v[128:131]
    s_waitcnt vmcnt(13) lgkmcnt(4)
    s_barrier
    v_mfma_f32_16x16x32_bf16 v[152:155], a[240:243], a[116:119], v[152:155]
    ds_read_b128 a[16:19], v17 offset:49152
    v_mfma_f32_16x16x32_bf16 v[108:111], a[56:59], a[88:91], v[108:111]
    ds_read_b128 a[156:159], v27 offset:49152
    v_mfma_f32_16x16x32_bf16 v[132:135], a[56:59], a[112:115], v[132:135]
    ds_read_b128 a[160:163], v38 offset:49152
    v_mfma_f32_16x16x32_bf16 v[156:159], a[56:59], a[116:119], v[156:159]
    buffer_load_dword v59, v58, s[20:23], s54 offen sc1
    v_mfma_f32_16x16x32_bf16 v[88:91], a[0:3], a[200:203], v[88:91]
    ds_read_b64_tr_b16 a[192:193], v8 offset:37888
    ds_read_b64_tr_b16 a[194:195], v8 offset:44032
    v_mfma_f32_16x16x32_bf16 v[112:115], a[0:3], a[232:235], v[112:115]
    ds_read_b64_tr_b16 a[196:197], v9 offset:37888
    v_mfma_f32_16x16x32_bf16 v[136:139], a[0:3], a[236:239], v[136:139]
    ds_read_b64_tr_b16 a[198:199], v9 offset:44032
    v_mfma_f32_16x16x32_bf16 v[92:95], a[4:7], a[200:203], v[92:95]
    ds_read_b64_tr_b16 a[240:241], v23 offset:0
    v_mfma_f32_16x16x32_bf16 v[116:119], a[4:7], a[232:235], v[116:119]
    ds_read_b64_tr_b16 a[242:243], v23 offset:6144
    v_mfma_f32_16x16x32_bf16 v[140:143], a[4:7], a[236:239], v[140:143]
    s_waitcnt lgkmcnt(6)
    ds_read_b64_tr_b16 a[88:89], v24 offset:0
    v_mfma_f32_16x16x32_bf16 v[96:99], a[76:79], a[200:203], v[96:99]
    ds_read_b64_tr_b16 a[90:91], v24 offset:6144
    v_mfma_f32_16x16x32_bf16 v[120:123], a[76:79], a[232:235], v[120:123]
    v_mfma_f32_16x16x32_bf16 v[144:147], a[76:79], a[236:239], v[144:147]
    ds_read_b64_tr_b16 a[112:113], v25 offset:0
    v_mfma_f32_16x16x32_bf16 v[100:103], a[48:51], a[200:203], v[100:103]
    ds_read_b64_tr_b16 a[114:115], v25 offset:6144
    v_mfma_f32_16x16x32_bf16 v[124:127], a[48:51], a[232:235], v[124:127]
    v_mfma_f32_16x16x32_bf16 v[148:151], a[48:51], a[236:239], v[148:151]
    s_waitcnt lgkmcnt(3)
    ds_read_b64_tr_b16 a[56:57], v26 offset:0
    v_mfma_f32_16x16x32_bf16 v[104:107], a[192:195], a[200:203], v[104:107]
    ds_read_b64_tr_b16 a[58:59], v26 offset:6144
    v_mfma_f32_16x16x32_bf16 v[128:131], a[192:195], a[232:235], v[128:131]
    s_waitcnt vmcnt(9) lgkmcnt(4)
    s_barrier
    v_mfma_f32_16x16x32_bf16 v[152:155], a[192:195], a[236:239], v[152:155]
    ds_read_b128 a[116:119], v17 offset:57344
    v_mfma_f32_16x16x32_bf16 v[108:111], a[196:199], a[200:203], v[108:111]
    ds_read_b128 a[0:3], v27 offset:57344
    v_mfma_f32_16x16x32_bf16 v[132:135], a[196:199], a[232:235], v[132:135]
    ds_read_b128 a[4:7], v38 offset:57344
    v_mfma_f32_16x16x32_bf16 v[156:159], a[196:199], a[236:239], v[156:159]
    ds_read_b64_tr_b16 a[76:77], v23 offset:1024
    ds_read_b64_tr_b16 a[78:79], v23 offset:7168
    v_mfma_f32_16x16x32_bf16 v[88:91], a[240:243], a[16:19], v[88:91]
    ds_read_b64_tr_b16 a[48:49], v24 offset:1024
    v_mfma_f32_16x16x32_bf16 v[112:115], a[240:243], a[156:159], v[112:115]
    ds_read_b64_tr_b16 a[50:51], v24 offset:7168
    v_mfma_f32_16x16x32_bf16 v[136:139], a[240:243], a[160:163], v[136:139]
    ds_read_b64_tr_b16 a[192:193], v23 offset:12288
    v_mfma_f32_16x16x32_bf16 v[92:95], a[88:91], a[16:19], v[92:95]
    ds_read_b64_tr_b16 a[194:195], v23 offset:18432
    v_mfma_f32_16x16x32_bf16 v[116:119], a[88:91], a[156:159], v[116:119]
    v_mfma_f32_16x16x32_bf16 v[140:143], a[88:91], a[160:163], v[140:143]
    s_waitcnt lgkmcnt(4)
    ds_read_b64_tr_b16 a[200:201], v24 offset:12288
    v_mfma_f32_16x16x32_bf16 v[96:99], a[112:115], a[16:19], v[96:99]
    ds_read_b64_tr_b16 a[202:203], v24 offset:18432
    v_mfma_f32_16x16x32_bf16 v[120:123], a[112:115], a[156:159], v[120:123]
    v_mfma_f32_16x16x32_bf16 v[144:147], a[112:115], a[160:163], v[144:147]
    ds_read_b64_tr_b16 a[232:233], v25 offset:12288
    v_mfma_f32_16x16x32_bf16 v[100:103], a[56:59], a[16:19], v[100:103]
    ds_read_b64_tr_b16 a[234:235], v25 offset:18432
    v_mfma_f32_16x16x32_bf16 v[124:127], a[56:59], a[156:159], v[124:127]
    v_mfma_f32_16x16x32_bf16 v[148:151], a[56:59], a[160:163], v[148:151]
    ds_read_b64_tr_b16 a[196:197], v26 offset:12288
    v_mfma_f32_16x16x32_bf16 v[104:107], a[76:79], a[16:19], v[104:107]
    ds_read_b64_tr_b16 a[198:199], v26 offset:18432
    v_mfma_f32_16x16x32_bf16 v[128:131], a[76:79], a[156:159], v[128:131]
    s_waitcnt vmcnt(4) lgkmcnt(4)
    s_barrier
    v_mfma_f32_16x16x32_bf16 v[152:155], a[76:79], a[160:163], v[152:155]
    ds_read_b128 a[236:239], v17 offset:0
    v_mfma_f32_16x16x32_bf16 v[108:111], a[48:51], a[16:19], v[108:111]
    ds_read_b128 a[240:243], v27 offset:0
    v_mfma_f32_16x16x32_bf16 v[132:135], a[48:51], a[156:159], v[132:135]
    ds_read_b128 a[88:91], v38 offset:0
    v_mfma_f32_16x16x32_bf16 v[156:159], a[48:51], a[160:163], v[156:159]
    ds_read_b64_tr_b16 a[112:113], v23 offset:13312
    ds_read_b64_tr_b16 a[114:115], v23 offset:19456
    v_mfma_f32_16x16x32_bf16 v[88:91], a[192:195], a[116:119], v[88:91]
    ds_read_b64_tr_b16 a[56:57], v24 offset:13312
    v_mfma_f32_16x16x32_bf16 v[112:115], a[192:195], a[0:3], v[112:115]
    ds_read_b64_tr_b16 a[58:59], v24 offset:19456
    v_mfma_f32_16x16x32_bf16 v[136:139], a[192:195], a[4:7], v[136:139]
    ds_read_b64_tr_b16 a[76:77], v23 offset:24576
    v_mfma_f32_16x16x32_bf16 v[92:95], a[200:203], a[116:119], v[92:95]
    ds_read_b64_tr_b16 a[78:79], v23 offset:30720
    v_mfma_f32_16x16x32_bf16 v[116:119], a[200:203], a[0:3], v[116:119]
    v_mfma_f32_16x16x32_bf16 v[140:143], a[200:203], a[4:7], v[140:143]
    s_waitcnt lgkmcnt(4)
    ds_read_b64_tr_b16 a[16:17], v24 offset:24576
    v_mfma_f32_16x16x32_bf16 v[96:99], a[232:235], a[116:119], v[96:99]
    ds_read_b64_tr_b16 a[18:19], v24 offset:30720
    v_mfma_f32_16x16x32_bf16 v[120:123], a[232:235], a[0:3], v[120:123]
    v_mfma_f32_16x16x32_bf16 v[144:147], a[232:235], a[4:7], v[144:147]
    ds_read_b64_tr_b16 a[156:157], v25 offset:24576
    v_mfma_f32_16x16x32_bf16 v[100:103], a[196:199], a[116:119], v[100:103]
    ds_read_b64_tr_b16 a[158:159], v25 offset:30720
    v_mfma_f32_16x16x32_bf16 v[124:127], a[196:199], a[0:3], v[124:127]
    v_mfma_f32_16x16x32_bf16 v[148:151], a[196:199], a[4:7], v[148:151]
    ds_read_b64_tr_b16 a[48:49], v26 offset:24576
    v_mfma_f32_16x16x32_bf16 v[104:107], a[112:115], a[116:119], v[104:107]
    ds_read_b64_tr_b16 a[50:51], v26 offset:30720
    v_mfma_f32_16x16x32_bf16 v[128:131], a[112:115], a[0:3], v[128:131]
    s_waitcnt vmcnt(1) lgkmcnt(4)
    s_barrier
    v_mfma_f32_16x16x32_bf16 v[152:155], a[112:115], a[4:7], v[152:155]
    s_waitcnt vmcnt(0)
    ds_read_b128 a[160:163], v17 offset:8192
    v_cmp_eq_u32 s[78:79], 0, v59
    v_mfma_f32_16x16x32_bf16 v[108:111], a[56:59], a[116:119], v[108:111]
    ds_read_b128 a[192:195], v27 offset:8192
    v_mfma_f32_16x16x32_bf16 v[132:135], a[56:59], a[0:3], v[132:135]
    s_cmp_lg_u64 s[78:79], 0
    s_cbranch_scc1 gated_mix__ssm_conv_s5__swiglu_ffn__prompt_kernel_lk_s
gated_mix__ssm_conv_s5__swiglu_ffn__prompt_kernel_lk:
    ds_read_b128 a[200:203], v38 offset:8192
    v_mfma_f32_16x16x32_bf16 v[156:159], a[56:59], a[4:7], v[156:159]
    ds_read_b64_tr_b16 a[232:233], v23 offset:25600
    ds_read_b64_tr_b16 a[234:235], v23 offset:31744
    v_mfma_f32_16x16x32_bf16 v[88:91], a[76:79], a[236:239], v[88:91]
    ds_read_b64_tr_b16 a[196:197], v24 offset:25600
    v_mfma_f32_16x16x32_bf16 v[112:115], a[76:79], a[240:243], v[112:115]
    ds_read_b64_tr_b16 a[198:199], v24 offset:31744
    v_mfma_f32_16x16x32_bf16 v[136:139], a[76:79], a[88:91], v[136:139]
    ds_read_b64_tr_b16 a[112:113], v23 offset:36864
    v_mfma_f32_16x16x32_bf16 v[92:95], a[16:19], a[236:239], v[92:95]
    ds_read_b64_tr_b16 a[114:115], v23 offset:43008
    v_mfma_f32_16x16x32_bf16 v[116:119], a[16:19], a[240:243], v[116:119]
    v_mfma_f32_16x16x32_bf16 v[140:143], a[16:19], a[88:91], v[140:143]
    s_waitcnt lgkmcnt(4)
    ds_read_b64_tr_b16 a[116:117], v24 offset:36864
    v_mfma_f32_16x16x32_bf16 v[96:99], a[156:159], a[236:239], v[96:99]
    ds_read_b64_tr_b16 a[118:119], v24 offset:43008
    v_mfma_f32_16x16x32_bf16 v[120:123], a[156:159], a[240:243], v[120:123]
    v_mfma_f32_16x16x32_bf16 v[144:147], a[156:159], a[88:91], v[144:147]
    ds_read_b64_tr_b16 a[0:1], v25 offset:36864
    v_mfma_f32_16x16x32_bf16 v[100:103], a[48:51], a[236:239], v[100:103]
    ds_read_b64_tr_b16 a[2:3], v25 offset:43008
    v_mfma_f32_16x16x32_bf16 v[124:127], a[48:51], a[240:243], v[124:127]
    v_mfma_f32_16x16x32_bf16 v[148:151], a[48:51], a[88:91], v[148:151]
    ds_read_b64_tr_b16 a[4:5], v26 offset:36864
    v_mfma_f32_16x16x32_bf16 v[104:107], a[232:235], a[236:239], v[104:107]
    ds_read_b64_tr_b16 a[6:7], v26 offset:43008
    v_mfma_f32_16x16x32_bf16 v[128:131], a[232:235], a[240:243], v[128:131]
    v_mfma_f32_16x16x32_bf16 v[152:155], a[232:235], a[88:91], v[152:155]
    s_waitcnt lgkmcnt(3)
    ds_read_b64_tr_b16 a[56:57], v23 offset:37888
    v_mfma_f32_16x16x32_bf16 v[108:111], a[196:199], a[236:239], v[108:111]
    ds_read_b64_tr_b16 a[58:59], v23 offset:44032
    v_mfma_f32_16x16x32_bf16 v[132:135], a[196:199], a[240:243], v[132:135]
    v_mfma_f32_16x16x32_bf16 v[156:159], a[196:199], a[88:91], v[156:159]
    ds_read_b64_tr_b16 a[76:77], v24 offset:37888
    v_mfma_f32_16x16x32_bf16 v[88:91], a[112:115], a[160:163], v[88:91]
    ds_read_b64_tr_b16 a[78:79], v24 offset:44032
    v_mfma_f32_16x16x32_bf16 v[112:115], a[112:115], a[192:195], v[112:115]
    v_mfma_f32_16x16x32_bf16 v[136:139], a[112:115], a[200:203], v[136:139]
    v_mfma_f32_16x16x32_bf16 v[92:95], a[116:119], a[160:163], v[92:95]
    v_mfma_f32_16x16x32_bf16 v[116:119], a[116:119], a[192:195], v[116:119]
    v_mfma_f32_16x16x32_bf16 v[140:143], a[116:119], a[200:203], v[140:143]
    s_waitcnt lgkmcnt(1)
    s_nop 0
    v_cvt_pk_bf16_f32 v88, -v88, -v89
    v_cvt_pk_bf16_f32 v89, -v90, -v91
    v_mfma_f32_16x16x32_bf16 v[96:99], a[0:3], a[160:163], v[96:99]
    v_mfma_f32_16x16x32_bf16 v[120:123], a[0:3], a[192:195], v[120:123]
    v_mfma_f32_16x16x32_bf16 v[144:147], a[0:3], a[200:203], v[144:147]
    v_cvt_pk_bf16_f32 v90, -v92, -v93
    v_cvt_pk_bf16_f32 v91, -v94, -v95
    v_mfma_f32_16x16x32_bf16 v[100:103], a[4:7], a[160:163], v[100:103]
    buffer_store_dwordx4 v[88:91], v5, s[20:23], s8 offen offset:0 sc1
    v_mfma_f32_16x16x32_bf16 v[124:127], a[4:7], a[192:195], v[124:127]
    v_cvt_pk_bf16_f32 v112, -v112, -v113
    v_cvt_pk_bf16_f32 v113, -v114, -v115
    v_mfma_f32_16x16x32_bf16 v[148:151], a[4:7], a[200:203], v[148:151]
    v_cvt_pk_bf16_f32 v114, -v116, -v117
    v_cvt_pk_bf16_f32 v115, -v118, -v119
    v_mfma_f32_16x16x32_bf16 v[104:107], a[56:59], a[160:163], v[104:107]
    v_mfma_f32_16x16x32_bf16 v[128:131], a[56:59], a[192:195], v[128:131]
    buffer_store_dwordx4 v[112:115], v5, s[20:23], s11 offen offset:0 sc1
    v_mfma_f32_16x16x32_bf16 v[152:155], a[56:59], a[200:203], v[152:155]
    s_waitcnt lgkmcnt(0)
    v_cvt_pk_bf16_f32 v136, -v136, -v137
    v_cvt_pk_bf16_f32 v137, -v138, -v139
    v_mfma_f32_16x16x32_bf16 v[108:111], a[76:79], a[160:163], v[108:111]
    v_cvt_pk_bf16_f32 v138, -v140, -v141
    v_cvt_pk_bf16_f32 v139, -v142, -v143
    v_mfma_f32_16x16x32_bf16 v[132:135], a[76:79], a[192:195], v[132:135]
    v_mfma_f32_16x16x32_bf16 v[156:159], a[76:79], a[200:203], v[156:159]
    buffer_store_dwordx4 v[136:139], v52, s[20:23], s17 offen offset:1024 sc1
    v_mfma_f32_16x16x32_bf16 v[64:67], a[92:95], a[104:107], v[64:67]
    v_cvt_pk_bf16_f32 v96, -v96, -v97
    v_cvt_pk_bf16_f32 v97, -v98, -v99
    v_cvt_pk_bf16_f32 v98, -v100, -v101
    v_cvt_pk_bf16_f32 v99, -v102, -v103
    buffer_store_dwordx4 v[96:99], v5, s[20:23], s8 offen offset:1024 sc1
    v_cvt_pk_bf16_f32 v120, -v120, -v121
    v_cvt_pk_bf16_f32 v121, -v122, -v123
    v_cvt_pk_bf16_f32 v122, -v124, -v125
    v_cvt_pk_bf16_f32 v123, -v126, -v127
    buffer_store_dwordx4 v[120:123], v5, s[20:23], s11 offen offset:1024 sc1
    v_cvt_pk_bf16_f32 v144, -v144, -v145
    v_cvt_pk_bf16_f32 v145, -v146, -v147
    v_cvt_pk_bf16_f32 v146, -v148, -v149
    v_cvt_pk_bf16_f32 v147, -v150, -v151
    buffer_store_dwordx4 v[144:147], v52, s[20:23], s18 offen offset:0 sc1
    v_cvt_pk_bf16_f32 v104, -v104, -v105
    v_cvt_pk_bf16_f32 v105, -v106, -v107
    v_cvt_pk_bf16_f32 v106, -v108, -v109
    v_cvt_pk_bf16_f32 v107, -v110, -v111
    buffer_store_dwordx4 v[104:107], v5, s[20:23], s9 offen offset:0 sc1
    v_cvt_pk_bf16_f32 v128, -v128, -v129
    v_cvt_pk_bf16_f32 v129, -v130, -v131
    v_cvt_pk_bf16_f32 v130, -v132, -v133
    v_cvt_pk_bf16_f32 v131, -v134, -v135
    buffer_store_dwordx4 v[128:131], v52, s[20:23], s10 offen offset:0 sc1
    v_cvt_pk_bf16_f32 v152, -v152, -v153
    v_cvt_pk_bf16_f32 v153, -v154, -v155
    v_cvt_pk_bf16_f32 v154, -v156, -v157
    v_cvt_pk_bf16_f32 v155, -v158, -v159
    buffer_store_dwordx4 v[152:155], v52, s[20:23], s18 offen offset:1024 sc1
    v_mfma_f32_16x16x32_bf16 v[68:71], a[96:99], a[104:107], v[68:71]
    v_mfma_f32_16x16x32_bf16 v[72:75], a[100:103], a[104:107], v[72:75]
    ds_read_b64_tr_b16 a[16:17], v8 offset:24576
    v_mfma_f32_16x16x32_bf16 v[76:79], a[108:111], a[104:107], v[76:79]
    ds_read_b64_tr_b16 a[18:19], v8 offset:30720
    v_mfma_f32_16x16x32_bf16 v[80:83], a[124:127], a[104:107], v[80:83]
    ds_read_b64_tr_b16 a[156:157], v9 offset:24576
    v_mfma_f32_16x16x32_bf16 v[84:87], a[128:131], a[104:107], v[84:87]
    ds_read_b64_tr_b16 a[158:159], v9 offset:30720
    v_mfma_f32_16x16x32_bf16 v[64:67], a[132:135], a[144:147], v[64:67]
    ds_read_b64_tr_b16 a[48:49], v10 offset:24576
    v_mfma_f32_16x16x32_bf16 v[68:71], a[136:139], a[144:147], v[68:71]
    ds_read_b64_tr_b16 a[50:51], v10 offset:30720
    v_mfma_f32_16x16x32_bf16 v[72:75], a[140:143], a[144:147], v[72:75]
    ds_read_b64_tr_b16 a[232:233], v11 offset:24576
    ds_read_b64_tr_b16 a[234:235], v11 offset:30720
    v_mfma_f32_16x16x32_bf16 v[76:79], a[148:151], a[144:147], v[76:79]
    ds_read_b128 a[236:239], v16 offset:16384
    ds_read_b64_tr_b16 a[240:241], v8 offset:25600
    v_mfma_f32_16x16x32_bf16 v[80:83], a[164:167], a[144:147], v[80:83]
    ds_read_b64_tr_b16 a[242:243], v8 offset:31744
    ds_read_b64_tr_b16 a[88:89], v9 offset:25600
    v_mfma_f32_16x16x32_bf16 v[84:87], a[168:171], a[144:147], v[84:87]
    ds_read_b64_tr_b16 a[90:91], v9 offset:31744
    ds_read_b64_tr_b16 a[196:197], v8 offset:36864
    v_mfma_f32_16x16x32_bf16 v[64:67], a[172:175], a[184:187], v[64:67]
    ds_read_b64_tr_b16 a[198:199], v8 offset:43008
    ds_read_b64_tr_b16 a[112:113], v9 offset:36864
    v_mfma_f32_16x16x32_bf16 v[68:71], a[176:179], a[184:187], v[68:71]
    ds_read_b64_tr_b16 a[114:115], v9 offset:43008
    ds_read_b64_tr_b16 a[116:117], v10 offset:36864
    v_mfma_f32_16x16x32_bf16 v[72:75], a[180:183], a[184:187], v[72:75]
    ds_read_b64_tr_b16 a[118:119], v10 offset:43008
    ds_read_b64_tr_b16 a[0:1], v11 offset:36864
    v_mfma_f32_16x16x32_bf16 v[76:79], a[188:191], a[184:187], v[76:79]
    ds_read_b64_tr_b16 a[2:3], v11 offset:43008
    ds_read_b128 a[4:7], v16 offset:24576
    v_mfma_f32_16x16x32_bf16 v[80:83], a[204:207], a[184:187], v[80:83]
    ds_read_b64_tr_b16 a[56:57], v8 offset:37888
    ds_read_b64_tr_b16 a[58:59], v8 offset:44032
    v_mfma_f32_16x16x32_bf16 v[84:87], a[208:211], a[184:187], v[84:87]
    ds_read_b64_tr_b16 a[160:161], v9 offset:37888
    ds_read_b64_tr_b16 a[162:163], v9 offset:44032
    v_mfma_f32_16x16x32_bf16 v[64:67], a[212:215], a[224:227], v[64:67]
    ds_read_b64_tr_b16 a[192:193], v23 offset:0
    ds_read_b64_tr_b16 a[194:195], v23 offset:6144
    v_mfma_f32_16x16x32_bf16 v[68:71], a[216:219], a[224:227], v[68:71]
    ds_read_b64_tr_b16 a[76:77], v24 offset:0
    ds_read_b64_tr_b16 a[78:79], v24 offset:6144
    v_mfma_f32_16x16x32_bf16 v[72:75], a[220:223], a[224:227], v[72:75]
    ds_read_b64_tr_b16 a[200:201], v25 offset:0
    ds_read_b64_tr_b16 a[202:203], v25 offset:6144
    v_mfma_f32_16x16x32_bf16 v[76:79], a[228:231], a[224:227], v[76:79]
    ds_read_b64_tr_b16 a[92:93], v26 offset:0
    ds_read_b64_tr_b16 a[94:95], v26 offset:6144
    v_mfma_f32_16x16x32_bf16 v[80:83], a[244:247], a[224:227], v[80:83]
    ds_read_b128 a[96:99], v16 offset:32768
    ds_read_b64_tr_b16 a[100:101], v23 offset:1024
    v_mfma_f32_16x16x32_bf16 v[84:87], a[248:251], a[224:227], v[84:87]
    ds_read_b64_tr_b16 a[102:103], v23 offset:7168
    ds_read_b64_tr_b16 a[108:109], v24 offset:1024
    v_mfma_f32_16x16x32_bf16 v[64:67], a[252:255], a[40:43], v[64:67]
    ds_read_b64_tr_b16 a[110:111], v24 offset:7168
    ds_read_b64_tr_b16 a[124:125], v23 offset:12288
    v_mfma_f32_16x16x32_bf16 v[68:71], a[32:35], a[40:43], v[68:71]
    ds_read_b64_tr_b16 a[126:127], v23 offset:18432
    ds_read_b64_tr_b16 a[104:105], v24 offset:12288
    v_mfma_f32_16x16x32_bf16 v[72:75], a[36:39], a[40:43], v[72:75]
    ds_read_b64_tr_b16 a[106:107], v24 offset:18432
    ds_read_b64_tr_b16 a[128:129], v25 offset:12288
    v_mfma_f32_16x16x32_bf16 v[76:79], a[44:47], a[40:43], v[76:79]
    ds_read_b64_tr_b16 a[130:131], v25 offset:18432
    ds_read_b64_tr_b16 a[132:133], v26 offset:12288
    v_mfma_f32_16x16x32_bf16 v[80:83], a[8:11], a[40:43], v[80:83]
    ds_read_b64_tr_b16 a[134:135], v26 offset:18432
    ds_read_b128 a[136:139], v16 offset:40960
    v_mfma_f32_16x16x32_bf16 v[84:87], a[12:15], a[40:43], v[84:87]
    s_waitcnt lgkmcnt(10)
    ds_read_b64_tr_b16 a[140:141], v23 offset:13312
    ds_read_b64_tr_b16 a[142:143], v23 offset:19456
    v_mfma_f32_16x16x32_bf16 v[64:67], a[60:63], a[236:239], v[64:67]
    ds_read_b64_tr_b16 a[148:149], v24 offset:13312
    ds_read_b64_tr_b16 a[150:151], v24 offset:19456
    v_mfma_f32_16x16x32_bf16 v[68:71], a[64:67], a[236:239], v[68:71]
    ds_read_b64_tr_b16 a[164:165], v23 offset:24576
    ds_read_b64_tr_b16 a[166:167], v23 offset:30720
    v_mfma_f32_16x16x32_bf16 v[72:75], a[68:71], a[236:239], v[72:75]
    ds_read_b64_tr_b16 a[144:145], v24 offset:24576
    ds_read_b64_tr_b16 a[146:147], v24 offset:30720
    v_mfma_f32_16x16x32_bf16 v[76:79], a[72:75], a[236:239], v[76:79]
    ds_read_b64_tr_b16 a[168:169], v25 offset:24576
    ds_read_b64_tr_b16 a[170:171], v25 offset:30720
    v_mfma_f32_16x16x32_bf16 v[80:83], a[20:23], a[236:239], v[80:83]
    ds_read_b64_tr_b16 a[172:173], v26 offset:24576
    ds_read_b64_tr_b16 a[174:175], v26 offset:30720
    v_mfma_f32_16x16x32_bf16 v[84:87], a[24:27], a[236:239], v[84:87]
    ds_read_b128 a[176:179], v16 offset:49152
    ds_read_b64_tr_b16 a[180:181], v23 offset:25600
    v_mfma_f32_16x16x32_bf16 v[64:67], a[28:31], a[4:7], v[64:67]
    ds_read_b64_tr_b16 a[182:183], v23 offset:31744
    ds_read_b64_tr_b16 a[188:189], v24 offset:25600
    v_mfma_f32_16x16x32_bf16 v[68:71], a[52:55], a[4:7], v[68:71]
    ds_read_b64_tr_b16 a[190:191], v24 offset:31744
    ds_read_b64_tr_b16 a[204:205], v23 offset:36864
    v_mfma_f32_16x16x32_bf16 v[72:75], a[80:83], a[4:7], v[72:75]
    ds_read_b64_tr_b16 a[206:207], v23 offset:43008
    ds_read_b64_tr_b16 a[184:185], v24 offset:36864
    v_mfma_f32_16x16x32_bf16 v[76:79], a[84:87], a[4:7], v[76:79]
    ds_read_b64_tr_b16 a[186:187], v24 offset:43008
    ds_read_b64_tr_b16 a[208:209], v25 offset:36864
    v_mfma_f32_16x16x32_bf16 v[80:83], a[120:123], a[4:7], v[80:83]
    ds_read_b64_tr_b16 a[210:211], v25 offset:43008
    ds_read_b64_tr_b16 a[212:213], v26 offset:36864
    v_mfma_f32_16x16x32_bf16 v[84:87], a[152:155], a[4:7], v[84:87]
    ds_read_b64_tr_b16 a[214:215], v26 offset:43008
    ds_read_b128 a[216:219], v16 offset:57344
    v_mfma_f32_16x16x32_bf16 v[64:67], a[16:19], a[96:99], v[64:67]
    ds_read_b64_tr_b16 a[220:221], v23 offset:37888
    ds_read_b64_tr_b16 a[222:223], v23 offset:44032
    v_mfma_f32_16x16x32_bf16 v[68:71], a[156:159], a[96:99], v[68:71]
    ds_read_b64_tr_b16 a[228:229], v24 offset:37888
    ds_read_b64_tr_b16 a[230:231], v24 offset:44032
    v_mfma_f32_16x16x32_bf16 v[72:75], a[48:51], a[96:99], v[72:75]
    ds_read_b128 a[244:247], v16 offset:0
    v_mfma_f32_16x16x32_bf16 v[76:79], a[232:235], a[96:99], v[76:79]
    v_mfma_f32_16x16x32_bf16 v[80:83], a[240:243], a[96:99], v[80:83]
    v_mfma_f32_16x16x32_bf16 v[84:87], a[88:91], a[96:99], v[84:87]
    s_waitcnt lgkmcnt(5)
    v_mfma_f32_16x16x32_bf16 v[64:67], a[196:199], a[136:139], v[64:67]
    ds_read_b128 a[224:227], v16 offset:8192
    v_mfma_f32_16x16x32_bf16 v[68:71], a[112:115], a[136:139], v[68:71]
    v_mfma_f32_16x16x32_bf16 v[72:75], a[116:119], a[136:139], v[72:75]
    v_mfma_f32_16x16x32_bf16 v[76:79], a[0:3], a[136:139], v[76:79]
    v_mfma_f32_16x16x32_bf16 v[80:83], a[56:59], a[136:139], v[80:83]
    v_mfma_f32_16x16x32_bf16 v[84:87], a[160:163], a[136:139], v[84:87]
    v_mfma_f32_16x16x32_bf16 v[64:67], a[192:195], a[176:179], v[64:67]
    v_mfma_f32_16x16x32_bf16 v[68:71], a[76:79], a[176:179], v[68:71]
    v_mfma_f32_16x16x32_bf16 v[72:75], a[200:203], a[176:179], v[72:75]
    v_mfma_f32_16x16x32_bf16 v[76:79], a[92:95], a[176:179], v[76:79]
    v_mfma_f32_16x16x32_bf16 v[80:83], a[100:103], a[176:179], v[80:83]
    v_mfma_f32_16x16x32_bf16 v[84:87], a[108:111], a[176:179], v[84:87]
    v_mfma_f32_16x16x32_bf16 v[64:67], a[124:127], a[216:219], v[64:67]
    v_mfma_f32_16x16x32_bf16 v[68:71], a[104:107], a[216:219], v[68:71]
    v_mfma_f32_16x16x32_bf16 v[72:75], a[128:131], a[216:219], v[72:75]
    v_mfma_f32_16x16x32_bf16 v[76:79], a[132:135], a[216:219], v[76:79]
    v_mfma_f32_16x16x32_bf16 v[80:83], a[140:143], a[216:219], v[80:83]
    v_mfma_f32_16x16x32_bf16 v[84:87], a[148:151], a[216:219], v[84:87]
    s_waitcnt lgkmcnt(0)
    v_mfma_f32_16x16x32_bf16 v[64:67], a[164:167], a[244:247], v[64:67]
    v_mfma_f32_16x16x32_bf16 v[68:71], a[144:147], a[244:247], v[68:71]
    v_mfma_f32_16x16x32_bf16 v[72:75], a[168:171], a[244:247], v[72:75]
    v_mfma_f32_16x16x32_bf16 v[76:79], a[172:175], a[244:247], v[76:79]
    v_mfma_f32_16x16x32_bf16 v[80:83], a[180:183], a[244:247], v[80:83]
    v_mfma_f32_16x16x32_bf16 v[84:87], a[188:191], a[244:247], v[84:87]
    v_mfma_f32_16x16x32_bf16 v[64:67], a[204:207], a[224:227], v[64:67]
    v_mfma_f32_16x16x32_bf16 v[68:71], a[184:187], a[224:227], v[68:71]
    v_mfma_f32_16x16x32_bf16 v[72:75], a[208:211], a[224:227], v[72:75]
    v_mfma_f32_16x16x32_bf16 v[76:79], a[212:215], a[224:227], v[76:79]
    v_mfma_f32_16x16x32_bf16 v[80:83], a[220:223], a[224:227], v[80:83]
    v_mfma_f32_16x16x32_bf16 v[84:87], a[228:231], a[224:227], v[84:87]
    s_mov_b32 s50, 0
    buffer_load_dwordx4 v[192:195], v5, s[20:23], s40 offen offset:0 sc1
    buffer_load_dwordx4 v[196:199], v5, s[20:23], s40 offen offset:1024 sc1
    buffer_load_dwordx4 v[200:203], v5, s[20:23], s42 offen offset:0 sc1
    v_fmac_f32 v160, v33, v64
    v_fmac_f32 v161, v33, v65
    v_fmac_f32 v162, v33, v66
    v_fmac_f32 v163, v33, v67
    v_fmac_f32 v164, v33, v68
    v_fmac_f32 v165, v33, v69
    buffer_load_dwordx4 v[204:207], v5, s[20:23], s41 offen offset:0 sc1
    buffer_load_dwordx4 v[208:211], v5, s[20:23], s41 offen offset:1024 sc1
    buffer_load_dwordx4 v[212:215], v52, s[20:23], s40 offen offset:0 sc1
    v_fmac_f32 v166, v33, v70
    v_fmac_f32 v167, v33, v71
    v_fmac_f32 v168, v33, v72
    v_fmac_f32 v169, v33, v73
    v_fmac_f32 v170, v33, v74
    v_fmac_f32 v171, v33, v75
    buffer_load_dwordx4 v[216:219], v52, s[20:23], s40 offen offset:1024 sc1
    buffer_load_dwordx4 v[220:223], v52, s[20:23], s41 offen offset:0 sc1
    buffer_load_dwordx4 v[224:227], v52, s[20:23], s41 offen offset:1024 sc1
    v_fmac_f32 v172, v33, v76
    v_fmac_f32 v173, v33, v77
    v_fmac_f32 v174, v33, v78
    v_fmac_f32 v175, v33, v79
    v_fmac_f32 v176, v33, v80
    v_fmac_f32 v177, v33, v81
    buffer_load_dwordx4 v[228:231], v5, s[20:23], s12 offen offset:0 sc1
    buffer_load_dwordx4 v[232:235], v5, s[20:23], s12 offen offset:1024 sc1
    v_fmac_f32 v178, v33, v82
    v_fmac_f32 v179, v33, v83
    v_fmac_f32 v180, v33, v84
    v_fmac_f32 v181, v33, v85
    v_fmac_f32 v182, v33, v86
    v_fmac_f32 v183, v33, v87
    buffer_load_dwordx4 v[236:239], v5, s[20:23], s13 offen offset:0 sc1
    buffer_load_dwordx4 v[240:243], v5, s[20:23], s13 offen offset:1024 sc1
    s_waitcnt vmcnt(10)
gated_mix__ssm_conv_s5__swiglu_ffn__prompt_kernel_rx_c0:
    v_lshl_add_u32 v60, v193, 8, v192
    v_lshl_add_u32 v61, v197, 8, v196
    v_lshl_add_u32 v62, v201, 8, v200
    v_xor_b32 v60, v60, v40
    v_xor_b32 v61, v61, v41
    v_xor_b32 v62, v62, v48
    v_min3_u32 v60, v60, v61, v62
    v_cmp_eq_u32 s[76:77], 0, v60
    s_mov_b32 s43, 0
    s_nop 0
    s_and_b64 s[76:77], s[76:77], s[44:45]
    s_cbranch_scc1 gated_mix__ssm_conv_s5__swiglu_ffn__prompt_kernel_rx_s0
    v_dot2_f32_bf16 v160, v192, v55, v160 neg_lo:[1,0,0] neg_hi:[1,0,0]
    v_dot2_f32_bf16 v161, v192, v33, v161 neg_lo:[1,0,0] neg_hi:[1,0,0]
    v_dot2_f32_bf16 v162, v193, v55, v162 neg_lo:[1,0,0] neg_hi:[1,0,0]
    v_dot2_f32_bf16 v163, v193, v33, v163 neg_lo:[1,0,0] neg_hi:[1,0,0]
    v_dot2_f32_bf16 v164, v194, v55, v164 neg_lo:[1,0,0] neg_hi:[1,0,0]
    v_dot2_f32_bf16 v165, v194, v33, v165 neg_lo:[1,0,0] neg_hi:[1,0,0]
    v_dot2_f32_bf16 v166, v195, v55, v166 neg_lo:[1,0,0] neg_hi:[1,0,0]
    v_dot2_f32_bf16 v167, v195, v33, v167 neg_lo:[1,0,0] neg_hi:[1,0,0]
    v_dot2_f32_bf16 v168, v196, v55, v168 neg_lo:[1,0,0] neg_hi:[1,0,0]
    v_dot2_f32_bf16 v169, v196, v33, v169 neg_lo:[1,0,0] neg_hi:[1,0,0]
    v_dot2_f32_bf16 v170, v197, v55, v170 neg_lo:[1,0,0] neg_hi:[1,0,0]
    v_dot2_f32_bf16 v171, v197, v33, v171 neg_lo:[1,0,0] neg_hi:[1,0,0]
    v_dot2_f32_bf16 v172, v198, v55, v172 neg_lo:[1,0,0] neg_hi:[1,0,0]
    v_dot2_f32_bf16 v173, v198, v33, v173 neg_lo:[1,0,0] neg_hi:[1,0,0]
    v_dot2_f32_bf16 v174, v199, v55, v174 neg_lo:[1,0,0] neg_hi:[1,0,0]
    v_dot2_f32_bf16 v175, v199, v33, v175 neg_lo:[1,0,0] neg_hi:[1,0,0]
    v_dot2_f32_bf16 v176, v200, v55, v176 neg_lo:[1,0,0] neg_hi:[1,0,0]
    v_dot2_f32_bf16 v177, v200, v33, v177 neg_lo:[1,0,0] neg_hi:[1,0,0]
    v_dot2_f32_bf16 v178, v201, v55, v178 neg_lo:[1,0,0] neg_hi:[1,0,0]
    v_dot2_f32_bf16 v179, v201, v33, v179 neg_lo:[1,0,0] neg_hi:[1,0,0]
    v_dot2_f32_bf16 v180, v202, v55, v180 neg_lo:[1,0,0] neg_hi:[1,0,0]
    v_dot2_f32_bf16 v181, v202, v33, v181 neg_lo:[1,0,0] neg_hi:[1,0,0]
    v_dot2_f32_bf16 v182, v203, v55, v182 neg_lo:[1,0,0] neg_hi:[1,0,0]
    v_dot2_f32_bf16 v183, v203, v33, v183 neg_lo:[1,0,0] neg_hi:[1,0,0]
    s_waitcnt vmcnt(7)
gated_mix__ssm_conv_s5__swiglu_ffn__prompt_kernel_rx_c1:
    v_lshl_add_u32 v60, v205, 8, v204
    v_lshl_add_u32 v61, v209, 8, v208
    v_lshl_add_u32 v62, v213, 8, v212
    v_xor_b32 v60, v60, v42
    v_xor_b32 v61, v61, v43
    v_xor_b32 v62, v62, v44
    v_min3_u32 v60, v60, v61, v62
    v_cmp_eq_u32 s[76:77], 0, v60
    s_mov_b32 s43, 1
    s_nop 0
    s_and_b64 s[76:77], s[76:77], s[44:45]
    s_cbranch_scc1 gated_mix__ssm_conv_s5__swiglu_ffn__prompt_kernel_rx_s1
    v_dot2_f32_bf16 v160, v204, v55, v160 neg_lo:[1,0,0] neg_hi:[1,0,0]
    v_dot2_f32_bf16 v161, v204, v33, v161 neg_lo:[1,0,0] neg_hi:[1,0,0]
    v_dot2_f32_bf16 v162, v205, v55, v162 neg_lo:[1,0,0] neg_hi:[1,0,0]
    v_dot2_f32_bf16 v163, v205, v33, v163 neg_lo:[1,0,0] neg_hi:[1,0,0]
    v_dot2_f32_bf16 v164, v206, v55, v164 neg_lo:[1,0,0] neg_hi:[1,0,0]
    v_dot2_f32_bf16 v165, v206, v33, v165 neg_lo:[1,0,0] neg_hi:[1,0,0]
    v_dot2_f32_bf16 v166, v207, v55, v166 neg_lo:[1,0,0] neg_hi:[1,0,0]
    v_dot2_f32_bf16 v167, v207, v33, v167 neg_lo:[1,0,0] neg_hi:[1,0,0]
    v_dot2_f32_bf16 v168, v208, v55, v168 neg_lo:[1,0,0] neg_hi:[1,0,0]
    v_dot2_f32_bf16 v169, v208, v33, v169 neg_lo:[1,0,0] neg_hi:[1,0,0]
    v_dot2_f32_bf16 v170, v209, v55, v170 neg_lo:[1,0,0] neg_hi:[1,0,0]
    v_dot2_f32_bf16 v171, v209, v33, v171 neg_lo:[1,0,0] neg_hi:[1,0,0]
    v_dot2_f32_bf16 v172, v210, v55, v172 neg_lo:[1,0,0] neg_hi:[1,0,0]
    v_dot2_f32_bf16 v173, v210, v33, v173 neg_lo:[1,0,0] neg_hi:[1,0,0]
    v_dot2_f32_bf16 v174, v211, v55, v174 neg_lo:[1,0,0] neg_hi:[1,0,0]
    v_dot2_f32_bf16 v175, v211, v33, v175 neg_lo:[1,0,0] neg_hi:[1,0,0]
    v_dot2_f32_bf16 v176, v212, v55, v176 neg_lo:[1,0,0] neg_hi:[1,0,0]
    v_dot2_f32_bf16 v177, v212, v33, v177 neg_lo:[1,0,0] neg_hi:[1,0,0]
    v_dot2_f32_bf16 v178, v213, v55, v178 neg_lo:[1,0,0] neg_hi:[1,0,0]
    v_dot2_f32_bf16 v179, v213, v33, v179 neg_lo:[1,0,0] neg_hi:[1,0,0]
    v_dot2_f32_bf16 v180, v214, v55, v180 neg_lo:[1,0,0] neg_hi:[1,0,0]
    v_dot2_f32_bf16 v181, v214, v33, v181 neg_lo:[1,0,0] neg_hi:[1,0,0]
    v_dot2_f32_bf16 v182, v215, v55, v182 neg_lo:[1,0,0] neg_hi:[1,0,0]
    v_dot2_f32_bf16 v183, v215, v33, v183 neg_lo:[1,0,0] neg_hi:[1,0,0]
    s_waitcnt vmcnt(4)
gated_mix__ssm_conv_s5__swiglu_ffn__prompt_kernel_rx_c2:
    v_lshl_add_u32 v60, v217, 8, v216
    v_lshl_add_u32 v61, v221, 8, v220
    v_lshl_add_u32 v62, v225, 8, v224
    v_xor_b32 v60, v60, v45
    v_xor_b32 v61, v61, v46
    s_branch gated_mix__ssm_conv_s5__swiglu_ffn__prompt_kernel_A_sk11
.p2align 12
gated_mix__ssm_conv_s5__swiglu_ffn__prompt_kernel_A_pg0_11:
    s_branch gated_mix__ssm_conv_s5__swiglu_ffn__prompt_kernel_A_pr0
gated_mix__ssm_conv_s5__swiglu_ffn__prompt_kernel_A_pg3_11:
    s_branch gated_mix__ssm_conv_s5__swiglu_ffn__prompt_kernel_A_pr3
gated_mix__ssm_conv_s5__swiglu_ffn__prompt_kernel_A_sk11:
    v_xor_b32 v62, v62, v47
    v_min3_u32 v60, v60, v61, v62
    v_cmp_eq_u32 s[76:77], 0, v60
    s_mov_b32 s43, 2
    s_nop 0
    s_and_b64 s[76:77], s[76:77], s[44:45]
    s_cbranch_scc1 gated_mix__ssm_conv_s5__swiglu_ffn__prompt_kernel_rx_s2
    v_dot2_f32_bf16 v160, v216, v55, v160 neg_lo:[1,0,0] neg_hi:[1,0,0]
    v_dot2_f32_bf16 v161, v216, v33, v161 neg_lo:[1,0,0] neg_hi:[1,0,0]
    v_dot2_f32_bf16 v162, v217, v55, v162 neg_lo:[1,0,0] neg_hi:[1,0,0]
    v_dot2_f32_bf16 v163, v217, v33, v163 neg_lo:[1,0,0] neg_hi:[1,0,0]
    v_dot2_f32_bf16 v164, v218, v55, v164 neg_lo:[1,0,0] neg_hi:[1,0,0]
    v_dot2_f32_bf16 v165, v218, v33, v165 neg_lo:[1,0,0] neg_hi:[1,0,0]
    v_dot2_f32_bf16 v166, v219, v55, v166 neg_lo:[1,0,0] neg_hi:[1,0,0]
    v_dot2_f32_bf16 v167, v219, v33, v167 neg_lo:[1,0,0] neg_hi:[1,0,0]
    v_dot2_f32_bf16 v168, v220, v55, v168 neg_lo:[1,0,0] neg_hi:[1,0,0]
    v_dot2_f32_bf16 v169, v220, v33, v169 neg_lo:[1,0,0] neg_hi:[1,0,0]
    v_dot2_f32_bf16 v170, v221, v55, v170 neg_lo:[1,0,0] neg_hi:[1,0,0]
    v_dot2_f32_bf16 v171, v221, v33, v171 neg_lo:[1,0,0] neg_hi:[1,0,0]
    v_dot2_f32_bf16 v172, v222, v55, v172 neg_lo:[1,0,0] neg_hi:[1,0,0]
    v_dot2_f32_bf16 v173, v222, v33, v173 neg_lo:[1,0,0] neg_hi:[1,0,0]
    v_dot2_f32_bf16 v174, v223, v55, v174 neg_lo:[1,0,0] neg_hi:[1,0,0]
    v_dot2_f32_bf16 v175, v223, v33, v175 neg_lo:[1,0,0] neg_hi:[1,0,0]
    v_dot2_f32_bf16 v176, v224, v55, v176 neg_lo:[1,0,0] neg_hi:[1,0,0]
    v_dot2_f32_bf16 v177, v224, v33, v177 neg_lo:[1,0,0] neg_hi:[1,0,0]
    v_dot2_f32_bf16 v178, v225, v55, v178 neg_lo:[1,0,0] neg_hi:[1,0,0]
    v_dot2_f32_bf16 v179, v225, v33, v179 neg_lo:[1,0,0] neg_hi:[1,0,0]
    v_dot2_f32_bf16 v180, v226, v55, v180 neg_lo:[1,0,0] neg_hi:[1,0,0]
    v_dot2_f32_bf16 v181, v226, v33, v181 neg_lo:[1,0,0] neg_hi:[1,0,0]
    v_dot2_f32_bf16 v182, v227, v55, v182 neg_lo:[1,0,0] neg_hi:[1,0,0]
    v_dot2_f32_bf16 v183, v227, v33, v183 neg_lo:[1,0,0] neg_hi:[1,0,0]
    s_waitcnt vmcnt(2)
gated_mix__ssm_conv_s5__swiglu_ffn__prompt_kernel_rx_c3:
    v_and_b32 v60, v231, v235
    v_cmp_ne_u32 s[76:77], -1, v60
    s_mov_b32 s43, 3
    s_nop 0
    s_and_b64 s[76:77], s[76:77], s[44:45]
    s_cbranch_scc1 gated_mix__ssm_conv_s5__swiglu_ffn__prompt_kernel_rx_s3
    s_waitcnt vmcnt(0)
    v_and_b32 v60, v239, v243
    v_cmp_ne_u32 s[76:77], -1, v60
    s_nop 1
    s_cmp_eq_u64 s[76:77], 0
    s_cbranch_scc1 gated_mix__ssm_conv_s5__swiglu_ffn__prompt_kernel_rx_p
    buffer_load_dwordx4 v[236:239], v5, s[20:23], s13 offen offset:0 sc1
    buffer_load_dwordx4 v[240:243], v5, s[20:23], s13 offen offset:1024 sc1
gated_mix__ssm_conv_s5__swiglu_ffn__prompt_kernel_rx_p:
    v_dot2_f32_bf16 v160, v228, v54, v160
    v_dot2_f32_bf16 v161, v228, v32, v161
    v_dot2_f32_bf16 v162, v229, v54, v162
    v_dot2_f32_bf16 v163, v229, v32, v163
    v_dot2_f32_bf16 v164, v230, v54, v164
    v_dot2_f32_bf16 v165, v230, v32, v165
    v_dot2_f32_bf16 v166, v232, v54, v166
    v_dot2_f32_bf16 v167, v232, v32, v167
    buffer_store_dwordx4 v[160:163], v19, s[36:39], 0 offen offset:0 sc1
    v_dot2_f32_bf16 v168, v233, v54, v168
    v_dot2_f32_bf16 v169, v233, v32, v169
    v_dot2_f32_bf16 v170, v234, v54, v170
    v_dot2_f32_bf16 v171, v234, v32, v171
    buffer_store_dwordx4 v[164:167], v19, s[36:39], 0 offen offset:64 sc1
    s_nop 1
    buffer_store_dwordx4 v[168:171], v19, s[36:39], 0 offen offset:128 sc1
    s_waitcnt vmcnt(3)
gated_mix__ssm_conv_s5__swiglu_ffn__prompt_kernel_rx_c4:
    v_and_b32 v60, v239, v243
    v_cmp_ne_u32 s[76:77], -1, v60
    s_mov_b32 s43, 4
    s_nop 0
    s_and_b64 s[76:77], s[76:77], s[44:45]
    s_cbranch_scc1 gated_mix__ssm_conv_s5__swiglu_ffn__prompt_kernel_rx_s4
    v_dot2_f32_bf16 v172, v236, v54, v172
    v_dot2_f32_bf16 v173, v236, v32, v173
    v_dot2_f32_bf16 v174, v237, v54, v174
    v_dot2_f32_bf16 v175, v237, v32, v175
    v_dot2_f32_bf16 v176, v238, v54, v176
    v_dot2_f32_bf16 v177, v238, v32, v177
    v_dot2_f32_bf16 v178, v240, v54, v178
    v_dot2_f32_bf16 v179, v240, v32, v179
    buffer_store_dwordx4 v[172:175], v19, s[36:39], 0 offen offset:192 sc1
    v_dot2_f32_bf16 v180, v241, v54, v180
    v_dot2_f32_bf16 v181, v241, v32, v181
    v_dot2_f32_bf16 v182, v242, v54, v182
    v_dot2_f32_bf16 v183, v242, v32, v183
    buffer_store_dwordx4 v[176:179], v19, s[36:39], 0 offen offset:256 sc1
    s_nop 1
    buffer_store_dwordx4 v[180:183], v19, s[36:39], 0 offen offset:320 sc1
    buffer_store_dword v4, v6, s[20:23], s55 offen sc1
    s_endpgm
gated_mix__ssm_conv_s5__swiglu_ffn__prompt_kernel_rx_s0:
    buffer_load_dwordx4 v[192:195], v5, s[20:23], s40 offen offset:0 sc1
    buffer_load_dwordx4 v[196:199], v5, s[20:23], s40 offen offset:1024 sc1
    buffer_load_dwordx4 v[200:203], v5, s[20:23], s42 offen offset:0 sc1
    s_waitcnt vmcnt(3)
    s_branch gated_mix__ssm_conv_s5__swiglu_ffn__prompt_kernel_rx_t1
gated_mix__ssm_conv_s5__swiglu_ffn__prompt_kernel_rx_s1:
    buffer_load_dwordx4 v[204:207], v5, s[20:23], s41 offen offset:0 sc1
    buffer_load_dwordx4 v[208:211], v5, s[20:23], s41 offen offset:1024 sc1
    buffer_load_dwordx4 v[212:215], v52, s[20:23], s40 offen offset:0 sc1
    s_waitcnt vmcnt(3)
    s_branch gated_mix__ssm_conv_s5__swiglu_ffn__prompt_kernel_rx_t2
gated_mix__ssm_conv_s5__swiglu_ffn__prompt_kernel_rx_s2:
    buffer_load_dwordx4 v[216:219], v52, s[20:23], s40 offen offset:1024 sc1
    buffer_load_dwordx4 v[220:223], v52, s[20:23], s41 offen offset:0 sc1
    buffer_load_dwordx4 v[224:227], v52, s[20:23], s41 offen offset:1024 sc1
    s_waitcnt vmcnt(3)
    s_branch gated_mix__ssm_conv_s5__swiglu_ffn__prompt_kernel_rx_t3
gated_mix__ssm_conv_s5__swiglu_ffn__prompt_kernel_rx_s3:
    buffer_load_dwordx4 v[228:231], v5, s[20:23], s12 offen offset:0 sc1
    buffer_load_dwordx4 v[232:235], v5, s[20:23], s12 offen offset:1024 sc1
    s_waitcnt vmcnt(2)
    s_branch gated_mix__ssm_conv_s5__swiglu_ffn__prompt_kernel_rx_t4
gated_mix__ssm_conv_s5__swiglu_ffn__prompt_kernel_rx_s4:
    buffer_load_dwordx4 v[236:239], v5, s[20:23], s13 offen offset:0 sc1
    buffer_load_dwordx4 v[240:243], v5, s[20:23], s13 offen offset:1024 sc1
    s_waitcnt vmcnt(2)
    s_branch gated_mix__ssm_conv_s5__swiglu_ffn__prompt_kernel_rx_t5
gated_mix__ssm_conv_s5__swiglu_ffn__prompt_kernel_rx_t1:
    v_lshl_add_u32 v60, v205, 8, v204
    v_lshl_add_u32 v61, v209, 8, v208
    v_lshl_add_u32 v62, v213, 8, v212
    v_xor_b32 v60, v60, v42
    v_xor_b32 v61, v61, v43
    v_xor_b32 v62, v62, v44
    v_min3_u32 v60, v60, v61, v62
    v_cmp_eq_u32 s[76:77], 0, v60
    s_nop 1
    s_cmp_eq_u64 s[76:77], 0
    s_cbranch_scc1 gated_mix__ssm_conv_s5__swiglu_ffn__prompt_kernel_rx_t2
    buffer_load_dwordx4 v[204:207], v5, s[20:23], s41 offen offset:0 sc1
    buffer_load_dwordx4 v[208:211], v5, s[20:23], s41 offen offset:1024 sc1
    buffer_load_dwordx4 v[212:215], v52, s[20:23], s40 offen offset:0 sc1
gated_mix__ssm_conv_s5__swiglu_ffn__prompt_kernel_rx_t2:
    v_lshl_add_u32 v60, v217, 8, v216
    v_lshl_add_u32 v61, v221, 8, v220
    v_lshl_add_u32 v62, v225, 8, v224
    v_xor_b32 v60, v60, v45
    v_xor_b32 v61, v61, v46
    v_xor_b32 v62, v62, v47
    v_min3_u32 v60, v60, v61, v62
    v_cmp_eq_u32 s[76:77], 0, v60
    s_nop 1
    s_cmp_eq_u64 s[76:77], 0
    s_cbranch_scc1 gated_mix__ssm_conv_s5__swiglu_ffn__prompt_kernel_rx_t3
    buffer_load_dwordx4 v[216:219], v52, s[20:23], s40 offen offset:1024 sc1
    buffer_load_dwordx4 v[220:223], v52, s[20:23], s41 offen offset:0 sc1
    buffer_load_dwordx4 v[224:227], v52, s[20:23], s41 offen offset:1024 sc1
gated_mix__ssm_conv_s5__swiglu_ffn__prompt_kernel_rx_t3:
    v_and_b32 v60, v231, v235
    v_cmp_ne_u32 s[76:77], -1, v60
    s_nop 1
    s_cmp_eq_u64 s[76:77], 0
    s_cbranch_scc1 gated_mix__ssm_conv_s5__swiglu_ffn__prompt_kernel_rx_t4
    buffer_load_dwordx4 v[228:231], v5, s[20:23], s12 offen offset:0 sc1
    buffer_load_dwordx4 v[232:235], v5, s[20:23], s12 offen offset:1024 sc1
gated_mix__ssm_conv_s5__swiglu_ffn__prompt_kernel_rx_t4:
    v_and_b32 v60, v239, v243
    v_cmp_ne_u32 s[76:77], -1, v60
    s_nop 1
    s_cmp_eq_u64 s[76:77], 0
    s_cbranch_scc1 gated_mix__ssm_conv_s5__swiglu_ffn__prompt_kernel_rx_t5
    buffer_load_dwordx4 v[236:239], v5, s[20:23], s13 offen offset:0 sc1
    buffer_load_dwordx4 v[240:243], v5, s[20:23], s13 offen offset:1024 sc1
gated_mix__ssm_conv_s5__swiglu_ffn__prompt_kernel_rx_t5:
    v_cmp_ne_u32 s[46:47], 0, v51
    s_cmp_lt_u32 s50, 10
    s_cbranch_scc1 gated_mix__ssm_conv_s5__swiglu_ffn__prompt_kernel_rx_u
    buffer_load_dword v51, v50, s[20:23], s19 offen sc1
    buffer_store_dword v4, v6, s[20:23], s55 offen sc1
gated_mix__ssm_conv_s5__swiglu_ffn__prompt_kernel_rx_u:
    s_add_u32 s50, s50, 1
    s_cmp_lt_u32 s50, 32768
    s_cselect_b64 s[44:45], -1, 0
    s_and_b32 s46, s46, 7
    s_waitcnt vmcnt(0)
    s_cbranch_scc0 gated_mix__ssm_conv_s5__swiglu_ffn__prompt_kernel_rx_v2
    s_bitcmp1_b32 s46, 0
    s_cbranch_scc0 gated_mix__ssm_conv_s5__swiglu_ffn__prompt_kernel_rx_v0
    v_lshl_add_u32 v40, v193, 8, v192
    v_not_b32 v40, v40
    v_lshl_add_u32 v41, v197, 8, v196
    v_not_b32 v41, v41
    v_lshl_add_u32 v48, v201, 8, v200
    v_not_b32 v48, v48
gated_mix__ssm_conv_s5__swiglu_ffn__prompt_kernel_rx_v0:
    s_bitcmp1_b32 s46, 1
    s_cbranch_scc0 gated_mix__ssm_conv_s5__swiglu_ffn__prompt_kernel_rx_v1
    v_lshl_add_u32 v42, v205, 8, v204
    v_not_b32 v42, v42
    v_lshl_add_u32 v43, v209, 8, v208
    v_not_b32 v43, v43
    v_lshl_add_u32 v44, v213, 8, v212
    v_not_b32 v44, v44
gated_mix__ssm_conv_s5__swiglu_ffn__prompt_kernel_rx_v1:
    s_bitcmp1_b32 s46, 2
    s_cbranch_scc0 gated_mix__ssm_conv_s5__swiglu_ffn__prompt_kernel_rx_v2
    v_lshl_add_u32 v45, v217, 8, v216
    v_not_b32 v45, v45
    v_lshl_add_u32 v46, v221, 8, v220
    v_not_b32 v46, v46
    v_lshl_add_u32 v47, v225, 8, v224
    v_not_b32 v47, v47
gated_mix__ssm_conv_s5__swiglu_ffn__prompt_kernel_rx_v2:
    s_cmp_eq_u32 s43, 4
    s_cbranch_scc1 gated_mix__ssm_conv_s5__swiglu_ffn__prompt_kernel_rx_c4
    s_cmp_eq_u32 s43, 3
    s_cbranch_scc1 gated_mix__ssm_conv_s5__swiglu_ffn__prompt_kernel_rx_c3
    s_cmp_eq_u32 s43, 2
    s_cbranch_scc1 gated_mix__ssm_conv_s5__swiglu_ffn__prompt_kernel_rx_c2
    s_cmp_eq_u32 s43, 1
    s_cbranch_scc1 gated_mix__ssm_conv_s5__swiglu_ffn__prompt_kernel_rx_c1
    s_branch gated_mix__ssm_conv_s5__swiglu_ffn__prompt_kernel_rx_c0
gated_mix__ssm_conv_s5__swiglu_ffn__prompt_kernel_B:
    s_add_u32 s49, s49, 128
    s_cmp_lg_u32 s49, 1152
    s_cselect_b32 s49, s49, 0
    s_cmp_eq_u32 s6, 0
    s_cbranch_scc1 gated_mix__ssm_conv_s5__swiglu_ffn__prompt_kernel_B_pg0_7
    s_cmp_eq_u32 s6, 1
    s_cbranch_scc1 gated_mix__ssm_conv_s5__swiglu_ffn__prompt_kernel_B_pg0_8
    s_cmp_eq_u32 s6, 2
    s_cbranch_scc1 gated_mix__ssm_conv_s5__swiglu_ffn__prompt_kernel_B_pg0_9
    s_cmp_eq_u32 s6, 3
    s_cbranch_scc1 gated_mix__ssm_conv_s5__swiglu_ffn__prompt_kernel_B_pg0_10
gated_mix__ssm_conv_s5__swiglu_ffn__prompt_kernel_B_pr0:
    s_waitcnt vmcnt(8)
    s_barrier
    ds_read_b128 a[0:3], v34 offset:32768
    ds_read_b128 a[4:7], v34 offset:34816
    ds_read_b128 a[8:11], v34 offset:36864
    ds_read_b128 a[12:15], v34 offset:38912
    ds_read_b128 a[16:19], v35 offset:32768
    ds_read_b128 a[20:23], v35 offset:34816
    ds_read_b128 a[24:27], v35 offset:36864
    ds_read_b128 a[28:31], v35 offset:38912
    ds_read_b64_tr_b16 v[40:41], v3 offset:0
    ds_read_b64_tr_b16 v[42:43], v3 offset:1024
    ds_read_b64_tr_b16 v[44:45], v3 offset:8192
    ds_read_b64_tr_b16 v[46:47], v3 offset:9216
    ds_read_b64_tr_b16 v[48:49], v3 offset:4096
    ds_read_b64_tr_b16 v[50:51], v3 offset:5120
    ds_read_b64_tr_b16 v[52:53], v3 offset:12288
    ds_read_b64_tr_b16 v[54:55], v3 offset:13312
    s_waitcnt lgkmcnt(6)
    v_mfma_f32_16x16x32_bf16 v[96:99], v[40:43], a[0:3], 0
    s_add_u32 vcc_lo, s41, 35840
    ds_read_b64_tr_b16 v[56:57], v4 offset:0
    v_min_u32 v29, 36, v0
    v_mfma_f32_16x16x32_bf16 v[100:103], v[40:43], a[4:7], 0
    s_lshl1_add_u32 m0, s74, 16384
    ds_read_b64_tr_b16 v[58:59], v4 offset:1024
    v_lshlrev_b32 v29, 2, v29
    v_mfma_f32_16x16x32_bf16 v[104:107], v[40:43], a[8:11], 0
    buffer_load_dwordx4 v2, s[12:15], s41 offen nt lds
    v_mfma_f32_16x16x32_bf16 v[108:111], v[40:43], a[12:15], 0
    s_waitcnt lgkmcnt(6)
    s_add_u32 s65, s75, 4096
    s_add_u32 s70, s75, 8192
    v_mfma_f32_16x16x32_bf16 v[112:115], v[44:47], a[0:3], 0
    buffer_load_dwordx4 v2, s[12:15], vcc_lo offen offset:1024 nt lds
    v_mfma_f32_16x16x32_bf16 v[116:119], v[44:47], a[4:7], 0
    s_lshl1_add_u32 m0, s74, 24576
    ds_read_b64_tr_b16 v[60:61], v4 offset:8192
    v_mfma_f32_16x16x32_bf16 v[120:123], v[44:47], a[8:11], 0
    buffer_load_dwordx4 v2, s[16:19], s41 offen nt lds
    v_mfma_f32_16x16x32_bf16 v[124:127], v[44:47], a[12:15], 0
    s_waitcnt lgkmcnt(1)
    ds_read_b64_tr_b16 v[62:63], v4 offset:9216
    v_mfma_f32_16x16x32_bf16 v[96:99], v[48:51], a[16:19], v[96:99]
    buffer_load_dwordx4 v2, s[16:19], vcc_lo offen offset:1024 nt lds
    v_mfma_f32_16x16x32_bf16 v[100:103], v[48:51], a[20:23], v[100:103]
    s_add_u32 m0, s57, 98304
    ds_read_b64_tr_b16 v[40:41], v4 offset:4096
    v_and_b32 v16, 15, v0
    v_mfma_f32_16x16x32_bf16 v[104:107], v[48:51], a[24:27], v[104:107]
    buffer_load_dwordx4 v30, s[8:11], s49 offen offset:0  lds
    v_mfma_f32_16x16x32_bf16 v[108:111], v[48:51], a[28:31], v[108:111]
    buffer_load_dwordx4 v31, s[8:11], s49 offen offset:1024  lds
    v_mfma_f32_16x16x32_bf16 v[112:115], v[52:55], a[16:19], v[112:115]
    buffer_load_dwordx4 v32, s[8:11], s49 offen offset:2048  lds
    v_mfma_f32_16x16x32_bf16 v[116:119], v[52:55], a[20:23], v[116:119]
    buffer_load_dwordx4 v33, s[8:11], s49 offen offset:3072  lds
    v_mfma_f32_16x16x32_bf16 v[120:123], v[52:55], a[24:27], v[120:123]
    s_add_u32 m0, s57, 102400
    ds_read_b64_tr_b16 v[42:43], v4 offset:5120
    v_lshrrev_b32 v17, 1, v16
    v_mfma_f32_16x16x32_bf16 v[124:127], v[52:55], a[28:31], v[124:127]
    s_add_u32 s51, s49, 9216
    ds_read_b64_tr_b16 v[44:45], v4 offset:12288
    v_bfe_u32 v8, v0, 4, 1
    v_mfma_f32_16x16x32_bf16 v[128:131], v[56:59], a[0:3], 0
    buffer_load_dwordx4 v30, s[8:11], s51 offen offset:0  lds
    v_mfma_f32_16x16x32_bf16 v[132:135], v[56:59], a[4:7], 0
    buffer_load_dwordx4 v31, s[8:11], s51 offen offset:1024  lds
    v_mfma_f32_16x16x32_bf16 v[136:139], v[56:59], a[8:11], 0
    s_lshl2_add_u32 s80, s4, s3
    ds_read_b64_tr_b16 v[46:47], v4 offset:13312
    v_xor_b32 v17, v17, v8
    v_mfma_f32_16x16x32_bf16 v[140:143], v[56:59], a[12:15], 0
    buffer_load_dwordx4 v32, s[8:11], s51 offen offset:2048  lds
    buffer_load_dwordx4 v33, s[8:11], s51 offen offset:3072  lds
    s_cmp_eq_u32 s6, 0
    s_cbranch_scc1 gated_mix__ssm_conv_s5__swiglu_ffn__prompt_kernel_B_pg1_0
    s_cmp_eq_u32 s6, 1
    s_cbranch_scc1 gated_mix__ssm_conv_s5__swiglu_ffn__prompt_kernel_B_pg1_4
    s_cmp_eq_u32 s6, 2
    s_cbranch_scc1 gated_mix__ssm_conv_s5__swiglu_ffn__prompt_kernel_B_pg1_5
    s_cmp_eq_u32 s6, 3
    s_cbranch_scc1 gated_mix__ssm_conv_s5__swiglu_ffn__prompt_kernel_B_pg1_6
gated_mix__ssm_conv_s5__swiglu_ffn__prompt_kernel_B_pr1:
    s_waitcnt vmcnt(8) lgkmcnt(3)
    s_barrier
    v_mfma_f32_16x16x32_bf16 v[144:147], v[60:63], a[0:3], 0
    s_add_u32 s49, s49, 128
    ds_read_b128 a[32:35], v34 offset:0
    v_lshlrev_b32 v17, 4, v17
    v_mfma_f32_16x16x32_bf16 v[148:151], v[60:63], a[4:7], 0
    s_cmp_lg_u32 s49, 1152
    s_cselect_b32 s49, s49, 0
    ds_read_b128 a[36:39], v34 offset:2048
    v_lshl_add_u32 v16, v16, 7, v17
    v_mfma_f32_16x16x32_bf16 v[152:155], v[60:63], a[8:11], 0
    s_add_u32 vcc_lo, s42, 35840
    ds_read_b128 a[40:43], v34 offset:4096
    v_lshrrev_b32 v17, 5, v0
    v_mfma_f32_16x16x32_bf16 v[156:159], v[60:63], a[12:15], 0
    s_waitcnt lgkmcnt(4)
    ds_read_b128 a[44:47], v34 offset:6144
    v_mul_u32_u24 v17, 18432, v17
    v_mfma_f32_16x16x32_bf16 v[128:131], v[40:43], a[16:19], v[128:131]
    s_lshl1_add_u32 m0, s74, 32768
    ds_read_b128 a[48:51], v35 offset:0
    v_add_u32 v8, v16, v17
    v_mfma_f32_16x16x32_bf16 v[132:135], v[40:43], a[20:23], v[132:135]
    s_lshl1_add_u32 s80, s80, s7
    ds_read_b128 a[52:55], v35 offset:2048
    v_xor_b32 v9, 32, v8
    v_mfma_f32_16x16x32_bf16 v[136:139], v[40:43], a[24:27], v[136:139]
    s_sub_u32 s80, s80, 6
    ds_read_b128 a[56:59], v35 offset:4096
    v_xor_b32 v10, 64, v8
    v_mfma_f32_16x16x32_bf16 v[140:143], v[40:43], a[28:31], v[140:143]
    s_waitcnt lgkmcnt(5)
    ds_read_b128 a[60:63], v35 offset:6144
    v_xor_b32 v11, 96, v8
    v_mfma_f32_16x16x32_bf16 v[144:147], v[44:47], a[16:19], v[144:147]
    s_and_b32 s85, s5, 3
    ds_read_b64_tr_b16 v[48:49], v3 offset:16384
    v_add_u32 v12, 73728, v8
    v_mfma_f32_16x16x32_bf16 v[148:151], v[44:47], a[20:23], v[148:151]
    s_lshl1_add_u32 s88, s7, s85
    ds_read_b64_tr_b16 v[50:51], v3 offset:17408
    v_add_u32 v13, 73728, v9
    v_mfma_f32_16x16x32_bf16 v[152:155], v[44:47], a[24:27], v[152:155]
    s_and_b32 s88, s88, 3
    ds_read_b64_tr_b16 v[52:53], v3 offset:24576
    v_add_u32 v14, 73728, v10
    v_mfma_f32_16x16x32_bf16 v[156:159], v[44:47], a[28:31], v[156:159]
    s_waitcnt lgkmcnt(1)
    ds_read_b64_tr_b16 v[54:55], v3 offset:25600
    v_add_u32 v15, 73728, v11
    v_mfma_f32_16x16x32_bf16 v[96:99], v[48:51], a[32:35], v[96:99]
    s_mul_i32 s88, s88, 19
    ds_read_b64_tr_b16 v[56:57], v3 offset:20480
    v_mfma_f32_16x16x32_bf16 v[100:103], v[48:51], a[36:39], v[100:103]
    s_lshr_b32 s88, s88, 3
    ds_read_b64_tr_b16 v[58:59], v3 offset:21504
    v_mfma_f32_16x16x32_bf16 v[104:107], v[48:51], a[40:43], v[104:107]
    s_lshl_b32 s89, s88, 14
    ds_read_b64_tr_b16 v[60:61], v3 offset:28672
    v_mfma_f32_16x16x32_bf16 v[108:111], v[48:51], a[44:47], v[108:111]
    s_waitcnt lgkmcnt(3)
    ds_read_b64_tr_b16 v[62:63], v3 offset:29696
    v_mfma_f32_16x16x32_bf16 v[112:115], v[52:55], a[32:35], v[112:115]
    buffer_load_dwordx4 v2, s[12:15], s42 offen nt lds
    v_mfma_f32_16x16x32_bf16 v[116:119], v[52:55], a[36:39], v[116:119]
    buffer_load_dwordx4 v2, s[12:15], vcc_lo offen offset:1024 nt lds
    v_mfma_f32_16x16x32_bf16 v[120:123], v[52:55], a[40:43], v[120:123]
    s_lshl1_add_u32 m0, s74, 40960
    ds_read_b64_tr_b16 v[40:41], v4 offset:16384
    v_mfma_f32_16x16x32_bf16 v[124:127], v[52:55], a[44:47], v[124:127]
    s_waitcnt lgkmcnt(3)
    ds_read_b64_tr_b16 v[42:43], v4 offset:17408
    v_mfma_f32_16x16x32_bf16 v[96:99], v[56:59], a[48:51], v[96:99]
    buffer_load_dwordx4 v2, s[16:19], s42 offen nt lds
    v_mfma_f32_16x16x32_bf16 v[100:103], v[56:59], a[52:55], v[100:103]
    buffer_load_dwordx4 v2, s[16:19], vcc_lo offen offset:1024 nt lds
    v_mfma_f32_16x16x32_bf16 v[104:107], v[56:59], a[56:59], v[104:107]
    s_add_u32 m0, s57, 65536
    ds_read_b64_tr_b16 v[44:45], v4 offset:24576
    v_mfma_f32_16x16x32_bf16 v[108:111], v[56:59], a[60:63], v[108:111]
    s_waitcnt lgkmcnt(3)
    ds_read_b64_tr_b16 v[46:47], v4 offset:25600
    v_mfma_f32_16x16x32_bf16 v[112:115], v[60:63], a[48:51], v[112:115]
    buffer_load_dwordx4 v30, s[8:11], s49 offen offset:0  lds
    v_mfma_f32_16x16x32_bf16 v[116:119], v[60:63], a[52:55], v[116:119]
    buffer_load_dwordx4 v31, s[8:11], s49 offen offset:1024  lds
    v_mfma_f32_16x16x32_bf16 v[120:123], v[60:63], a[56:59], v[120:123]
    s_lshl_b32 s88, s88, 7
    ds_read_b64_tr_b16 v[48:49], v4 offset:20480
    v_mfma_f32_16x16x32_bf16 v[124:127], v[60:63], a[60:63], v[124:127]
    s_waitcnt lgkmcnt(3)
    ds_read_b64_tr_b16 v[50:51], v4 offset:21504
    v_mfma_f32_16x16x32_bf16 v[128:131], v[40:43], a[32:35], v[128:131]
    buffer_load_dwordx4 v32, s[8:11], s49 offen offset:2048  lds
    v_mfma_f32_16x16x32_bf16 v[132:135], v[40:43], a[36:39], v[132:135]
    buffer_load_dwordx4 v33, s[8:11], s49 offen offset:3072  lds
    v_mfma_f32_16x16x32_bf16 v[136:139], v[40:43], a[40:43], v[136:139]
    s_add_u32 m0, s57, 69632
    ds_read_b64_tr_b16 v[52:53], v4 offset:28672
    v_mfma_f32_16x16x32_bf16 v[140:143], v[40:43], a[44:47], v[140:143]
    s_waitcnt lgkmcnt(3)
    ds_read_b64_tr_b16 v[54:55], v4 offset:29696
    v_mfma_f32_16x16x32_bf16 v[144:147], v[44:47], a[32:35], v[144:147]
    s_add_u32 s51, s49, 9216
    v_xor_b32 v3, 64, v3
    v_mfma_f32_16x16x32_bf16 v[148:151], v[44:47], a[36:39], v[148:151]
    buffer_load_dwordx4 v30, s[8:11], s51 offen offset:0  lds
    v_mfma_f32_16x16x32_bf16 v[152:155], v[44:47], a[40:43], v[152:155]
    s_cmp_lt_u32 s6, 2
    s_cselect_b32 s24, s66, s68
    s_cselect_b32 s25, s67, s69
    ds_read_b64_tr_b16 v[56:57], v3 offset:0
    v_mfma_f32_16x16x32_bf16 v[156:159], v[44:47], a[44:47], v[156:159]
    s_waitcnt lgkmcnt(3)
    ds_read_b64_tr_b16 v[58:59], v3 offset:1024
    v_mfma_f32_16x16x32_bf16 v[128:131], v[48:51], a[48:51], v[128:131]
    buffer_load_dwordx4 v31, s[8:11], s51 offen offset:1024  lds
    v_mfma_f32_16x16x32_bf16 v[132:135], v[48:51], a[52:55], v[132:135]
    buffer_load_dwordx4 v32, s[8:11], s51 offen offset:2048  lds
    v_mfma_f32_16x16x32_bf16 v[136:139], v[48:51], a[56:59], v[136:139]
    s_and_b32 s25, s25, 0xffff
    ds_read_b64_tr_b16 v[60:61], v3 offset:8192
    v_mfma_f32_16x16x32_bf16 v[140:143], v[48:51], a[60:63], v[140:143]
    s_waitcnt lgkmcnt(3)
    ds_read_b64_tr_b16 v[62:63], v3 offset:9216
    v_mfma_f32_16x16x32_bf16 v[144:147], v[52:55], a[48:51], v[144:147]
    buffer_load_dwordx4 v33, s[8:11], s51 offen offset:3072  lds
    v_mfma_f32_16x16x32_bf16 v[148:151], v[52:55], a[52:55], v[148:151]
    s_add_u32 s49, s49, 128
    ds_read_b64_tr_b16 v[40:41], v3 offset:4096
    v_mfma_f32_16x16x32_bf16 v[152:155], v[52:55], a[56:59], v[152:155]
    s_cmp_lg_u32 s49, 1152
    s_cselect_b32 s49, s49, 0
    ds_read_b64_tr_b16 v[42:43], v3 offset:5120
    v_mfma_f32_16x16x32_bf16 v[156:159], v[52:55], a[60:63], v[156:159]
    s_waitcnt lgkmcnt(4)
    ds_read_b64_tr_b16 v[44:45], v3 offset:12288
    v_mfma_f32_16x16x32_bf16 v[160:163], v[56:59], a[0:3], 0
    s_add_u32 vcc_lo, s43, 35840
    ds_read_b64_tr_b16 v[46:47], v3 offset:13312
    v_mfma_f32_16x16x32_bf16 v[164:167], v[56:59], a[4:7], 0
    s_cmp_eq_u32 s6, 0
    s_cbranch_scc1 gated_mix__ssm_conv_s5__swiglu_ffn__prompt_kernel_B_pg2_1
    s_cmp_eq_u32 s6, 1
    s_cbranch_scc1 gated_mix__ssm_conv_s5__swiglu_ffn__prompt_kernel_B_pg2_2
    s_cmp_eq_u32 s6, 2
    s_cbranch_scc1 gated_mix__ssm_conv_s5__swiglu_ffn__prompt_kernel_B_pg2_3
gated_mix__ssm_conv_s5__swiglu_ffn__prompt_kernel_B_pr2:
    s_waitcnt vmcnt(8) lgkmcnt(4)
    s_barrier
    v_mfma_f32_16x16x32_bf16 v[168:171], v[56:59], a[8:11], 0
    s_lshl1_add_u32 m0, s74, 49152
    ds_read_b128 a[64:67], v34 offset:32768
    v_mfma_f32_16x16x32_bf16 v[172:175], v[56:59], a[12:15], 0
    s_lshl_b32 s81, s80, 1
    ds_read_b128 a[68:71], v34 offset:34816
    v_mfma_f32_16x16x32_bf16 v[176:179], v[60:63], a[0:3], 0
    s_lshr_b32 s72, s6, 1
    ds_read_b128 a[72:75], v34 offset:36864
    v_mfma_f32_16x16x32_bf16 v[180:183], v[60:63], a[4:7], 0
    s_add_u32 s81, s81, s72
    ds_read_b128 a[76:79], v34 offset:38912
    v_mfma_f32_16x16x32_bf16 v[184:187], v[60:63], a[8:11], 0
    s_lshl_b32 s73, s81, 8
    ds_read_b128 a[80:83], v35 offset:32768
    v_mfma_f32_16x16x32_bf16 v[188:191], v[60:63], a[12:15], 0
    s_waitcnt lgkmcnt(5)
    ds_read_b128 a[84:87], v35 offset:34816
    v_mfma_f32_16x16x32_bf16 v[160:163], v[40:43], a[16:19], v[160:163]
    s_add_u32 s73, s73, 23715840
    ds_read_b128 a[88:91], v35 offset:36864
    v_mfma_f32_16x16x32_bf16 v[164:167], v[40:43], a[20:23], v[164:167]
    s_mul_i32 s81, s81, 147456
    ds_read_b128 a[92:95], v35 offset:38912
    v_mfma_f32_16x16x32_bf16 v[168:171], v[40:43], a[24:27], v[168:171]
    s_and_b32 s72, s6, 1
    v_xor_b32 v4, 64, v4
    v_mfma_f32_16x16x32_bf16 v[172:175], v[40:43], a[28:31], v[172:175]
    s_lshl_b32 s84, s72, 11
    ds_read_b64_tr_b16 v[48:49], v4 offset:0
    v_mfma_f32_16x16x32_bf16 v[176:179], v[44:47], a[16:19], v[176:179]
    s_add_u32 s81, s81, s84
    ds_read_b64_tr_b16 v[50:51], v4 offset:1024
    v_mfma_f32_16x16x32_bf16 v[180:183], v[44:47], a[20:23], v[180:183]
    s_add_u32 s81, s81, 18874368
    ds_read_b64_tr_b16 v[52:53], v4 offset:8192
    v_and_b32 v22, 7, v0
    v_mfma_f32_16x16x32_bf16 v[184:187], v[44:47], a[24:27], v[184:187]
    s_add_u32 s71, s75, 12288
    ds_read_b64_tr_b16 v[54:55], v4 offset:9216
    v_lshrrev_b32 v23, 4, v0
    v_mfma_f32_16x16x32_bf16 v[188:191], v[44:47], a[28:31], v[188:191]
    s_waitcnt lgkmcnt(2)
    ds_read_b64_tr_b16 v[56:57], v4 offset:4096
    v_xor_b32 v22, v22, v23
    v_mfma_f32_16x16x32_bf16 v[224:227], v[48:51], a[0:3], 0
    s_add_u32 s59, s58, 4096
    ds_read_b64_tr_b16 v[58:59], v4 offset:5120
    v_lshlrev_b32 v22, 4, v22
    v_mfma_f32_16x16x32_bf16 v[228:231], v[48:51], a[4:7], 0
    buffer_load_dwordx4 v2, s[12:15], s43 offen  lds
    v_mfma_f32_16x16x32_bf16 v[232:235], v[48:51], a[8:11], 0
    s_lshl_b32 s84, s72, 6
    ds_read_b64_tr_b16 v[60:61], v4 offset:12288
    v_xor_b32 v22, s84, v22
    v_mfma_f32_16x16x32_bf16 v[236:239], v[48:51], a[12:15], 0
    s_waitcnt lgkmcnt(3)
    ds_read_b64_tr_b16 v[62:63], v4 offset:13312
    v_mfma_f32_16x16x32_bf16 v[240:243], v[52:55], a[0:3], 0
    buffer_load_dwordx4 v2, s[12:15], vcc_lo offen offset:1024  lds
    v_mfma_f32_16x16x32_bf16 v[244:247], v[52:55], a[4:7], 0
    s_lshl1_add_u32 m0, s74, 57344
    v_xor_b32 v3, 64, v3
    v_mfma_f32_16x16x32_bf16 v[248:251], v[52:55], a[8:11], 0
    s_lshl_b32 s84, s85, 1
    ds_read_b64_tr_b16 v[40:41], v3 offset:32768
    v_mfma_f32_16x16x32_bf16 v[252:255], v[52:55], a[12:15], 0
    s_waitcnt lgkmcnt(3)
    ds_read_b64_tr_b16 v[42:43], v3 offset:33792
    v_mfma_f32_16x16x32_bf16 v[224:227], v[56:59], a[16:19], v[224:227]
    buffer_load_dwordx4 v2, s[16:19], s43 offen  lds
    v_mfma_f32_16x16x32_bf16 v[228:231], v[56:59], a[20:23], v[228:231]
    buffer_load_dwordx4 v2, s[16:19], vcc_lo offen offset:1024  lds
    v_mfma_f32_16x16x32_bf16 v[232:235], v[56:59], a[24:27], v[232:235]
    s_add_u32 m0, s57, 98304
    ds_read_b64_tr_b16 v[44:45], v3 offset:40960
    v_mfma_f32_16x16x32_bf16 v[236:239], v[56:59], a[28:31], v[236:239]
    s_waitcnt lgkmcnt(3)
    ds_read_b64_tr_b16 v[46:47], v3 offset:41984
    v_mfma_f32_16x16x32_bf16 v[240:243], v[60:63], a[16:19], v[240:243]
    buffer_load_dwordx4 v30, s[8:11], s49 offen offset:0  lds
    v_mfma_f32_16x16x32_bf16 v[244:247], v[60:63], a[20:23], v[244:247]
    buffer_load_dwordx4 v31, s[8:11], s49 offen offset:1024  lds
    v_mfma_f32_16x16x32_bf16 v[248:251], v[60:63], a[24:27], v[248:251]
    s_add_u32 s84, s84, s72
    ds_read_b64_tr_b16 v[48:49], v3 offset:36864
    v_mfma_f32_16x16x32_bf16 v[252:255], v[60:63], a[28:31], v[252:255]
    s_waitcnt lgkmcnt(3)
    ds_read_b64_tr_b16 v[50:51], v3 offset:37888
    v_mfma_f32_16x16x32_bf16 v[96:99], v[40:43], a[64:67], v[96:99]
    buffer_load_dwordx4 v32, s[8:11], s49 offen offset:2048  lds
    v_mfma_f32_16x16x32_bf16 v[100:103], v[40:43], a[68:71], v[100:103]
    buffer_load_dwordx4 v33, s[8:11], s49 offen offset:3072  lds
    v_mfma_f32_16x16x32_bf16 v[104:107], v[40:43], a[72:75], v[104:107]
    s_add_u32 m0, s57, 102400
    ds_read_b64_tr_b16 v[52:53], v3 offset:45056
    v_mfma_f32_16x16x32_bf16 v[108:111], v[40:43], a[76:79], v[108:111]
    s_waitcnt lgkmcnt(3)
    ds_read_b64_tr_b16 v[54:55], v3 offset:46080
    v_mfma_f32_16x16x32_bf16 v[112:115], v[44:47], a[64:67], v[112:115]
    s_add_u32 s51, s49, 9216
    v_xor_b32 v4, 64, v4
    v_mfma_f32_16x16x32_bf16 v[116:119], v[44:47], a[68:71], v[116:119]
    buffer_load_dwordx4 v30, s[8:11], s51 offen offset:0  lds
    v_mfma_f32_16x16x32_bf16 v[120:123], v[44:47], a[72:75], v[120:123]
    s_mul_i32 s84, s84, 72
    ds_read_b64_tr_b16 v[56:57], v4 offset:32768
    v_lshrrev_b32 v23, 3, v0
    v_mfma_f32_16x16x32_bf16 v[124:127], v[44:47], a[76:79], v[124:127]
    s_waitcnt lgkmcnt(3)
    ds_read_b64_tr_b16 v[58:59], v4 offset:33792
    v_add_u32 v23, s84, v23
    v_mfma_f32_16x16x32_bf16 v[96:99], v[48:51], a[80:83], v[96:99]
    buffer_load_dwordx4 v31, s[8:11], s51 offen offset:1024  lds
    v_mfma_f32_16x16x32_bf16 v[100:103], v[48:51], a[84:87], v[100:103]
    buffer_load_dwordx4 v32, s[8:11], s51 offen offset:2048  lds
    v_mfma_f32_16x16x32_bf16 v[104:107], v[48:51], a[88:91], v[104:107]
    ds_read_b64_tr_b16 v[60:61], v4 offset:40960
    v_mul_u32_u24 v23, 1152, v23
    v_mfma_f32_16x16x32_bf16 v[108:111], v[48:51], a[92:95], v[108:111]
    s_waitcnt lgkmcnt(3)
    ds_read_b64_tr_b16 v[62:63], v4 offset:41984
    v_add_u32 v18, v23, v22
    v_mfma_f32_16x16x32_bf16 v[112:115], v[52:55], a[80:83], v[112:115]
    buffer_load_dwordx4 v33, s[8:11], s51 offen offset:3072  lds
    v_mfma_f32_16x16x32_bf16 v[116:119], v[52:55], a[84:87], v[116:119]
    s_add_u32 s49, s49, 128
    ds_read_b64_tr_b16 v[40:41], v4 offset:36864
    v_xor_b32 v19, 64, v18
    v_mfma_f32_16x16x32_bf16 v[120:123], v[52:55], a[88:91], v[120:123]
    s_cmp_lg_u32 s49, 1152
    s_cselect_b32 s49, s49, 0
    ds_read_b64_tr_b16 v[42:43], v4 offset:37888
    v_add_u32 v19, 8192, v19
    v_mfma_f32_16x16x32_bf16 v[124:127], v[52:55], a[92:95], v[124:127]
    s_waitcnt lgkmcnt(4)
    ds_read_b64_tr_b16 v[44:45], v4 offset:45056
    v_add_u32 v20, 16384, v18
    v_mfma_f32_16x16x32_bf16 v[128:131], v[56:59], a[64:67], v[128:131]
    s_add_u32 vcc_lo, s44, 35840
    ds_read_b64_tr_b16 v[46:47], v4 offset:46080
    v_add_u32 v21, 16384, v19
    v_mfma_f32_16x16x32_bf16 v[132:135], v[56:59], a[68:71], v[132:135]
    s_lshl1_add_u32 m0, s74, 131072
    v_xor_b32 v3, 64, v3
    v_mfma_f32_16x16x32_bf16 v[136:139], v[56:59], a[72:75], v[136:139]
    buffer_load_dwordx4 v2, s[12:15], s44 offen  lds
    v_mfma_f32_16x16x32_bf16 v[140:143], v[56:59], a[76:79], v[140:143]
    s_waitcnt lgkmcnt(3)
    ds_read_b64_tr_b16 v[48:49], v3 offset:16384
    v_mfma_f32_16x16x32_bf16 v[144:147], v[60:63], a[64:67], v[144:147]
    buffer_load_dwordx4 v2, s[12:15], vcc_lo offen offset:1024  lds
    v_mfma_f32_16x16x32_bf16 v[148:151], v[60:63], a[68:71], v[148:151]
    s_lshl1_add_u32 m0, s74, 139264
    ds_read_b64_tr_b16 v[50:51], v3 offset:17408
    v_mfma_f32_16x16x32_bf16 v[152:155], v[60:63], a[72:75], v[152:155]
    buffer_load_dwordx4 v2, s[16:19], s44 offen  lds
    v_mfma_f32_16x16x32_bf16 v[156:159], v[60:63], a[76:79], v[156:159]
    s_waitcnt lgkmcnt(2)
    ds_read_b64_tr_b16 v[52:53], v3 offset:24576
    v_mfma_f32_16x16x32_bf16 v[128:131], v[40:43], a[80:83], v[128:131]
    buffer_load_dwordx4 v2, s[16:19], vcc_lo offen offset:1024  lds
    v_mfma_f32_16x16x32_bf16 v[132:135], v[40:43], a[84:87], v[132:135]
    s_branch gated_mix__ssm_conv_s5__swiglu_ffn__prompt_kernel_B_sk0
.p2align 12
gated_mix__ssm_conv_s5__swiglu_ffn__prompt_kernel_B_pg1_0:
    s_branch gated_mix__ssm_conv_s5__swiglu_ffn__prompt_kernel_B_pr1
gated_mix__ssm_conv_s5__swiglu_ffn__prompt_kernel_B_sk0:
    s_mul_i32 s72, s6, 9216
    ds_read_b64_tr_b16 v[54:55], v3 offset:25600
    v_min_u32 v22, 23, v0
    v_mfma_f32_16x16x32_bf16 v[136:139], v[40:43], a[88:91], v[136:139]
    ds_read_b64_tr_b16 v[56:57], v3 offset:20480
    v_lshlrev_b32 v22, 2, v22
    v_mfma_f32_16x16x32_bf16 v[140:143], v[40:43], a[92:95], v[140:143]
    ds_read_b64_tr_b16 v[58:59], v3 offset:21504
    v_mfma_f32_16x16x32_bf16 v[144:147], v[44:47], a[80:83], v[144:147]
    ds_read_b64_tr_b16 v[60:61], v3 offset:28672
    v_mfma_f32_16x16x32_bf16 v[148:151], v[44:47], a[84:87], v[148:151]
    ds_read_b64_tr_b16 v[62:63], v3 offset:29696
    v_mfma_f32_16x16x32_bf16 v[152:155], v[44:47], a[88:91], v[152:155]
    v_mfma_f32_16x16x32_bf16 v[156:159], v[44:47], a[92:95], v[156:159]
    s_waitcnt lgkmcnt(4)
    v_mfma_f32_16x16x32_bf16 v[160:163], v[48:51], a[32:35], v[160:163]
    v_mfma_f32_16x16x32_bf16 v[164:167], v[48:51], a[36:39], v[164:167]
    s_waitcnt vmcnt(12) lgkmcnt(2)
    s_barrier
    v_mfma_f32_16x16x32_bf16 v[168:171], v[48:51], a[40:43], v[168:171]
    ds_read_b128 a[96:99], v34 offset:0
    v_mfma_f32_16x16x32_bf16 v[172:175], v[48:51], a[44:47], v[172:175]
    ds_read_b128 a[100:103], v34 offset:2048
    v_mfma_f32_16x16x32_bf16 v[176:179], v[52:55], a[32:35], v[176:179]
    ds_read_b128 a[104:107], v34 offset:4096
    v_mfma_f32_16x16x32_bf16 v[180:183], v[52:55], a[36:39], v[180:183]
    ds_read_b128 a[108:111], v34 offset:6144
    v_mfma_f32_16x16x32_bf16 v[184:187], v[52:55], a[40:43], v[184:187]
    ds_read_b128 a[112:115], v35 offset:0
    v_mfma_f32_16x16x32_bf16 v[188:191], v[52:55], a[44:47], v[188:191]
    ds_read_b128 a[116:119], v35 offset:2048
    v_mfma_f32_16x16x32_bf16 v[160:163], v[56:59], a[48:51], v[160:163]
    ds_read_b128 a[120:123], v35 offset:4096
    v_mfma_f32_16x16x32_bf16 v[164:167], v[56:59], a[52:55], v[164:167]
    ds_read_b128 a[124:127], v35 offset:6144
    v_mfma_f32_16x16x32_bf16 v[168:171], v[56:59], a[56:59], v[168:171]
    v_xor_b32 v4, 64, v4
    v_mfma_f32_16x16x32_bf16 v[172:175], v[56:59], a[60:63], v[172:175]
    s_waitcnt lgkmcnt(4)
    ds_read_b64_tr_b16 v[40:41], v4 offset:16384
    v_mfma_f32_16x16x32_bf16 v[176:179], v[60:63], a[48:51], v[176:179]
    s_waitcnt lgkmcnt(1)
    ds_read_b64_tr_b16 v[42:43], v4 offset:17408
    v_mfma_f32_16x16x32_bf16 v[180:183], v[60:63], a[52:55], v[180:183]
    s_add_u32 m0, s57, 65536
    ds_read_b64_tr_b16 v[44:45], v4 offset:24576
    v_mfma_f32_16x16x32_bf16 v[184:187], v[60:63], a[56:59], v[184:187]
    ds_read_b64_tr_b16 v[46:47], v4 offset:25600
    v_mfma_f32_16x16x32_bf16 v[188:191], v[60:63], a[60:63], v[188:191]
    s_waitcnt lgkmcnt(2)
    ds_read_b64_tr_b16 v[48:49], v4 offset:20480
    v_mfma_f32_16x16x32_bf16 v[224:227], v[40:43], a[32:35], v[224:227]
    ds_read_b64_tr_b16 v[50:51], v4 offset:21504
    v_mfma_f32_16x16x32_bf16 v[228:231], v[40:43], a[36:39], v[228:231]
    buffer_load_dwordx4 v30, s[8:11], s49 offen offset:0  lds
    v_mfma_f32_16x16x32_bf16 v[232:235], v[40:43], a[40:43], v[232:235]
    ds_read_b64_tr_b16 v[52:53], v4 offset:28672
    v_mfma_f32_16x16x32_bf16 v[236:239], v[40:43], a[44:47], v[236:239]
    s_waitcnt lgkmcnt(3)
    ds_read_b64_tr_b16 v[54:55], v4 offset:29696
    v_mfma_f32_16x16x32_bf16 v[240:243], v[44:47], a[32:35], v[240:243]
    buffer_load_dwordx4 v31, s[8:11], s49 offen offset:1024  lds
    v_mfma_f32_16x16x32_bf16 v[244:247], v[44:47], a[36:39], v[244:247]
    buffer_load_dwordx4 v32, s[8:11], s49 offen offset:2048  lds
    v_mfma_f32_16x16x32_bf16 v[248:251], v[44:47], a[40:43], v[248:251]
    v_xor_b32 v3, 64, v3
    v_mfma_f32_16x16x32_bf16 v[252:255], v[44:47], a[44:47], v[252:255]
    s_waitcnt lgkmcnt(2)
    ds_read_b64_tr_b16 v[56:57], v3 offset:49152
    v_mfma_f32_16x16x32_bf16 v[224:227], v[48:51], a[48:51], v[224:227]
    ds_read_b64_tr_b16 v[58:59], v3 offset:50176
    v_mfma_f32_16x16x32_bf16 v[228:231], v[48:51], a[52:55], v[228:231]
    buffer_load_dwordx4 v33, s[8:11], s49 offen offset:3072  lds
    v_mfma_f32_16x16x32_bf16 v[232:235], v[48:51], a[56:59], v[232:235]
    s_add_u32 m0, s57, 69632
    ds_read_b64_tr_b16 v[60:61], v3 offset:57344
    v_mfma_f32_16x16x32_bf16 v[236:239], v[48:51], a[60:63], v[236:239]
    s_waitcnt lgkmcnt(3)
    ds_read_b64_tr_b16 v[62:63], v3 offset:58368
    v_mfma_f32_16x16x32_bf16 v[240:243], v[52:55], a[48:51], v[240:243]
    s_add_u32 s51, s49, 9216
    ds_read_b64_tr_b16 v[40:41], v3 offset:53248
    v_mfma_f32_16x16x32_bf16 v[244:247], v[52:55], a[52:55], v[244:247]
    buffer_load_dwordx4 v30, s[8:11], s51 offen offset:0  lds
    v_mfma_f32_16x16x32_bf16 v[248:251], v[52:55], a[56:59], v[248:251]
    ds_read_b64_tr_b16 v[42:43], v3 offset:54272
    v_mfma_f32_16x16x32_bf16 v[252:255], v[52:55], a[60:63], v[252:255]
    s_waitcnt lgkmcnt(4)
    ds_read_b64_tr_b16 v[44:45], v3 offset:61440
    v_mfma_f32_16x16x32_bf16 v[96:99], v[56:59], a[96:99], v[96:99]
    buffer_load_dwordx4 v31, s[8:11], s51 offen offset:1024  lds
    v_mfma_f32_16x16x32_bf16 v[100:103], v[56:59], a[100:103], v[100:103]
    buffer_load_dwordx4 v32, s[8:11], s51 offen offset:2048  lds
    v_mfma_f32_16x16x32_bf16 v[104:107], v[56:59], a[104:107], v[104:107]
    ds_read_b64_tr_b16 v[46:47], v3 offset:62464
    v_mfma_f32_16x16x32_bf16 v[108:111], v[56:59], a[108:111], v[108:111]
    s_waitcnt lgkmcnt(3)
    v_xor_b32 v4, 64, v4
    v_mfma_f32_16x16x32_bf16 v[112:115], v[60:63], a[96:99], v[112:115]
    buffer_load_dwordx4 v33, s[8:11], s51 offen offset:3072  lds
    v_mfma_f32_16x16x32_bf16 v[116:119], v[60:63], a[100:103], v[116:119]
    s_add_u32 s49, s49, 128
    ds_read_b64_tr_b16 v[48:49], v4 offset:49152
    v_mfma_f32_16x16x32_bf16 v[120:123], v[60:63], a[104:107], v[120:123]
    s_cmp_lg_u32 s49, 1152
    s_cselect_b32 s49, s49, 0
    ds_read_b64_tr_b16 v[50:51], v4 offset:50176
    v_mfma_f32_16x16x32_bf16 v[124:127], v[60:63], a[108:111], v[124:127]
    s_waitcnt lgkmcnt(3)
    ds_read_b64_tr_b16 v[52:53], v4 offset:57344
    v_mfma_f32_16x16x32_bf16 v[96:99], v[40:43], a[112:115], v[96:99]
    s_add_u32 vcc_lo, s45, 35840
    ds_read_b64_tr_b16 v[54:55], v4 offset:58368
    v_mfma_f32_16x16x32_bf16 v[100:103], v[40:43], a[116:119], v[100:103]
    s_lshl1_add_u32 m0, s74, 0
    ds_read_b64_tr_b16 v[56:57], v4 offset:53248
    v_mfma_f32_16x16x32_bf16 v[104:107], v[40:43], a[120:123], v[104:107]
    buffer_load_dwordx4 v2, s[12:15], s45 offen  lds
    v_mfma_f32_16x16x32_bf16 v[108:111], v[40:43], a[124:127], v[108:111]
    s_waitcnt lgkmcnt(4)
    ds_read_b64_tr_b16 v[58:59], v4 offset:54272
    v_mfma_f32_16x16x32_bf16 v[112:115], v[44:47], a[112:115], v[112:115]
    buffer_load_dwordx4 v2, s[12:15], vcc_lo offen offset:1024  lds
    v_mfma_f32_16x16x32_bf16 v[116:119], v[44:47], a[116:119], v[116:119]
    s_lshl1_add_u32 m0, s74, 8192
    ds_read_b64_tr_b16 v[60:61], v4 offset:61440
    v_mfma_f32_16x16x32_bf16 v[120:123], v[44:47], a[120:123], v[120:123]
    buffer_load_dwordx4 v2, s[16:19], s45 offen  lds
    v_mfma_f32_16x16x32_bf16 v[124:127], v[44:47], a[124:127], v[124:127]
    s_waitcnt lgkmcnt(2)
    ds_read_b64_tr_b16 v[62:63], v4 offset:62464
    v_mfma_f32_16x16x32_bf16 v[128:131], v[48:51], a[96:99], v[128:131]
    buffer_load_dwordx4 v2, s[16:19], vcc_lo offen offset:1024  lds
    v_mfma_f32_16x16x32_bf16 v[132:135], v[48:51], a[100:103], v[132:135]
    v_xor_b32 v3, 64, v3
    v_mfma_f32_16x16x32_bf16 v[136:139], v[48:51], a[104:107], v[136:139]
    ds_read_b64_tr_b16 v[40:41], v3 offset:32768
    v_mfma_f32_16x16x32_bf16 v[140:143], v[48:51], a[108:111], v[140:143]
    ds_read_b64_tr_b16 v[42:43], v3 offset:33792
    v_mfma_f32_16x16x32_bf16 v[144:147], v[52:55], a[96:99], v[144:147]
    ds_read_b64_tr_b16 v[44:45], v3 offset:40960
    v_mfma_f32_16x16x32_bf16 v[148:151], v[52:55], a[100:103], v[148:151]
    ds_read_b64_tr_b16 v[46:47], v3 offset:41984
    v_mfma_f32_16x16x32_bf16 v[152:155], v[52:55], a[104:107], v[152:155]
    v_mfma_f32_16x16x32_bf16 v[156:159], v[52:55], a[108:111], v[156:159]
    s_waitcnt lgkmcnt(4)
    v_mfma_f32_16x16x32_bf16 v[128:131], v[56:59], a[112:115], v[128:131]
    ds_read_b64_tr_b16 v[48:49], v3 offset:36864
    v_mfma_f32_16x16x32_bf16 v[132:135], v[56:59], a[116:119], v[132:135]
    ds_read_b64_tr_b16 v[50:51], v3 offset:37888
    v_mfma_f32_16x16x32_bf16 v[136:139], v[56:59], a[120:123], v[136:139]
    v_mfma_f32_16x16x32_bf16 v[140:143], v[56:59], a[124:127], v[140:143]
    v_mfma_f32_16x16x32_bf16 v[144:147], v[60:63], a[112:115], v[144:147]
    ds_read_b64_tr_b16 v[52:53], v3 offset:45056
    v_mfma_f32_16x16x32_bf16 v[148:151], v[60:63], a[116:119], v[148:151]
    ds_read_b64_tr_b16 v[54:55], v3 offset:46080
    v_mfma_f32_16x16x32_bf16 v[152:155], v[60:63], a[120:123], v[152:155]
    v_mfma_f32_16x16x32_bf16 v[156:159], v[60:63], a[124:127], v[156:159]
    s_waitcnt lgkmcnt(2)
    v_mfma_f32_16x16x32_bf16 v[160:163], v[40:43], a[64:67], v[160:163]
    v_mfma_f32_16x16x32_bf16 v[164:167], v[40:43], a[68:71], v[164:167]
    s_waitcnt vmcnt(12)
    s_barrier
    v_mfma_f32_16x16x32_bf16 v[168:171], v[40:43], a[72:75], v[168:171]
    ds_read_b128 a[128:131], v34 offset:32768
    v_mfma_f32_16x16x32_bf16 v[172:175], v[40:43], a[76:79], v[172:175]
    ds_read_b128 a[132:135], v34 offset:34816
    v_mfma_f32_16x16x32_bf16 v[176:179], v[44:47], a[64:67], v[176:179]
    ds_read_b128 a[136:139], v34 offset:36864
    v_mfma_f32_16x16x32_bf16 v[180:183], v[44:47], a[68:71], v[180:183]
    ds_read_b128 a[140:143], v34 offset:38912
    v_mfma_f32_16x16x32_bf16 v[184:187], v[44:47], a[72:75], v[184:187]
    ds_read_b128 a[144:147], v35 offset:32768
    v_mfma_f32_16x16x32_bf16 v[188:191], v[44:47], a[76:79], v[188:191]
    ds_read_b128 a[148:151], v35 offset:34816
    v_mfma_f32_16x16x32_bf16 v[160:163], v[48:51], a[80:83], v[160:163]
    ds_read_b128 a[152:155], v35 offset:36864
    v_mfma_f32_16x16x32_bf16 v[164:167], v[48:51], a[84:87], v[164:167]
    ds_read_b128 a[156:159], v35 offset:38912
    v_mfma_f32_16x16x32_bf16 v[168:171], v[48:51], a[88:91], v[168:171]
    v_xor_b32 v4, 64, v4
    v_mfma_f32_16x16x32_bf16 v[172:175], v[48:51], a[92:95], v[172:175]
    s_waitcnt lgkmcnt(4)
    ds_read_b64_tr_b16 v[56:57], v4 offset:32768
    v_mfma_f32_16x16x32_bf16 v[176:179], v[52:55], a[80:83], v[176:179]
    s_waitcnt lgkmcnt(1)
    ds_read_b64_tr_b16 v[58:59], v4 offset:33792
    v_mfma_f32_16x16x32_bf16 v[180:183], v[52:55], a[84:87], v[180:183]
    s_add_u32 m0, s57, 98304
    ds_read_b64_tr_b16 v[60:61], v4 offset:40960
    v_mfma_f32_16x16x32_bf16 v[184:187], v[52:55], a[88:91], v[184:187]
    ds_read_b64_tr_b16 v[62:63], v4 offset:41984
    v_mfma_f32_16x16x32_bf16 v[188:191], v[52:55], a[92:95], v[188:191]
    s_waitcnt lgkmcnt(2)
    ds_read_b64_tr_b16 v[40:41], v4 offset:36864
    v_mfma_f32_16x16x32_bf16 v[224:227], v[56:59], a[64:67], v[224:227]
    ds_read_b64_tr_b16 v[42:43], v4 offset:37888
    v_mfma_f32_16x16x32_bf16 v[228:231], v[56:59], a[68:71], v[228:231]
    buffer_load_dwordx4 v30, s[8:11], s49 offen offset:0  lds
    v_mfma_f32_16x16x32_bf16 v[232:235], v[56:59], a[72:75], v[232:235]
    ds_read_b64_tr_b16 v[44:45], v4 offset:45056
    v_mfma_f32_16x16x32_bf16 v[236:239], v[56:59], a[76:79], v[236:239]
    s_waitcnt lgkmcnt(3)
    ds_read_b64_tr_b16 v[46:47], v4 offset:46080
    v_mfma_f32_16x16x32_bf16 v[240:243], v[60:63], a[64:67], v[240:243]
    buffer_load_dwordx4 v31, s[8:11], s49 offen offset:1024  lds
    v_mfma_f32_16x16x32_bf16 v[244:247], v[60:63], a[68:71], v[244:247]
    buffer_load_dwordx4 v32, s[8:11], s49 offen offset:2048  lds
    v_mfma_f32_16x16x32_bf16 v[248:251], v[60:63], a[72:75], v[248:251]
    v_xor_b32 v3, 64, v3
    v_mfma_f32_16x16x32_bf16 v[252:255], v[60:63], a[76:79], v[252:255]
    s_waitcnt lgkmcnt(2)
    v_add_u32 v3, 0x20000, v3
    v_mfma_f32_16x16x32_bf16 v[224:227], v[40:43], a[80:83], v[224:227]
    ds_read_b64_tr_b16 v[48:49], v3 offset:0
    v_mfma_f32_16x16x32_bf16 v[228:231], v[40:43], a[84:87], v[228:231]
    ds_read_b64_tr_b16 v[50:51], v3 offset:1024
    v_mfma_f32_16x16x32_bf16 v[232:235], v[40:43], a[88:91], v[232:235]
    ds_read_b64_tr_b16 v[52:53], v3 offset:8192
    v_mfma_f32_16x16x32_bf16 v[236:239], v[40:43], a[92:95], v[236:239]
    s_waitcnt lgkmcnt(3)
    ds_read_b64_tr_b16 v[54:55], v3 offset:9216
    v_mfma_f32_16x16x32_bf16 v[240:243], v[44:47], a[80:83], v[240:243]
    buffer_load_dwordx4 v33, s[8:11], s49 offen offset:3072  lds
    v_mfma_f32_16x16x32_bf16 v[244:247], v[44:47], a[84:87], v[244:247]
    s_add_u32 m0, s57, 102400
    ds_read_b64_tr_b16 v[56:57], v3 offset:4096
    v_mfma_f32_16x16x32_bf16 v[248:251], v[44:47], a[88:91], v[248:251]
    s_add_u32 s51, s49, 9216
    ds_read_b64_tr_b16 v[58:59], v3 offset:5120
    v_mfma_f32_16x16x32_bf16 v[252:255], v[44:47], a[92:95], v[252:255]
    s_waitcnt lgkmcnt(4)
    ds_read_b64_tr_b16 v[60:61], v3 offset:12288
    v_mfma_f32_16x16x32_bf16 v[96:99], v[48:51], a[128:131], v[96:99]
    buffer_load_dwordx4 v30, s[8:11], s51 offen offset:0  lds
    v_mfma_f32_16x16x32_bf16 v[100:103], v[48:51], a[132:135], v[100:103]
    buffer_load_dwordx4 v31, s[8:11], s51 offen offset:1024  lds
    v_mfma_f32_16x16x32_bf16 v[104:107], v[48:51], a[136:139], v[104:107]
    ds_read_b64_tr_b16 v[62:63], v3 offset:13312
    v_mfma_f32_16x16x32_bf16 v[108:111], v[48:51], a[140:143], v[108:111]
    s_waitcnt lgkmcnt(3)
    v_xor_b32 v4, 64, v4
    v_mfma_f32_16x16x32_bf16 v[112:115], v[52:55], a[128:131], v[112:115]
    buffer_load_dwordx4 v32, s[8:11], s51 offen offset:2048  lds
    v_mfma_f32_16x16x32_bf16 v[116:119], v[52:55], a[132:135], v[116:119]
    buffer_load_dwordx4 v33, s[8:11], s51 offen offset:3072  lds
    v_mfma_f32_16x16x32_bf16 v[120:123], v[52:55], a[136:139], v[120:123]
    s_add_u32 s49, s49, 128
    v_add_u32 v4, 0x20000, v4
    v_mfma_f32_16x16x32_bf16 v[124:127], v[52:55], a[140:143], v[124:127]
    s_waitcnt lgkmcnt(1)
    ds_read_b64_tr_b16 v[40:41], v4 offset:0
    v_mfma_f32_16x16x32_bf16 v[96:99], v[56:59], a[144:147], v[96:99]
    s_cmp_lg_u32 s49, 1152
    s_cselect_b32 s49, s49, 0
    ds_read_b64_tr_b16 v[42:43], v4 offset:1024
    v_mfma_f32_16x16x32_bf16 v[100:103], v[56:59], a[148:151], v[100:103]
    s_add_u32 vcc_lo, s46, 35840
    ds_read_b64_tr_b16 v[44:45], v4 offset:8192
    v_mfma_f32_16x16x32_bf16 v[104:107], v[56:59], a[152:155], v[104:107]
    s_lshl1_add_u32 m0, s74, 16384
    ds_read_b64_tr_b16 v[46:47], v4 offset:9216
    v_mfma_f32_16x16x32_bf16 v[108:111], v[56:59], a[156:159], v[108:111]
    s_waitcnt lgkmcnt(4)
    ds_read_b64_tr_b16 v[48:49], v4 offset:4096
    v_mfma_f32_16x16x32_bf16 v[112:115], v[60:63], a[144:147], v[112:115]
    buffer_load_dwordx4 v2, s[12:15], s46 offen  lds
    v_mfma_f32_16x16x32_bf16 v[116:119], v[60:63], a[148:151], v[116:119]
    buffer_load_dwordx4 v2, s[12:15], vcc_lo offen offset:1024  lds
    v_mfma_f32_16x16x32_bf16 v[120:123], v[60:63], a[152:155], v[120:123]
    s_lshl1_add_u32 m0, s74, 24576
    ds_read_b64_tr_b16 v[50:51], v4 offset:5120
    v_mfma_f32_16x16x32_bf16 v[124:127], v[60:63], a[156:159], v[124:127]
    s_waitcnt lgkmcnt(3)
    ds_read_b64_tr_b16 v[52:53], v4 offset:12288
    v_mfma_f32_16x16x32_bf16 v[128:131], v[40:43], a[128:131], v[128:131]
    buffer_load_dwordx4 v2, s[16:19], s46 offen  lds
    v_mfma_f32_16x16x32_bf16 v[132:135], v[40:43], a[132:135], v[132:135]
    buffer_load_dwordx4 v2, s[16:19], vcc_lo offen offset:1024  lds
    v_mfma_f32_16x16x32_bf16 v[136:139], v[40:43], a[136:139], v[136:139]
    ds_read_b64_tr_b16 v[54:55], v4 offset:13312
    v_mfma_f32_16x16x32_bf16 v[140:143], v[40:43], a[140:143], v[140:143]
    s_waitcnt lgkmcnt(3)
    v_xor_b32 v3, 64, v3
    v_mfma_f32_16x16x32_bf16 v[144:147], v[44:47], a[128:131], v[144:147]
    v_add_u32 v3, 0xfffe0000, v3
    v_mfma_f32_16x16x32_bf16 v[148:151], v[44:47], a[132:135], v[148:151]
    ds_read_b64_tr_b16 v[56:57], v3 offset:49152
    v_mfma_f32_16x16x32_bf16 v[152:155], v[44:47], a[136:139], v[152:155]
    ds_read_b64_tr_b16 v[58:59], v3 offset:50176
    v_mfma_f32_16x16x32_bf16 v[156:159], v[44:47], a[140:143], v[156:159]
    s_waitcnt lgkmcnt(3)
    ds_read_b64_tr_b16 v[60:61], v3 offset:57344
    v_mfma_f32_16x16x32_bf16 v[128:131], v[48:51], a[144:147], v[128:131]
    ds_read_b64_tr_b16 v[62:63], v3 offset:58368
    v_mfma_f32_16x16x32_bf16 v[132:135], v[48:51], a[148:151], v[132:135]
    ds_read_b64_tr_b16 v[40:41], v3 offset:53248
    v_mfma_f32_16x16x32_bf16 v[136:139], v[48:51], a[152:155], v[136:139]
    ds_read_b64_tr_b16 v[42:43], v3 offset:54272
    v_mfma_f32_16x16x32_bf16 v[140:143], v[48:51], a[156:159], v[140:143]
    s_waitcnt lgkmcnt(5)
    v_mfma_f32_16x16x32_bf16 v[144:147], v[52:55], a[144:147], v[144:147]
    ds_read_b64_tr_b16 v[44:45], v3 offset:61440
    v_mfma_f32_16x16x32_bf16 v[148:151], v[52:55], a[148:151], v[148:151]
    ds_read_b64_tr_b16 v[46:47], v3 offset:62464
    v_mfma_f32_16x16x32_bf16 v[152:155], v[52:55], a[152:155], v[152:155]
    v_mfma_f32_16x16x32_bf16 v[156:159], v[52:55], a[156:159], v[156:159]
    s_waitcnt lgkmcnt(3)
    v_mfma_f32_16x16x32_bf16 v[160:163], v[56:59], a[96:99], v[160:163]
    v_mfma_f32_16x16x32_bf16 v[164:167], v[56:59], a[100:103], v[164:167]
    s_waitcnt vmcnt(12) lgkmcnt(2)
    s_barrier
    v_mfma_f32_16x16x32_bf16 v[168:171], v[56:59], a[104:107], v[168:171]
    ds_read_b128 a[160:163], v34 offset:0
    v_mfma_f32_16x16x32_bf16 v[172:175], v[56:59], a[108:111], v[172:175]
    ds_read_b128 a[164:167], v34 offset:2048
    v_mfma_f32_16x16x32_bf16 v[176:179], v[60:63], a[96:99], v[176:179]
    ds_read_b128 a[168:171], v34 offset:4096
    v_mfma_f32_16x16x32_bf16 v[180:183], v[60:63], a[100:103], v[180:183]
    ds_read_b128 a[172:175], v34 offset:6144
    v_mfma_f32_16x16x32_bf16 v[184:187], v[60:63], a[104:107], v[184:187]
    ds_read_b128 a[176:179], v35 offset:0
    v_mfma_f32_16x16x32_bf16 v[188:191], v[60:63], a[108:111], v[188:191]
    ds_read_b128 a[180:183], v35 offset:2048
    v_mfma_f32_16x16x32_bf16 v[160:163], v[40:43], a[112:115], v[160:163]
    ds_read_b128 a[184:187], v35 offset:4096
    v_mfma_f32_16x16x32_bf16 v[164:167], v[40:43], a[116:119], v[164:167]
    ds_read_b128 a[188:191], v35 offset:6144
    v_mfma_f32_16x16x32_bf16 v[168:171], v[40:43], a[120:123], v[168:171]
    v_xor_b32 v4, 64, v4
    v_mfma_f32_16x16x32_bf16 v[172:175], v[40:43], a[124:127], v[172:175]
    s_waitcnt lgkmcnt(4)
    v_add_u32 v4, 0xfffe0000, v4
    v_mfma_f32_16x16x32_bf16 v[176:179], v[44:47], a[112:115], v[176:179]
    s_waitcnt lgkmcnt(0)
    ds_read_b64_tr_b16 v[48:49], v4 offset:49152
    v_mfma_f32_16x16x32_bf16 v[180:183], v[44:47], a[116:119], v[180:183]
    s_add_u32 m0, s57, 65536
    ds_read_b64_tr_b16 v[50:51], v4 offset:50176
    v_mfma_f32_16x16x32_bf16 v[184:187], v[44:47], a[120:123], v[184:187]
    ds_read_b64_tr_b16 v[52:53], v4 offset:57344
    v_mfma_f32_16x16x32_bf16 v[188:191], v[44:47], a[124:127], v[188:191]
    s_waitcnt lgkmcnt(1)
    ds_read_b64_tr_b16 v[54:55], v4 offset:58368
    v_mfma_f32_16x16x32_bf16 v[224:227], v[48:51], a[96:99], v[224:227]
    ds_read_b64_tr_b16 v[56:57], v4 offset:53248
    v_mfma_f32_16x16x32_bf16 v[228:231], v[48:51], a[100:103], v[228:231]
    ds_read_b64_tr_b16 v[58:59], v4 offset:54272
    v_mfma_f32_16x16x32_bf16 v[232:235], v[48:51], a[104:107], v[232:235]
    ds_read_b64_tr_b16 v[60:61], v4 offset:61440
    v_mfma_f32_16x16x32_bf16 v[236:239], v[48:51], a[108:111], v[236:239]
    s_waitcnt lgkmcnt(3)
    ds_read_b64_tr_b16 v[62:63], v4 offset:62464
    v_mfma_f32_16x16x32_bf16 v[240:243], v[52:55], a[96:99], v[240:243]
    buffer_load_dwordx4 v30, s[8:11], s49 offen offset:0  lds
    v_mfma_f32_16x16x32_bf16 v[244:247], v[52:55], a[100:103], v[244:247]
    buffer_load_dwordx4 v31, s[8:11], s49 offen offset:1024  lds
    v_mfma_f32_16x16x32_bf16 v[248:251], v[52:55], a[104:107], v[248:251]
    v_xor_b32 v3, 64, v3
    v_mfma_f32_16x16x32_bf16 v[252:255], v[52:55], a[108:111], v[252:255]
    s_waitcnt lgkmcnt(2)
    ds_read_b64_tr_b16 v[40:41], v3 offset:0
    v_mfma_f32_16x16x32_bf16 v[224:227], v[56:59], a[112:115], v[224:227]
    ds_read_b64_tr_b16 v[42:43], v3 offset:1024
    v_mfma_f32_16x16x32_bf16 v[228:231], v[56:59], a[116:119], v[228:231]
    buffer_load_dwordx4 v32, s[8:11], s49 offen offset:2048  lds
    v_mfma_f32_16x16x32_bf16 v[232:235], v[56:59], a[120:123], v[232:235]
    ds_read_b64_tr_b16 v[44:45], v3 offset:8192
    v_mfma_f32_16x16x32_bf16 v[236:239], v[56:59], a[124:127], v[236:239]
    s_waitcnt lgkmcnt(3)
    ds_read_b64_tr_b16 v[46:47], v3 offset:9216
    v_mfma_f32_16x16x32_bf16 v[240:243], v[60:63], a[112:115], v[240:243]
    buffer_load_dwordx4 v33, s[8:11], s49 offen offset:3072  lds
    v_mfma_f32_16x16x32_bf16 v[244:247], v[60:63], a[116:119], v[244:247]
    s_add_u32 m0, s57, 69632
    ds_read_b64_tr_b16 v[48:49], v3 offset:4096
    v_mfma_f32_16x16x32_bf16 v[248:251], v[60:63], a[120:123], v[248:251]
    s_add_u32 s51, s49, 9216
    ds_read_b64_tr_b16 v[50:51], v3 offset:5120
    v_mfma_f32_16x16x32_bf16 v[252:255], v[60:63], a[124:127], v[252:255]
    s_waitcnt lgkmcnt(4)
    ds_read_b64_tr_b16 v[52:53], v3 offset:12288
    v_mfma_f32_16x16x32_bf16 v[96:99], v[40:43], a[160:163], v[96:99]
    buffer_load_dwordx4 v30, s[8:11], s51 offen offset:0  lds
    v_mfma_f32_16x16x32_bf16 v[100:103], v[40:43], a[164:167], v[100:103]
    buffer_load_dwordx4 v31, s[8:11], s51 offen offset:1024  lds
    v_mfma_f32_16x16x32_bf16 v[104:107], v[40:43], a[168:171], v[104:107]
    ds_read_b64_tr_b16 v[54:55], v3 offset:13312
    v_mfma_f32_16x16x32_bf16 v[108:111], v[40:43], a[172:175], v[108:111]
    s_waitcnt lgkmcnt(3)
    v_xor_b32 v4, 64, v4
    v_mfma_f32_16x16x32_bf16 v[112:115], v[44:47], a[160:163], v[112:115]
    buffer_load_dwordx4 v32, s[8:11], s51 offen offset:2048  lds
    v_mfma_f32_16x16x32_bf16 v[116:119], v[44:47], a[164:167], v[116:119]
    buffer_load_dwordx4 v33, s[8:11], s51 offen offset:3072  lds
    v_mfma_f32_16x16x32_bf16 v[120:123], v[44:47], a[168:171], v[120:123]
    s_add_u32 s49, s49, 128
    ds_read_b64_tr_b16 v[56:57], v4 offset:0
    v_mfma_f32_16x16x32_bf16 v[124:127], v[44:47], a[172:175], v[124:127]
    s_waitcnt lgkmcnt(2)
    ds_read_b64_tr_b16 v[58:59], v4 offset:1024
    v_mfma_f32_16x16x32_bf16 v[96:99], v[48:51], a[176:179], v[96:99]
    s_cmp_lg_u32 s49, 1152
    s_cselect_b32 s49, s49, 0
    ds_read_b64_tr_b16 v[60:61], v4 offset:8192
    v_mfma_f32_16x16x32_bf16 v[100:103], v[48:51], a[180:183], v[100:103]
    s_add_u32 vcc_lo, s47, 35840
    ds_read_b64_tr_b16 v[62:63], v4 offset:9216
    v_mfma_f32_16x16x32_bf16 v[104:107], v[48:51], a[184:187], v[104:107]
    s_lshl1_add_u32 m0, s74, 32768
    ds_read_b64_tr_b16 v[40:41], v4 offset:4096
    v_mfma_f32_16x16x32_bf16 v[108:111], v[48:51], a[188:191], v[108:111]
    s_waitcnt lgkmcnt(5)
    ds_read_b64_tr_b16 v[42:43], v4 offset:5120
    v_mfma_f32_16x16x32_bf16 v[112:115], v[52:55], a[176:179], v[112:115]
    buffer_load_dwordx4 v2, s[12:15], s47 offen  lds
    v_mfma_f32_16x16x32_bf16 v[116:119], v[52:55], a[180:183], v[116:119]
    buffer_load_dwordx4 v2, s[12:15], vcc_lo offen offset:1024  lds
    v_mfma_f32_16x16x32_bf16 v[120:123], v[52:55], a[184:187], v[120:123]
    s_lshl1_add_u32 m0, s74, 40960
    ds_read_b64_tr_b16 v[44:45], v4 offset:12288
    v_mfma_f32_16x16x32_bf16 v[124:127], v[52:55], a[188:191], v[124:127]
    s_waitcnt lgkmcnt(3)
    ds_read_b64_tr_b16 v[46:47], v4 offset:13312
    v_mfma_f32_16x16x32_bf16 v[128:131], v[56:59], a[160:163], v[128:131]
    buffer_load_dwordx4 v2, s[16:19], s47 offen  lds
    v_mfma_f32_16x16x32_bf16 v[132:135], v[56:59], a[164:167], v[132:135]
    buffer_load_dwordx4 v2, s[16:19], vcc_lo offen offset:1024  lds
    v_mfma_f32_16x16x32_bf16 v[136:139], v[56:59], a[168:171], v[136:139]
    v_xor_b32 v3, 64, v3
    v_mfma_f32_16x16x32_bf16 v[140:143], v[56:59], a[172:175], v[140:143]
    v_add_u32 v3, 0x20000, v3
    v_mfma_f32_16x16x32_bf16 v[144:147], v[60:63], a[160:163], v[144:147]
    ds_read_b64_tr_b16 v[48:49], v3 offset:0
    v_mfma_f32_16x16x32_bf16 v[148:151], v[60:63], a[164:167], v[148:151]
    ds_read_b64_tr_b16 v[50:51], v3 offset:1024
    v_mfma_f32_16x16x32_bf16 v[152:155], v[60:63], a[168:171], v[152:155]
    ds_read_b64_tr_b16 v[52:53], v3 offset:8192
    v_mfma_f32_16x16x32_bf16 v[156:159], v[60:63], a[172:175], v[156:159]
    s_waitcnt lgkmcnt(3)
    ds_read_b64_tr_b16 v[54:55], v3 offset:9216
    v_mfma_f32_16x16x32_bf16 v[128:131], v[40:43], a[176:179], v[128:131]
    ds_read_b64_tr_b16 v[56:57], v3 offset:4096
    v_mfma_f32_16x16x32_bf16 v[132:135], v[40:43], a[180:183], v[132:135]
    ds_read_b64_tr_b16 v[58:59], v3 offset:5120
    v_mfma_f32_16x16x32_bf16 v[136:139], v[40:43], a[184:187], v[136:139]
    v_mfma_f32_16x16x32_bf16 v[140:143], v[40:43], a[188:191], v[140:143]
    v_mfma_f32_16x16x32_bf16 v[144:147], v[44:47], a[176:179], v[144:147]
    ds_read_b64_tr_b16 v[60:61], v3 offset:12288
    v_mfma_f32_16x16x32_bf16 v[148:151], v[44:47], a[180:183], v[148:151]
    ds_read_b64_tr_b16 v[62:63], v3 offset:13312
    v_mfma_f32_16x16x32_bf16 v[152:155], v[44:47], a[184:187], v[152:155]
    v_mfma_f32_16x16x32_bf16 v[156:159], v[44:47], a[188:191], v[156:159]
    s_waitcnt lgkmcnt(2)
    v_mfma_f32_16x16x32_bf16 v[160:163], v[48:51], a[128:131], v[160:163]
    v_mfma_f32_16x16x32_bf16 v[164:167], v[48:51], a[132:135], v[164:167]
    s_waitcnt vmcnt(12)
    s_barrier
    v_mfma_f32_16x16x32_bf16 v[168:171], v[48:51], a[136:139], v[168:171]
    ds_read_b128 a[192:195], v34 offset:32768
    v_mfma_f32_16x16x32_bf16 v[172:175], v[48:51], a[140:143], v[172:175]
    ds_read_b128 a[196:199], v34 offset:34816
    v_mfma_f32_16x16x32_bf16 v[176:179], v[52:55], a[128:131], v[176:179]
    ds_read_b128 a[200:203], v34 offset:36864
    v_mfma_f32_16x16x32_bf16 v[180:183], v[52:55], a[132:135], v[180:183]
    ds_read_b128 a[204:207], v34 offset:38912
    v_mfma_f32_16x16x32_bf16 v[184:187], v[52:55], a[136:139], v[184:187]
    ds_read_b128 a[208:211], v35 offset:32768
    v_mfma_f32_16x16x32_bf16 v[188:191], v[52:55], a[140:143], v[188:191]
    ds_read_b128 a[212:215], v35 offset:34816
    v_mfma_f32_16x16x32_bf16 v[160:163], v[56:59], a[144:147], v[160:163]
    ds_read_b128 a[216:219], v35 offset:36864
    v_mfma_f32_16x16x32_bf16 v[164:167], v[56:59], a[148:151], v[164:167]
    ds_read_b128 a[220:223], v35 offset:38912
    v_mfma_f32_16x16x32_bf16 v[168:171], v[56:59], a[152:155], v[168:171]
    v_xor_b32 v4, 64, v4
    v_mfma_f32_16x16x32_bf16 v[172:175], v[56:59], a[156:159], v[172:175]
    s_waitcnt lgkmcnt(4)
    v_add_u32 v4, 0x20000, v4
    v_mfma_f32_16x16x32_bf16 v[176:179], v[60:63], a[144:147], v[176:179]
    s_waitcnt lgkmcnt(0)
    ds_read_b64_tr_b16 v[40:41], v4 offset:0
    v_mfma_f32_16x16x32_bf16 v[180:183], v[60:63], a[148:151], v[180:183]
    s_add_u32 m0, s57, 98304
    ds_read_b64_tr_b16 v[42:43], v4 offset:1024
    v_mfma_f32_16x16x32_bf16 v[184:187], v[60:63], a[152:155], v[184:187]
    ds_read_b64_tr_b16 v[44:45], v4 offset:8192
    v_mfma_f32_16x16x32_bf16 v[188:191], v[60:63], a[156:159], v[188:191]
    s_waitcnt lgkmcnt(1)
    ds_read_b64_tr_b16 v[46:47], v4 offset:9216
    v_mfma_f32_16x16x32_bf16 v[224:227], v[40:43], a[128:131], v[224:227]
    ds_read_b64_tr_b16 v[48:49], v4 offset:4096
    v_mfma_f32_16x16x32_bf16 v[228:231], v[40:43], a[132:135], v[228:231]
    ds_read_b64_tr_b16 v[50:51], v4 offset:5120
    v_mfma_f32_16x16x32_bf16 v[232:235], v[40:43], a[136:139], v[232:235]
    ds_read_b64_tr_b16 v[52:53], v4 offset:12288
    v_mfma_f32_16x16x32_bf16 v[236:239], v[40:43], a[140:143], v[236:239]
    s_waitcnt lgkmcnt(3)
    ds_read_b64_tr_b16 v[54:55], v4 offset:13312
    v_mfma_f32_16x16x32_bf16 v[240:243], v[44:47], a[128:131], v[240:243]
    buffer_load_dwordx4 v30, s[8:11], s49 offen offset:0  lds
    v_mfma_f32_16x16x32_bf16 v[244:247], v[44:47], a[132:135], v[244:247]
    buffer_load_dwordx4 v31, s[8:11], s49 offen offset:1024  lds
    v_mfma_f32_16x16x32_bf16 v[248:251], v[44:47], a[136:139], v[248:251]
    v_xor_b32 v3, 64, v3
    v_mfma_f32_16x16x32_bf16 v[252:255], v[44:47], a[140:143], v[252:255]
    s_waitcnt lgkmcnt(2)
    v_add_u32 v3, 0xfffe0000, v3
    v_mfma_f32_16x16x32_bf16 v[224:227], v[48:51], a[144:147], v[224:227]
    ds_read_b64_tr_b16 v[56:57], v3 offset:16384
    v_mfma_f32_16x16x32_bf16 v[228:231], v[48:51], a[148:151], v[228:231]
    ds_read_b64_tr_b16 v[58:59], v3 offset:17408
    v_mfma_f32_16x16x32_bf16 v[232:235], v[48:51], a[152:155], v[232:235]
    ds_read_b64_tr_b16 v[60:61], v3 offset:24576
    v_mfma_f32_16x16x32_bf16 v[236:239], v[48:51], a[156:159], v[236:239]
    s_waitcnt lgkmcnt(3)
    ds_read_b64_tr_b16 v[62:63], v3 offset:25600
    v_mfma_f32_16x16x32_bf16 v[240:243], v[52:55], a[144:147], v[240:243]
    buffer_load_dwordx4 v32, s[8:11], s49 offen offset:2048  lds
    v_mfma_f32_16x16x32_bf16 v[244:247], v[52:55], a[148:151], v[244:247]
    buffer_load_dwordx4 v33, s[8:11], s49 offen offset:3072  lds
    v_mfma_f32_16x16x32_bf16 v[248:251], v[52:55], a[152:155], v[248:251]
    s_add_u32 m0, s57, 102400
    ds_read_b64_tr_b16 v[40:41], v3 offset:20480
    v_mfma_f32_16x16x32_bf16 v[252:255], v[52:55], a[156:159], v[252:255]
    s_waitcnt lgkmcnt(3)
    ds_read_b64_tr_b16 v[42:43], v3 offset:21504
    v_mfma_f32_16x16x32_bf16 v[96:99], v[56:59], a[192:195], v[96:99]
    s_add_u32 s51, s49, 9216
    ds_read_b64_tr_b16 v[44:45], v3 offset:28672
    v_mfma_f32_16x16x32_bf16 v[100:103], v[56:59], a[196:199], v[100:103]
    buffer_load_dwordx4 v30, s[8:11], s51 offen offset:0  lds
    v_mfma_f32_16x16x32_bf16 v[104:107], v[56:59], a[200:203], v[104:107]
    ds_read_b64_tr_b16 v[46:47], v3 offset:29696
    v_mfma_f32_16x16x32_bf16 v[108:111], v[56:59], a[204:207], v[108:111]
    s_waitcnt lgkmcnt(4)
    v_xor_b32 v4, 64, v4
    v_mfma_f32_16x16x32_bf16 v[112:115], v[60:63], a[192:195], v[112:115]
    buffer_load_dwordx4 v31, s[8:11], s51 offen offset:1024  lds
    v_mfma_f32_16x16x32_bf16 v[116:119], v[60:63], a[196:199], v[116:119]
    buffer_load_dwordx4 v32, s[8:11], s51 offen offset:2048  lds
    v_mfma_f32_16x16x32_bf16 v[120:123], v[60:63], a[200:203], v[120:123]
    v_add_u32 v4, 0xfffe0000, v4
    v_mfma_f32_16x16x32_bf16 v[124:127], v[60:63], a[204:207], v[124:127]
    s_waitcnt lgkmcnt(1)
    ds_read_b64_tr_b16 v[48:49], v4 offset:16384
    v_mfma_f32_16x16x32_bf16 v[96:99], v[40:43], a[208:211], v[96:99]
    ds_read_b64_tr_b16 v[50:51], v4 offset:17408
    v_mfma_f32_16x16x32_bf16 v[100:103], v[40:43], a[212:215], v[100:103]
    buffer_load_dwordx4 v33, s[8:11], s51 offen offset:3072  lds
    v_mfma_f32_16x16x32_bf16 v[104:107], v[40:43], a[216:219], v[104:107]
    s_branch gated_mix__ssm_conv_s5__swiglu_ffn__prompt_kernel_B_sk1
.p2align 12
gated_mix__ssm_conv_s5__swiglu_ffn__prompt_kernel_B_pg2_1:
    s_branch gated_mix__ssm_conv_s5__swiglu_ffn__prompt_kernel_B_pr2
gated_mix__ssm_conv_s5__swiglu_ffn__prompt_kernel_B_sk1:
    s_add_u32 vcc_lo, s48, 35840
    ds_read_b64_tr_b16 v[52:53], v4 offset:24576
    v_mfma_f32_16x16x32_bf16 v[108:111], v[40:43], a[220:223], v[108:111]
    s_waitcnt lgkmcnt(3)
    ds_read_b64_tr_b16 v[54:55], v4 offset:25600
    v_mfma_f32_16x16x32_bf16 v[112:115], v[44:47], a[208:211], v[112:115]
    s_lshl1_add_u32 m0, s74, 49152
    ds_read_b64_tr_b16 v[56:57], v4 offset:20480
    v_mfma_f32_16x16x32_bf16 v[116:119], v[44:47], a[212:215], v[116:119]
    buffer_load_dwordx4 v2, s[12:15], s48 offen  lds
    v_mfma_f32_16x16x32_bf16 v[120:123], v[44:47], a[216:219], v[120:123]
    ds_read_b64_tr_b16 v[58:59], v4 offset:21504
    v_mfma_f32_16x16x32_bf16 v[124:127], v[44:47], a[220:223], v[124:127]
    s_waitcnt lgkmcnt(4)
    ds_read_b64_tr_b16 v[60:61], v4 offset:28672
    v_mfma_f32_16x16x32_bf16 v[128:131], v[48:51], a[192:195], v[128:131]
    buffer_load_dwordx4 v2, s[12:15], vcc_lo offen offset:1024  lds
    v_mfma_f32_16x16x32_bf16 v[132:135], v[48:51], a[196:199], v[132:135]
    s_lshl1_add_u32 m0, s74, 57344
    ds_read_b64_tr_b16 v[62:63], v4 offset:29696
    v_mfma_f32_16x16x32_bf16 v[136:139], v[48:51], a[200:203], v[136:139]
    buffer_load_dwordx4 v2, s[16:19], s48 offen  lds
    v_mfma_f32_16x16x32_bf16 v[140:143], v[48:51], a[204:207], v[140:143]
    s_waitcnt lgkmcnt(3)
    v_xor_b32 v3, 64, v3
    v_mfma_f32_16x16x32_bf16 v[144:147], v[52:55], a[192:195], v[144:147]
    buffer_load_dwordx4 v2, s[16:19], vcc_lo offen offset:1024  lds
    v_mfma_f32_16x16x32_bf16 v[148:151], v[52:55], a[196:199], v[148:151]
    ds_read_b64_tr_b16 v[40:41], v3 offset:0
    v_add_u32 v2, 128, v2
    v_mfma_f32_16x16x32_bf16 v[152:155], v[52:55], a[200:203], v[152:155]
    s_add_u32 vcc_lo, s40, 35840
    ds_read_b64_tr_b16 v[42:43], v3 offset:1024
    v_mfma_f32_16x16x32_bf16 v[156:159], v[52:55], a[204:207], v[156:159]
    s_waitcnt lgkmcnt(2)
    ds_read_b64_tr_b16 v[44:45], v3 offset:8192
    v_mfma_f32_16x16x32_bf16 v[128:131], v[56:59], a[208:211], v[128:131]
    ds_read_b64_tr_b16 v[46:47], v3 offset:9216
    v_mfma_f32_16x16x32_bf16 v[132:135], v[56:59], a[212:215], v[132:135]
    ds_read_b64_tr_b16 v[48:49], v3 offset:4096
    v_mfma_f32_16x16x32_bf16 v[136:139], v[56:59], a[216:219], v[136:139]
    ds_read_b64_tr_b16 v[50:51], v3 offset:5120
    v_mfma_f32_16x16x32_bf16 v[140:143], v[56:59], a[220:223], v[140:143]
    v_mfma_f32_16x16x32_bf16 v[144:147], v[60:63], a[208:211], v[144:147]
    ds_read_b64_tr_b16 v[52:53], v3 offset:12288
    v_mfma_f32_16x16x32_bf16 v[148:151], v[60:63], a[212:215], v[148:151]
    ds_read_b64_tr_b16 v[54:55], v3 offset:13312
    v_mfma_f32_16x16x32_bf16 v[152:155], v[60:63], a[216:219], v[152:155]
    v_mfma_f32_16x16x32_bf16 v[156:159], v[60:63], a[220:223], v[156:159]
    s_waitcnt lgkmcnt(3)
    v_mfma_f32_16x16x32_bf16 v[160:163], v[40:43], a[160:163], v[160:163]
    v_mfma_f32_16x16x32_bf16 v[164:167], v[40:43], a[164:167], v[164:167]
    s_waitcnt vmcnt(12) lgkmcnt(2)
    s_barrier
    v_mfma_f32_16x16x32_bf16 v[168:171], v[40:43], a[168:171], v[168:171]
    s_lshl1_add_u32 m0, s74, 131072
    ds_read_b128 a[224:227], v34 offset:0
    v_mfma_f32_16x16x32_bf16 v[172:175], v[40:43], a[172:175], v[172:175]
    ds_read_b128 a[228:231], v34 offset:2048
    v_mfma_f32_16x16x32_bf16 v[176:179], v[44:47], a[160:163], v[176:179]
    ds_read_b128 a[232:235], v34 offset:4096
    v_mfma_f32_16x16x32_bf16 v[180:183], v[44:47], a[164:167], v[180:183]
    ds_read_b128 a[236:239], v34 offset:6144
    v_mfma_f32_16x16x32_bf16 v[184:187], v[44:47], a[168:171], v[184:187]
    ds_read_b128 a[240:243], v35 offset:0
    v_mfma_f32_16x16x32_bf16 v[188:191], v[44:47], a[172:175], v[188:191]
    ds_read_b128 a[244:247], v35 offset:2048
    v_mfma_f32_16x16x32_bf16 v[160:163], v[48:51], a[176:179], v[160:163]
    ds_read_b128 a[248:251], v35 offset:4096
    v_mfma_f32_16x16x32_bf16 v[164:167], v[48:51], a[180:183], v[164:167]
    ds_read_b128 a[252:255], v35 offset:6144
    v_mfma_f32_16x16x32_bf16 v[168:171], v[48:51], a[184:187], v[168:171]
    v_xor_b32 v4, 64, v4
    v_mfma_f32_16x16x32_bf16 v[172:175], v[48:51], a[188:191], v[172:175]
    s_waitcnt lgkmcnt(4)
    ds_read_b64_tr_b16 v[56:57], v4 offset:0
    v_mfma_f32_16x16x32_bf16 v[176:179], v[52:55], a[176:179], v[176:179]
    ds_read_b64_tr_b16 v[58:59], v4 offset:1024
    v_mfma_f32_16x16x32_bf16 v[180:183], v[52:55], a[180:183], v[180:183]
    ds_read_b64_tr_b16 v[60:61], v4 offset:8192
    v_mfma_f32_16x16x32_bf16 v[184:187], v[52:55], a[184:187], v[184:187]
    ds_read_b64_tr_b16 v[62:63], v4 offset:9216
    v_mfma_f32_16x16x32_bf16 v[188:191], v[52:55], a[188:191], v[188:191]
    s_waitcnt lgkmcnt(2)
    ds_read_b64_tr_b16 v[40:41], v4 offset:4096
    v_mfma_f32_16x16x32_bf16 v[224:227], v[56:59], a[160:163], v[224:227]
    ds_read_b64_tr_b16 v[42:43], v4 offset:5120
    v_mfma_f32_16x16x32_bf16 v[228:231], v[56:59], a[164:167], v[228:231]
    buffer_load_dwordx4 v2, s[12:15], s40 offen  lds
    v_mfma_f32_16x16x32_bf16 v[232:235], v[56:59], a[168:171], v[232:235]
    ds_read_b64_tr_b16 v[44:45], v4 offset:12288
    v_mfma_f32_16x16x32_bf16 v[236:239], v[56:59], a[172:175], v[236:239]
    s_waitcnt lgkmcnt(3)
    ds_read_b64_tr_b16 v[46:47], v4 offset:13312
    v_mfma_f32_16x16x32_bf16 v[240:243], v[60:63], a[160:163], v[240:243]
    s_barrier
    v_mfma_f32_16x16x32_bf16 v[244:247], v[60:63], a[164:167], v[244:247]
    buffer_load_dwordx4 v2, s[12:15], vcc_lo offen offset:1024  lds
    v_mfma_f32_16x16x32_bf16 v[248:251], v[60:63], a[168:171], v[248:251]
    s_lshl1_add_u32 m0, s74, 139264
    v_xor_b32 v3, 64, v3
    v_mfma_f32_16x16x32_bf16 v[252:255], v[60:63], a[172:175], v[252:255]
    s_waitcnt lgkmcnt(2)
    ds_read_b64_tr_b16 v[48:49], v3 offset:32768
    v_mfma_f32_16x16x32_bf16 v[224:227], v[40:43], a[176:179], v[224:227]
    ds_read_b64_tr_b16 v[50:51], v3 offset:33792
    v_mfma_f32_16x16x32_bf16 v[228:231], v[40:43], a[180:183], v[228:231]
    buffer_load_dwordx4 v2, s[16:19], s40 offen  lds
    v_mfma_f32_16x16x32_bf16 v[232:235], v[40:43], a[184:187], v[232:235]
    ds_read_b64_tr_b16 v[52:53], v3 offset:40960
    v_mfma_f32_16x16x32_bf16 v[236:239], v[40:43], a[188:191], v[236:239]
    s_waitcnt lgkmcnt(3)
    ds_read_b64_tr_b16 v[54:55], v3 offset:41984
    v_mfma_f32_16x16x32_bf16 v[240:243], v[44:47], a[176:179], v[240:243]
    ds_read_b64_tr_b16 v[56:57], v3 offset:36864
    v_mfma_f32_16x16x32_bf16 v[244:247], v[44:47], a[180:183], v[244:247]
    buffer_load_dwordx4 v2, s[16:19], vcc_lo offen offset:1024  lds
    v_mfma_f32_16x16x32_bf16 v[248:251], v[44:47], a[184:187], v[248:251]
    s_add_u32 vcc_lo, s41, 35840
    ds_read_b64_tr_b16 v[58:59], v3 offset:37888
    v_mfma_f32_16x16x32_bf16 v[252:255], v[44:47], a[188:191], v[252:255]
    s_waitcnt lgkmcnt(4)
    ds_read_b64_tr_b16 v[60:61], v3 offset:45056
    v_mfma_f32_16x16x32_bf16 v[96:99], v[48:51], a[224:227], v[96:99]
    s_lshl1_add_u32 m0, s74, 65536
    ds_read_b64_tr_b16 v[62:63], v3 offset:46080
    v_mfma_f32_16x16x32_bf16 v[100:103], v[48:51], a[228:231], v[100:103]
    buffer_load_dwordx4 v2, s[12:15], s41 offen  lds
    v_mfma_f32_16x16x32_bf16 v[104:107], v[48:51], a[232:235], v[104:107]
    v_xor_b32 v4, 64, v4
    v_mfma_f32_16x16x32_bf16 v[108:111], v[48:51], a[236:239], v[108:111]
    s_waitcnt lgkmcnt(3)
    ds_read_b64_tr_b16 v[40:41], v4 offset:32768
    v_mfma_f32_16x16x32_bf16 v[112:115], v[52:55], a[224:227], v[112:115]
    ds_read_b64_tr_b16 v[42:43], v4 offset:33792
    v_mfma_f32_16x16x32_bf16 v[116:119], v[52:55], a[228:231], v[116:119]
    buffer_load_dwordx4 v2, s[12:15], vcc_lo offen offset:1024  lds
    v_mfma_f32_16x16x32_bf16 v[120:123], v[52:55], a[232:235], v[120:123]
    s_lshl1_add_u32 m0, s74, 73728
    ds_read_b64_tr_b16 v[44:45], v4 offset:40960
    v_mfma_f32_16x16x32_bf16 v[124:127], v[52:55], a[236:239], v[124:127]
    s_waitcnt lgkmcnt(3)
    ds_read_b64_tr_b16 v[46:47], v4 offset:41984
    v_mfma_f32_16x16x32_bf16 v[96:99], v[56:59], a[240:243], v[96:99]
    ds_read_b64_tr_b16 v[48:49], v4 offset:36864
    v_mfma_f32_16x16x32_bf16 v[100:103], v[56:59], a[244:247], v[100:103]
    buffer_load_dwordx4 v2, s[16:19], s41 offen  lds
    v_mfma_f32_16x16x32_bf16 v[104:107], v[56:59], a[248:251], v[104:107]
    ds_read_b64_tr_b16 v[50:51], v4 offset:37888
    v_mfma_f32_16x16x32_bf16 v[108:111], v[56:59], a[252:255], v[108:111]
    v_mfma_f32_16x16x32_bf16 v[112:115], v[60:63], a[240:243], v[112:115]
    ds_read_b64_tr_b16 v[52:53], v4 offset:45056
    v_mfma_f32_16x16x32_bf16 v[116:119], v[60:63], a[244:247], v[116:119]
    buffer_load_dwordx4 v2, s[16:19], vcc_lo offen offset:1024  lds
    v_mfma_f32_16x16x32_bf16 v[120:123], v[60:63], a[248:251], v[120:123]
    s_add_u32 vcc_lo, s42, 35840
    ds_read_b64_tr_b16 v[54:55], v4 offset:46080
    v_mfma_f32_16x16x32_bf16 v[124:127], v[60:63], a[252:255], v[124:127]
    s_waitcnt lgkmcnt(3)
    s_lshl1_add_u32 m0, s74, 81920
    v_mfma_f32_16x16x32_bf16 v[128:131], v[40:43], a[224:227], v[128:131]
    v_xor_b32 v3, 64, v3
    v_mfma_f32_16x16x32_bf16 v[132:135], v[40:43], a[228:231], v[132:135]
    ds_read_b64_tr_b16 v[56:57], v3 offset:16384
    v_mfma_f32_16x16x32_bf16 v[136:139], v[40:43], a[232:235], v[136:139]
    ds_read_b64_tr_b16 v[58:59], v3 offset:17408
    v_mfma_f32_16x16x32_bf16 v[140:143], v[40:43], a[236:239], v[140:143]
    v_mfma_f32_16x16x32_bf16 v[144:147], v[44:47], a[224:227], v[144:147]
    ds_read_b64_tr_b16 v[60:61], v3 offset:24576
    v_mfma_f32_16x16x32_bf16 v[148:151], v[44:47], a[228:231], v[148:151]
    ds_read_b64_tr_b16 v[62:63], v3 offset:25600
    v_mfma_f32_16x16x32_bf16 v[152:155], v[44:47], a[232:235], v[152:155]
    v_mfma_f32_16x16x32_bf16 v[156:159], v[44:47], a[236:239], v[156:159]
    s_waitcnt lgkmcnt(3)
    v_mfma_f32_16x16x32_bf16 v[128:131], v[48:51], a[240:243], v[128:131]
    ds_read_b64_tr_b16 v[40:41], v3 offset:20480
    v_mfma_f32_16x16x32_bf16 v[132:135], v[48:51], a[244:247], v[132:135]
    ds_read_b64_tr_b16 v[42:43], v3 offset:21504
    v_mfma_f32_16x16x32_bf16 v[136:139], v[48:51], a[248:251], v[136:139]
    v_mfma_f32_16x16x32_bf16 v[140:143], v[48:51], a[252:255], v[140:143]
    v_mfma_f32_16x16x32_bf16 v[144:147], v[52:55], a[240:243], v[144:147]
    ds_read_b64_tr_b16 v[44:45], v3 offset:28672
    v_mfma_f32_16x16x32_bf16 v[148:151], v[52:55], a[244:247], v[148:151]
    ds_read_b64_tr_b16 v[46:47], v3 offset:29696
    v_mfma_f32_16x16x32_bf16 v[152:155], v[52:55], a[248:251], v[152:155]
    v_mfma_f32_16x16x32_bf16 v[156:159], v[52:55], a[252:255], v[156:159]
    s_waitcnt lgkmcnt(2)
    v_mfma_f32_16x16x32_bf16 v[160:163], v[56:59], a[192:195], v[160:163]
    v_mfma_f32_16x16x32_bf16 v[164:167], v[56:59], a[196:199], v[164:167]
    s_waitcnt vmcnt(8)
    s_barrier
    v_mfma_f32_16x16x32_bf16 v[168:171], v[56:59], a[200:203], v[168:171]
    ds_read_b128 v[64:67], v34 offset:32768
    v_mfma_f32_16x16x32_bf16 v[172:175], v[56:59], a[204:207], v[172:175]
    ds_read_b128 v[68:71], v34 offset:34816
    v_mfma_f32_16x16x32_bf16 v[176:179], v[60:63], a[192:195], v[176:179]
    ds_read_b128 v[72:75], v34 offset:36864
    v_mfma_f32_16x16x32_bf16 v[180:183], v[60:63], a[196:199], v[180:183]
    ds_read_b128 v[76:79], v34 offset:38912
    v_mfma_f32_16x16x32_bf16 v[184:187], v[60:63], a[200:203], v[184:187]
    ds_read_b128 v[80:83], v35 offset:32768
    v_mfma_f32_16x16x32_bf16 v[188:191], v[60:63], a[204:207], v[188:191]
    ds_read_b128 v[84:87], v35 offset:34816
    v_mfma_f32_16x16x32_bf16 v[160:163], v[40:43], a[208:211], v[160:163]
    ds_read_b128 v[88:91], v35 offset:36864
    v_mfma_f32_16x16x32_bf16 v[164:167], v[40:43], a[212:215], v[164:167]
    ds_read_b128 v[92:95], v35 offset:38912
    v_mfma_f32_16x16x32_bf16 v[168:171], v[40:43], a[216:219], v[168:171]
    v_xor_b32 v4, 64, v4
    v_mfma_f32_16x16x32_bf16 v[172:175], v[40:43], a[220:223], v[172:175]
    s_waitcnt lgkmcnt(4)
    ds_read_b64_tr_b16 v[48:49], v4 offset:16384
    v_mfma_f32_16x16x32_bf16 v[176:179], v[44:47], a[208:211], v[176:179]
    ds_read_b64_tr_b16 v[50:51], v4 offset:17408
    v_mfma_f32_16x16x32_bf16 v[180:183], v[44:47], a[212:215], v[180:183]
    ds_read_b64_tr_b16 v[52:53], v4 offset:24576
    v_mfma_f32_16x16x32_bf16 v[184:187], v[44:47], a[216:219], v[184:187]
    ds_read_b64_tr_b16 v[54:55], v4 offset:25600
    v_mfma_f32_16x16x32_bf16 v[188:191], v[44:47], a[220:223], v[188:191]
    s_waitcnt lgkmcnt(2)
    ds_read_b64_tr_b16 v[56:57], v4 offset:20480
    v_mfma_f32_16x16x32_bf16 v[224:227], v[48:51], a[192:195], v[224:227]
    ds_read_b64_tr_b16 v[58:59], v4 offset:21504
    v_mfma_f32_16x16x32_bf16 v[228:231], v[48:51], a[196:199], v[228:231]
    ds_read_b64_tr_b16 v[60:61], v4 offset:28672
    v_mfma_f32_16x16x32_bf16 v[232:235], v[48:51], a[200:203], v[232:235]
    ds_read_b64_tr_b16 v[62:63], v4 offset:29696
    v_mfma_f32_16x16x32_bf16 v[236:239], v[48:51], a[204:207], v[236:239]
    s_waitcnt lgkmcnt(4)
    s_barrier
    v_mfma_f32_16x16x32_bf16 v[240:243], v[52:55], a[192:195], v[240:243]
    v_xor_b32 v3, 64, v3
    v_mfma_f32_16x16x32_bf16 v[244:247], v[52:55], a[196:199], v[244:247]
    ds_read_b64_tr_b16 v[40:41], v3 offset:49152
    v_mfma_f32_16x16x32_bf16 v[248:251], v[52:55], a[200:203], v[248:251]
    ds_read_b64_tr_b16 v[42:43], v3 offset:50176
    v_mfma_f32_16x16x32_bf16 v[252:255], v[52:55], a[204:207], v[252:255]
    s_waitcnt lgkmcnt(3)
    ds_read_b64_tr_b16 v[44:45], v3 offset:57344
    v_mfma_f32_16x16x32_bf16 v[224:227], v[56:59], a[208:211], v[224:227]
    ds_read_b64_tr_b16 v[46:47], v3 offset:58368
    v_mfma_f32_16x16x32_bf16 v[228:231], v[56:59], a[212:215], v[228:231]
    ds_read_b64_tr_b16 v[48:49], v3 offset:53248
    v_mfma_f32_16x16x32_bf16 v[232:235], v[56:59], a[216:219], v[232:235]
    ds_read_b64_tr_b16 v[50:51], v3 offset:54272
    v_mfma_f32_16x16x32_bf16 v[236:239], v[56:59], a[220:223], v[236:239]
    s_waitcnt lgkmcnt(5)
    v_mfma_f32_16x16x32_bf16 v[240:243], v[60:63], a[208:211], v[240:243]
    ds_read_b64_tr_b16 v[52:53], v3 offset:61440
    v_mfma_f32_16x16x32_bf16 v[244:247], v[60:63], a[212:215], v[244:247]
    ds_read_b64_tr_b16 v[54:55], v3 offset:62464
    v_mfma_f32_16x16x32_bf16 v[248:251], v[60:63], a[216:219], v[248:251]
    v_mfma_f32_16x16x32_bf16 v[252:255], v[60:63], a[220:223], v[252:255]
    s_waitcnt lgkmcnt(3)
    s_barrier
    v_mfma_f32_16x16x32_bf16 v[96:99], v[40:43], v[64:67], v[96:99]
    v_xor_b32 v4, 64, v4
    v_mfma_f32_16x16x32_bf16 v[100:103], v[40:43], v[68:71], v[100:103]
    ds_read_b64_tr_b16 v[56:57], v4 offset:49152
    v_mfma_f32_16x16x32_bf16 v[104:107], v[40:43], v[72:75], v[104:107]
    ds_read_b64_tr_b16 v[58:59], v4 offset:50176
    v_mfma_f32_16x16x32_bf16 v[108:111], v[40:43], v[76:79], v[108:111]
    v_mfma_f32_16x16x32_bf16 v[112:115], v[44:47], v[64:67], v[112:115]
    ds_read_b64_tr_b16 v[60:61], v4 offset:57344
    v_mfma_f32_16x16x32_bf16 v[116:119], v[44:47], v[68:71], v[116:119]
    ds_read_b64_tr_b16 v[62:63], v4 offset:58368
    v_mfma_f32_16x16x32_bf16 v[120:123], v[44:47], v[72:75], v[120:123]
    v_mfma_f32_16x16x32_bf16 v[124:127], v[44:47], v[76:79], v[124:127]
    s_waitcnt lgkmcnt(3)
    v_mfma_f32_16x16x32_bf16 v[96:99], v[48:51], v[80:83], v[96:99]
    ds_read_b64_tr_b16 v[40:41], v4 offset:53248
    v_mfma_f32_16x16x32_bf16 v[100:103], v[48:51], v[84:87], v[100:103]
    ds_read_b64_tr_b16 v[42:43], v4 offset:54272
    v_mfma_f32_16x16x32_bf16 v[104:107], v[48:51], v[88:91], v[104:107]
    v_mfma_f32_16x16x32_bf16 v[108:111], v[48:51], v[92:95], v[108:111]
    v_mfma_f32_16x16x32_bf16 v[112:115], v[52:55], v[80:83], v[112:115]
    ds_read_b64_tr_b16 v[44:45], v4 offset:61440
    v_mfma_f32_16x16x32_bf16 v[116:119], v[52:55], v[84:87], v[116:119]
    ds_read_b64_tr_b16 v[46:47], v4 offset:62464
    v_mfma_f32_16x16x32_bf16 v[120:123], v[52:55], v[88:91], v[120:123]
    v_mfma_f32_16x16x32_bf16 v[124:127], v[52:55], v[92:95], v[124:127]
    s_waitcnt lgkmcnt(2)
    v_mfma_f32_16x16x32_bf16 v[128:131], v[56:59], v[64:67], v[128:131]
    v_xor_b32 v3, 64, v3
    v_mfma_f32_16x16x32_bf16 v[132:135], v[56:59], v[68:71], v[132:135]
    ds_read_b64_tr_b16 v[48:49], v3 offset:32768
    v_mul_f32 v112, v96, v112
    v_mfma_f32_16x16x32_bf16 v[136:139], v[56:59], v[72:75], v[136:139]
    ds_read_b64_tr_b16 v[50:51], v3 offset:33792
    v_mul_f32 v96, s56, v96
    v_mfma_f32_16x16x32_bf16 v[140:143], v[56:59], v[76:79], v[140:143]
    v_exp_f32 v96, v96
    v_mfma_f32_16x16x32_bf16 v[144:147], v[60:63], v[64:67], v[144:147]
    ds_read_b64_tr_b16 v[52:53], v3 offset:40960
    v_add_f32 v96, 1.0, v96
    v_mfma_f32_16x16x32_bf16 v[148:151], v[60:63], v[68:71], v[148:151]
    ds_read_b64_tr_b16 v[54:55], v3 offset:41984
    v_mul_f32 v116, v100, v116
    v_mfma_f32_16x16x32_bf16 v[152:155], v[60:63], v[72:75], v[152:155]
    v_rcp_f32 v96, v96
    v_mfma_f32_16x16x32_bf16 v[156:159], v[60:63], v[76:79], v[156:159]
    v_mul_f32 v96, v96, v112
    v_mul_f32 v113, v97, v113
    v_mfma_f32_16x16x32_bf16 v[128:131], v[40:43], v[80:83], v[128:131]
    ds_read_b64_tr_b16 v[56:57], v3 offset:36864
    v_mul_f32 v97, s56, v97
    v_mfma_f32_16x16x32_bf16 v[132:135], v[40:43], v[84:87], v[132:135]
    ds_read_b64_tr_b16 v[58:59], v3 offset:37888
    v_mul_f32 v100, s56, v100
    v_mfma_f32_16x16x32_bf16 v[136:139], v[40:43], v[88:91], v[136:139]
    v_exp_f32 v97, v97
    v_mfma_f32_16x16x32_bf16 v[140:143], v[40:43], v[92:95], v[140:143]
    s_waitcnt lgkmcnt(2)
    v_exp_f32 v100, v100
    v_mfma_f32_16x16x32_bf16 v[144:147], v[44:47], v[80:83], v[144:147]
    ds_read_b64_tr_b16 v[60:61], v3 offset:45056
    v_add_f32 v97, 1.0, v97
    v_mfma_f32_16x16x32_bf16 v[148:151], v[44:47], v[84:87], v[148:151]
    ds_read_b64_tr_b16 v[62:63], v3 offset:46080
    v_add_f32 v100, 1.0, v100
    v_mfma_f32_16x16x32_bf16 v[152:155], v[44:47], v[88:91], v[152:155]
    v_rcp_f32 v97, v97
    v_mfma_f32_16x16x32_bf16 v[156:159], v[44:47], v[92:95], v[156:159]
    buffer_load_dword v28, v29, s[52:55], 0 offen sc1
    v_mfma_f32_16x16x32_bf16 v[160:163], v[48:51], a[224:227], v[160:163]
    v_xor_b32 v4, 64, v4
    v_min_u32 v35, 40, v0
    v_mfma_f32_16x16x32_bf16 v[164:167], v[48:51], a[228:231], v[164:167]
    ds_read_b64_tr_b16 v[40:41], v4 offset:32768
    v_lshlrev_b32 v35, 7, v35
    v_mfma_f32_16x16x32_bf16 v[168:171], v[48:51], a[232:235], v[168:171]
    s_lshl_b32 s86, s80, 1
    ds_read_b64_tr_b16 v[42:43], v4 offset:33792
    v_mul_f32 v97, v97, v113
    v_mfma_f32_16x16x32_bf16 v[172:175], v[48:51], a[236:239], v[172:175]
    buffer_load_dwordx4 v2, s[12:15], s42 offen  lds
    v_mfma_f32_16x16x32_bf16 v[176:179], v[52:55], a[224:227], v[176:179]
    s_and_b32 s87, s6, 1
    ds_read_b64_tr_b16 v[44:45], v4 offset:40960
    v_cvt_pk_bf16_f32 v208, v96, v97
    v_mfma_f32_16x16x32_bf16 v[180:183], v[52:55], a[228:231], v[180:183]
    s_add_u32 s86, s86, s87
    ds_read_b64_tr_b16 v[46:47], v4 offset:41984
    v_mul_f32 v114, v98, v114
    v_mfma_f32_16x16x32_bf16 v[184:187], v[52:55], a[232:235], v[184:187]
    s_mul_i32 s86, s86, 5248
    v_rcp_f32 v100, v100
    v_mfma_f32_16x16x32_bf16 v[188:191], v[52:55], a[236:239], v[188:191]
    s_waitcnt lgkmcnt(3)
    v_mul_f32 v98, s56, v98
    s_mul_i32 s87, s85, 165888
    v_mfma_f32_16x16x32_bf16 v[160:163], v[56:59], a[240:243], v[160:163]
    buffer_load_dwordx4 v2, s[12:15], vcc_lo offen offset:1024  lds
    v_mfma_f32_16x16x32_bf16 v[164:167], v[56:59], a[244:247], v[164:167]
    s_add_u32 s86, s86, s87
    ds_read_b64_tr_b16 v[48:49], v4 offset:36864
    v_mul_f32 v100, v100, v116
    v_mfma_f32_16x16x32_bf16 v[168:171], v[56:59], a[248:251], v[168:171]
    s_lshl1_add_u32 m0, s74, 90112
    ds_read_b64_tr_b16 v[50:51], v4 offset:37888
    v_mul_f32 v117, v101, v117
    v_mfma_f32_16x16x32_bf16 v[172:175], v[56:59], a[252:255], v[172:175]
    v_exp_f32 v98, v98
    v_mfma_f32_16x16x32_bf16 v[176:179], v[60:63], a[240:243], v[176:179]
    buffer_load_dwordx4 v2, s[16:19], s42 offen  lds
    v_mfma_f32_16x16x32_bf16 v[180:183], v[60:63], a[244:247], v[180:183]
    ds_read_b64_tr_b16 v[52:53], v4 offset:45056
    v_add_f32 v98, 1.0, v98
    v_mfma_f32_16x16x32_bf16 v[184:187], v[60:63], a[248:251], v[184:187]
    ds_read_b64_tr_b16 v[54:55], v4 offset:46080
    v_mul_f32 v101, s56, v101
    v_mfma_f32_16x16x32_bf16 v[188:191], v[60:63], a[252:255], v[188:191]
    s_waitcnt lgkmcnt(3)
    v_rcp_f32 v98, v98
    v_mfma_f32_16x16x32_bf16 v[224:227], v[40:43], a[224:227], v[224:227]
    buffer_load_dwordx4 v2, s[16:19], vcc_lo offen offset:1024  lds
    v_mfma_f32_16x16x32_bf16 v[228:231], v[40:43], a[228:231], v[228:231]
    s_add_u32 vcc_lo, s43, 35840
    ds_read_b64_tr_b16 v[56:57], v3 offset:49152
    v_mul_f32 v98, v98, v114
    v_mfma_f32_16x16x32_bf16 v[232:235], v[40:43], a[232:235], v[232:235]
    s_lshl1_add_u32 m0, s74, 98304
    ds_read_b64_tr_b16 v[58:59], v3 offset:50176
    v_mul_f32 v115, v99, v115
    v_mfma_f32_16x16x32_bf16 v[236:239], v[40:43], a[236:239], v[236:239]
    v_exp_f32 v101, v101
    v_mfma_f32_16x16x32_bf16 v[240:243], v[44:47], a[224:227], v[240:243]
    buffer_load_dwordx4 v2, s[12:15], s43 offen  lds
    v_mfma_f32_16x16x32_bf16 v[244:247], v[44:47], a[228:231], v[244:247]
    ds_read_b64_tr_b16 v[60:61], v3 offset:57344
    v_mul_f32 v99, s56, v99
    v_mfma_f32_16x16x32_bf16 v[248:251], v[44:47], a[232:235], v[248:251]
    ds_read_b64_tr_b16 v[62:63], v3 offset:58368
    v_add_f32 v101, 1.0, v101
    v_mfma_f32_16x16x32_bf16 v[252:255], v[44:47], a[236:239], v[252:255]
    s_waitcnt lgkmcnt(3)
    v_exp_f32 v99, v99
    v_mfma_f32_16x16x32_bf16 v[224:227], v[48:51], a[240:243], v[224:227]
    buffer_load_dwordx4 v2, s[12:15], vcc_lo offen offset:1024  lds
    v_mfma_f32_16x16x32_bf16 v[228:231], v[48:51], a[244:247], v[228:231]
    s_lshl1_add_u32 m0, s74, 106496
    ds_read_b64_tr_b16 v[40:41], v3 offset:53248
    v_add_f32 v99, 1.0, v99
    v_mfma_f32_16x16x32_bf16 v[232:235], v[48:51], a[248:251], v[232:235]
    ds_read_b64_tr_b16 v[42:43], v3 offset:54272
    v_mul_f32 v120, v104, v120
    v_mfma_f32_16x16x32_bf16 v[236:239], v[48:51], a[252:255], v[236:239]
    v_rcp_f32 v99, v99
    v_mfma_f32_16x16x32_bf16 v[240:243], v[52:55], a[240:243], v[240:243]
    buffer_load_dwordx4 v2, s[16:19], s43 offen  lds
    v_mfma_f32_16x16x32_bf16 v[244:247], v[52:55], a[244:247], v[244:247]
    ds_read_b64_tr_b16 v[44:45], v3 offset:61440
    v_mul_f32 v99, v99, v115
    v_mfma_f32_16x16x32_bf16 v[248:251], v[52:55], a[248:251], v[248:251]
    ds_read_b64_tr_b16 v[46:47], v3 offset:62464
    v_cvt_pk_bf16_f32 v209, v98, v99
    v_mfma_f32_16x16x32_bf16 v[252:255], v[52:55], a[252:255], v[252:255]
    s_waitcnt lgkmcnt(3)
    s_barrier
    v_mul_f32 v104, s56, v104
    v_mfma_f32_16x16x32_bf16 v[160:163], v[56:59], v[64:67], v[160:163]
    ds_read_b64_tr_b16 v[48:49], v4 offset:49152
    v_mul_f32 v124, v108, v124
    v_mfma_f32_16x16x32_bf16 v[164:167], v[56:59], v[68:71], v[164:167]
    ds_read_b64_tr_b16 v[50:51], v4 offset:50176
    v_mul_f32 v108, s56, v108
    v_mfma_f32_16x16x32_bf16 v[168:171], v[56:59], v[72:75], v[168:171]
    v_rcp_f32 v101, v101
    v_mfma_f32_16x16x32_bf16 v[172:175], v[56:59], v[76:79], v[172:175]
    buffer_load_dwordx4 v2, s[16:19], vcc_lo offen offset:1024  lds
    v_mfma_f32_16x16x32_bf16 v[176:179], v[60:63], v[64:67], v[176:179]
    s_add_u32 vcc_lo, s44, 35840
    ds_read_b64_tr_b16 v[52:53], v4 offset:57344
    v_mul_f32 v101, v101, v117
    v_mfma_f32_16x16x32_bf16 v[180:183], v[60:63], v[68:71], v[180:183]
    s_lshl1_add_u32 m0, s74, 114688
    ds_read_b64_tr_b16 v[54:55], v4 offset:58368
    v_cvt_pk_bf16_f32 v212, v100, v101
    v_mfma_f32_16x16x32_bf16 v[184:187], v[60:63], v[72:75], v[184:187]
    v_exp_f32 v104, v104
    v_mfma_f32_16x16x32_bf16 v[188:191], v[60:63], v[76:79], v[188:191]
    s_waitcnt lgkmcnt(2)
    v_exp_f32 v108, v108
    v_mfma_f32_16x16x32_bf16 v[160:163], v[40:43], v[80:83], v[160:163]
    ds_read_b64_tr_b16 v[56:57], v4 offset:53248
    v_mul_f32 v118, v102, v118
    v_mfma_f32_16x16x32_bf16 v[164:167], v[40:43], v[84:87], v[164:167]
    ds_read_b64_tr_b16 v[58:59], v4 offset:54272
    v_mul_f32 v102, s56, v102
    v_mfma_f32_16x16x32_bf16 v[168:171], v[40:43], v[88:91], v[168:171]
    v_exp_f32 v102, v102
    v_mfma_f32_16x16x32_bf16 v[172:175], v[40:43], v[92:95], v[172:175]
    v_add_f32 v102, 1.0, v102
    v_add_f32 v104, 1.0, v104
    v_mfma_f32_16x16x32_bf16 v[176:179], v[44:47], v[80:83], v[176:179]
    ds_read_b64_tr_b16 v[60:61], v4 offset:61440
    v_add_f32 v108, 1.0, v108
    v_mfma_f32_16x16x32_bf16 v[180:183], v[44:47], v[84:87], v[180:183]
    ds_read_b64_tr_b16 v[62:63], v4 offset:62464
    v_mul_f32 v144, v128, v144
    v_mfma_f32_16x16x32_bf16 v[184:187], v[44:47], v[88:91], v[184:187]
    v_rcp_f32 v102, v102
    v_mfma_f32_16x16x32_bf16 v[188:191], v[44:47], v[92:95], v[188:191]
    v_rcp_f32 v104, v104
    v_mfma_f32_16x16x32_bf16 v[224:227], v[48:51], v[64:67], v[224:227]
    ds_read_b128 v[40:43], v38 offset:0
    v_mul_f32 v102, v102, v118
    v_mfma_f32_16x16x32_bf16 v[228:231], v[48:51], v[68:71], v[228:231]
    s_waitcnt vmcnt(8)
    v_rcp_f32 v108, v108
    v_mfma_f32_16x16x32_bf16 v[232:235], v[48:51], v[72:75], v[232:235]
    v_cmp_eq_u32 s[76:77], 0, v28
    v_mul_f32 v119, v103, v119
    v_mfma_f32_16x16x32_bf16 v[236:239], v[48:51], v[76:79], v[236:239]
    s_waitcnt lgkmcnt(1)
    v_mul_f32 v103, s56, v103
    v_mul_f32 v104, v104, v120
    v_mfma_f32_16x16x32_bf16 v[240:243], v[52:55], v[64:67], v[240:243]
    s_cmp_lg_u64 s[76:77], 0
    s_cbranch_scc1 gated_mix__ssm_conv_s5__swiglu_ffn__prompt_kernel_B_rd_s
gated_mix__ssm_conv_s5__swiglu_ffn__prompt_kernel_B_rd:
    ds_read_b128 v[44:47], v38 offset:64
    v_mul_f32 v121, v105, v121
    v_mfma_f32_16x16x32_bf16 v[244:247], v[52:55], v[68:71], v[244:247]
    v_exp_f32 v103, v103
    v_mfma_f32_16x16x32_bf16 v[248:251], v[52:55], v[72:75], v[248:251]
    v_add_f32 v103, 1.0, v103
    v_mul_f32 v105, s56, v105
    v_mfma_f32_16x16x32_bf16 v[252:255], v[52:55], v[76:79], v[252:255]
    v_rcp_f32 v103, v103
    v_mfma_f32_16x16x32_bf16 v[224:227], v[56:59], v[80:83], v[224:227]
    ds_read_b128 v[48:51], v38 offset:128
    v_mul_f32 v103, v103, v119
    v_mfma_f32_16x16x32_bf16 v[228:231], v[56:59], v[84:87], v[228:231]
    v_exp_f32 v105, v105
    v_mfma_f32_16x16x32_bf16 v[232:235], v[56:59], v[88:91], v[232:235]
    v_cvt_pk_bf16_f32 v213, v102, v103
    v_add_f32 v105, 1.0, v105
    v_mfma_f32_16x16x32_bf16 v[236:239], v[56:59], v[92:95], v[236:239]
    v_rcp_f32 v105, v105
    v_mfma_f32_16x16x32_bf16 v[240:243], v[60:63], v[80:83], v[240:243]
    ds_read_b128 v[52:55], v38 offset:192
    v_mul_f32 v105, v105, v121
    v_mfma_f32_16x16x32_bf16 v[244:247], v[60:63], v[84:87], v[244:247]
    v_cvt_pk_bf16_f32 v216, v104, v105
    v_mul_f32 v122, v106, v122
    v_mfma_f32_16x16x32_bf16 v[248:251], v[60:63], v[88:91], v[248:251]
    v_mul_f32 v106, s56, v106
    v_mul_f32 v108, v108, v124
    v_mfma_f32_16x16x32_bf16 v[252:255], v[60:63], v[92:95], v[252:255]
    s_waitcnt lgkmcnt(1)
    s_barrier
    v_mul_f32 v125, v109, v125
    v_mfma_f32_16x16x32_bf16 v[192:195], a[0:3], v[40:43], 0
    ds_read_b128 v[56:59], v38 offset:256
    v_mul_f32 v109, s56, v109
    v_mfma_f32_16x16x32_bf16 v[196:199], a[4:7], v[40:43], 0
    v_exp_f32 v106, v106
    v_mfma_f32_16x16x32_bf16 v[200:203], a[8:11], v[40:43], 0
    v_exp_f32 v109, v109
    v_mfma_f32_16x16x32_bf16 v[204:207], a[12:15], v[40:43], 0
    v_add_f32 v106, 1.0, v106
    v_add_f32 v109, 1.0, v109
    v_mfma_f32_16x16x32_bf16 v[192:195], a[16:19], v[44:47], v[192:195]
    ds_read_b128 v[60:63], v38 offset:320
    v_mul_f32 v128, s56, v128
    v_mfma_f32_16x16x32_bf16 v[196:199], a[20:23], v[44:47], v[196:199]
    v_rcp_f32 v106, v106
    v_mfma_f32_16x16x32_bf16 v[200:203], a[24:27], v[44:47], v[200:203]
    v_rcp_f32 v109, v109
    v_mfma_f32_16x16x32_bf16 v[204:207], a[28:31], v[44:47], v[204:207]
    v_exp_f32 v128, v128
    v_mfma_f32_16x16x32_bf16 v[192:195], a[32:35], v[48:51], v[192:195]
    ds_read_b128 v[40:43], v38 offset:384
    v_mul_f32 v106, v106, v122
    v_mfma_f32_16x16x32_bf16 v[196:199], a[36:39], v[48:51], v[196:199]
    v_mul_f32 v123, v107, v123
    v_mul_f32 v107, s56, v107
    v_mfma_f32_16x16x32_bf16 v[200:203], a[40:43], v[48:51], v[200:203]
    v_exp_f32 v107, v107
    v_mfma_f32_16x16x32_bf16 v[204:207], a[44:47], v[48:51], v[204:207]
    s_waitcnt lgkmcnt(1)
    v_add_f32 v107, 1.0, v107
    v_mul_f32 v109, v109, v125
    v_mfma_f32_16x16x32_bf16 v[192:195], a[48:51], v[52:55], v[192:195]
    ds_read_b128 v[44:47], v38 offset:448
    v_cvt_pk_bf16_f32 v220, v108, v109
    v_mfma_f32_16x16x32_bf16 v[196:199], a[52:55], v[52:55], v[196:199]
    v_rcp_f32 v107, v107
    v_mfma_f32_16x16x32_bf16 v[200:203], a[56:59], v[52:55], v[200:203]
    v_mul_f32 v107, v107, v123
    v_cvt_pk_bf16_f32 v217, v106, v107
    v_mfma_f32_16x16x32_bf16 v[204:207], a[60:63], v[52:55], v[204:207]
    v_mul_f32 v126, v110, v126
    v_mul_f32 v110, s56, v110
    v_mfma_f32_16x16x32_bf16 v[192:195], a[64:67], v[56:59], v[192:195]
    ds_read_b128 v[48:51], v38 offset:512
    v_add_f32 v128, 1.0, v128
    v_mfma_f32_16x16x32_bf16 v[196:199], a[68:71], v[56:59], v[196:199]
    v_exp_f32 v110, v110
    v_mfma_f32_16x16x32_bf16 v[200:203], a[72:75], v[56:59], v[200:203]
    v_rcp_f32 v128, v128
    v_mfma_f32_16x16x32_bf16 v[204:207], a[76:79], v[56:59], v[204:207]
    v_add_f32 v110, 1.0, v110
    v_mul_f32 v128, v128, v144
    v_mfma_f32_16x16x32_bf16 v[192:195], a[80:83], v[60:63], v[192:195]
    ds_read_b128 v[52:55], v38 offset:576
    v_mul_f32 v145, v129, v145
    v_mfma_f32_16x16x32_bf16 v[196:199], a[84:87], v[60:63], v[196:199]
    v_rcp_f32 v110, v110
    v_mfma_f32_16x16x32_bf16 v[200:203], a[88:91], v[60:63], v[200:203]
    v_mul_f32 v110, v110, v126
    v_mul_f32 v127, v111, v127
    v_mfma_f32_16x16x32_bf16 v[204:207], a[92:95], v[60:63], v[204:207]
    s_waitcnt lgkmcnt(1)
    v_mul_f32 v111, s56, v111
    v_mul_f32 v129, s56, v129
    v_mfma_f32_16x16x32_bf16 v[192:195], a[96:99], v[40:43], v[192:195]
    ds_read_b128 v[56:59], v38 offset:640
    v_mul_f32 v148, v132, v148
    v_mfma_f32_16x16x32_bf16 v[196:199], a[100:103], v[40:43], v[196:199]
    v_exp_f32 v111, v111
    v_mfma_f32_16x16x32_bf16 v[200:203], a[104:107], v[40:43], v[200:203]
    v_exp_f32 v129, v129
    v_mfma_f32_16x16x32_bf16 v[204:207], a[108:111], v[40:43], v[204:207]
    v_add_f32 v111, 1.0, v111
    v_add_f32 v129, 1.0, v129
    v_mfma_f32_16x16x32_bf16 v[192:195], a[112:115], v[44:47], v[192:195]
    ds_read_b128 v[60:63], v38 offset:704
    v_mul_f32 v132, s56, v132
    v_mfma_f32_16x16x32_bf16 v[196:199], a[116:119], v[44:47], v[196:199]
    v_rcp_f32 v111, v111
    v_mfma_f32_16x16x32_bf16 v[200:203], a[120:123], v[44:47], v[200:203]
    v_rcp_f32 v129, v129
    v_mfma_f32_16x16x32_bf16 v[204:207], a[124:127], v[44:47], v[204:207]
    v_exp_f32 v132, v132
    v_mfma_f32_16x16x32_bf16 v[192:195], a[128:131], v[48:51], v[192:195]
    s_branch gated_mix__ssm_conv_s5__swiglu_ffn__prompt_kernel_B_sk2
.p2align 12
gated_mix__ssm_conv_s5__swiglu_ffn__prompt_kernel_B_pg2_2:
    s_branch gated_mix__ssm_conv_s5__swiglu_ffn__prompt_kernel_B_pr2
gated_mix__ssm_conv_s5__swiglu_ffn__prompt_kernel_B_sk2:
    ds_read_b128 v[40:43], v38 offset:768
    v_mul_f32 v111, v111, v127
    v_mfma_f32_16x16x32_bf16 v[196:199], a[132:135], v[48:51], v[196:199]
    v_cvt_pk_bf16_f32 v221, v110, v111
    v_mul_f32 v129, v129, v145
    v_mfma_f32_16x16x32_bf16 v[200:203], a[136:139], v[48:51], v[200:203]
    v_cvt_pk_bf16_f32 v210, v128, v129
    v_mul_f32 v146, v130, v146
    v_mfma_f32_16x16x32_bf16 v[204:207], a[140:143], v[48:51], v[204:207]
    s_waitcnt lgkmcnt(1)
    v_mul_f32 v130, s56, v130
    v_add_f32 v132, 1.0, v132
    v_mfma_f32_16x16x32_bf16 v[192:195], a[144:147], v[52:55], v[192:195]
    ds_read_b128 v[44:47], v38 offset:832
    v_mul_f32 v152, v136, v152
    v_mfma_f32_16x16x32_bf16 v[196:199], a[148:151], v[52:55], v[196:199]
    v_exp_f32 v130, v130
    v_mfma_f32_16x16x32_bf16 v[200:203], a[152:155], v[52:55], v[200:203]
    v_rcp_f32 v132, v132
    v_mfma_f32_16x16x32_bf16 v[204:207], a[156:159], v[52:55], v[204:207]
    v_add_f32 v130, 1.0, v130
    v_mul_f32 v132, v132, v148
    v_mfma_f32_16x16x32_bf16 v[192:195], a[160:163], v[56:59], v[192:195]
    ds_read_b128 v[48:51], v38 offset:896
    v_mul_f32 v149, v133, v149
    v_mfma_f32_16x16x32_bf16 v[196:199], a[164:167], v[56:59], v[196:199]
    v_rcp_f32 v130, v130
    v_mfma_f32_16x16x32_bf16 v[200:203], a[168:171], v[56:59], v[200:203]
    v_mul_f32 v130, v130, v146
    v_mul_f32 v147, v131, v147
    v_mfma_f32_16x16x32_bf16 v[204:207], a[172:175], v[56:59], v[204:207]
    v_mul_f32 v131, s56, v131
    v_mul_f32 v133, s56, v133
    v_mfma_f32_16x16x32_bf16 v[192:195], a[176:179], v[60:63], v[192:195]
    ds_read_b128 v[52:55], v38 offset:960
    v_mul_f32 v136, s56, v136
    v_mfma_f32_16x16x32_bf16 v[196:199], a[180:183], v[60:63], v[196:199]
    v_exp_f32 v131, v131
    v_mfma_f32_16x16x32_bf16 v[200:203], a[184:187], v[60:63], v[200:203]
    v_exp_f32 v133, v133
    v_mfma_f32_16x16x32_bf16 v[204:207], a[188:191], v[60:63], v[204:207]
    s_waitcnt lgkmcnt(1)
    v_exp_f32 v136, v136
    v_mfma_f32_16x16x32_bf16 v[192:195], a[192:195], v[40:43], v[192:195]
    ds_read_b128 v[56:59], v38 offset:1024
    v_add_f32 v131, 1.0, v131
    v_mfma_f32_16x16x32_bf16 v[196:199], a[196:199], v[40:43], v[196:199]
    buffer_load_dwordx4 v2, s[12:15], s44 offen  lds
    v_mfma_f32_16x16x32_bf16 v[200:203], a[200:203], v[40:43], v[200:203]
    v_rcp_f32 v131, v131
    v_mfma_f32_16x16x32_bf16 v[204:207], a[204:207], v[40:43], v[204:207]
    v_mul_f32 v131, v131, v147
    v_cvt_pk_bf16_f32 v211, v130, v131
    v_mfma_f32_16x16x32_bf16 v[192:195], a[208:211], v[44:47], v[192:195]
    ds_read_b128 v[60:63], v38 offset:1088
    v_add_f32 v133, 1.0, v133
    v_mfma_f32_16x16x32_bf16 v[196:199], a[212:215], v[44:47], v[196:199]
    v_rcp_f32 v133, v133
    v_mfma_f32_16x16x32_bf16 v[200:203], a[216:219], v[44:47], v[200:203]
    buffer_load_dwordx4 v2, s[12:15], vcc_lo offen offset:1024  lds
    v_mfma_f32_16x16x32_bf16 v[204:207], a[220:223], v[44:47], v[204:207]
    s_waitcnt lgkmcnt(1)
    s_barrier
    v_mul_f32 v133, v133, v149
    v_mfma_f32_16x16x32_bf16 v[192:195], a[224:227], v[48:51], v[192:195]
    s_lshl1_add_u32 m0, s74, 122880
    v_xor_b32 v3, 64, v3
    v_cvt_pk_bf16_f32 v214, v132, v133
    v_mfma_f32_16x16x32_bf16 v[196:199], a[228:231], v[48:51], v[196:199]
    v_add_u32 v3, 0x20000, v3
    v_mul_f32 v150, v134, v150
    v_mfma_f32_16x16x32_bf16 v[200:203], a[232:235], v[48:51], v[200:203]
    buffer_load_dwordx4 v2, s[16:19], s44 offen  lds
    v_mfma_f32_16x16x32_bf16 v[204:207], a[236:239], v[48:51], v[204:207]
    ds_read_b64_tr_b16 v[40:41], v3 offset:0
    v_mul_f32 v134, s56, v134
    v_mfma_f32_16x16x32_bf16 v[192:195], a[240:243], v[52:55], v[192:195]
    ds_read_b64_tr_b16 v[42:43], v3 offset:1024
    v_add_f32 v136, 1.0, v136
    v_mfma_f32_16x16x32_bf16 v[196:199], a[244:247], v[52:55], v[196:199]
    ds_read_b64_tr_b16 v[44:45], v3 offset:8192
    v_mul_f32 v156, v140, v156
    v_mfma_f32_16x16x32_bf16 v[200:203], a[248:251], v[52:55], v[200:203]
    buffer_load_dwordx4 v2, s[16:19], vcc_lo offen offset:1024  lds
    v_mfma_f32_16x16x32_bf16 v[204:207], a[252:255], v[52:55], v[204:207]
    s_add_u32 vcc_lo, s45, 35840
    ds_read_b64_tr_b16 v[46:47], v3 offset:9216
    v_mul_f32 v140, s56, v140
    v_mfma_f32_16x16x32_bf16 v[192:195], v[64:67], v[56:59], v[192:195]
    s_lshl1_add_u32 m0, s74, 0
    ds_read_b64_tr_b16 v[48:49], v3 offset:4096
    v_mul_f32 v176, v160, v176
    v_mfma_f32_16x16x32_bf16 v[196:199], v[68:71], v[56:59], v[196:199]
    ds_read_b64_tr_b16 v[50:51], v3 offset:5120
    v_mul_f32 v160, s56, v160
    v_mfma_f32_16x16x32_bf16 v[200:203], v[72:75], v[56:59], v[200:203]
    buffer_load_dwordx4 v2, s[12:15], s45 offen  lds
    v_mfma_f32_16x16x32_bf16 v[204:207], v[76:79], v[56:59], v[204:207]
    s_waitcnt lgkmcnt(3)
    v_exp_f32 v134, v134
    v_mfma_f32_16x16x32_bf16 v[192:195], v[80:83], v[60:63], v[192:195]
    ds_read_b64_tr_b16 v[52:53], v3 offset:12288
    v_add_f32 v134, 1.0, v134
    v_mfma_f32_16x16x32_bf16 v[196:199], v[84:87], v[60:63], v[196:199]
    ds_read_b64_tr_b16 v[54:55], v3 offset:13312
    v_mul_f32 v180, v164, v180
    v_mfma_f32_16x16x32_bf16 v[200:203], v[88:91], v[60:63], v[200:203]
    buffer_load_dwordx4 v2, s[12:15], vcc_lo offen offset:1024  lds
    v_mfma_f32_16x16x32_bf16 v[204:207], v[92:95], v[60:63], v[204:207]
    s_waitcnt lgkmcnt(2)
    s_barrier
    v_mul_f32 v164, s56, v164
    v_mfma_f32_16x16x32_bf16 v[96:99], v[40:43], a[0:3], 0
    s_lshl1_add_u32 m0, s74, 8192
    v_add_u32 v3, 0xffff0000, v3
    v_mul_f32 v184, v168, v184
    v_mfma_f32_16x16x32_bf16 v[100:103], v[40:43], a[4:7], 0
    ds_read_b64_tr_b16 v[56:57], v3 offset:0
    v_mul_f32 v168, s56, v168
    v_mfma_f32_16x16x32_bf16 v[104:107], v[40:43], a[8:11], 0
    buffer_load_dwordx4 v2, s[16:19], s45 offen  lds
    v_mfma_f32_16x16x32_bf16 v[108:111], v[40:43], a[12:15], 0
    ds_read_b64_tr_b16 v[58:59], v3 offset:1024
    v_mul_f32 v188, v172, v188
    v_mfma_f32_16x16x32_bf16 v[112:115], v[44:47], a[0:3], 0
    ds_read_b64_tr_b16 v[60:61], v3 offset:8192
    v_mul_f32 v172, s56, v172
    v_mfma_f32_16x16x32_bf16 v[116:119], v[44:47], a[4:7], 0
    ds_read_b64_tr_b16 v[62:63], v3 offset:9216
    v_mul_f32 v240, v224, v240
    v_mfma_f32_16x16x32_bf16 v[120:123], v[44:47], a[8:11], 0
    buffer_load_dwordx4 v2, s[16:19], vcc_lo offen offset:1024  lds
    v_mfma_f32_16x16x32_bf16 v[124:127], v[44:47], a[12:15], 0
    s_add_u32 vcc_lo, s46, 35840
    v_rcp_f32 v134, v134
    v_mfma_f32_16x16x32_bf16 v[96:99], v[48:51], a[16:19], v[96:99]
    s_lshl1_add_u32 m0, s74, 16384
    ds_read_b64_tr_b16 v[40:41], v3 offset:4096
    v_mul_f32 v134, v134, v150
    v_mfma_f32_16x16x32_bf16 v[100:103], v[48:51], a[20:23], v[100:103]
    ds_read_b64_tr_b16 v[42:43], v3 offset:5120
    v_mul_f32 v151, v135, v151
    v_mfma_f32_16x16x32_bf16 v[104:107], v[48:51], a[24:27], v[104:107]
    buffer_load_dwordx4 v2, s[12:15], s46 offen  lds
    v_mfma_f32_16x16x32_bf16 v[108:111], v[48:51], a[28:31], v[108:111]
    s_waitcnt lgkmcnt(2)
    v_rcp_f32 v136, v136
    v_mfma_f32_16x16x32_bf16 v[112:115], v[52:55], a[16:19], v[112:115]
    ds_read_b64_tr_b16 v[44:45], v3 offset:12288
    v_mul_f32 v135, s56, v135
    v_mfma_f32_16x16x32_bf16 v[116:119], v[52:55], a[20:23], v[116:119]
    ds_read_b64_tr_b16 v[46:47], v3 offset:13312
    v_mul_f32 v136, v136, v152
    v_mfma_f32_16x16x32_bf16 v[120:123], v[52:55], a[24:27], v[120:123]
    buffer_load_dwordx4 v2, s[12:15], vcc_lo offen offset:1024  lds
    v_mfma_f32_16x16x32_bf16 v[124:127], v[52:55], a[28:31], v[124:127]
    s_waitcnt vmcnt(14) lgkmcnt(2)
    s_barrier
    v_mul_f32 v153, v137, v153
    v_mfma_f32_16x16x32_bf16 v[96:99], v[56:59], a[32:35], v[96:99]
    s_lshl1_add_u32 m0, s74, 24576
    ds_read_b64_tr_b16 v[48:49], v3 offset:16384
    v_mul_f32 v137, s56, v137
    v_mfma_f32_16x16x32_bf16 v[100:103], v[56:59], a[36:39], v[100:103]
    ds_read_b64_tr_b16 v[50:51], v3 offset:17408
    v_mul_f32 v224, s56, v224
    v_mfma_f32_16x16x32_bf16 v[104:107], v[56:59], a[40:43], v[104:107]
    buffer_load_dwordx4 v2, s[16:19], s46 offen  lds
    v_mfma_f32_16x16x32_bf16 v[108:111], v[56:59], a[44:47], v[108:111]
    v_exp_f32 v135, v135
    v_mfma_f32_16x16x32_bf16 v[112:115], v[60:63], a[32:35], v[112:115]
    ds_read_b64_tr_b16 v[52:53], v3 offset:24576
    v_add_f32 v135, 1.0, v135
    v_mfma_f32_16x16x32_bf16 v[116:119], v[60:63], a[36:39], v[116:119]
    ds_read_b64_tr_b16 v[54:55], v3 offset:25600
    v_mul_f32 v244, v228, v244
    v_mfma_f32_16x16x32_bf16 v[120:123], v[60:63], a[40:43], v[120:123]
    buffer_load_dwordx4 v2, s[16:19], vcc_lo offen offset:1024  lds
    v_mfma_f32_16x16x32_bf16 v[124:127], v[60:63], a[44:47], v[124:127]
    s_add_u32 vcc_lo, s47, 35840
    v_rcp_f32 v135, v135
    v_mfma_f32_16x16x32_bf16 v[96:99], v[40:43], a[48:51], v[96:99]
    s_lshl1_add_u32 m0, s74, 32768
    ds_read_b64_tr_b16 v[56:57], v3 offset:20480
    v_mul_f32 v135, v135, v151
    v_mfma_f32_16x16x32_bf16 v[100:103], v[40:43], a[52:55], v[100:103]
    ds_read_b64_tr_b16 v[58:59], v3 offset:21504
    v_cvt_pk_bf16_f32 v215, v134, v135
    v_mfma_f32_16x16x32_bf16 v[104:107], v[40:43], a[56:59], v[104:107]
    buffer_load_dwordx4 v2, s[12:15], s47 offen  lds
    v_mfma_f32_16x16x32_bf16 v[108:111], v[40:43], a[60:63], v[108:111]
    s_waitcnt lgkmcnt(2)
    v_exp_f32 v137, v137
    v_mfma_f32_16x16x32_bf16 v[112:115], v[44:47], a[48:51], v[112:115]
    ds_read_b64_tr_b16 v[60:61], v3 offset:28672
    v_add_f32 v137, 1.0, v137
    v_mfma_f32_16x16x32_bf16 v[116:119], v[44:47], a[52:55], v[116:119]
    ds_read_b64_tr_b16 v[62:63], v3 offset:29696
    v_mul_f32 v228, s56, v228
    v_mfma_f32_16x16x32_bf16 v[120:123], v[44:47], a[56:59], v[120:123]
    buffer_load_dwordx4 v2, s[12:15], vcc_lo offen offset:1024  lds
    v_mfma_f32_16x16x32_bf16 v[124:127], v[44:47], a[60:63], v[124:127]
    s_waitcnt vmcnt(14) lgkmcnt(2)
    s_barrier
    v_mul_f32 v248, v232, v248
    v_mfma_f32_16x16x32_bf16 v[96:99], v[48:51], a[64:67], v[96:99]
    s_lshl1_add_u32 m0, s74, 40960
    ds_read_b64_tr_b16 v[40:41], v3 offset:32768
    v_mul_f32 v232, s56, v232
    v_mfma_f32_16x16x32_bf16 v[100:103], v[48:51], a[68:71], v[100:103]
    ds_read_b64_tr_b16 v[42:43], v3 offset:33792
    v_mul_f32 v252, v236, v252
    v_mfma_f32_16x16x32_bf16 v[104:107], v[48:51], a[72:75], v[104:107]
    buffer_load_dwordx4 v2, s[16:19], s47 offen  lds
    v_mfma_f32_16x16x32_bf16 v[108:111], v[48:51], a[76:79], v[108:111]
    v_rcp_f32 v137, v137
    v_mfma_f32_16x16x32_bf16 v[112:115], v[52:55], a[64:67], v[112:115]
    ds_read_b64_tr_b16 v[44:45], v3 offset:40960
    v_mul_f32 v137, v137, v153
    v_mfma_f32_16x16x32_bf16 v[116:119], v[52:55], a[68:71], v[116:119]
    ds_read_b64_tr_b16 v[46:47], v3 offset:41984
    v_cvt_pk_bf16_f32 v218, v136, v137
    v_mfma_f32_16x16x32_bf16 v[120:123], v[52:55], a[72:75], v[120:123]
    buffer_load_dwordx4 v2, s[16:19], vcc_lo offen offset:1024  lds
    v_mfma_f32_16x16x32_bf16 v[124:127], v[52:55], a[76:79], v[124:127]
    s_add_u32 vcc_lo, s48, 35840
    v_exp_f32 v140, v140
    v_mfma_f32_16x16x32_bf16 v[96:99], v[56:59], a[80:83], v[96:99]
    s_lshl1_add_u32 m0, s74, 49152
    ds_read_b64_tr_b16 v[48:49], v3 offset:36864
    v_mul_f32 v154, v138, v154
    v_mfma_f32_16x16x32_bf16 v[100:103], v[56:59], a[84:87], v[100:103]
    ds_read_b64_tr_b16 v[50:51], v3 offset:37888
    v_mul_f32 v138, s56, v138
    v_mfma_f32_16x16x32_bf16 v[104:107], v[56:59], a[88:91], v[104:107]
    buffer_load_dwordx4 v2, s[12:15], s48 offen  lds
    v_mfma_f32_16x16x32_bf16 v[108:111], v[56:59], a[92:95], v[108:111]
    s_waitcnt lgkmcnt(2)
    v_exp_f32 v138, v138
    v_mfma_f32_16x16x32_bf16 v[112:115], v[60:63], a[80:83], v[112:115]
    ds_read_b64_tr_b16 v[52:53], v3 offset:45056
    v_add_f32 v138, 1.0, v138
    v_mfma_f32_16x16x32_bf16 v[116:119], v[60:63], a[84:87], v[116:119]
    ds_read_b64_tr_b16 v[54:55], v3 offset:46080
    v_add_f32 v140, 1.0, v140
    v_mfma_f32_16x16x32_bf16 v[120:123], v[60:63], a[88:91], v[120:123]
    buffer_load_dwordx4 v2, s[12:15], vcc_lo offen offset:1024  lds
    v_mfma_f32_16x16x32_bf16 v[124:127], v[60:63], a[92:95], v[124:127]
    s_waitcnt vmcnt(14) lgkmcnt(2)
    s_barrier
    v_mul_f32 v236, s56, v236
    v_mfma_f32_16x16x32_bf16 v[96:99], v[40:43], a[96:99], v[96:99]
    s_lshl1_add_u32 m0, s74, 57344
    ds_read_b64_tr_b16 v[56:57], v3 offset:49152
    v_mfma_f32_16x16x32_bf16 v[100:103], v[40:43], a[100:103], v[100:103]
    ds_read_b64_tr_b16 v[58:59], v3 offset:50176
    v_mfma_f32_16x16x32_bf16 v[104:107], v[40:43], a[104:107], v[104:107]
    buffer_load_dwordx4 v2, s[16:19], s48 offen  lds
    v_mfma_f32_16x16x32_bf16 v[108:111], v[40:43], a[108:111], v[108:111]
    v_rcp_f32 v138, v138
    v_mfma_f32_16x16x32_bf16 v[112:115], v[44:47], a[96:99], v[112:115]
    ds_read_b64_tr_b16 v[60:61], v3 offset:57344
    v_mul_f32 v138, v138, v154
    v_mfma_f32_16x16x32_bf16 v[116:119], v[44:47], a[100:103], v[116:119]
    ds_read_b64_tr_b16 v[62:63], v3 offset:58368
    v_mul_f32 v155, v139, v155
    v_mfma_f32_16x16x32_bf16 v[120:123], v[44:47], a[104:107], v[120:123]
    buffer_load_dwordx4 v2, s[16:19], vcc_lo offen offset:1024  lds
    v_mfma_f32_16x16x32_bf16 v[124:127], v[44:47], a[108:111], v[124:127]
    buffer_store_dwordx4 v[192:195], v27, s[20:23], s64 offen offset:0 sc1
    v_mfma_f32_16x16x32_bf16 v[96:99], v[48:51], a[112:115], v[96:99]
    s_sub_u32 vcc_lo, 9, s7
    ds_read_b64_tr_b16 v[40:41], v3 offset:53248
    v_mul_f32 v139, s56, v139
    v_mfma_f32_16x16x32_bf16 v[100:103], v[48:51], a[116:119], v[100:103]
    s_lshl_b32 vcc_lo, vcc_lo, 7
    ds_read_b64_tr_b16 v[42:43], v3 offset:54272
    v_add_u32 v2, vcc_lo, v2
    v_mfma_f32_16x16x32_bf16 v[104:107], v[48:51], a[120:123], v[104:107]
    s_add_u32 vcc_lo, s40, 35840
    v_exp_f32 v139, v139
    v_mfma_f32_16x16x32_bf16 v[108:111], v[48:51], a[124:127], v[108:111]
    s_waitcnt lgkmcnt(2)
    v_rcp_f32 v140, v140
    v_mfma_f32_16x16x32_bf16 v[112:115], v[52:55], a[112:115], v[112:115]
    buffer_store_dwordx4 v[196:199], v27, s[20:23], s64 offen offset:16 sc1
    v_mfma_f32_16x16x32_bf16 v[116:119], v[52:55], a[116:119], v[116:119]
    ds_read_b64_tr_b16 v[44:45], v3 offset:61440
    v_add_f32 v139, 1.0, v139
    v_mfma_f32_16x16x32_bf16 v[120:123], v[52:55], a[120:123], v[120:123]
    ds_read_b64_tr_b16 v[46:47], v3 offset:62464
    v_mul_f32 v140, v140, v156
    v_mfma_f32_16x16x32_bf16 v[124:127], v[52:55], a[124:127], v[124:127]
    s_waitcnt vmcnt(14) lgkmcnt(2)
    s_barrier
    v_mul_f32 v157, v141, v157
    v_mfma_f32_16x16x32_bf16 v[96:99], v[56:59], a[128:131], v[96:99]
    buffer_store_dwordx4 v[200:203], v27, s[20:23], s64 offen offset:32 sc1
    v_mfma_f32_16x16x32_bf16 v[100:103], v[56:59], a[132:135], v[100:103]
    v_add_u32 v3, 0xffff0000, v3
    v_mul_f32 v141, s56, v141
    v_mfma_f32_16x16x32_bf16 v[104:107], v[56:59], a[136:139], v[104:107]
    ds_read_b64_tr_b16 v[48:49], v3 offset:0
    v_mfma_f32_16x16x32_bf16 v[108:111], v[56:59], a[140:143], v[108:111]
    ds_read_b64_tr_b16 v[50:51], v3 offset:1024
    v_mfma_f32_16x16x32_bf16 v[112:115], v[60:63], a[128:131], v[112:115]
    buffer_store_dwordx4 v[204:207], v27, s[20:23], s64 offen offset:48 sc1
    v_mfma_f32_16x16x32_bf16 v[116:119], v[60:63], a[132:135], v[116:119]
    ds_read_b64_tr_b16 v[52:53], v3 offset:8192
    v_mfma_f32_16x16x32_bf16 v[120:123], v[60:63], a[136:139], v[120:123]
    ds_read_b64_tr_b16 v[54:55], v3 offset:9216
    v_mfma_f32_16x16x32_bf16 v[124:127], v[60:63], a[140:143], v[124:127]
    v_rcp_f32 v139, v139
    v_mfma_f32_16x16x32_bf16 v[96:99], v[40:43], a[144:147], v[96:99]
    ds_read_b64_tr_b16 v[56:57], v3 offset:4096
    v_mul_f32 v139, v139, v155
    v_mfma_f32_16x16x32_bf16 v[100:103], v[40:43], a[148:151], v[100:103]
    ds_read_b64_tr_b16 v[58:59], v3 offset:5120
    v_cvt_pk_bf16_f32 v219, v138, v139
    v_mfma_f32_16x16x32_bf16 v[104:107], v[40:43], a[152:155], v[104:107]
    v_exp_f32 v141, v141
    v_mfma_f32_16x16x32_bf16 v[108:111], v[40:43], a[156:159], v[108:111]
    s_waitcnt lgkmcnt(3)
    v_exp_f32 v160, v160
    v_mfma_f32_16x16x32_bf16 v[112:115], v[44:47], a[144:147], v[112:115]
    ds_read_b64_tr_b16 v[60:61], v3 offset:12288
    v_add_f32 v141, 1.0, v141
    v_mfma_f32_16x16x32_bf16 v[116:119], v[44:47], a[148:151], v[116:119]
    ds_read_b64_tr_b16 v[62:63], v3 offset:13312
    v_add_f32 v160, 1.0, v160
    v_mfma_f32_16x16x32_bf16 v[120:123], v[44:47], a[152:155], v[120:123]
    v_rcp_f32 v141, v141
    v_mfma_f32_16x16x32_bf16 v[124:127], v[44:47], a[156:159], v[124:127]
    s_waitcnt vmcnt(12) lgkmcnt(2)
    s_barrier
    v_mul_f32 v141, v141, v157
    v_mfma_f32_16x16x32_bf16 v[96:99], v[48:51], a[160:163], v[96:99]
    ds_read_b64_tr_b16 v[40:41], v3 offset:16384
    v_cvt_pk_bf16_f32 v222, v140, v141
    v_mfma_f32_16x16x32_bf16 v[100:103], v[48:51], a[164:167], v[100:103]
    ds_read_b64_tr_b16 v[42:43], v3 offset:17408
    v_mul_f32 v158, v142, v158
    v_mfma_f32_16x16x32_bf16 v[104:107], v[48:51], a[168:171], v[104:107]
    v_rcp_f32 v160, v160
    v_mfma_f32_16x16x32_bf16 v[108:111], v[48:51], a[172:175], v[108:111]
    v_exp_f32 v164, v164
    v_mfma_f32_16x16x32_bf16 v[112:115], v[52:55], a[160:163], v[112:115]
    ds_read_b64_tr_b16 v[44:45], v3 offset:24576
    v_mul_f32 v142, s56, v142
    v_mfma_f32_16x16x32_bf16 v[116:119], v[52:55], a[164:167], v[116:119]
    ds_read_b64_tr_b16 v[46:47], v3 offset:25600
    v_mul_f32 v160, v160, v176
    v_mfma_f32_16x16x32_bf16 v[120:123], v[52:55], a[168:171], v[120:123]
    v_exp_f32 v142, v142
    v_mfma_f32_16x16x32_bf16 v[124:127], v[52:55], a[172:175], v[124:127]
    v_exp_f32 v168, v168
    v_mfma_f32_16x16x32_bf16 v[96:99], v[56:59], a[176:179], v[96:99]
    ds_read_b64_tr_b16 v[48:49], v3 offset:20480
    v_add_f32 v142, 1.0, v142
    v_mfma_f32_16x16x32_bf16 v[100:103], v[56:59], a[180:183], v[100:103]
    ds_read_b64_tr_b16 v[50:51], v3 offset:21504
    v_mul_f32 v177, v161, v177
    v_mfma_f32_16x16x32_bf16 v[104:107], v[56:59], a[184:187], v[104:107]
    v_rcp_f32 v142, v142
    v_mfma_f32_16x16x32_bf16 v[108:111], v[56:59], a[188:191], v[108:111]
    s_waitcnt lgkmcnt(2)
    v_exp_f32 v172, v172
    v_mfma_f32_16x16x32_bf16 v[112:115], v[60:63], a[176:179], v[112:115]
    ds_read_b64_tr_b16 v[52:53], v3 offset:28672
    v_mul_f32 v142, v142, v158
    v_mfma_f32_16x16x32_bf16 v[116:119], v[60:63], a[180:183], v[116:119]
    ds_read_b64_tr_b16 v[54:55], v3 offset:29696
    v_mul_f32 v159, v143, v159
    v_mfma_f32_16x16x32_bf16 v[120:123], v[60:63], a[184:187], v[120:123]
    v_exp_f32 v224, v224
    v_mfma_f32_16x16x32_bf16 v[124:127], v[60:63], a[188:191], v[124:127]
    v_exp_f32 v228, v228
    v_mfma_f32_16x16x32_bf16 v[96:99], v[40:43], a[192:195], v[96:99]
    v_xor_b32 v4, 64, v4
    v_mul_f32 v143, s56, v143
    v_mfma_f32_16x16x32_bf16 v[100:103], v[40:43], a[196:199], v[100:103]
    v_add_u32 v4, 0x20000, v4
    v_mul_f32 v161, s56, v161
    v_mfma_f32_16x16x32_bf16 v[104:107], v[40:43], a[200:203], v[104:107]
    ds_read_b64_tr_b16 v[56:57], v4 offset:0
    v_add_f32 v164, 1.0, v164
    v_mfma_f32_16x16x32_bf16 v[108:111], v[40:43], a[204:207], v[108:111]
    ds_read_b64_tr_b16 v[58:59], v4 offset:1024
    v_add_f32 v168, 1.0, v168
    v_mfma_f32_16x16x32_bf16 v[112:115], v[44:47], a[192:195], v[112:115]
    ds_read_b64_tr_b16 v[60:61], v4 offset:8192
    v_add_f32 v172, 1.0, v172
    v_mfma_f32_16x16x32_bf16 v[116:119], v[44:47], a[196:199], v[116:119]
    ds_read_b64_tr_b16 v[62:63], v4 offset:9216
    v_add_f32 v224, 1.0, v224
    v_mfma_f32_16x16x32_bf16 v[120:123], v[44:47], a[200:203], v[120:123]
    v_exp_f32 v143, v143
    v_mfma_f32_16x16x32_bf16 v[124:127], v[44:47], a[204:207], v[124:127]
    s_waitcnt lgkmcnt(4)
    v_exp_f32 v161, v161
    v_mfma_f32_16x16x32_bf16 v[96:99], v[48:51], a[208:211], v[96:99]
    ds_read_b64_tr_b16 v[40:41], v4 offset:4096
    v_add_f32 v143, 1.0, v143
    v_mfma_f32_16x16x32_bf16 v[100:103], v[48:51], a[212:215], v[100:103]
    ds_read_b64_tr_b16 v[42:43], v4 offset:5120
    v_add_f32 v161, 1.0, v161
    v_mfma_f32_16x16x32_bf16 v[104:107], v[48:51], a[216:219], v[104:107]
    v_rcp_f32 v143, v143
    v_mfma_f32_16x16x32_bf16 v[108:111], v[48:51], a[220:223], v[108:111]
    v_rcp_f32 v161, v161
    v_mfma_f32_16x16x32_bf16 v[112:115], v[52:55], a[208:211], v[112:115]
    ds_read_b64_tr_b16 v[44:45], v4 offset:12288
    v_mul_f32 v143, v143, v159
    v_mfma_f32_16x16x32_bf16 v[116:119], v[52:55], a[212:215], v[116:119]
    ds_read_b64_tr_b16 v[46:47], v4 offset:13312
    v_cvt_pk_bf16_f32 v223, v142, v143
    v_mfma_f32_16x16x32_bf16 v[120:123], v[52:55], a[216:219], v[120:123]
    buffer_store_dwordx4 v[208:211], v5, s[20:23], s75 offen offset:0 sc1
    v_mfma_f32_16x16x32_bf16 v[124:127], v[52:55], a[220:223], v[124:127]
    s_waitcnt lgkmcnt(2)
    v_rcp_f32 v164, v164
    v_mfma_f32_16x16x32_bf16 v[128:131], v[56:59], a[0:3], 0
    v_add_u32 v4, 0xffff0000, v4
    v_mul_f32 v161, v161, v177
    v_mfma_f32_16x16x32_bf16 v[132:135], v[56:59], a[4:7], 0
    ds_read_b64_tr_b16 v[48:49], v4 offset:0
    v_cvt_pk_bf16_f32 v208, v160, v161
    v_mfma_f32_16x16x32_bf16 v[136:139], v[56:59], a[8:11], 0
    buffer_store_dwordx4 v[212:215], v5, s[20:23], s75 offen offset:1024 sc1
    v_mfma_f32_16x16x32_bf16 v[140:143], v[56:59], a[12:15], 0
    ds_read_b64_tr_b16 v[50:51], v4 offset:1024
    v_mul_f32 v178, v162, v178
    v_mfma_f32_16x16x32_bf16 v[144:147], v[60:63], a[0:3], 0
    ds_read_b64_tr_b16 v[52:53], v4 offset:8192
    v_mul_f32 v162, s56, v162
    v_mfma_f32_16x16x32_bf16 v[148:151], v[60:63], a[4:7], 0
    ds_read_b64_tr_b16 v[54:55], v4 offset:9216
    v_mul_f32 v164, v164, v180
    v_mfma_f32_16x16x32_bf16 v[152:155], v[60:63], a[8:11], 0
    buffer_store_dwordx4 v[216:219], v5, s[20:23], s75 offen offset:2048 sc1
    v_mfma_f32_16x16x32_bf16 v[156:159], v[60:63], a[12:15], 0
    v_exp_f32 v162, v162
    v_mfma_f32_16x16x32_bf16 v[128:131], v[40:43], a[16:19], v[128:131]
    ds_read_b64_tr_b16 v[56:57], v4 offset:4096
    v_add_f32 v162, 1.0, v162
    v_mfma_f32_16x16x32_bf16 v[132:135], v[40:43], a[20:23], v[132:135]
    ds_read_b64_tr_b16 v[58:59], v4 offset:5120
    v_mul_f32 v181, v165, v181
    v_mfma_f32_16x16x32_bf16 v[136:139], v[40:43], a[24:27], v[136:139]
    buffer_store_dwordx4 v[220:223], v5, s[20:23], s75 offen offset:3072 sc1
    v_mfma_f32_16x16x32_bf16 v[140:143], v[40:43], a[28:31], v[140:143]
    s_waitcnt lgkmcnt(2)
    v_rcp_f32 v162, v162
    v_mfma_f32_16x16x32_bf16 v[144:147], v[44:47], a[16:19], v[144:147]
    ds_read_b64_tr_b16 v[60:61], v4 offset:12288
    v_mul_f32 v162, v162, v178
    v_mfma_f32_16x16x32_bf16 v[148:151], v[44:47], a[20:23], v[148:151]
    ds_read_b64_tr_b16 v[62:63], v4 offset:13312
    v_mul_f32 v179, v163, v179
    v_mfma_f32_16x16x32_bf16 v[152:155], v[44:47], a[24:27], v[152:155]
    v_rcp_f32 v168, v168
    v_mfma_f32_16x16x32_bf16 v[156:159], v[44:47], a[28:31], v[156:159]
    v_rcp_f32 v172, v172
    v_mfma_f32_16x16x32_bf16 v[128:131], v[48:51], a[32:35], v[128:131]
    ds_read_b64_tr_b16 v[40:41], v4 offset:16384
    v_mul_f32 v163, s56, v163
    v_mfma_f32_16x16x32_bf16 v[132:135], v[48:51], a[36:39], v[132:135]
    ds_read_b64_tr_b16 v[42:43], v4 offset:17408
    v_mul_f32 v165, s56, v165
    v_mfma_f32_16x16x32_bf16 v[136:139], v[48:51], a[40:43], v[136:139]
    v_exp_f32 v163, v163
    v_mfma_f32_16x16x32_bf16 v[140:143], v[48:51], a[44:47], v[140:143]
    v_exp_f32 v165, v165
    v_mfma_f32_16x16x32_bf16 v[144:147], v[52:55], a[32:35], v[144:147]
    ds_read_b64_tr_b16 v[44:45], v4 offset:24576
    v_add_f32 v163, 1.0, v163
    v_mfma_f32_16x16x32_bf16 v[148:151], v[52:55], a[36:39], v[148:151]
    ds_read_b64_tr_b16 v[46:47], v4 offset:25600
    v_add_f32 v165, 1.0, v165
    v_mfma_f32_16x16x32_bf16 v[152:155], v[52:55], a[40:43], v[152:155]
    v_rcp_f32 v163, v163
    v_mfma_f32_16x16x32_bf16 v[156:159], v[52:55], a[44:47], v[156:159]
    s_waitcnt lgkmcnt(2)
    v_rcp_f32 v165, v165
    v_mfma_f32_16x16x32_bf16 v[128:131], v[56:59], a[48:51], v[128:131]
    ds_read_b64_tr_b16 v[48:49], v4 offset:20480
    v_mul_f32 v163, v163, v179
    v_mfma_f32_16x16x32_bf16 v[132:135], v[56:59], a[52:55], v[132:135]
    ds_read_b64_tr_b16 v[50:51], v4 offset:21504
    v_cvt_pk_bf16_f32 v209, v162, v163
    v_mfma_f32_16x16x32_bf16 v[136:139], v[56:59], a[56:59], v[136:139]
    v_rcp_f32 v224, v224
    v_mfma_f32_16x16x32_bf16 v[140:143], v[56:59], a[60:63], v[140:143]
    v_exp_f32 v232, v232
    v_mfma_f32_16x16x32_bf16 v[144:147], v[60:63], a[48:51], v[144:147]
    ds_read_b64_tr_b16 v[52:53], v4 offset:28672
    v_mul_f32 v165, v165, v181
    v_mfma_f32_16x16x32_bf16 v[148:151], v[60:63], a[52:55], v[148:151]
    ds_read_b64_tr_b16 v[54:55], v4 offset:29696
    v_cvt_pk_bf16_f32 v212, v164, v165
    v_mfma_f32_16x16x32_bf16 v[152:155], v[60:63], a[56:59], v[152:155]
    v_exp_f32 v236, v236
    v_mfma_f32_16x16x32_bf16 v[156:159], v[60:63], a[60:63], v[156:159]
    v_mul_f32 v182, v166, v182
    v_mul_f32 v166, s56, v166
    v_mfma_f32_16x16x32_bf16 v[128:131], v[40:43], a[64:67], v[128:131]
    ds_read_b64_tr_b16 v[56:57], v4 offset:32768
    v_mul_f32 v168, v168, v184
    v_mfma_f32_16x16x32_bf16 v[132:135], v[40:43], a[68:71], v[132:135]
    ds_read_b64_tr_b16 v[58:59], v4 offset:33792
    v_mul_f32 v185, v169, v185
    v_mfma_f32_16x16x32_bf16 v[136:139], v[40:43], a[72:75], v[136:139]
    v_exp_f32 v166, v166
    v_mfma_f32_16x16x32_bf16 v[140:143], v[40:43], a[76:79], v[140:143]
    s_waitcnt lgkmcnt(2)
    v_add_f32 v166, 1.0, v166
    v_mul_f32 v169, s56, v169
    v_mfma_f32_16x16x32_bf16 v[144:147], v[44:47], a[64:67], v[144:147]
    ds_read_b64_tr_b16 v[60:61], v4 offset:40960
    v_mul_f32 v172, v172, v188
    v_mfma_f32_16x16x32_bf16 v[148:151], v[44:47], a[68:71], v[148:151]
    ds_read_b64_tr_b16 v[62:63], v4 offset:41984
    v_mul_f32 v189, v173, v189
    v_mfma_f32_16x16x32_bf16 v[152:155], v[44:47], a[72:75], v[152:155]
    v_rcp_f32 v166, v166
    v_mfma_f32_16x16x32_bf16 v[156:159], v[44:47], a[76:79], v[156:159]
    v_exp_f32 v169, v169
    v_mfma_f32_16x16x32_bf16 v[128:131], v[48:51], a[80:83], v[128:131]
    ds_read_b64_tr_b16 v[40:41], v4 offset:36864
    v_mul_f32 v166, v166, v182
    v_mfma_f32_16x16x32_bf16 v[132:135], v[48:51], a[84:87], v[132:135]
    ds_read_b64_tr_b16 v[42:43], v4 offset:37888
    v_mul_f32 v183, v167, v183
    v_mfma_f32_16x16x32_bf16 v[136:139], v[48:51], a[88:91], v[136:139]
    v_mul_f32 v167, s56, v167
    v_add_f32 v169, 1.0, v169
    v_mfma_f32_16x16x32_bf16 v[140:143], v[48:51], a[92:95], v[140:143]
    v_exp_f32 v167, v167
    v_mfma_f32_16x16x32_bf16 v[144:147], v[52:55], a[80:83], v[144:147]
    ds_read_b64_tr_b16 v[44:45], v4 offset:45056
    v_add_f32 v167, 1.0, v167
    v_mfma_f32_16x16x32_bf16 v[148:151], v[52:55], a[84:87], v[148:151]
    ds_read_b64_tr_b16 v[46:47], v4 offset:46080
    v_mul_f32 v173, s56, v173
    v_mfma_f32_16x16x32_bf16 v[152:155], v[52:55], a[88:91], v[152:155]
    v_rcp_f32 v167, v167
    v_mfma_f32_16x16x32_bf16 v[156:159], v[52:55], a[92:95], v[156:159]
    s_waitcnt lgkmcnt(2)
    v_rcp_f32 v169, v169
    v_mfma_f32_16x16x32_bf16 v[128:131], v[56:59], a[96:99], v[128:131]
    ds_read_b64_tr_b16 v[48:49], v4 offset:49152
    v_mul_f32 v167, v167, v183
    v_mfma_f32_16x16x32_bf16 v[132:135], v[56:59], a[100:103], v[132:135]
    ds_read_b64_tr_b16 v[50:51], v4 offset:50176
    v_cvt_pk_bf16_f32 v213, v166, v167
    v_mfma_f32_16x16x32_bf16 v[136:139], v[56:59], a[104:107], v[136:139]
    v_exp_f32 v173, v173
    v_mfma_f32_16x16x32_bf16 v[140:143], v[56:59], a[108:111], v[140:143]
    v_mul_f32 v169, v169, v185
    v_cvt_pk_bf16_f32 v216, v168, v169
    v_mfma_f32_16x16x32_bf16 v[144:147], v[60:63], a[96:99], v[144:147]
    ds_read_b64_tr_b16 v[52:53], v4 offset:57344
    v_mul_f32 v186, v170, v186
    v_mfma_f32_16x16x32_bf16 v[148:151], v[60:63], a[100:103], v[148:151]
    ds_read_b64_tr_b16 v[54:55], v4 offset:58368
    v_mul_f32 v170, s56, v170
    v_mfma_f32_16x16x32_bf16 v[152:155], v[60:63], a[104:107], v[152:155]
    v_exp_f32 v170, v170
    v_mfma_f32_16x16x32_bf16 v[156:159], v[60:63], a[108:111], v[156:159]
    v_add_f32 v170, 1.0, v170
    v_add_f32 v173, 1.0, v173
    v_mfma_f32_16x16x32_bf16 v[128:131], v[40:43], a[112:115], v[128:131]
    ds_read_b64_tr_b16 v[56:57], v4 offset:53248
    v_mul_f32 v224, v224, v240
    v_mfma_f32_16x16x32_bf16 v[132:135], v[40:43], a[116:119], v[132:135]
    ds_read_b64_tr_b16 v[58:59], v4 offset:54272
    v_mul_f32 v241, v225, v241
    v_mfma_f32_16x16x32_bf16 v[136:139], v[40:43], a[120:123], v[136:139]
    v_rcp_f32 v170, v170
    v_mfma_f32_16x16x32_bf16 v[140:143], v[40:43], a[124:127], v[140:143]
    s_waitcnt lgkmcnt(2)
    v_rcp_f32 v173, v173
    v_mfma_f32_16x16x32_bf16 v[144:147], v[44:47], a[112:115], v[144:147]
    ds_read_b64_tr_b16 v[60:61], v4 offset:61440
    v_mul_f32 v170, v170, v186
    v_mfma_f32_16x16x32_bf16 v[148:151], v[44:47], a[116:119], v[148:151]
    ds_read_b64_tr_b16 v[62:63], v4 offset:62464
    v_mul_f32 v187, v171, v187
    v_mfma_f32_16x16x32_bf16 v[152:155], v[44:47], a[120:123], v[152:155]
    v_mul_f32 v171, s56, v171
    v_mul_f32 v173, v173, v189
    v_mfma_f32_16x16x32_bf16 v[156:159], v[44:47], a[124:127], v[156:159]
    v_exp_f32 v171, v171
    v_mfma_f32_16x16x32_bf16 v[128:131], v[48:51], a[128:131], v[128:131]
    v_add_u32 v4, 0xffff0000, v4
    v_add_f32 v171, 1.0, v171
    v_mfma_f32_16x16x32_bf16 v[132:135], v[48:51], a[132:135], v[132:135]
    ds_read_b64_tr_b16 v[40:41], v4 offset:0
    v_cvt_pk_bf16_f32 v220, v172, v173
    v_mfma_f32_16x16x32_bf16 v[136:139], v[48:51], a[136:139], v[136:139]
    ds_read_b64_tr_b16 v[42:43], v4 offset:1024
    v_mul_f32 v190, v174, v190
    v_mfma_f32_16x16x32_bf16 v[140:143], v[48:51], a[140:143], v[140:143]
    v_rcp_f32 v171, v171
    v_mfma_f32_16x16x32_bf16 v[144:147], v[52:55], a[128:131], v[144:147]
    ds_read_b64_tr_b16 v[44:45], v4 offset:8192
    v_mul_f32 v171, v171, v187
    v_mfma_f32_16x16x32_bf16 v[148:151], v[52:55], a[132:135], v[148:151]
    ds_read_b64_tr_b16 v[46:47], v4 offset:9216
    v_cvt_pk_bf16_f32 v217, v170, v171
    v_mfma_f32_16x16x32_bf16 v[152:155], v[52:55], a[136:139], v[152:155]
    v_mul_f32 v174, s56, v174
    v_mul_f32 v225, s56, v225
    v_mfma_f32_16x16x32_bf16 v[156:159], v[52:55], a[140:143], v[156:159]
    s_waitcnt lgkmcnt(3)
    v_exp_f32 v174, v174
    v_mfma_f32_16x16x32_bf16 v[128:131], v[56:59], a[144:147], v[128:131]
    ds_read_b64_tr_b16 v[48:49], v4 offset:4096
    v_add_f32 v174, 1.0, v174
    v_mfma_f32_16x16x32_bf16 v[132:135], v[56:59], a[148:151], v[132:135]
    ds_read_b64_tr_b16 v[50:51], v4 offset:5120
    v_add_f32 v228, 1.0, v228
    v_mfma_f32_16x16x32_bf16 v[136:139], v[56:59], a[152:155], v[136:139]
    s_branch gated_mix__ssm_conv_s5__swiglu_ffn__prompt_kernel_B_sk3
.p2align 12
gated_mix__ssm_conv_s5__swiglu_ffn__prompt_kernel_B_pg2_3:
    s_branch gated_mix__ssm_conv_s5__swiglu_ffn__prompt_kernel_B_pr2
gated_mix__ssm_conv_s5__swiglu_ffn__prompt_kernel_B_sk3:
    v_rcp_f32 v174, v174
    v_mfma_f32_16x16x32_bf16 v[140:143], v[56:59], a[156:159], v[140:143]
    v_exp_f32 v225, v225
    v_mfma_f32_16x16x32_bf16 v[144:147], v[60:63], a[144:147], v[144:147]
    ds_read_b64_tr_b16 v[52:53], v4 offset:12288
    v_mul_f32 v174, v174, v190
    v_mfma_f32_16x16x32_bf16 v[148:151], v[60:63], a[148:151], v[148:151]
    ds_read_b64_tr_b16 v[54:55], v4 offset:13312
    v_mul_f32 v191, v175, v191
    v_mfma_f32_16x16x32_bf16 v[152:155], v[60:63], a[152:155], v[152:155]
    v_rcp_f32 v228, v228
    v_mfma_f32_16x16x32_bf16 v[156:159], v[60:63], a[156:159], v[156:159]
    s_waitcnt lgkmcnt(2)
    v_mul_f32 v175, s56, v175
    v_add_f32 v225, 1.0, v225
    v_mfma_f32_16x16x32_bf16 v[128:131], v[40:43], a[160:163], v[128:131]
    ds_read_b64_tr_b16 v[56:57], v4 offset:16384
    v_mul_f32 v228, v228, v244
    v_mfma_f32_16x16x32_bf16 v[132:135], v[40:43], a[164:167], v[132:135]
    ds_read_b64_tr_b16 v[58:59], v4 offset:17408
    v_mul_f32 v245, v229, v245
    v_mfma_f32_16x16x32_bf16 v[136:139], v[40:43], a[168:171], v[136:139]
    v_exp_f32 v175, v175
    v_mfma_f32_16x16x32_bf16 v[140:143], v[40:43], a[172:175], v[140:143]
    v_rcp_f32 v225, v225
    v_mfma_f32_16x16x32_bf16 v[144:147], v[44:47], a[160:163], v[144:147]
    ds_read_b64_tr_b16 v[60:61], v4 offset:24576
    v_add_f32 v175, 1.0, v175
    v_mfma_f32_16x16x32_bf16 v[148:151], v[44:47], a[164:167], v[148:151]
    ds_read_b64_tr_b16 v[62:63], v4 offset:25600
    v_mul_f32 v225, v225, v241
    v_mfma_f32_16x16x32_bf16 v[152:155], v[44:47], a[168:171], v[152:155]
    s_waitcnt vmcnt(4)
    v_rcp_f32 v175, v175
    v_mfma_f32_16x16x32_bf16 v[156:159], v[44:47], a[172:175], v[156:159]
    buffer_store_dword v4, v26, s[20:23], s63 offen sc1
    v_mfma_f32_16x16x32_bf16 v[128:131], v[48:51], a[176:179], v[128:131]
    ds_read_b64_tr_b16 v[40:41], v4 offset:20480
    v_mul_f32 v175, v175, v191
    v_mfma_f32_16x16x32_bf16 v[132:135], v[48:51], a[180:183], v[132:135]
    ds_read_b64_tr_b16 v[42:43], v4 offset:21504
    v_cvt_pk_bf16_f32 v221, v174, v175
    v_mfma_f32_16x16x32_bf16 v[136:139], v[48:51], a[184:187], v[136:139]
    v_cvt_pk_bf16_f32 v210, v224, v225
    v_mul_f32 v242, v226, v242
    v_mfma_f32_16x16x32_bf16 v[140:143], v[48:51], a[188:191], v[140:143]
    s_waitcnt lgkmcnt(2)
    v_mul_f32 v226, s56, v226
    v_mul_f32 v229, s56, v229
    v_mfma_f32_16x16x32_bf16 v[144:147], v[52:55], a[176:179], v[144:147]
    ds_read_b64_tr_b16 v[44:45], v4 offset:28672
    v_add_f32 v232, 1.0, v232
    v_mfma_f32_16x16x32_bf16 v[148:151], v[52:55], a[180:183], v[148:151]
    ds_read_b64_tr_b16 v[46:47], v4 offset:29696
    v_add_f32 v236, 1.0, v236
    v_mfma_f32_16x16x32_bf16 v[152:155], v[52:55], a[184:187], v[152:155]
    v_exp_f32 v226, v226
    v_mfma_f32_16x16x32_bf16 v[156:159], v[52:55], a[188:191], v[156:159]
    s_waitcnt lgkmcnt(2)
    s_barrier
    v_add_f32 v226, 1.0, v226
    v_mfma_f32_16x16x32_bf16 v[128:131], v[56:59], a[192:195], v[128:131]
    ds_read_b64_tr_b16 v[48:49], v3 offset:32768
    v_mfma_f32_16x16x32_bf16 v[132:135], v[56:59], a[196:199], v[132:135]
    ds_read_b64_tr_b16 v[50:51], v3 offset:33792
    v_mfma_f32_16x16x32_bf16 v[136:139], v[56:59], a[200:203], v[136:139]
    v_rcp_f32 v226, v226
    v_mfma_f32_16x16x32_bf16 v[140:143], v[56:59], a[204:207], v[140:143]
    v_exp_f32 v229, v229
    v_mfma_f32_16x16x32_bf16 v[144:147], v[60:63], a[192:195], v[144:147]
    ds_read_b64_tr_b16 v[52:53], v3 offset:40960
    v_mul_f32 v226, v226, v242
    v_mfma_f32_16x16x32_bf16 v[148:151], v[60:63], a[196:199], v[148:151]
    ds_read_b64_tr_b16 v[54:55], v3 offset:41984
    v_mul_f32 v243, v227, v243
    v_mfma_f32_16x16x32_bf16 v[152:155], v[60:63], a[200:203], v[152:155]
    v_rcp_f32 v232, v232
    v_mfma_f32_16x16x32_bf16 v[156:159], v[60:63], a[204:207], v[156:159]
    v_rcp_f32 v236, v236
    v_mfma_f32_16x16x32_bf16 v[128:131], v[40:43], a[208:211], v[128:131]
    ds_read_b64_tr_b16 v[56:57], v3 offset:36864
    v_mul_f32 v227, s56, v227
    v_mfma_f32_16x16x32_bf16 v[132:135], v[40:43], a[212:215], v[132:135]
    ds_read_b64_tr_b16 v[58:59], v3 offset:37888
    v_add_f32 v229, 1.0, v229
    v_mfma_f32_16x16x32_bf16 v[136:139], v[40:43], a[216:219], v[136:139]
    v_exp_f32 v227, v227
    v_mfma_f32_16x16x32_bf16 v[140:143], v[40:43], a[220:223], v[140:143]
    s_waitcnt lgkmcnt(2)
    v_rcp_f32 v229, v229
    v_mfma_f32_16x16x32_bf16 v[144:147], v[44:47], a[208:211], v[144:147]
    ds_read_b64_tr_b16 v[60:61], v3 offset:45056
    v_add_f32 v227, 1.0, v227
    v_mfma_f32_16x16x32_bf16 v[148:151], v[44:47], a[212:215], v[148:151]
    ds_read_b64_tr_b16 v[62:63], v3 offset:46080
    v_mul_f32 v229, v229, v245
    v_mfma_f32_16x16x32_bf16 v[152:155], v[44:47], a[216:219], v[152:155]
    v_rcp_f32 v227, v227
    v_mfma_f32_16x16x32_bf16 v[156:159], v[44:47], a[220:223], v[156:159]
    v_mul_f32 v227, v227, v243
    v_cvt_pk_bf16_f32 v211, v226, v227
    v_mfma_f32_16x16x32_bf16 v[96:99], v[48:51], a[224:227], v[96:99]
    ds_read_b64_tr_b16 v[40:41], v4 offset:32768
    v_cvt_pk_bf16_f32 v214, v228, v229
    v_mfma_f32_16x16x32_bf16 v[100:103], v[48:51], a[228:231], v[100:103]
    ds_read_b64_tr_b16 v[42:43], v4 offset:33792
    v_mul_f32 v246, v230, v246
    v_mfma_f32_16x16x32_bf16 v[104:107], v[48:51], a[232:235], v[104:107]
    v_mul_f32 v230, s56, v230
    v_mul_f32 v232, v232, v248
    v_mfma_f32_16x16x32_bf16 v[108:111], v[48:51], a[236:239], v[108:111]
    v_exp_f32 v230, v230
    v_mfma_f32_16x16x32_bf16 v[112:115], v[52:55], a[224:227], v[112:115]
    ds_read_b64_tr_b16 v[44:45], v4 offset:40960
    v_add_f32 v230, 1.0, v230
    v_mfma_f32_16x16x32_bf16 v[116:119], v[52:55], a[228:231], v[116:119]
    ds_read_b64_tr_b16 v[46:47], v4 offset:41984
    v_mul_f32 v249, v233, v249
    v_mfma_f32_16x16x32_bf16 v[120:123], v[52:55], a[232:235], v[120:123]
    v_rcp_f32 v230, v230
    v_mfma_f32_16x16x32_bf16 v[124:127], v[52:55], a[236:239], v[124:127]
    s_waitcnt lgkmcnt(2)
    v_mul_f32 v230, v230, v246
    v_mul_f32 v247, v231, v247
    v_mfma_f32_16x16x32_bf16 v[96:99], v[56:59], a[240:243], v[96:99]
    ds_read_b64_tr_b16 v[48:49], v4 offset:36864
    v_mul_f32 v231, s56, v231
    v_mfma_f32_16x16x32_bf16 v[100:103], v[56:59], a[244:247], v[100:103]
    ds_read_b64_tr_b16 v[50:51], v4 offset:37888
    v_mul_f32 v233, s56, v233
    v_mfma_f32_16x16x32_bf16 v[104:107], v[56:59], a[248:251], v[104:107]
    v_exp_f32 v231, v231
    v_mfma_f32_16x16x32_bf16 v[108:111], v[56:59], a[252:255], v[108:111]
    v_exp_f32 v233, v233
    v_mfma_f32_16x16x32_bf16 v[112:115], v[60:63], a[240:243], v[112:115]
    ds_read_b64_tr_b16 v[52:53], v4 offset:45056
    v_add_f32 v231, 1.0, v231
    v_mfma_f32_16x16x32_bf16 v[116:119], v[60:63], a[244:247], v[116:119]
    ds_read_b64_tr_b16 v[54:55], v4 offset:46080
    v_add_f32 v233, 1.0, v233
    v_mfma_f32_16x16x32_bf16 v[120:123], v[60:63], a[248:251], v[120:123]
    v_rcp_f32 v231, v231
    v_mfma_f32_16x16x32_bf16 v[124:127], v[60:63], a[252:255], v[124:127]
    s_waitcnt lgkmcnt(2)
    s_barrier
    v_mul_f32 v231, v231, v247
    v_mfma_f32_16x16x32_bf16 v[128:131], v[40:43], a[224:227], v[128:131]
    ds_read_b64_tr_b16 v[56:57], v3 offset:49152
    v_cvt_pk_bf16_f32 v215, v230, v231
    v_mfma_f32_16x16x32_bf16 v[132:135], v[40:43], a[228:231], v[132:135]
    ds_read_b64_tr_b16 v[58:59], v3 offset:50176
    v_mul_f32 v236, v236, v252
    v_mfma_f32_16x16x32_bf16 v[136:139], v[40:43], a[232:235], v[136:139]
    v_rcp_f32 v233, v233
    v_mfma_f32_16x16x32_bf16 v[140:143], v[40:43], a[236:239], v[140:143]
    v_mul_f32 v233, v233, v249
    v_cvt_pk_bf16_f32 v218, v232, v233
    v_mfma_f32_16x16x32_bf16 v[144:147], v[44:47], a[224:227], v[144:147]
    ds_read_b64_tr_b16 v[60:61], v3 offset:57344
    v_mul_f32 v250, v234, v250
    v_mfma_f32_16x16x32_bf16 v[148:151], v[44:47], a[228:231], v[148:151]
    ds_read_b64_tr_b16 v[62:63], v3 offset:58368
    v_mul_f32 v234, s56, v234
    v_mfma_f32_16x16x32_bf16 v[152:155], v[44:47], a[232:235], v[152:155]
    v_exp_f32 v234, v234
    v_mfma_f32_16x16x32_bf16 v[156:159], v[44:47], a[236:239], v[156:159]
    v_add_f32 v234, 1.0, v234
    v_mul_f32 v253, v237, v253
    v_mfma_f32_16x16x32_bf16 v[128:131], v[48:51], a[240:243], v[128:131]
    ds_read_b64_tr_b16 v[40:41], v3 offset:53248
    v_mul_f32 v237, s56, v237
    v_mfma_f32_16x16x32_bf16 v[132:135], v[48:51], a[244:247], v[132:135]
    ds_read_b64_tr_b16 v[42:43], v3 offset:54272
    v_mfma_f32_16x16x32_bf16 v[136:139], v[48:51], a[248:251], v[136:139]
    v_rcp_f32 v234, v234
    v_mfma_f32_16x16x32_bf16 v[140:143], v[48:51], a[252:255], v[140:143]
    s_waitcnt lgkmcnt(2)
    v_exp_f32 v237, v237
    v_mfma_f32_16x16x32_bf16 v[144:147], v[52:55], a[240:243], v[144:147]
    ds_read_b64_tr_b16 v[44:45], v3 offset:61440
    v_mul_f32 v234, v234, v250
    v_mfma_f32_16x16x32_bf16 v[148:151], v[52:55], a[244:247], v[148:151]
    ds_read_b64_tr_b16 v[46:47], v3 offset:62464
    v_mul_f32 v251, v235, v251
    v_mfma_f32_16x16x32_bf16 v[152:155], v[52:55], a[248:251], v[152:155]
    v_mul_f32 v235, s56, v235
    v_add_f32 v237, 1.0, v237
    v_mfma_f32_16x16x32_bf16 v[156:159], v[52:55], a[252:255], v[156:159]
    v_exp_f32 v235, v235
    v_mfma_f32_16x16x32_bf16 v[96:99], v[56:59], v[64:67], v[96:99]
    ds_read_b64_tr_b16 v[48:49], v4 offset:49152
    v_add_f32 v235, 1.0, v235
    v_mfma_f32_16x16x32_bf16 v[100:103], v[56:59], v[68:71], v[100:103]
    ds_read_b64_tr_b16 v[50:51], v4 offset:50176
    v_mfma_f32_16x16x32_bf16 v[104:107], v[56:59], v[72:75], v[104:107]
    v_rcp_f32 v235, v235
    v_mfma_f32_16x16x32_bf16 v[108:111], v[56:59], v[76:79], v[108:111]
    v_rcp_f32 v237, v237
    v_mfma_f32_16x16x32_bf16 v[112:115], v[60:63], v[64:67], v[112:115]
    ds_read_b64_tr_b16 v[52:53], v4 offset:57344
    v_mul_f32 v235, v235, v251
    v_mfma_f32_16x16x32_bf16 v[116:119], v[60:63], v[68:71], v[116:119]
    ds_read_b64_tr_b16 v[54:55], v4 offset:58368
    v_cvt_pk_bf16_f32 v219, v234, v235
    v_mfma_f32_16x16x32_bf16 v[120:123], v[60:63], v[72:75], v[120:123]
    v_mul_f32 v237, v237, v253
    v_cvt_pk_bf16_f32 v222, v236, v237
    v_mfma_f32_16x16x32_bf16 v[124:127], v[60:63], v[76:79], v[124:127]
    s_waitcnt lgkmcnt(2)
    v_mul_f32 v254, v238, v254
    v_mul_f32 v238, s56, v238
    v_mfma_f32_16x16x32_bf16 v[96:99], v[40:43], v[80:83], v[96:99]
    ds_read_b64_tr_b16 v[56:57], v4 offset:53248
    v_mfma_f32_16x16x32_bf16 v[100:103], v[40:43], v[84:87], v[100:103]
    ds_read_b64_tr_b16 v[58:59], v4 offset:54272
    v_mfma_f32_16x16x32_bf16 v[104:107], v[40:43], v[88:91], v[104:107]
    v_exp_f32 v238, v238
    v_mfma_f32_16x16x32_bf16 v[108:111], v[40:43], v[92:95], v[108:111]
    v_add_f32 v238, 1.0, v238
    v_mfma_f32_16x16x32_bf16 v[112:115], v[44:47], v[80:83], v[112:115]
    ds_read_b64_tr_b16 v[60:61], v4 offset:61440
    v_mfma_f32_16x16x32_bf16 v[116:119], v[44:47], v[84:87], v[116:119]
    ds_read_b64_tr_b16 v[62:63], v4 offset:62464
    v_mfma_f32_16x16x32_bf16 v[120:123], v[44:47], v[88:91], v[120:123]
    v_rcp_f32 v238, v238
    v_mfma_f32_16x16x32_bf16 v[124:127], v[44:47], v[92:95], v[124:127]
    v_mul_f32 v238, v238, v254
    v_mul_f32 v255, v239, v255
    v_mfma_f32_16x16x32_bf16 v[128:131], v[48:51], v[64:67], v[128:131]
    v_xor_b32 v3, 64, v3
    v_mul_f32 v239, s56, v239
    v_mfma_f32_16x16x32_bf16 v[132:135], v[48:51], v[68:71], v[132:135]
    v_add_u32 v3, 0x10000, v3
    v_mul_f32 v112, v96, v112
    v_mfma_f32_16x16x32_bf16 v[136:139], v[48:51], v[72:75], v[136:139]
    ds_read_b64_tr_b16 v[40:41], v3 offset:0
    v_mul_f32 v96, s56, v96
    v_mfma_f32_16x16x32_bf16 v[140:143], v[48:51], v[76:79], v[140:143]
    s_waitcnt lgkmcnt(1)
    ds_read_b64_tr_b16 v[42:43], v3 offset:1024
    v_mul_f32 v116, v100, v116
    v_mfma_f32_16x16x32_bf16 v[144:147], v[52:55], v[64:67], v[144:147]
    ds_read_b64_tr_b16 v[44:45], v3 offset:8192
    v_mul_f32 v100, s56, v100
    v_mfma_f32_16x16x32_bf16 v[148:151], v[52:55], v[68:71], v[148:151]
    ds_read_b64_tr_b16 v[46:47], v3 offset:9216
    v_mul_f32 v120, v104, v120
    v_mfma_f32_16x16x32_bf16 v[152:155], v[52:55], v[72:75], v[152:155]
    v_exp_f32 v239, v239
    v_mfma_f32_16x16x32_bf16 v[156:159], v[52:55], v[76:79], v[156:159]
    v_exp_f32 v96, v96
    v_mfma_f32_16x16x32_bf16 v[128:131], v[56:59], v[80:83], v[128:131]
    ds_read_b64_tr_b16 v[48:49], v3 offset:4096
    v_add_f32 v239, 1.0, v239
    v_mfma_f32_16x16x32_bf16 v[132:135], v[56:59], v[84:87], v[132:135]
    ds_read_b64_tr_b16 v[50:51], v3 offset:5120
    v_add_f32 v96, 1.0, v96
    v_mfma_f32_16x16x32_bf16 v[136:139], v[56:59], v[88:91], v[136:139]
    v_rcp_f32 v239, v239
    v_mfma_f32_16x16x32_bf16 v[140:143], v[56:59], v[92:95], v[140:143]
    v_rcp_f32 v96, v96
    v_mfma_f32_16x16x32_bf16 v[144:147], v[60:63], v[80:83], v[144:147]
    ds_read_b64_tr_b16 v[52:53], v3 offset:12288
    v_mul_f32 v239, v239, v255
    v_mfma_f32_16x16x32_bf16 v[148:151], v[60:63], v[84:87], v[148:151]
    ds_read_b64_tr_b16 v[54:55], v3 offset:13312
    v_cvt_pk_bf16_f32 v223, v238, v239
    v_mfma_f32_16x16x32_bf16 v[152:155], v[60:63], v[88:91], v[152:155]
    buffer_store_dwordx4 v[208:211], v5, s[20:23], s65 offen offset:0 sc1
    v_mfma_f32_16x16x32_bf16 v[156:159], v[60:63], v[92:95], v[156:159]
    s_waitcnt lgkmcnt(2)
    v_exp_f32 v100, v100
    v_mfma_f32_16x16x32_bf16 v[160:163], v[40:43], a[32:35], 0
    v_xor_b32 v4, 64, v4
    v_mul_f32 v96, v96, v112
    v_mfma_f32_16x16x32_bf16 v[164:167], v[40:43], a[36:39], 0
    v_add_u32 v4, 0x10000, v4
    v_mul_f32 v113, v97, v113
    v_mfma_f32_16x16x32_bf16 v[168:171], v[40:43], a[40:43], 0
    buffer_store_dwordx4 v[212:215], v5, s[20:23], s65 offen offset:1024 sc1
    v_mfma_f32_16x16x32_bf16 v[172:175], v[40:43], a[44:47], 0
    ds_read_b64_tr_b16 v[56:57], v4 offset:0
    v_mul_f32 v97, s56, v97
    v_mfma_f32_16x16x32_bf16 v[176:179], v[44:47], a[32:35], 0
    ds_read_b64_tr_b16 v[58:59], v4 offset:1024
    v_add_f32 v100, 1.0, v100
    v_mfma_f32_16x16x32_bf16 v[180:183], v[44:47], a[36:39], 0
    ds_read_b64_tr_b16 v[60:61], v4 offset:8192
    v_mul_f32 v104, s56, v104
    v_mfma_f32_16x16x32_bf16 v[184:187], v[44:47], a[40:43], 0
    buffer_store_dwordx4 v[216:219], v5, s[20:23], s65 offen offset:2048 sc1
    v_mfma_f32_16x16x32_bf16 v[188:191], v[44:47], a[44:47], 0
    ds_read_b64_tr_b16 v[62:63], v4 offset:9216
    v_mul_f32 v124, v108, v124
    v_mfma_f32_16x16x32_bf16 v[160:163], v[48:51], a[48:51], v[160:163]
    ds_read_b64_tr_b16 v[40:41], v4 offset:4096
    v_mul_f32 v108, s56, v108
    v_mfma_f32_16x16x32_bf16 v[164:167], v[48:51], a[52:55], v[164:167]
    ds_read_b64_tr_b16 v[42:43], v4 offset:5120
    v_mul_f32 v144, v128, v144
    v_mfma_f32_16x16x32_bf16 v[168:171], v[48:51], a[56:59], v[168:171]
    buffer_store_dwordx4 v[220:223], v5, s[20:23], s65 offen offset:3072 sc1
    v_mfma_f32_16x16x32_bf16 v[172:175], v[48:51], a[60:63], v[172:175]
    s_waitcnt lgkmcnt(3)
    v_exp_f32 v97, v97
    v_mfma_f32_16x16x32_bf16 v[176:179], v[52:55], a[48:51], v[176:179]
    ds_read_b64_tr_b16 v[44:45], v4 offset:12288
    v_add_f32 v97, 1.0, v97
    v_mfma_f32_16x16x32_bf16 v[180:183], v[52:55], a[52:55], v[180:183]
    ds_read_b64_tr_b16 v[46:47], v4 offset:13312
    v_mul_f32 v128, s56, v128
    v_mfma_f32_16x16x32_bf16 v[184:187], v[52:55], a[56:59], v[184:187]
    v_rcp_f32 v97, v97
    v_mfma_f32_16x16x32_bf16 v[188:191], v[52:55], a[60:63], v[188:191]
    v_rcp_f32 v100, v100
    v_mfma_f32_16x16x32_bf16 v[224:227], v[56:59], a[32:35], 0
    ds_read_b64_tr_b16 v[48:49], v3 offset:16384
    v_mul_f32 v97, v97, v113
    v_mfma_f32_16x16x32_bf16 v[228:231], v[56:59], a[36:39], 0
    ds_read_b64_tr_b16 v[50:51], v3 offset:17408
    v_cvt_pk_bf16_f32 v208, v96, v97
    v_mfma_f32_16x16x32_bf16 v[232:235], v[56:59], a[40:43], 0
    v_exp_f32 v104, v104
    v_mfma_f32_16x16x32_bf16 v[236:239], v[56:59], a[44:47], 0
    s_waitcnt lgkmcnt(2)
    v_exp_f32 v108, v108
    v_mfma_f32_16x16x32_bf16 v[240:243], v[60:63], a[32:35], 0
    ds_read_b64_tr_b16 v[52:53], v3 offset:24576
    v_mul_f32 v114, v98, v114
    v_mfma_f32_16x16x32_bf16 v[244:247], v[60:63], a[36:39], 0
    ds_read_b64_tr_b16 v[54:55], v3 offset:25600
    v_mul_f32 v98, s56, v98
    v_mfma_f32_16x16x32_bf16 v[248:251], v[60:63], a[40:43], 0
    v_exp_f32 v98, v98
    v_mfma_f32_16x16x32_bf16 v[252:255], v[60:63], a[44:47], 0
    v_exp_f32 v128, v128
    v_mfma_f32_16x16x32_bf16 v[224:227], v[40:43], a[48:51], v[224:227]
    ds_read_b64_tr_b16 v[56:57], v3 offset:20480
    v_add_f32 v98, 1.0, v98
    v_mfma_f32_16x16x32_bf16 v[228:231], v[40:43], a[52:55], v[228:231]
    ds_read_b64_tr_b16 v[58:59], v3 offset:21504
    v_mul_f32 v100, v100, v116
    v_mfma_f32_16x16x32_bf16 v[232:235], v[40:43], a[56:59], v[232:235]
    v_rcp_f32 v98, v98
    v_mfma_f32_16x16x32_bf16 v[236:239], v[40:43], a[60:63], v[236:239]
    v_mul_f32 v98, v98, v114
    v_mul_f32 v115, v99, v115
    v_mfma_f32_16x16x32_bf16 v[240:243], v[44:47], a[48:51], v[240:243]
    ds_read_b64_tr_b16 v[60:61], v3 offset:28672
    v_mul_f32 v99, s56, v99
    v_mfma_f32_16x16x32_bf16 v[244:247], v[44:47], a[52:55], v[244:247]
    ds_read_b64_tr_b16 v[62:63], v3 offset:29696
    v_mul_f32 v117, v101, v117
    v_mfma_f32_16x16x32_bf16 v[248:251], v[44:47], a[56:59], v[248:251]
    v_exp_f32 v99, v99
    v_mfma_f32_16x16x32_bf16 v[252:255], v[44:47], a[60:63], v[252:255]
    s_waitcnt lgkmcnt(2)
    v_add_f32 v99, 1.0, v99
    v_mul_f32 v101, s56, v101
    v_mfma_f32_16x16x32_bf16 v[160:163], v[48:51], a[64:67], v[160:163]
    ds_read_b64_tr_b16 v[40:41], v4 offset:16384
    v_add_f32 v104, 1.0, v104
    v_mfma_f32_16x16x32_bf16 v[164:167], v[48:51], a[68:71], v[164:167]
    ds_read_b64_tr_b16 v[42:43], v4 offset:17408
    v_add_f32 v108, 1.0, v108
    v_mfma_f32_16x16x32_bf16 v[168:171], v[48:51], a[72:75], v[168:171]
    v_rcp_f32 v99, v99
    v_mfma_f32_16x16x32_bf16 v[172:175], v[48:51], a[76:79], v[172:175]
    v_exp_f32 v101, v101
    v_mfma_f32_16x16x32_bf16 v[176:179], v[52:55], a[64:67], v[176:179]
    ds_read_b64_tr_b16 v[44:45], v4 offset:24576
    v_mul_f32 v99, v99, v115
    v_mfma_f32_16x16x32_bf16 v[180:183], v[52:55], a[68:71], v[180:183]
    ds_read_b64_tr_b16 v[46:47], v4 offset:25600
    v_cvt_pk_bf16_f32 v209, v98, v99
    v_mfma_f32_16x16x32_bf16 v[184:187], v[52:55], a[72:75], v[184:187]
    v_rcp_f32 v104, v104
    v_mfma_f32_16x16x32_bf16 v[188:191], v[52:55], a[76:79], v[188:191]
    v_rcp_f32 v108, v108
    v_mfma_f32_16x16x32_bf16 v[160:163], v[56:59], a[80:83], v[160:163]
    ds_read_b64_tr_b16 v[48:49], v4 offset:20480
    v_add_f32 v101, 1.0, v101
    v_mfma_f32_16x16x32_bf16 v[164:167], v[56:59], a[84:87], v[164:167]
    ds_read_b64_tr_b16 v[50:51], v4 offset:21504
    v_mul_f32 v104, v104, v120
    v_mfma_f32_16x16x32_bf16 v[168:171], v[56:59], a[88:91], v[168:171]
    v_rcp_f32 v101, v101
    v_mfma_f32_16x16x32_bf16 v[172:175], v[56:59], a[92:95], v[172:175]
    s_waitcnt lgkmcnt(2)
    v_mul_f32 v101, v101, v117
    v_cvt_pk_bf16_f32 v212, v100, v101
    v_mfma_f32_16x16x32_bf16 v[176:179], v[60:63], a[80:83], v[176:179]
    ds_read_b64_tr_b16 v[52:53], v4 offset:28672
    v_mul_f32 v118, v102, v118
    v_mfma_f32_16x16x32_bf16 v[180:183], v[60:63], a[84:87], v[180:183]
    ds_read_b64_tr_b16 v[54:55], v4 offset:29696
    v_mul_f32 v102, s56, v102
    v_mfma_f32_16x16x32_bf16 v[184:187], v[60:63], a[88:91], v[184:187]
    v_exp_f32 v102, v102
    v_mfma_f32_16x16x32_bf16 v[188:191], v[60:63], a[92:95], v[188:191]
    v_add_f32 v102, 1.0, v102
    v_mul_f32 v121, v105, v121
    v_mfma_f32_16x16x32_bf16 v[224:227], v[40:43], a[64:67], v[224:227]
    ds_read_b64_tr_b16 v[56:57], v3 offset:32768
    v_mul_f32 v105, s56, v105
    v_mfma_f32_16x16x32_bf16 v[228:231], v[40:43], a[68:71], v[228:231]
    ds_read_b64_tr_b16 v[58:59], v3 offset:33792
    v_mul_f32 v108, v108, v124
    v_mfma_f32_16x16x32_bf16 v[232:235], v[40:43], a[72:75], v[232:235]
    v_rcp_f32 v102, v102
    v_mfma_f32_16x16x32_bf16 v[236:239], v[40:43], a[76:79], v[236:239]
    v_exp_f32 v105, v105
    v_mfma_f32_16x16x32_bf16 v[240:243], v[44:47], a[64:67], v[240:243]
    ds_read_b64_tr_b16 v[60:61], v3 offset:40960
    v_mul_f32 v102, v102, v118
    v_mfma_f32_16x16x32_bf16 v[244:247], v[44:47], a[68:71], v[244:247]
    ds_read_b64_tr_b16 v[62:63], v3 offset:41984
    v_mul_f32 v119, v103, v119
    v_mfma_f32_16x16x32_bf16 v[248:251], v[44:47], a[72:75], v[248:251]
    v_mul_f32 v103, s56, v103
    v_add_f32 v105, 1.0, v105
    v_mfma_f32_16x16x32_bf16 v[252:255], v[44:47], a[76:79], v[252:255]
    s_waitcnt lgkmcnt(2)
    v_exp_f32 v103, v103
    v_mfma_f32_16x16x32_bf16 v[224:227], v[48:51], a[80:83], v[224:227]
    ds_read_b64_tr_b16 v[40:41], v3 offset:36864
    v_add_f32 v103, 1.0, v103
    v_mfma_f32_16x16x32_bf16 v[228:231], v[48:51], a[84:87], v[228:231]
    ds_read_b64_tr_b16 v[42:43], v3 offset:37888
    v_mul_f32 v125, v109, v125
    v_mfma_f32_16x16x32_bf16 v[232:235], v[48:51], a[88:91], v[232:235]
    v_rcp_f32 v103, v103
    v_mfma_f32_16x16x32_bf16 v[236:239], v[48:51], a[92:95], v[236:239]
    v_rcp_f32 v105, v105
    v_mfma_f32_16x16x32_bf16 v[240:243], v[52:55], a[80:83], v[240:243]
    ds_read_b64_tr_b16 v[44:45], v3 offset:45056
    v_mul_f32 v103, v103, v119
    v_mfma_f32_16x16x32_bf16 v[244:247], v[52:55], a[84:87], v[244:247]
    ds_read_b64_tr_b16 v[46:47], v3 offset:46080
    v_cvt_pk_bf16_f32 v213, v102, v103
    v_mfma_f32_16x16x32_bf16 v[248:251], v[52:55], a[88:91], v[248:251]
    v_mul_f32 v105, v105, v121
    v_cvt_pk_bf16_f32 v216, v104, v105
    v_mfma_f32_16x16x32_bf16 v[252:255], v[52:55], a[92:95], v[252:255]
    s_waitcnt lgkmcnt(2)
    s_barrier
    v_mul_f32 v122, v106, v122
    v_mfma_f32_16x16x32_bf16 v[160:163], v[56:59], a[96:99], v[160:163]
    s_lshl1_add_u32 m0, s74, 65536
    ds_read_b64_tr_b16 v[48:49], v4 offset:32768
    v_mul_f32 v106, s56, v106
    v_mfma_f32_16x16x32_bf16 v[164:167], v[56:59], a[100:103], v[164:167]
    buffer_load_dwordx4 v2, s[12:15], s40 offen  lds
    v_mfma_f32_16x16x32_bf16 v[168:171], v[56:59], a[104:107], v[168:171]
    ds_read_b64_tr_b16 v[50:51], v4 offset:33792
    v_mul_f32 v109, s56, v109
    v_mfma_f32_16x16x32_bf16 v[172:175], v[56:59], a[108:111], v[172:175]
    v_exp_f32 v106, v106
    v_mfma_f32_16x16x32_bf16 v[176:179], v[60:63], a[96:99], v[176:179]
    ds_read_b64_tr_b16 v[52:53], v4 offset:40960
    v_add_f32 v106, 1.0, v106
    v_mfma_f32_16x16x32_bf16 v[180:183], v[60:63], a[100:103], v[180:183]
    buffer_load_dwordx4 v2, s[12:15], vcc_lo offen offset:1024  lds
    v_mfma_f32_16x16x32_bf16 v[184:187], v[60:63], a[104:107], v[184:187]
    s_lshl1_add_u32 m0, s74, 73728
    ds_read_b64_tr_b16 v[54:55], v4 offset:41984
    v_add_f32 v128, 1.0, v128
    v_mfma_f32_16x16x32_bf16 v[188:191], v[60:63], a[108:111], v[188:191]
    v_rcp_f32 v106, v106
    v_mfma_f32_16x16x32_bf16 v[160:163], v[40:43], a[112:115], v[160:163]
    ds_read_b64_tr_b16 v[56:57], v4 offset:36864
    v_mul_f32 v106, v106, v122
    v_mfma_f32_16x16x32_bf16 v[164:167], v[40:43], a[116:119], v[164:167]
    buffer_load_dwordx4 v2, s[16:19], s40 offen  lds
    v_mfma_f32_16x16x32_bf16 v[168:171], v[40:43], a[120:123], v[168:171]
    ds_read_b64_tr_b16 v[58:59], v4 offset:37888
    v_mul_f32 v123, v107, v123
    v_mfma_f32_16x16x32_bf16 v[172:175], v[40:43], a[124:127], v[172:175]
    s_waitcnt lgkmcnt(3)
    v_exp_f32 v109, v109
    v_mfma_f32_16x16x32_bf16 v[176:179], v[44:47], a[112:115], v[176:179]
    ds_read_b64_tr_b16 v[60:61], v4 offset:45056
    v_mul_f32 v107, s56, v107
    v_mfma_f32_16x16x32_bf16 v[180:183], v[44:47], a[116:119], v[180:183]
    buffer_load_dwordx4 v2, s[16:19], vcc_lo offen offset:1024  lds
    v_mfma_f32_16x16x32_bf16 v[184:187], v[44:47], a[120:123], v[184:187]
    s_add_u32 vcc_lo, s41, 35840
    ds_read_b64_tr_b16 v[62:63], v4 offset:46080
    v_add_f32 v109, 1.0, v109
    v_mfma_f32_16x16x32_bf16 v[188:191], v[44:47], a[124:127], v[188:191]
    s_lshl1_add_u32 m0, s74, 81920
    v_exp_f32 v107, v107
    v_mfma_f32_16x16x32_bf16 v[224:227], v[48:51], a[96:99], v[224:227]
    s_waitcnt vmcnt(4)
    ds_read_b64_tr_b16 v[40:41], v3 offset:49152
    v_add_f32 v107, 1.0, v107
    v_mfma_f32_16x16x32_bf16 v[228:231], v[48:51], a[100:103], v[228:231]
    buffer_store_dword v4, v6, s[20:23], s61 offen offset:0 sc1
    v_mfma_f32_16x16x32_bf16 v[232:235], v[48:51], a[104:107], v[232:235]
    buffer_load_dwordx4 v2, s[12:15], s41 offen  lds
    v_mfma_f32_16x16x32_bf16 v[236:239], v[48:51], a[108:111], v[236:239]
    s_waitcnt lgkmcnt(2)
    ds_read_b64_tr_b16 v[42:43], v3 offset:50176
    v_mul_f32 v148, v132, v148
    v_mfma_f32_16x16x32_bf16 v[240:243], v[52:55], a[96:99], v[240:243]
    ds_read_b64_tr_b16 v[44:45], v3 offset:57344
    v_mul_f32 v132, s56, v132
    v_mfma_f32_16x16x32_bf16 v[244:247], v[52:55], a[100:103], v[244:247]
    ds_read_b64_tr_b16 v[46:47], v3 offset:58368
    v_mul_f32 v152, v136, v152
    v_mfma_f32_16x16x32_bf16 v[248:251], v[52:55], a[104:107], v[248:251]
    buffer_load_dwordx4 v2, s[12:15], vcc_lo offen offset:1024  lds
    v_mfma_f32_16x16x32_bf16 v[252:255], v[52:55], a[108:111], v[252:255]
    s_lshl1_add_u32 m0, s74, 90112
    v_rcp_f32 v107, v107
    v_mfma_f32_16x16x32_bf16 v[224:227], v[56:59], a[112:115], v[224:227]
    ds_read_b64_tr_b16 v[48:49], v3 offset:53248
    v_mul_f32 v107, v107, v123
    v_mfma_f32_16x16x32_bf16 v[228:231], v[56:59], a[116:119], v[228:231]
    ds_read_b64_tr_b16 v[50:51], v3 offset:54272
    v_cvt_pk_bf16_f32 v217, v106, v107
    v_mfma_f32_16x16x32_bf16 v[232:235], v[56:59], a[120:123], v[232:235]
    buffer_load_dwordx4 v2, s[16:19], s41 offen  lds
    v_mfma_f32_16x16x32_bf16 v[236:239], v[56:59], a[124:127], v[236:239]
    s_waitcnt lgkmcnt(2)
    v_rcp_f32 v109, v109
    v_mfma_f32_16x16x32_bf16 v[240:243], v[60:63], a[112:115], v[240:243]
    ds_read_b64_tr_b16 v[52:53], v3 offset:61440
    v_mul_f32 v109, v109, v125
    v_mfma_f32_16x16x32_bf16 v[244:247], v[60:63], a[116:119], v[244:247]
    ds_read_b64_tr_b16 v[54:55], v3 offset:62464
    v_cvt_pk_bf16_f32 v220, v108, v109
    v_mfma_f32_16x16x32_bf16 v[248:251], v[60:63], a[120:123], v[248:251]
    buffer_load_dwordx4 v2, s[16:19], vcc_lo offen offset:1024  lds
    v_mfma_f32_16x16x32_bf16 v[252:255], v[60:63], a[124:127], v[252:255]
    s_add_u32 vcc_lo, s42, 35840
    v_rcp_f32 v128, v128
    v_mfma_f32_16x16x32_bf16 v[160:163], v[40:43], a[128:131], v[160:163]
    ds_read_b64_tr_b16 v[56:57], v4 offset:49152
    v_mul_f32 v126, v110, v126
    v_mfma_f32_16x16x32_bf16 v[164:167], v[40:43], a[132:135], v[164:167]
    ds_read_b64_tr_b16 v[58:59], v4 offset:50176
    v_mul_f32 v110, s56, v110
    v_mfma_f32_16x16x32_bf16 v[168:171], v[40:43], a[136:139], v[168:171]
    v_exp_f32 v110, v110
    v_mfma_f32_16x16x32_bf16 v[172:175], v[40:43], a[140:143], v[172:175]
    v_exp_f32 v132, v132
    v_mfma_f32_16x16x32_bf16 v[176:179], v[44:47], a[128:131], v[176:179]
    ds_read_b64_tr_b16 v[60:61], v4 offset:57344
    v_add_f32 v110, 1.0, v110
    v_mfma_f32_16x16x32_bf16 v[180:183], v[44:47], a[132:135], v[180:183]
    ds_read_b64_tr_b16 v[62:63], v4 offset:58368
    v_mul_f32 v128, v128, v144
    v_mfma_f32_16x16x32_bf16 v[184:187], v[44:47], a[136:139], v[184:187]
    v_rcp_f32 v110, v110
    v_mfma_f32_16x16x32_bf16 v[188:191], v[44:47], a[140:143], v[188:191]
    s_waitcnt lgkmcnt(2)
    v_mul_f32 v110, v110, v126
    v_mul_f32 v127, v111, v127
    v_mfma_f32_16x16x32_bf16 v[160:163], v[48:51], a[144:147], v[160:163]
    ds_read_b64_tr_b16 v[40:41], v4 offset:53248
    v_mul_f32 v111, s56, v111
    v_mfma_f32_16x16x32_bf16 v[164:167], v[48:51], a[148:151], v[164:167]
    ds_read_b64_tr_b16 v[42:43], v4 offset:54272
    v_mul_f32 v145, v129, v145
    v_mfma_f32_16x16x32_bf16 v[168:171], v[48:51], a[152:155], v[168:171]
    v_exp_f32 v111, v111
    v_mfma_f32_16x16x32_bf16 v[172:175], v[48:51], a[156:159], v[172:175]
    v_add_f32 v111, 1.0, v111
    v_mul_f32 v129, s56, v129
    v_mfma_f32_16x16x32_bf16 v[176:179], v[52:55], a[144:147], v[176:179]
    ds_read_b64_tr_b16 v[44:45], v4 offset:61440
    v_add_f32 v132, 1.0, v132
    v_mfma_f32_16x16x32_bf16 v[180:183], v[52:55], a[148:151], v[180:183]
    ds_read_b64_tr_b16 v[46:47], v4 offset:62464
    v_mul_f32 v136, s56, v136
    v_mfma_f32_16x16x32_bf16 v[184:187], v[52:55], a[152:155], v[184:187]
    v_rcp_f32 v111, v111
    v_mfma_f32_16x16x32_bf16 v[188:191], v[52:55], a[156:159], v[188:191]
    v_exp_f32 v129, v129
    v_mfma_f32_16x16x32_bf16 v[224:227], v[56:59], a[128:131], v[224:227]
    v_add_u32 v3, 0x10000, v3
    v_mul_f32 v111, v111, v127
    v_mfma_f32_16x16x32_bf16 v[228:231], v[56:59], a[132:135], v[228:231]
    ds_read_b64_tr_b16 v[48:49], v3 offset:0
    v_cvt_pk_bf16_f32 v221, v110, v111
    v_mfma_f32_16x16x32_bf16 v[232:235], v[56:59], a[136:139], v[232:235]
    ds_read_b64_tr_b16 v[50:51], v3 offset:1024
    v_add_f32 v129, 1.0, v129
    v_mfma_f32_16x16x32_bf16 v[236:239], v[56:59], a[140:143], v[236:239]
    s_waitcnt lgkmcnt(2)
    v_rcp_f32 v129, v129
    v_mfma_f32_16x16x32_bf16 v[240:243], v[60:63], a[128:131], v[240:243]
    ds_read_b64_tr_b16 v[52:53], v3 offset:8192
    v_mul_f32 v129, v129, v145
    v_mfma_f32_16x16x32_bf16 v[244:247], v[60:63], a[132:135], v[244:247]
    ds_read_b64_tr_b16 v[54:55], v3 offset:9216
    v_cvt_pk_bf16_f32 v210, v128, v129
    v_mfma_f32_16x16x32_bf16 v[248:251], v[60:63], a[136:139], v[248:251]
    v_rcp_f32 v132, v132
    v_mfma_f32_16x16x32_bf16 v[252:255], v[60:63], a[140:143], v[252:255]
    v_exp_f32 v136, v136
    v_mfma_f32_16x16x32_bf16 v[224:227], v[40:43], a[144:147], v[224:227]
    ds_read_b64_tr_b16 v[56:57], v3 offset:4096
    v_mul_f32 v146, v130, v146
    v_mfma_f32_16x16x32_bf16 v[228:231], v[40:43], a[148:151], v[228:231]
    ds_read_b64_tr_b16 v[58:59], v3 offset:5120
    v_mul_f32 v130, s56, v130
    v_mfma_f32_16x16x32_bf16 v[232:235], v[40:43], a[152:155], v[232:235]
    v_exp_f32 v130, v130
    v_mfma_f32_16x16x32_bf16 v[236:239], v[40:43], a[156:159], v[236:239]
    v_add_f32 v130, 1.0, v130
    v_mul_f32 v132, v132, v148
    v_mfma_f32_16x16x32_bf16 v[240:243], v[44:47], a[144:147], v[240:243]
    ds_read_b64_tr_b16 v[60:61], v3 offset:12288
    v_mul_f32 v149, v133, v149
    v_mfma_f32_16x16x32_bf16 v[244:247], v[44:47], a[148:151], v[244:247]
    ds_read_b64_tr_b16 v[62:63], v3 offset:13312
    v_mul_f32 v133, s56, v133
    v_mfma_f32_16x16x32_bf16 v[248:251], v[44:47], a[152:155], v[248:251]
    v_rcp_f32 v130, v130
    v_mfma_f32_16x16x32_bf16 v[252:255], v[44:47], a[156:159], v[252:255]
    s_waitcnt lgkmcnt(2)
    s_barrier
    v_mul_f32 v130, v130, v146
    v_mfma_f32_16x16x32_bf16 v[160:163], v[48:51], a[0:3], v[160:163]
    s_lshl1_add_u32 m0, s74, 98304
    v_add_u32 v4, 0x10000, v4
    v_mul_f32 v147, v131, v147
    v_mfma_f32_16x16x32_bf16 v[164:167], v[48:51], a[4:7], v[164:167]
    buffer_load_dwordx4 v2, s[12:15], s42 offen  lds
    v_mfma_f32_16x16x32_bf16 v[168:171], v[48:51], a[8:11], v[168:171]
    s_branch gated_mix__ssm_conv_s5__swiglu_ffn__prompt_kernel_B_sk4
.p2align 12
gated_mix__ssm_conv_s5__swiglu_ffn__prompt_kernel_B_pg1_4:
    s_branch gated_mix__ssm_conv_s5__swiglu_ffn__prompt_kernel_B_pr1
gated_mix__ssm_conv_s5__swiglu_ffn__prompt_kernel_B_sk4:
    ds_read_b64_tr_b16 v[40:41], v4 offset:0
    v_mul_f32 v131, s56, v131
    v_mfma_f32_16x16x32_bf16 v[172:175], v[48:51], a[12:15], v[172:175]
    ds_read_b64_tr_b16 v[42:43], v4 offset:1024
    v_add_f32 v136, 1.0, v136
    v_mfma_f32_16x16x32_bf16 v[176:179], v[52:55], a[0:3], v[176:179]
    ds_read_b64_tr_b16 v[44:45], v4 offset:8192
    v_mul_f32 v156, v140, v156
    v_mfma_f32_16x16x32_bf16 v[180:183], v[52:55], a[4:7], v[180:183]
    buffer_load_dwordx4 v2, s[12:15], vcc_lo offen offset:1024  lds
    v_mfma_f32_16x16x32_bf16 v[184:187], v[52:55], a[8:11], v[184:187]
    s_lshl1_add_u32 m0, s74, 106496
    ds_read_b64_tr_b16 v[46:47], v4 offset:9216
    v_mul_f32 v140, s56, v140
    v_mfma_f32_16x16x32_bf16 v[188:191], v[52:55], a[12:15], v[188:191]
    v_exp_f32 v131, v131
    v_mfma_f32_16x16x32_bf16 v[160:163], v[56:59], a[16:19], v[160:163]
    ds_read_b64_tr_b16 v[48:49], v4 offset:4096
    v_add_f32 v131, 1.0, v131
    v_mfma_f32_16x16x32_bf16 v[164:167], v[56:59], a[20:23], v[164:167]
    buffer_load_dwordx4 v2, s[16:19], s42 offen  lds
    v_mfma_f32_16x16x32_bf16 v[168:171], v[56:59], a[24:27], v[168:171]
    ds_read_b64_tr_b16 v[50:51], v4 offset:5120
    v_mfma_f32_16x16x32_bf16 v[172:175], v[56:59], a[28:31], v[172:175]
    s_waitcnt lgkmcnt(3)
    v_rcp_f32 v131, v131
    v_mfma_f32_16x16x32_bf16 v[176:179], v[60:63], a[16:19], v[176:179]
    ds_read_b64_tr_b16 v[52:53], v4 offset:12288
    v_mul_f32 v131, v131, v147
    v_mfma_f32_16x16x32_bf16 v[180:183], v[60:63], a[20:23], v[180:183]
    buffer_load_dwordx4 v2, s[16:19], vcc_lo offen offset:1024  lds
    v_mfma_f32_16x16x32_bf16 v[184:187], v[60:63], a[24:27], v[184:187]
    s_add_u32 vcc_lo, s43, 35840
    ds_read_b64_tr_b16 v[54:55], v4 offset:13312
    v_cvt_pk_bf16_f32 v211, v130, v131
    v_mfma_f32_16x16x32_bf16 v[188:191], v[60:63], a[28:31], v[188:191]
    s_lshl1_add_u32 m0, s74, 114688
    v_exp_f32 v133, v133
    v_mfma_f32_16x16x32_bf16 v[224:227], v[40:43], a[0:3], v[224:227]
    v_add_u32 v3, 0xfffe0000, v3
    v_add_f32 v133, 1.0, v133
    v_mfma_f32_16x16x32_bf16 v[228:231], v[40:43], a[4:7], v[228:231]
    buffer_load_dwordx4 v2, s[12:15], s43 offen  lds
    v_mfma_f32_16x16x32_bf16 v[232:235], v[40:43], a[8:11], v[232:235]
    ds_read_b64_tr_b16 v[56:57], v3 offset:0
    v_mfma_f32_16x16x32_bf16 v[236:239], v[40:43], a[12:15], v[236:239]
    s_waitcnt lgkmcnt(2)
    ds_read_b64_tr_b16 v[58:59], v3 offset:1024
    v_mfma_f32_16x16x32_bf16 v[240:243], v[44:47], a[0:3], v[240:243]
    ds_read_b64_tr_b16 v[60:61], v3 offset:8192
    v_mfma_f32_16x16x32_bf16 v[244:247], v[44:47], a[4:7], v[244:247]
    buffer_load_dwordx4 v2, s[12:15], vcc_lo offen offset:1024  lds
    v_mfma_f32_16x16x32_bf16 v[248:251], v[44:47], a[8:11], v[248:251]
    s_lshl1_add_u32 m0, s74, 122880
    ds_read_b64_tr_b16 v[62:63], v3 offset:9216
    v_mfma_f32_16x16x32_bf16 v[252:255], v[44:47], a[12:15], v[252:255]
    v_rcp_f32 v133, v133
    v_mfma_f32_16x16x32_bf16 v[224:227], v[48:51], a[16:19], v[224:227]
    ds_read_b64_tr_b16 v[40:41], v3 offset:4096
    v_mul_f32 v133, v133, v149
    v_mfma_f32_16x16x32_bf16 v[228:231], v[48:51], a[20:23], v[228:231]
    buffer_load_dwordx4 v2, s[16:19], s43 offen  lds
    v_mfma_f32_16x16x32_bf16 v[232:235], v[48:51], a[24:27], v[232:235]
    ds_read_b64_tr_b16 v[42:43], v3 offset:5120
    v_cvt_pk_bf16_f32 v214, v132, v133
    v_mfma_f32_16x16x32_bf16 v[236:239], v[48:51], a[28:31], v[236:239]
    s_waitcnt lgkmcnt(3)
    v_rcp_f32 v136, v136
    v_mfma_f32_16x16x32_bf16 v[240:243], v[52:55], a[16:19], v[240:243]
    ds_read_b64_tr_b16 v[44:45], v3 offset:12288
    v_mul_f32 v150, v134, v150
    v_mfma_f32_16x16x32_bf16 v[244:247], v[52:55], a[20:23], v[244:247]
    buffer_load_dwordx4 v2, s[16:19], vcc_lo offen offset:1024  lds
    v_mfma_f32_16x16x32_bf16 v[248:251], v[52:55], a[24:27], v[248:251]
    s_add_u32 vcc_lo, s44, 35840
    ds_read_b64_tr_b16 v[46:47], v3 offset:13312
    v_mul_f32 v134, s56, v134
    v_mfma_f32_16x16x32_bf16 v[252:255], v[52:55], a[28:31], v[252:255]
    v_exp_f32 v134, v134
    v_mfma_f32_16x16x32_bf16 v[160:163], v[56:59], a[160:163], v[160:163]
    v_add_u32 v4, 0xfffe0000, v4
    v_add_f32 v134, 1.0, v134
    v_mfma_f32_16x16x32_bf16 v[164:167], v[56:59], a[164:167], v[164:167]
    ds_read_b64_tr_b16 v[48:49], v4 offset:0
    v_mul_f32 v136, v136, v152
    v_mfma_f32_16x16x32_bf16 v[168:171], v[56:59], a[168:171], v[168:171]
    ds_read_b64_tr_b16 v[50:51], v4 offset:1024
    v_mul_f32 v153, v137, v153
    v_mfma_f32_16x16x32_bf16 v[172:175], v[56:59], a[172:175], v[172:175]
    s_waitcnt lgkmcnt(3)
    v_rcp_f32 v134, v134
    v_mfma_f32_16x16x32_bf16 v[176:179], v[60:63], a[160:163], v[176:179]
    ds_read_b64_tr_b16 v[52:53], v4 offset:8192
    v_mul_f32 v134, v134, v150
    v_mfma_f32_16x16x32_bf16 v[180:183], v[60:63], a[164:167], v[180:183]
    ds_read_b64_tr_b16 v[54:55], v4 offset:9216
    v_mul_f32 v151, v135, v151
    v_mfma_f32_16x16x32_bf16 v[184:187], v[60:63], a[168:171], v[184:187]
    v_exp_f32 v140, v140
    v_mfma_f32_16x16x32_bf16 v[188:191], v[60:63], a[172:175], v[188:191]
    v_mul_f32 v135, s56, v135
    v_mul_f32 v137, s56, v137
    v_mfma_f32_16x16x32_bf16 v[160:163], v[40:43], a[176:179], v[160:163]
    ds_read_b64_tr_b16 v[56:57], v4 offset:4096
    v_add_f32 v140, 1.0, v140
    v_mfma_f32_16x16x32_bf16 v[164:167], v[40:43], a[180:183], v[164:167]
    ds_read_b64_tr_b16 v[58:59], v4 offset:5120
    v_mfma_f32_16x16x32_bf16 v[168:171], v[40:43], a[184:187], v[168:171]
    v_exp_f32 v135, v135
    v_mfma_f32_16x16x32_bf16 v[172:175], v[40:43], a[188:191], v[172:175]
    s_waitcnt lgkmcnt(2)
    v_exp_f32 v137, v137
    v_mfma_f32_16x16x32_bf16 v[176:179], v[44:47], a[176:179], v[176:179]
    ds_read_b64_tr_b16 v[60:61], v4 offset:12288
    v_add_f32 v135, 1.0, v135
    v_mfma_f32_16x16x32_bf16 v[180:183], v[44:47], a[180:183], v[180:183]
    ds_read_b64_tr_b16 v[62:63], v4 offset:13312
    v_add_f32 v137, 1.0, v137
    v_mfma_f32_16x16x32_bf16 v[184:187], v[44:47], a[184:187], v[184:187]
    v_rcp_f32 v135, v135
    v_mfma_f32_16x16x32_bf16 v[188:191], v[44:47], a[188:191], v[188:191]
    v_rcp_f32 v137, v137
    v_mfma_f32_16x16x32_bf16 v[224:227], v[48:51], a[160:163], v[224:227]
    ds_read_b64_tr_b16 v[40:41], v3 offset:16384
    v_mul_f32 v135, v135, v151
    v_mfma_f32_16x16x32_bf16 v[228:231], v[48:51], a[164:167], v[228:231]
    ds_read_b64_tr_b16 v[42:43], v3 offset:17408
    v_cvt_pk_bf16_f32 v215, v134, v135
    v_mfma_f32_16x16x32_bf16 v[232:235], v[48:51], a[168:171], v[232:235]
    v_rcp_f32 v140, v140
    v_mfma_f32_16x16x32_bf16 v[236:239], v[48:51], a[172:175], v[236:239]
    v_mul_f32 v137, v137, v153
    v_cvt_pk_bf16_f32 v218, v136, v137
    v_mfma_f32_16x16x32_bf16 v[240:243], v[52:55], a[160:163], v[240:243]
    ds_read_b64_tr_b16 v[44:45], v3 offset:24576
    v_mul_f32 v154, v138, v154
    v_mfma_f32_16x16x32_bf16 v[244:247], v[52:55], a[164:167], v[244:247]
    ds_read_b64_tr_b16 v[46:47], v3 offset:25600
    v_mul_f32 v138, s56, v138
    v_mfma_f32_16x16x32_bf16 v[248:251], v[52:55], a[168:171], v[248:251]
    v_exp_f32 v138, v138
    v_mfma_f32_16x16x32_bf16 v[252:255], v[52:55], a[172:175], v[252:255]
    s_waitcnt lgkmcnt(2)
    v_add_f32 v138, 1.0, v138
    v_mul_f32 v140, v140, v156
    v_mfma_f32_16x16x32_bf16 v[224:227], v[56:59], a[176:179], v[224:227]
    ds_read_b64_tr_b16 v[48:49], v3 offset:20480
    v_mul_f32 v157, v141, v157
    v_mfma_f32_16x16x32_bf16 v[228:231], v[56:59], a[180:183], v[228:231]
    ds_read_b64_tr_b16 v[50:51], v3 offset:21504
    v_mul_f32 v141, s56, v141
    v_mfma_f32_16x16x32_bf16 v[232:235], v[56:59], a[184:187], v[232:235]
    v_rcp_f32 v138, v138
    v_mfma_f32_16x16x32_bf16 v[236:239], v[56:59], a[188:191], v[236:239]
    v_exp_f32 v141, v141
    v_mfma_f32_16x16x32_bf16 v[240:243], v[60:63], a[176:179], v[240:243]
    ds_read_b64_tr_b16 v[52:53], v3 offset:28672
    v_mul_f32 v138, v138, v154
    v_mfma_f32_16x16x32_bf16 v[244:247], v[60:63], a[180:183], v[244:247]
    ds_read_b64_tr_b16 v[54:55], v3 offset:29696
    v_mul_f32 v155, v139, v155
    v_mfma_f32_16x16x32_bf16 v[248:251], v[60:63], a[184:187], v[248:251]
    v_mul_f32 v139, s56, v139
    v_add_f32 v141, 1.0, v141
    v_mfma_f32_16x16x32_bf16 v[252:255], v[60:63], a[188:191], v[252:255]
    s_waitcnt lgkmcnt(2)
    s_barrier
    v_mfma_f32_16x16x32_bf16 v[160:163], v[40:43], a[192:195], v[160:163]
    s_lshl1_add_u32 m0, s74, 131072
    ds_read_b64_tr_b16 v[56:57], v4 offset:16384
    v_mfma_f32_16x16x32_bf16 v[164:167], v[40:43], a[196:199], v[164:167]
    buffer_load_dwordx4 v2, s[12:15], s44 offen  lds
    v_mfma_f32_16x16x32_bf16 v[168:171], v[40:43], a[200:203], v[168:171]
    ds_read_b64_tr_b16 v[58:59], v4 offset:17408
    v_mfma_f32_16x16x32_bf16 v[172:175], v[40:43], a[204:207], v[172:175]
    v_exp_f32 v139, v139
    v_mfma_f32_16x16x32_bf16 v[176:179], v[44:47], a[192:195], v[176:179]
    ds_read_b64_tr_b16 v[60:61], v4 offset:24576
    v_add_f32 v139, 1.0, v139
    v_mfma_f32_16x16x32_bf16 v[180:183], v[44:47], a[196:199], v[180:183]
    buffer_load_dwordx4 v2, s[12:15], vcc_lo offen offset:1024  lds
    v_mfma_f32_16x16x32_bf16 v[184:187], v[44:47], a[200:203], v[184:187]
    s_lshl1_add_u32 m0, s74, 139264
    ds_read_b64_tr_b16 v[62:63], v4 offset:25600
    v_mfma_f32_16x16x32_bf16 v[188:191], v[44:47], a[204:207], v[188:191]
    v_rcp_f32 v139, v139
    v_mfma_f32_16x16x32_bf16 v[160:163], v[48:51], a[208:211], v[160:163]
    ds_read_b64_tr_b16 v[40:41], v4 offset:20480
    v_mul_f32 v139, v139, v155
    v_mfma_f32_16x16x32_bf16 v[164:167], v[48:51], a[212:215], v[164:167]
    buffer_load_dwordx4 v2, s[16:19], s44 offen  lds
    v_mfma_f32_16x16x32_bf16 v[168:171], v[48:51], a[216:219], v[168:171]
    ds_read_b64_tr_b16 v[42:43], v4 offset:21504
    v_cvt_pk_bf16_f32 v219, v138, v139
    v_mfma_f32_16x16x32_bf16 v[172:175], v[48:51], a[220:223], v[172:175]
    s_waitcnt lgkmcnt(3)
    v_rcp_f32 v141, v141
    v_mfma_f32_16x16x32_bf16 v[176:179], v[52:55], a[208:211], v[176:179]
    ds_read_b64_tr_b16 v[44:45], v4 offset:28672
    v_mul_f32 v141, v141, v157
    v_mfma_f32_16x16x32_bf16 v[180:183], v[52:55], a[212:215], v[180:183]
    buffer_load_dwordx4 v2, s[16:19], vcc_lo offen offset:1024  lds
    v_mfma_f32_16x16x32_bf16 v[184:187], v[52:55], a[216:219], v[184:187]
    s_add_u32 vcc_lo, s45, 35840
    ds_read_b64_tr_b16 v[46:47], v4 offset:29696
    v_cvt_pk_bf16_f32 v222, v140, v141
    v_mfma_f32_16x16x32_bf16 v[188:191], v[52:55], a[220:223], v[188:191]
    s_lshl1_add_u32 m0, s74, 0
    v_mul_f32 v158, v142, v158
    v_mul_f32 v142, s56, v142
    v_mfma_f32_16x16x32_bf16 v[224:227], v[56:59], a[192:195], v[224:227]
    ds_read_b64_tr_b16 v[48:49], v3 offset:32768
    v_mfma_f32_16x16x32_bf16 v[228:231], v[56:59], a[196:199], v[228:231]
    buffer_load_dwordx4 v2, s[12:15], s45 offen  lds
    v_mfma_f32_16x16x32_bf16 v[232:235], v[56:59], a[200:203], v[232:235]
    ds_read_b64_tr_b16 v[50:51], v3 offset:33792
    v_mfma_f32_16x16x32_bf16 v[236:239], v[56:59], a[204:207], v[236:239]
    s_waitcnt lgkmcnt(3)
    v_exp_f32 v142, v142
    v_mfma_f32_16x16x32_bf16 v[240:243], v[60:63], a[192:195], v[240:243]
    ds_read_b64_tr_b16 v[52:53], v3 offset:40960
    v_add_f32 v142, 1.0, v142
    v_mfma_f32_16x16x32_bf16 v[244:247], v[60:63], a[196:199], v[244:247]
    buffer_load_dwordx4 v2, s[12:15], vcc_lo offen offset:1024  lds
    v_mfma_f32_16x16x32_bf16 v[248:251], v[60:63], a[200:203], v[248:251]
    s_lshl1_add_u32 m0, s74, 8192
    ds_read_b64_tr_b16 v[54:55], v3 offset:41984
    v_mfma_f32_16x16x32_bf16 v[252:255], v[60:63], a[204:207], v[252:255]
    v_rcp_f32 v142, v142
    v_mfma_f32_16x16x32_bf16 v[224:227], v[40:43], a[208:211], v[224:227]
    ds_read_b64_tr_b16 v[56:57], v3 offset:36864
    v_mul_f32 v142, v142, v158
    v_mfma_f32_16x16x32_bf16 v[228:231], v[40:43], a[212:215], v[228:231]
    buffer_load_dwordx4 v2, s[16:19], s45 offen  lds
    v_mfma_f32_16x16x32_bf16 v[232:235], v[40:43], a[216:219], v[232:235]
    ds_read_b64_tr_b16 v[58:59], v3 offset:37888
    v_mul_f32 v159, v143, v159
    v_mfma_f32_16x16x32_bf16 v[236:239], v[40:43], a[220:223], v[236:239]
    s_waitcnt lgkmcnt(3)
    v_mul_f32 v143, s56, v143
    v_mfma_f32_16x16x32_bf16 v[240:243], v[44:47], a[208:211], v[240:243]
    ds_read_b64_tr_b16 v[60:61], v3 offset:45056
    v_mfma_f32_16x16x32_bf16 v[244:247], v[44:47], a[212:215], v[244:247]
    buffer_load_dwordx4 v2, s[16:19], vcc_lo offen offset:1024  lds
    v_mfma_f32_16x16x32_bf16 v[248:251], v[44:47], a[216:219], v[248:251]
    s_add_u32 vcc_lo, s46, 35840
    ds_read_b64_tr_b16 v[62:63], v3 offset:46080
    v_mfma_f32_16x16x32_bf16 v[252:255], v[44:47], a[220:223], v[252:255]
    v_exp_f32 v143, v143
    v_mfma_f32_16x16x32_bf16 v[160:163], v[48:51], a[224:227], v[160:163]
    ds_read_b64_tr_b16 v[40:41], v4 offset:32768
    v_add_f32 v143, 1.0, v143
    v_mfma_f32_16x16x32_bf16 v[164:167], v[48:51], a[228:231], v[164:167]
    ds_read_b64_tr_b16 v[42:43], v4 offset:33792
    v_mfma_f32_16x16x32_bf16 v[168:171], v[48:51], a[232:235], v[168:171]
    v_rcp_f32 v143, v143
    v_mfma_f32_16x16x32_bf16 v[172:175], v[48:51], a[236:239], v[172:175]
    s_waitcnt lgkmcnt(3)
    v_mul_f32 v143, v143, v159
    v_cvt_pk_bf16_f32 v223, v142, v143
    v_mfma_f32_16x16x32_bf16 v[176:179], v[52:55], a[224:227], v[176:179]
    ds_read_b64_tr_b16 v[44:45], v4 offset:40960
    v_mfma_f32_16x16x32_bf16 v[180:183], v[52:55], a[228:231], v[180:183]
    ds_read_b64_tr_b16 v[46:47], v4 offset:41984
    v_mfma_f32_16x16x32_bf16 v[184:187], v[52:55], a[232:235], v[184:187]
    v_mfma_f32_16x16x32_bf16 v[188:191], v[52:55], a[236:239], v[188:191]
    v_mfma_f32_16x16x32_bf16 v[160:163], v[56:59], a[240:243], v[160:163]
    ds_read_b64_tr_b16 v[48:49], v4 offset:36864
    v_mfma_f32_16x16x32_bf16 v[164:167], v[56:59], a[244:247], v[164:167]
    buffer_store_dwordx4 v[208:211], v5, s[20:23], s70 offen offset:0 sc1
    v_mfma_f32_16x16x32_bf16 v[168:171], v[56:59], a[248:251], v[168:171]
    ds_read_b64_tr_b16 v[50:51], v4 offset:37888
    v_mfma_f32_16x16x32_bf16 v[172:175], v[56:59], a[252:255], v[172:175]
    s_waitcnt lgkmcnt(2)
    v_mfma_f32_16x16x32_bf16 v[176:179], v[60:63], a[240:243], v[176:179]
    ds_read_b64_tr_b16 v[52:53], v4 offset:45056
    v_mfma_f32_16x16x32_bf16 v[180:183], v[60:63], a[244:247], v[180:183]
    buffer_store_dwordx4 v[212:215], v5, s[20:23], s70 offen offset:1024 sc1
    v_mfma_f32_16x16x32_bf16 v[184:187], v[60:63], a[248:251], v[184:187]
    ds_read_b64_tr_b16 v[54:55], v4 offset:46080
    v_mfma_f32_16x16x32_bf16 v[188:191], v[60:63], a[252:255], v[188:191]
    v_mfma_f32_16x16x32_bf16 v[224:227], v[40:43], a[224:227], v[224:227]
    ds_read_b64_tr_b16 v[56:57], v3 offset:49152
    v_mfma_f32_16x16x32_bf16 v[228:231], v[40:43], a[228:231], v[228:231]
    buffer_store_dwordx4 v[216:219], v5, s[20:23], s70 offen offset:2048 sc1
    v_mfma_f32_16x16x32_bf16 v[232:235], v[40:43], a[232:235], v[232:235]
    ds_read_b64_tr_b16 v[58:59], v3 offset:50176
    v_mfma_f32_16x16x32_bf16 v[236:239], v[40:43], a[236:239], v[236:239]
    v_mfma_f32_16x16x32_bf16 v[240:243], v[44:47], a[224:227], v[240:243]
    ds_read_b64_tr_b16 v[60:61], v3 offset:57344
    v_mfma_f32_16x16x32_bf16 v[244:247], v[44:47], a[228:231], v[244:247]
    buffer_store_dwordx4 v[220:223], v5, s[20:23], s70 offen offset:3072 sc1
    v_mfma_f32_16x16x32_bf16 v[248:251], v[44:47], a[232:235], v[248:251]
    ds_read_b64_tr_b16 v[62:63], v3 offset:58368
    v_mfma_f32_16x16x32_bf16 v[252:255], v[44:47], a[236:239], v[252:255]
    s_waitcnt lgkmcnt(3)
    v_mfma_f32_16x16x32_bf16 v[224:227], v[48:51], a[240:243], v[224:227]
    ds_read_b64_tr_b16 v[40:41], v3 offset:53248
    v_mfma_f32_16x16x32_bf16 v[228:231], v[48:51], a[244:247], v[228:231]
    ds_read_b64_tr_b16 v[42:43], v3 offset:54272
    v_mfma_f32_16x16x32_bf16 v[232:235], v[48:51], a[248:251], v[232:235]
    v_mfma_f32_16x16x32_bf16 v[236:239], v[48:51], a[252:255], v[236:239]
    v_mfma_f32_16x16x32_bf16 v[240:243], v[52:55], a[240:243], v[240:243]
    ds_read_b64_tr_b16 v[44:45], v3 offset:61440
    v_mfma_f32_16x16x32_bf16 v[244:247], v[52:55], a[244:247], v[244:247]
    ds_read_b64_tr_b16 v[46:47], v3 offset:62464
    v_mfma_f32_16x16x32_bf16 v[248:251], v[52:55], a[248:251], v[248:251]
    v_mfma_f32_16x16x32_bf16 v[252:255], v[52:55], a[252:255], v[252:255]
    s_waitcnt lgkmcnt(2)
    s_barrier
    v_mfma_f32_16x16x32_bf16 v[160:163], v[56:59], v[64:67], v[160:163]
    s_lshl1_add_u32 m0, s74, 16384
    ds_read_b64_tr_b16 v[48:49], v4 offset:49152
    v_mfma_f32_16x16x32_bf16 v[164:167], v[56:59], v[68:71], v[164:167]
    buffer_load_dwordx4 v2, s[12:15], s46 offen  lds
    v_mfma_f32_16x16x32_bf16 v[168:171], v[56:59], v[72:75], v[168:171]
    ds_read_b64_tr_b16 v[50:51], v4 offset:50176
    v_mfma_f32_16x16x32_bf16 v[172:175], v[56:59], v[76:79], v[172:175]
    v_mfma_f32_16x16x32_bf16 v[176:179], v[60:63], v[64:67], v[176:179]
    ds_read_b64_tr_b16 v[52:53], v4 offset:57344
    v_mfma_f32_16x16x32_bf16 v[180:183], v[60:63], v[68:71], v[180:183]
    buffer_load_dwordx4 v2, s[12:15], vcc_lo offen offset:1024  lds
    v_mfma_f32_16x16x32_bf16 v[184:187], v[60:63], v[72:75], v[184:187]
    s_lshl1_add_u32 m0, s74, 24576
    ds_read_b64_tr_b16 v[54:55], v4 offset:58368
    v_mfma_f32_16x16x32_bf16 v[188:191], v[60:63], v[76:79], v[188:191]
    v_mfma_f32_16x16x32_bf16 v[160:163], v[40:43], v[80:83], v[160:163]
    ds_read_b64_tr_b16 v[56:57], v4 offset:53248
    v_mfma_f32_16x16x32_bf16 v[164:167], v[40:43], v[84:87], v[164:167]
    buffer_load_dwordx4 v2, s[16:19], s46 offen  lds
    v_mfma_f32_16x16x32_bf16 v[168:171], v[40:43], v[88:91], v[168:171]
    ds_read_b64_tr_b16 v[58:59], v4 offset:54272
    v_mfma_f32_16x16x32_bf16 v[172:175], v[40:43], v[92:95], v[172:175]
    s_waitcnt lgkmcnt(3)
    v_mfma_f32_16x16x32_bf16 v[176:179], v[44:47], v[80:83], v[176:179]
    ds_read_b64_tr_b16 v[60:61], v4 offset:61440
    v_mfma_f32_16x16x32_bf16 v[180:183], v[44:47], v[84:87], v[180:183]
    buffer_load_dwordx4 v2, s[16:19], vcc_lo offen offset:1024  lds
    v_mfma_f32_16x16x32_bf16 v[184:187], v[44:47], v[88:91], v[184:187]
    s_add_u32 vcc_lo, s47, 35840
    ds_read_b64_tr_b16 v[62:63], v4 offset:62464
    v_mfma_f32_16x16x32_bf16 v[188:191], v[44:47], v[92:95], v[188:191]
    s_waitcnt vmcnt(29) lgkmcnt(3)
    s_barrier
    v_mfma_f32_16x16x32_bf16 v[224:227], v[48:51], v[64:67], v[224:227]
    s_lshl1_add_u32 m0, s74, 32768
    v_xor_b32 v3, 64, v3
    v_mfma_f32_16x16x32_bf16 v[228:231], v[48:51], v[68:71], v[228:231]
    v_add_u32 v3, 0x10000, v3
    v_mul_f32 v176, v160, v176
    v_mfma_f32_16x16x32_bf16 v[232:235], v[48:51], v[72:75], v[232:235]
    ds_read_b64_tr_b16 v[40:41], v3 offset:0
    v_mul_f32 v160, s56, v160
    v_mfma_f32_16x16x32_bf16 v[236:239], v[48:51], v[76:79], v[236:239]
    ds_read_b64_tr_b16 v[42:43], v3 offset:1024
    v_mul_f32 v180, v164, v180
    v_mfma_f32_16x16x32_bf16 v[240:243], v[52:55], v[64:67], v[240:243]
    ds_read_b64_tr_b16 v[44:45], v3 offset:8192
    v_mul_f32 v164, s56, v164
    v_mfma_f32_16x16x32_bf16 v[244:247], v[52:55], v[68:71], v[244:247]
    ds_read_b64_tr_b16 v[46:47], v3 offset:9216
    v_mul_f32 v184, v168, v184
    v_mfma_f32_16x16x32_bf16 v[248:251], v[52:55], v[72:75], v[248:251]
    v_exp_f32 v160, v160
    v_mfma_f32_16x16x32_bf16 v[252:255], v[52:55], v[76:79], v[252:255]
    s_waitcnt lgkmcnt(4)
    v_exp_f32 v164, v164
    v_mfma_f32_16x16x32_bf16 v[224:227], v[56:59], v[80:83], v[224:227]
    ds_read_b64_tr_b16 v[48:49], v3 offset:4096
    v_add_f32 v160, 1.0, v160
    v_mfma_f32_16x16x32_bf16 v[228:231], v[56:59], v[84:87], v[228:231]
    ds_read_b64_tr_b16 v[50:51], v3 offset:5120
    v_add_f32 v164, 1.0, v164
    v_mfma_f32_16x16x32_bf16 v[232:235], v[56:59], v[88:91], v[232:235]
    v_rcp_f32 v160, v160
    v_mfma_f32_16x16x32_bf16 v[236:239], v[56:59], v[92:95], v[236:239]
    buffer_load_dwordx4 v2, s[12:15], s47 offen  lds
    v_mfma_f32_16x16x32_bf16 v[240:243], v[60:63], v[80:83], v[240:243]
    ds_read_b64_tr_b16 v[52:53], v3 offset:12288
    v_mul_f32 v160, v160, v176
    v_mfma_f32_16x16x32_bf16 v[244:247], v[60:63], v[84:87], v[244:247]
    ds_read_b64_tr_b16 v[54:55], v3 offset:13312
    v_mul_f32 v177, v161, v177
    v_mfma_f32_16x16x32_bf16 v[248:251], v[60:63], v[88:91], v[248:251]
    v_rcp_f32 v164, v164
    v_mfma_f32_16x16x32_bf16 v[252:255], v[60:63], v[92:95], v[252:255]
    s_waitcnt lgkmcnt(2)
    s_barrier
    v_mul_f32 v161, s56, v161
    v_mfma_f32_16x16x32_bf16 v[96:99], v[40:43], a[0:3], 0
    buffer_load_dwordx4 v2, s[12:15], vcc_lo offen offset:1024  lds
    v_mfma_f32_16x16x32_bf16 v[100:103], v[40:43], a[4:7], 0
    s_lshl1_add_u32 m0, s74, 40960
    v_xor_b32 v4, 64, v4
    v_mul_f32 v164, v164, v180
    v_mfma_f32_16x16x32_bf16 v[104:107], v[40:43], a[8:11], 0
    v_add_u32 v4, 0x10000, v4
    v_mul_f32 v181, v165, v181
    v_mfma_f32_16x16x32_bf16 v[108:111], v[40:43], a[12:15], 0
    ds_read_b64_tr_b16 v[56:57], v4 offset:0
    v_mul_f32 v165, s56, v165
    v_mfma_f32_16x16x32_bf16 v[112:115], v[44:47], a[0:3], 0
    buffer_load_dwordx4 v2, s[16:19], s47 offen  lds
    v_mfma_f32_16x16x32_bf16 v[116:119], v[44:47], a[4:7], 0
    ds_read_b64_tr_b16 v[58:59], v4 offset:1024
    v_mul_f32 v168, s56, v168
    v_mfma_f32_16x16x32_bf16 v[120:123], v[44:47], a[8:11], 0
    ds_read_b64_tr_b16 v[60:61], v4 offset:8192
    v_mul_f32 v188, v172, v188
    v_mfma_f32_16x16x32_bf16 v[124:127], v[44:47], a[12:15], 0
    ds_read_b64_tr_b16 v[62:63], v4 offset:9216
    v_mul_f32 v172, s56, v172
    v_mfma_f32_16x16x32_bf16 v[96:99], v[48:51], a[16:19], v[96:99]
    buffer_load_dwordx4 v2, s[16:19], vcc_lo offen offset:1024  lds
    v_mfma_f32_16x16x32_bf16 v[100:103], v[48:51], a[20:23], v[100:103]
    s_add_u32 vcc_lo, s48, 35840
    ds_read_b64_tr_b16 v[40:41], v4 offset:4096
    v_mul_f32 v240, v224, v240
    v_mfma_f32_16x16x32_bf16 v[104:107], v[48:51], a[24:27], v[104:107]
    s_lshl1_add_u32 m0, s74, 49152
    ds_read_b64_tr_b16 v[42:43], v4 offset:5120
    v_mul_f32 v224, s56, v224
    v_mfma_f32_16x16x32_bf16 v[108:111], v[48:51], a[28:31], v[108:111]
    s_waitcnt lgkmcnt(4)
    v_exp_f32 v161, v161
    v_mfma_f32_16x16x32_bf16 v[112:115], v[52:55], a[16:19], v[112:115]
    buffer_load_dwordx4 v2, s[12:15], s48 offen  lds
    v_mfma_f32_16x16x32_bf16 v[116:119], v[52:55], a[20:23], v[116:119]
    ds_read_b64_tr_b16 v[44:45], v4 offset:12288
    v_add_f32 v161, 1.0, v161
    v_mfma_f32_16x16x32_bf16 v[120:123], v[52:55], a[24:27], v[120:123]
    ds_read_b64_tr_b16 v[46:47], v4 offset:13312
    v_mul_f32 v244, v228, v244
    v_mfma_f32_16x16x32_bf16 v[124:127], v[52:55], a[28:31], v[124:127]
    s_waitcnt vmcnt(29) lgkmcnt(3)
    s_barrier
    v_mul_f32 v228, s56, v228
    v_mfma_f32_16x16x32_bf16 v[128:131], v[56:59], a[0:3], 0
    buffer_load_dwordx4 v2, s[12:15], vcc_lo offen offset:1024  lds
    v_mfma_f32_16x16x32_bf16 v[132:135], v[56:59], a[4:7], 0
    s_lshl1_add_u32 m0, s74, 57344
    ds_read_b64_tr_b16 v[48:49], v3 offset:16384
    v_mul_f32 v248, v232, v248
    v_mfma_f32_16x16x32_bf16 v[136:139], v[56:59], a[8:11], 0
    ds_read_b64_tr_b16 v[50:51], v3 offset:17408
    v_mul_f32 v232, s56, v232
    v_mfma_f32_16x16x32_bf16 v[140:143], v[56:59], a[12:15], 0
    v_rcp_f32 v161, v161
    v_mfma_f32_16x16x32_bf16 v[144:147], v[60:63], a[0:3], 0
    buffer_load_dwordx4 v2, s[16:19], s48 offen  lds
    v_mfma_f32_16x16x32_bf16 v[148:151], v[60:63], a[4:7], 0
    ds_read_b64_tr_b16 v[52:53], v3 offset:24576
    v_mul_f32 v161, v161, v177
    v_mfma_f32_16x16x32_bf16 v[152:155], v[60:63], a[8:11], 0
    ds_read_b64_tr_b16 v[54:55], v3 offset:25600
    v_cvt_pk_bf16_f32 v208, v160, v161
    v_mfma_f32_16x16x32_bf16 v[156:159], v[60:63], a[12:15], 0
    s_waitcnt lgkmcnt(3)
    v_exp_f32 v165, v165
    v_mfma_f32_16x16x32_bf16 v[128:131], v[40:43], a[16:19], v[128:131]
    buffer_load_dwordx4 v2, s[16:19], vcc_lo offen offset:1024  lds
    v_mfma_f32_16x16x32_bf16 v[132:135], v[40:43], a[20:23], v[132:135]
    ds_read_b64_tr_b16 v[56:57], v3 offset:20480
    v_mul_f32 v178, v162, v178
    v_mfma_f32_16x16x32_bf16 v[136:139], v[40:43], a[24:27], v[136:139]
    ds_read_b64_tr_b16 v[58:59], v3 offset:21504
    v_mul_f32 v162, s56, v162
    v_mfma_f32_16x16x32_bf16 v[140:143], v[40:43], a[28:31], v[140:143]
    s_waitcnt vmcnt(12)
    v_exp_f32 v162, v162
    v_mfma_f32_16x16x32_bf16 v[144:147], v[44:47], a[16:19], v[144:147]
    buffer_store_dword v4, v6, s[20:23], s61 offen offset:128 sc1
    v_mfma_f32_16x16x32_bf16 v[148:151], v[44:47], a[20:23], v[148:151]
    ds_read_b64_tr_b16 v[60:61], v3 offset:28672
    v_add_f32 v162, 1.0, v162
    v_mfma_f32_16x16x32_bf16 v[152:155], v[44:47], a[24:27], v[152:155]
    ds_read_b64_tr_b16 v[62:63], v3 offset:29696
    v_add_f32 v165, 1.0, v165
    v_mfma_f32_16x16x32_bf16 v[156:159], v[44:47], a[28:31], v[156:159]
    s_waitcnt lgkmcnt(3)
    v_rcp_f32 v162, v162
    v_mfma_f32_16x16x32_bf16 v[96:99], v[48:51], a[32:35], v[96:99]
    ds_read_b64_tr_b16 v[40:41], v4 offset:16384
    v_mul_f32 v162, v162, v178
    v_mfma_f32_16x16x32_bf16 v[100:103], v[48:51], a[36:39], v[100:103]
    ds_read_b64_tr_b16 v[42:43], v4 offset:17408
    v_mul_f32 v179, v163, v179
    v_mfma_f32_16x16x32_bf16 v[104:107], v[48:51], a[40:43], v[104:107]
    v_rcp_f32 v165, v165
    v_mfma_f32_16x16x32_bf16 v[108:111], v[48:51], a[44:47], v[108:111]
    v_exp_f32 v168, v168
    v_mfma_f32_16x16x32_bf16 v[112:115], v[52:55], a[32:35], v[112:115]
    ds_read_b64_tr_b16 v[44:45], v4 offset:24576
    v_mul_f32 v163, s56, v163
    v_mfma_f32_16x16x32_bf16 v[116:119], v[52:55], a[36:39], v[116:119]
    ds_read_b64_tr_b16 v[46:47], v4 offset:25600
    v_mul_f32 v165, v165, v181
    v_mfma_f32_16x16x32_bf16 v[120:123], v[52:55], a[40:43], v[120:123]
    v_exp_f32 v163, v163
    v_mfma_f32_16x16x32_bf16 v[124:127], v[52:55], a[44:47], v[124:127]
    s_waitcnt lgkmcnt(2)
    v_exp_f32 v172, v172
    v_mfma_f32_16x16x32_bf16 v[96:99], v[56:59], a[48:51], v[96:99]
    ds_read_b64_tr_b16 v[48:49], v4 offset:20480
    v_add_f32 v163, 1.0, v163
    v_mfma_f32_16x16x32_bf16 v[100:103], v[56:59], a[52:55], v[100:103]
    ds_read_b64_tr_b16 v[50:51], v4 offset:21504
    v_cvt_pk_bf16_f32 v212, v164, v165
    v_mfma_f32_16x16x32_bf16 v[104:107], v[56:59], a[56:59], v[104:107]
    v_rcp_f32 v163, v163
    v_mfma_f32_16x16x32_bf16 v[108:111], v[56:59], a[60:63], v[108:111]
    v_exp_f32 v224, v224
    v_mfma_f32_16x16x32_bf16 v[112:115], v[60:63], a[48:51], v[112:115]
    buffer_load_dword v39, v35, s[24:27], s86 offen
    v_mfma_f32_16x16x32_bf16 v[116:119], v[60:63], a[52:55], v[116:119]
    s_add_u32 s86, s86, 5248
    ds_read_b64_tr_b16 v[52:53], v4 offset:28672
    v_mul_f32 v163, v163, v179
    v_mfma_f32_16x16x32_bf16 v[120:123], v[60:63], a[56:59], v[120:123]
    ds_read_b64_tr_b16 v[54:55], v4 offset:29696
    v_cvt_pk_bf16_f32 v209, v162, v163
    v_mfma_f32_16x16x32_bf16 v[124:127], v[60:63], a[60:63], v[124:127]
    s_waitcnt lgkmcnt(2)
    s_barrier
    v_mul_f32 v182, v166, v182
    v_mfma_f32_16x16x32_bf16 v[128:131], v[40:43], a[32:35], v[128:131]
    ds_read_b64_tr_b16 v[56:57], v3 offset:32768
    v_mul_f32 v166, s56, v166
    v_mfma_f32_16x16x32_bf16 v[132:135], v[40:43], a[36:39], v[132:135]
    ds_read_b64_tr_b16 v[58:59], v3 offset:33792
    v_add_f32 v168, 1.0, v168
    v_mfma_f32_16x16x32_bf16 v[136:139], v[40:43], a[40:43], v[136:139]
    v_exp_f32 v166, v166
    v_mfma_f32_16x16x32_bf16 v[140:143], v[40:43], a[44:47], v[140:143]
    v_rcp_f32 v168, v168
    v_mfma_f32_16x16x32_bf16 v[144:147], v[44:47], a[32:35], v[144:147]
    ds_read_b64_tr_b16 v[60:61], v3 offset:40960
    v_add_f32 v166, 1.0, v166
    v_mfma_f32_16x16x32_bf16 v[148:151], v[44:47], a[36:39], v[148:151]
    ds_read_b64_tr_b16 v[62:63], v3 offset:41984
    v_mul_f32 v168, v168, v184
    v_mfma_f32_16x16x32_bf16 v[152:155], v[44:47], a[40:43], v[152:155]
    v_rcp_f32 v166, v166
    v_mfma_f32_16x16x32_bf16 v[156:159], v[44:47], a[44:47], v[156:159]
    v_exp_f32 v228, v228
    v_mfma_f32_16x16x32_bf16 v[128:131], v[48:51], a[48:51], v[128:131]
    ds_read_b64_tr_b16 v[40:41], v3 offset:36864
    v_mul_f32 v166, v166, v182
    v_mfma_f32_16x16x32_bf16 v[132:135], v[48:51], a[52:55], v[132:135]
    ds_read_b64_tr_b16 v[42:43], v3 offset:37888
    v_mul_f32 v183, v167, v183
    v_mfma_f32_16x16x32_bf16 v[136:139], v[48:51], a[56:59], v[136:139]
    v_exp_f32 v232, v232
    v_mfma_f32_16x16x32_bf16 v[140:143], v[48:51], a[60:63], v[140:143]
    s_waitcnt lgkmcnt(2)
    v_mul_f32 v167, s56, v167
    v_mul_f32 v185, v169, v185
    v_mfma_f32_16x16x32_bf16 v[144:147], v[52:55], a[48:51], v[144:147]
    ds_read_b64_tr_b16 v[44:45], v3 offset:45056
    v_mul_f32 v169, s56, v169
    v_mfma_f32_16x16x32_bf16 v[148:151], v[52:55], a[52:55], v[148:151]
    ds_read_b64_tr_b16 v[46:47], v3 offset:46080
    v_add_f32 v172, 1.0, v172
    v_mfma_f32_16x16x32_bf16 v[152:155], v[52:55], a[56:59], v[152:155]
    v_exp_f32 v167, v167
    v_mfma_f32_16x16x32_bf16 v[156:159], v[52:55], a[60:63], v[156:159]
    v_exp_f32 v169, v169
    v_mfma_f32_16x16x32_bf16 v[96:99], v[56:59], a[64:67], v[96:99]
    ds_read_b64_tr_b16 v[48:49], v4 offset:32768
    v_add_f32 v167, 1.0, v167
    v_mfma_f32_16x16x32_bf16 v[100:103], v[56:59], a[68:71], v[100:103]
    ds_read_b64_tr_b16 v[50:51], v4 offset:33792
    v_add_f32 v169, 1.0, v169
    v_mfma_f32_16x16x32_bf16 v[104:107], v[56:59], a[72:75], v[104:107]
    s_cmp_eq_u32 s6, 0
    s_cbranch_scc1 gated_mix__ssm_conv_s5__swiglu_ffn__prompt_kernel_B_pg3_6
    s_cmp_eq_u32 s6, 1
    s_cbranch_scc1 gated_mix__ssm_conv_s5__swiglu_ffn__prompt_kernel_B_pg3_7
    s_cmp_eq_u32 s6, 2
    s_cbranch_scc1 gated_mix__ssm_conv_s5__swiglu_ffn__prompt_kernel_B_pg3_8
    s_cmp_eq_u32 s6, 3
    s_cbranch_scc1 gated_mix__ssm_conv_s5__swiglu_ffn__prompt_kernel_B_pg3_9
gated_mix__ssm_conv_s5__swiglu_ffn__prompt_kernel_B_pr3:
    v_rcp_f32 v167, v167
    v_mfma_f32_16x16x32_bf16 v[108:111], v[56:59], a[76:79], v[108:111]
    v_rcp_f32 v169, v169
    v_mfma_f32_16x16x32_bf16 v[112:115], v[60:63], a[64:67], v[112:115]
    ds_read_b64_tr_b16 v[52:53], v4 offset:40960
    v_mul_f32 v167, v167, v183
    v_mfma_f32_16x16x32_bf16 v[116:119], v[60:63], a[68:71], v[116:119]
    ds_read_b64_tr_b16 v[54:55], v4 offset:41984
    v_cvt_pk_bf16_f32 v213, v166, v167
    v_mfma_f32_16x16x32_bf16 v[120:123], v[60:63], a[72:75], v[120:123]
    v_rcp_f32 v172, v172
    v_mfma_f32_16x16x32_bf16 v[124:127], v[60:63], a[76:79], v[124:127]
    s_waitcnt lgkmcnt(2)
    v_mul_f32 v169, v169, v185
    v_cvt_pk_bf16_f32 v216, v168, v169
    v_mfma_f32_16x16x32_bf16 v[96:99], v[40:43], a[80:83], v[96:99]
    ds_read_b64_tr_b16 v[56:57], v4 offset:36864
    v_mul_f32 v186, v170, v186
    v_mfma_f32_16x16x32_bf16 v[100:103], v[40:43], a[84:87], v[100:103]
    ds_read_b64_tr_b16 v[58:59], v4 offset:37888
    v_mul_f32 v170, s56, v170
    v_mfma_f32_16x16x32_bf16 v[104:107], v[40:43], a[88:91], v[104:107]
    s_branch gated_mix__ssm_conv_s5__swiglu_ffn__prompt_kernel_B_sk5
.p2align 12
gated_mix__ssm_conv_s5__swiglu_ffn__prompt_kernel_B_pg1_5:
    s_branch gated_mix__ssm_conv_s5__swiglu_ffn__prompt_kernel_B_pr1
gated_mix__ssm_conv_s5__swiglu_ffn__prompt_kernel_B_sk5:
    v_exp_f32 v170, v170
    v_mfma_f32_16x16x32_bf16 v[108:111], v[40:43], a[92:95], v[108:111]
    v_add_f32 v170, 1.0, v170
    v_mul_f32 v172, v172, v188
    v_mfma_f32_16x16x32_bf16 v[112:115], v[44:47], a[80:83], v[112:115]
    ds_read_b64_tr_b16 v[60:61], v4 offset:45056
    v_mul_f32 v189, v173, v189
    v_mfma_f32_16x16x32_bf16 v[116:119], v[44:47], a[84:87], v[116:119]
    ds_read_b64_tr_b16 v[62:63], v4 offset:46080
    v_mul_f32 v173, s56, v173
    v_mfma_f32_16x16x32_bf16 v[120:123], v[44:47], a[88:91], v[120:123]
    v_rcp_f32 v170, v170
    v_mfma_f32_16x16x32_bf16 v[124:127], v[44:47], a[92:95], v[124:127]
    v_exp_f32 v173, v173
    v_mfma_f32_16x16x32_bf16 v[128:131], v[48:51], a[64:67], v[128:131]
    ds_read_b64_tr_b16 v[40:41], v3 offset:49152
    v_mul_f32 v170, v170, v186
    v_mfma_f32_16x16x32_bf16 v[132:135], v[48:51], a[68:71], v[132:135]
    ds_read_b64_tr_b16 v[42:43], v3 offset:50176
    v_mul_f32 v187, v171, v187
    v_mfma_f32_16x16x32_bf16 v[136:139], v[48:51], a[72:75], v[136:139]
    v_mul_f32 v171, s56, v171
    v_add_f32 v173, 1.0, v173
    v_mfma_f32_16x16x32_bf16 v[140:143], v[48:51], a[76:79], v[140:143]
    s_waitcnt lgkmcnt(2)
    v_exp_f32 v171, v171
    v_mfma_f32_16x16x32_bf16 v[144:147], v[52:55], a[64:67], v[144:147]
    ds_read_b64_tr_b16 v[44:45], v3 offset:57344
    v_add_f32 v171, 1.0, v171
    v_mfma_f32_16x16x32_bf16 v[148:151], v[52:55], a[68:71], v[148:151]
    ds_read_b64_tr_b16 v[46:47], v3 offset:58368
    v_add_f32 v224, 1.0, v224
    v_mfma_f32_16x16x32_bf16 v[152:155], v[52:55], a[72:75], v[152:155]
    v_rcp_f32 v171, v171
    v_mfma_f32_16x16x32_bf16 v[156:159], v[52:55], a[76:79], v[156:159]
    v_rcp_f32 v173, v173
    v_mfma_f32_16x16x32_bf16 v[128:131], v[56:59], a[80:83], v[128:131]
    ds_read_b64_tr_b16 v[48:49], v3 offset:53248
    v_mul_f32 v171, v171, v187
    v_mfma_f32_16x16x32_bf16 v[132:135], v[56:59], a[84:87], v[132:135]
    ds_read_b64_tr_b16 v[50:51], v3 offset:54272
    v_cvt_pk_bf16_f32 v217, v170, v171
    v_mfma_f32_16x16x32_bf16 v[136:139], v[56:59], a[88:91], v[136:139]
    v_rcp_f32 v224, v224
    v_mfma_f32_16x16x32_bf16 v[140:143], v[56:59], a[92:95], v[140:143]
    v_mul_f32 v173, v173, v189
    v_cvt_pk_bf16_f32 v220, v172, v173
    v_mfma_f32_16x16x32_bf16 v[144:147], v[60:63], a[80:83], v[144:147]
    ds_read_b64_tr_b16 v[52:53], v3 offset:61440
    v_mul_f32 v190, v174, v190
    v_mfma_f32_16x16x32_bf16 v[148:151], v[60:63], a[84:87], v[148:151]
    ds_read_b64_tr_b16 v[54:55], v3 offset:62464
    v_mul_f32 v174, s56, v174
    v_mfma_f32_16x16x32_bf16 v[152:155], v[60:63], a[88:91], v[152:155]
    v_exp_f32 v174, v174
    v_mfma_f32_16x16x32_bf16 v[156:159], v[60:63], a[92:95], v[156:159]
    s_waitcnt lgkmcnt(2)
    v_add_f32 v174, 1.0, v174
    v_mul_f32 v224, v224, v240
    v_mfma_f32_16x16x32_bf16 v[96:99], v[40:43], a[96:99], v[96:99]
    ds_read_b64_tr_b16 v[56:57], v4 offset:49152
    v_mul_f32 v241, v225, v241
    v_mfma_f32_16x16x32_bf16 v[100:103], v[40:43], a[100:103], v[100:103]
    ds_read_b64_tr_b16 v[58:59], v4 offset:50176
    v_mul_f32 v225, s56, v225
    v_mfma_f32_16x16x32_bf16 v[104:107], v[40:43], a[104:107], v[104:107]
    v_rcp_f32 v174, v174
    v_mfma_f32_16x16x32_bf16 v[108:111], v[40:43], a[108:111], v[108:111]
    v_exp_f32 v225, v225
    v_mfma_f32_16x16x32_bf16 v[112:115], v[44:47], a[96:99], v[112:115]
    ds_read_b64_tr_b16 v[60:61], v4 offset:57344
    v_mul_f32 v174, v174, v190
    v_mfma_f32_16x16x32_bf16 v[116:119], v[44:47], a[100:103], v[116:119]
    ds_read_b64_tr_b16 v[62:63], v4 offset:58368
    v_mul_f32 v191, v175, v191
    v_mfma_f32_16x16x32_bf16 v[120:123], v[44:47], a[104:107], v[120:123]
    v_mul_f32 v175, s56, v175
    v_add_f32 v225, 1.0, v225
    v_mfma_f32_16x16x32_bf16 v[124:127], v[44:47], a[108:111], v[124:127]
    v_exp_f32 v175, v175
    v_mfma_f32_16x16x32_bf16 v[96:99], v[48:51], a[112:115], v[96:99]
    ds_read_b64_tr_b16 v[40:41], v4 offset:53248
    v_add_f32 v175, 1.0, v175
    v_mfma_f32_16x16x32_bf16 v[100:103], v[48:51], a[116:119], v[100:103]
    ds_read_b64_tr_b16 v[42:43], v4 offset:54272
    v_add_f32 v228, 1.0, v228
    v_mfma_f32_16x16x32_bf16 v[104:107], v[48:51], a[120:123], v[104:107]
    v_rcp_f32 v175, v175
    v_mfma_f32_16x16x32_bf16 v[108:111], v[48:51], a[124:127], v[108:111]
    s_waitcnt lgkmcnt(2)
    v_rcp_f32 v225, v225
    v_mfma_f32_16x16x32_bf16 v[112:115], v[52:55], a[112:115], v[112:115]
    ds_read_b64_tr_b16 v[44:45], v4 offset:61440
    v_mul_f32 v175, v175, v191
    v_mfma_f32_16x16x32_bf16 v[116:119], v[52:55], a[116:119], v[116:119]
    ds_read_b64_tr_b16 v[46:47], v4 offset:62464
    v_cvt_pk_bf16_f32 v221, v174, v175
    v_mfma_f32_16x16x32_bf16 v[120:123], v[52:55], a[120:123], v[120:123]
    v_rcp_f32 v228, v228
    v_mfma_f32_16x16x32_bf16 v[124:127], v[52:55], a[124:127], v[124:127]
    s_waitcnt lgkmcnt(2)
    s_barrier
    v_mul_f32 v225, v225, v241
    v_mfma_f32_16x16x32_bf16 v[128:131], v[56:59], a[96:99], v[128:131]
    v_add_u32 v3, 0x10000, v3
    v_cvt_pk_bf16_f32 v210, v224, v225
    v_mfma_f32_16x16x32_bf16 v[132:135], v[56:59], a[100:103], v[132:135]
    ds_read_b64_tr_b16 v[48:49], v3 offset:0
    v_mul_f32 v242, v226, v242
    v_mfma_f32_16x16x32_bf16 v[136:139], v[56:59], a[104:107], v[136:139]
    ds_read_b64_tr_b16 v[50:51], v3 offset:1024
    v_mul_f32 v226, s56, v226
    v_mfma_f32_16x16x32_bf16 v[140:143], v[56:59], a[108:111], v[140:143]
    v_exp_f32 v226, v226
    v_mfma_f32_16x16x32_bf16 v[144:147], v[60:63], a[96:99], v[144:147]
    ds_read_b64_tr_b16 v[52:53], v3 offset:8192
    v_add_f32 v226, 1.0, v226
    v_mfma_f32_16x16x32_bf16 v[148:151], v[60:63], a[100:103], v[148:151]
    ds_read_b64_tr_b16 v[54:55], v3 offset:9216
    v_mul_f32 v228, v228, v244
    v_mfma_f32_16x16x32_bf16 v[152:155], v[60:63], a[104:107], v[152:155]
    v_rcp_f32 v226, v226
    v_mfma_f32_16x16x32_bf16 v[156:159], v[60:63], a[108:111], v[156:159]
    v_mul_f32 v226, v226, v242
    v_mul_f32 v243, v227, v243
    v_mfma_f32_16x16x32_bf16 v[128:131], v[40:43], a[112:115], v[128:131]
    ds_read_b64_tr_b16 v[56:57], v3 offset:4096
    v_mul_f32 v227, s56, v227
    v_mfma_f32_16x16x32_bf16 v[132:135], v[40:43], a[116:119], v[132:135]
    ds_read_b64_tr_b16 v[58:59], v3 offset:5120
    v_mul_f32 v245, v229, v245
    v_mfma_f32_16x16x32_bf16 v[136:139], v[40:43], a[120:123], v[136:139]
    v_exp_f32 v227, v227
    v_mfma_f32_16x16x32_bf16 v[140:143], v[40:43], a[124:127], v[140:143]
    s_waitcnt lgkmcnt(2)
    v_add_f32 v227, 1.0, v227
    v_mul_f32 v229, s56, v229
    v_mfma_f32_16x16x32_bf16 v[144:147], v[44:47], a[112:115], v[144:147]
    ds_read_b64_tr_b16 v[60:61], v3 offset:12288
    v_add_f32 v232, 1.0, v232
    v_mfma_f32_16x16x32_bf16 v[148:151], v[44:47], a[116:119], v[148:151]
    ds_read_b64_tr_b16 v[62:63], v3 offset:13312
    v_mul_f32 v252, v236, v252
    v_mfma_f32_16x16x32_bf16 v[152:155], v[44:47], a[120:123], v[152:155]
    v_rcp_f32 v227, v227
    v_mfma_f32_16x16x32_bf16 v[156:159], v[44:47], a[124:127], v[156:159]
    v_exp_f32 v229, v229
    v_mfma_f32_16x16x32_bf16 v[96:99], v[48:51], a[128:131], v[96:99]
    v_add_u32 v4, 0x10000, v4
    v_mul_f32 v227, v227, v243
    v_mfma_f32_16x16x32_bf16 v[100:103], v[48:51], a[132:135], v[100:103]
    ds_read_b64_tr_b16 v[40:41], v4 offset:0
    v_cvt_pk_bf16_f32 v211, v226, v227
    v_mfma_f32_16x16x32_bf16 v[104:107], v[48:51], a[136:139], v[104:107]
    ds_read_b64_tr_b16 v[42:43], v4 offset:1024
    v_add_f32 v229, 1.0, v229
    v_mfma_f32_16x16x32_bf16 v[108:111], v[48:51], a[140:143], v[108:111]
    v_rcp_f32 v229, v229
    v_mfma_f32_16x16x32_bf16 v[112:115], v[52:55], a[128:131], v[112:115]
    ds_read_b64_tr_b16 v[44:45], v4 offset:8192
    v_mul_f32 v229, v229, v245
    v_mfma_f32_16x16x32_bf16 v[116:119], v[52:55], a[132:135], v[116:119]
    ds_read_b64_tr_b16 v[46:47], v4 offset:9216
    v_cvt_pk_bf16_f32 v214, v228, v229
    v_mfma_f32_16x16x32_bf16 v[120:123], v[52:55], a[136:139], v[120:123]
    v_rcp_f32 v232, v232
    v_mfma_f32_16x16x32_bf16 v[124:127], v[52:55], a[140:143], v[124:127]
    s_waitcnt lgkmcnt(3)
    v_mul_f32 v246, v230, v246
    v_mul_f32 v230, s56, v230
    v_mfma_f32_16x16x32_bf16 v[96:99], v[56:59], a[144:147], v[96:99]
    ds_read_b64_tr_b16 v[48:49], v4 offset:4096
    v_mul_f32 v232, v232, v248
    v_mfma_f32_16x16x32_bf16 v[100:103], v[56:59], a[148:151], v[100:103]
    ds_read_b64_tr_b16 v[50:51], v4 offset:5120
    v_mul_f32 v249, v233, v249
    v_mfma_f32_16x16x32_bf16 v[104:107], v[56:59], a[152:155], v[104:107]
    v_exp_f32 v230, v230
    v_mfma_f32_16x16x32_bf16 v[108:111], v[56:59], a[156:159], v[108:111]
    v_add_f32 v230, 1.0, v230
    v_mul_f32 v233, s56, v233
    v_mfma_f32_16x16x32_bf16 v[112:115], v[60:63], a[144:147], v[112:115]
    ds_read_b64_tr_b16 v[52:53], v4 offset:12288
    v_mul_f32 v236, s56, v236
    v_mfma_f32_16x16x32_bf16 v[116:119], v[60:63], a[148:151], v[116:119]
    ds_read_b64_tr_b16 v[54:55], v4 offset:13312
    v_mfma_f32_16x16x32_bf16 v[120:123], v[60:63], a[152:155], v[120:123]
    v_rcp_f32 v230, v230
    v_mfma_f32_16x16x32_bf16 v[124:127], v[60:63], a[156:159], v[124:127]
    s_waitcnt lgkmcnt(2)
    v_exp_f32 v233, v233
    v_mfma_f32_16x16x32_bf16 v[128:131], v[40:43], a[128:131], v[128:131]
    v_add_u32 v3, 0xfffe0000, v3
    v_mul_f32 v230, v230, v246
    v_mfma_f32_16x16x32_bf16 v[132:135], v[40:43], a[132:135], v[132:135]
    ds_read_b64_tr_b16 v[56:57], v3 offset:0
    v_mul_f32 v247, v231, v247
    v_mfma_f32_16x16x32_bf16 v[136:139], v[40:43], a[136:139], v[136:139]
    ds_read_b64_tr_b16 v[58:59], v3 offset:1024
    v_mul_f32 v231, s56, v231
    v_mfma_f32_16x16x32_bf16 v[140:143], v[40:43], a[140:143], v[140:143]
    v_exp_f32 v231, v231
    v_mfma_f32_16x16x32_bf16 v[144:147], v[44:47], a[128:131], v[144:147]
    ds_read_b64_tr_b16 v[60:61], v3 offset:8192
    v_add_f32 v231, 1.0, v231
    v_mfma_f32_16x16x32_bf16 v[148:151], v[44:47], a[132:135], v[148:151]
    ds_read_b64_tr_b16 v[62:63], v3 offset:9216
    v_add_f32 v233, 1.0, v233
    v_mfma_f32_16x16x32_bf16 v[152:155], v[44:47], a[136:139], v[152:155]
    v_rcp_f32 v231, v231
    v_mfma_f32_16x16x32_bf16 v[156:159], v[44:47], a[140:143], v[156:159]
    v_rcp_f32 v233, v233
    v_mfma_f32_16x16x32_bf16 v[128:131], v[48:51], a[144:147], v[128:131]
    ds_read_b64_tr_b16 v[40:41], v3 offset:4096
    v_mul_f32 v231, v231, v247
    v_mfma_f32_16x16x32_bf16 v[132:135], v[48:51], a[148:151], v[132:135]
    ds_read_b64_tr_b16 v[42:43], v3 offset:5120
    v_cvt_pk_bf16_f32 v215, v230, v231
    v_mfma_f32_16x16x32_bf16 v[136:139], v[48:51], a[152:155], v[136:139]
    v_exp_f32 v236, v236
    v_mfma_f32_16x16x32_bf16 v[140:143], v[48:51], a[156:159], v[140:143]
    s_waitcnt lgkmcnt(2)
    v_mul_f32 v233, v233, v249
    v_cvt_pk_bf16_f32 v218, v232, v233
    v_mfma_f32_16x16x32_bf16 v[144:147], v[52:55], a[144:147], v[144:147]
    ds_read_b64_tr_b16 v[44:45], v3 offset:12288
    v_mul_f32 v250, v234, v250
    v_mfma_f32_16x16x32_bf16 v[148:151], v[52:55], a[148:151], v[148:151]
    ds_read_b64_tr_b16 v[46:47], v3 offset:13312
    v_mul_f32 v234, s56, v234
    v_mfma_f32_16x16x32_bf16 v[152:155], v[52:55], a[152:155], v[152:155]
    v_exp_f32 v234, v234
    v_mfma_f32_16x16x32_bf16 v[156:159], v[52:55], a[156:159], v[156:159]
    s_waitcnt vmcnt(6) lgkmcnt(2)
    s_barrier
    v_add_f32 v234, 1.0, v234
    v_mfma_f32_16x16x32_bf16 v[96:99], v[56:59], a[160:163], v[96:99]
    ds_read_b64_tr_b16 v[48:49], v3 offset:16384
    v_add_f32 v236, 1.0, v236
    v_mfma_f32_16x16x32_bf16 v[100:103], v[56:59], a[164:167], v[100:103]
    ds_read_b64_tr_b16 v[50:51], v3 offset:17408
    v_mfma_f32_16x16x32_bf16 v[104:107], v[56:59], a[168:171], v[104:107]
    v_rcp_f32 v234, v234
    v_mfma_f32_16x16x32_bf16 v[108:111], v[56:59], a[172:175], v[108:111]
    v_rcp_f32 v236, v236
    v_mfma_f32_16x16x32_bf16 v[112:115], v[60:63], a[160:163], v[112:115]
    ds_read_b64_tr_b16 v[52:53], v3 offset:24576
    v_mul_f32 v234, v234, v250
    v_mfma_f32_16x16x32_bf16 v[116:119], v[60:63], a[164:167], v[116:119]
    ds_read_b64_tr_b16 v[54:55], v3 offset:25600
    v_mul_f32 v251, v235, v251
    v_mfma_f32_16x16x32_bf16 v[120:123], v[60:63], a[168:171], v[120:123]
    v_mul_f32 v235, s56, v235
    v_mul_f32 v236, v236, v252
    v_mfma_f32_16x16x32_bf16 v[124:127], v[60:63], a[172:175], v[124:127]
    v_exp_f32 v235, v235
    v_mfma_f32_16x16x32_bf16 v[96:99], v[40:43], a[176:179], v[96:99]
    ds_read_b64_tr_b16 v[56:57], v3 offset:20480
    v_add_f32 v235, 1.0, v235
    v_mfma_f32_16x16x32_bf16 v[100:103], v[40:43], a[180:183], v[100:103]
    ds_read_b64_tr_b16 v[58:59], v3 offset:21504
    v_mul_f32 v253, v237, v253
    v_mfma_f32_16x16x32_bf16 v[104:107], v[40:43], a[184:187], v[104:107]
    v_rcp_f32 v235, v235
    v_mfma_f32_16x16x32_bf16 v[108:111], v[40:43], a[188:191], v[108:111]
    s_waitcnt lgkmcnt(2)
    v_mul_f32 v235, v235, v251
    v_cvt_pk_bf16_f32 v219, v234, v235
    v_mfma_f32_16x16x32_bf16 v[112:115], v[44:47], a[176:179], v[112:115]
    ds_read_b64_tr_b16 v[60:61], v3 offset:28672
    v_mul_f32 v237, s56, v237
    v_mfma_f32_16x16x32_bf16 v[116:119], v[44:47], a[180:183], v[116:119]
    ds_read_b64_tr_b16 v[62:63], v3 offset:29696
    v_mfma_f32_16x16x32_bf16 v[120:123], v[44:47], a[184:187], v[120:123]
    v_exp_f32 v237, v237
    v_mfma_f32_16x16x32_bf16 v[124:127], v[44:47], a[188:191], v[124:127]
    v_add_f32 v237, 1.0, v237
    v_mfma_f32_16x16x32_bf16 v[96:99], v[48:51], a[192:195], v[96:99]
    ds_read_b64_tr_b16 v[40:41], v3 offset:32768
    v_mfma_f32_16x16x32_bf16 v[100:103], v[48:51], a[196:199], v[100:103]
    ds_read_b64_tr_b16 v[42:43], v3 offset:33792
    v_mfma_f32_16x16x32_bf16 v[104:107], v[48:51], a[200:203], v[104:107]
    v_rcp_f32 v237, v237
    v_mfma_f32_16x16x32_bf16 v[108:111], v[48:51], a[204:207], v[108:111]
    v_mul_f32 v237, v237, v253
    v_cvt_pk_bf16_f32 v222, v236, v237
    v_mfma_f32_16x16x32_bf16 v[112:115], v[52:55], a[192:195], v[112:115]
    ds_read_b64_tr_b16 v[44:45], v3 offset:40960
    v_mul_f32 v254, v238, v254
    v_mfma_f32_16x16x32_bf16 v[116:119], v[52:55], a[196:199], v[116:119]
    ds_read_b64_tr_b16 v[46:47], v3 offset:41984
    v_mul_f32 v238, s56, v238
    v_mfma_f32_16x16x32_bf16 v[120:123], v[52:55], a[200:203], v[120:123]
    v_exp_f32 v238, v238
    v_mfma_f32_16x16x32_bf16 v[124:127], v[52:55], a[204:207], v[124:127]
    s_waitcnt lgkmcnt(2)
    v_add_f32 v238, 1.0, v238
    v_mfma_f32_16x16x32_bf16 v[96:99], v[56:59], a[208:211], v[96:99]
    ds_read_b64_tr_b16 v[48:49], v3 offset:36864
    v_mfma_f32_16x16x32_bf16 v[100:103], v[56:59], a[212:215], v[100:103]
    ds_read_b64_tr_b16 v[50:51], v3 offset:37888
    v_mfma_f32_16x16x32_bf16 v[104:107], v[56:59], a[216:219], v[104:107]
    v_rcp_f32 v238, v238
    v_mfma_f32_16x16x32_bf16 v[108:111], v[56:59], a[220:223], v[108:111]
    v_mul_f32 v238, v238, v254
    v_mul_f32 v255, v239, v255
    v_mfma_f32_16x16x32_bf16 v[112:115], v[60:63], a[208:211], v[112:115]
    ds_read_b64_tr_b16 v[52:53], v3 offset:45056
    v_mul_f32 v239, s56, v239
    v_mfma_f32_16x16x32_bf16 v[116:119], v[60:63], a[212:215], v[116:119]
    ds_read_b64_tr_b16 v[54:55], v3 offset:46080
    v_mfma_f32_16x16x32_bf16 v[120:123], v[60:63], a[216:219], v[120:123]
    v_exp_f32 v239, v239
    v_mfma_f32_16x16x32_bf16 v[124:127], v[60:63], a[220:223], v[124:127]
    s_waitcnt vmcnt(2) lgkmcnt(2)
    s_barrier
    v_add_f32 v239, 1.0, v239
    v_mfma_f32_16x16x32_bf16 v[96:99], v[40:43], a[224:227], v[96:99]
    ds_read_b64_tr_b16 v[56:57], v3 offset:49152
    v_mfma_f32_16x16x32_bf16 v[100:103], v[40:43], a[228:231], v[100:103]
    ds_read_b64_tr_b16 v[58:59], v3 offset:50176
    v_mfma_f32_16x16x32_bf16 v[104:107], v[40:43], a[232:235], v[104:107]
    v_rcp_f32 v239, v239
    v_mfma_f32_16x16x32_bf16 v[108:111], v[40:43], a[236:239], v[108:111]
    v_mul_f32 v239, v239, v255
    v_cvt_pk_bf16_f32 v223, v238, v239
    v_mfma_f32_16x16x32_bf16 v[112:115], v[44:47], a[224:227], v[112:115]
    buffer_store_dwordx4 v[208:211], v5, s[20:23], s71 offen offset:0 sc1
    v_mfma_f32_16x16x32_bf16 v[116:119], v[44:47], a[228:231], v[116:119]
    ds_read_b64_tr_b16 v[60:61], v3 offset:57344
    v_mfma_f32_16x16x32_bf16 v[120:123], v[44:47], a[232:235], v[120:123]
    ds_read_b64_tr_b16 v[62:63], v3 offset:58368
    v_mfma_f32_16x16x32_bf16 v[124:127], v[44:47], a[236:239], v[124:127]
    v_mfma_f32_16x16x32_bf16 v[96:99], v[48:51], a[240:243], v[96:99]
    buffer_store_dwordx4 v[212:215], v5, s[20:23], s71 offen offset:1024 sc1
    v_mfma_f32_16x16x32_bf16 v[100:103], v[48:51], a[244:247], v[100:103]
    ds_read_b64_tr_b16 v[40:41], v3 offset:53248
    v_mfma_f32_16x16x32_bf16 v[104:107], v[48:51], a[248:251], v[104:107]
    ds_read_b64_tr_b16 v[42:43], v3 offset:54272
    v_mfma_f32_16x16x32_bf16 v[108:111], v[48:51], a[252:255], v[108:111]
    s_waitcnt lgkmcnt(3)
    v_mfma_f32_16x16x32_bf16 v[112:115], v[52:55], a[240:243], v[112:115]
    buffer_store_dwordx4 v[216:219], v5, s[20:23], s71 offen offset:2048 sc1
    v_mfma_f32_16x16x32_bf16 v[116:119], v[52:55], a[244:247], v[116:119]
    ds_read_b64_tr_b16 v[44:45], v3 offset:61440
    v_mfma_f32_16x16x32_bf16 v[120:123], v[52:55], a[248:251], v[120:123]
    ds_read_b64_tr_b16 v[46:47], v3 offset:62464
    v_mfma_f32_16x16x32_bf16 v[124:127], v[52:55], a[252:255], v[124:127]
    v_mfma_f32_16x16x32_bf16 v[96:99], v[56:59], v[64:67], v[96:99]
    buffer_store_dwordx4 v[220:223], v5, s[20:23], s71 offen offset:3072 sc1
    v_mfma_f32_16x16x32_bf16 v[100:103], v[56:59], v[68:71], v[100:103]
    v_add_u32 v4, 0xfffe0000, v4
    v_mfma_f32_16x16x32_bf16 v[104:107], v[56:59], v[72:75], v[104:107]
    ds_read_b64_tr_b16 v[48:49], v4 offset:0
    v_mfma_f32_16x16x32_bf16 v[108:111], v[56:59], v[76:79], v[108:111]
    s_waitcnt lgkmcnt(2)
    ds_read_b64_tr_b16 v[50:51], v4 offset:1024
    v_mfma_f32_16x16x32_bf16 v[112:115], v[60:63], v[64:67], v[112:115]
    ds_read_b64_tr_b16 v[52:53], v4 offset:8192
    v_mfma_f32_16x16x32_bf16 v[116:119], v[60:63], v[68:71], v[116:119]
    ds_read_b64_tr_b16 v[54:55], v4 offset:9216
    v_mfma_f32_16x16x32_bf16 v[120:123], v[60:63], v[72:75], v[120:123]
    v_mfma_f32_16x16x32_bf16 v[124:127], v[60:63], v[76:79], v[124:127]
    v_mfma_f32_16x16x32_bf16 v[96:99], v[40:43], v[80:83], v[96:99]
    ds_read_b64_tr_b16 v[56:57], v4 offset:4096
    v_mfma_f32_16x16x32_bf16 v[100:103], v[40:43], v[84:87], v[100:103]
    ds_read_b64_tr_b16 v[58:59], v4 offset:5120
    v_mfma_f32_16x16x32_bf16 v[104:107], v[40:43], v[88:91], v[104:107]
    v_mfma_f32_16x16x32_bf16 v[108:111], v[40:43], v[92:95], v[108:111]
    s_waitcnt lgkmcnt(2)
    v_mfma_f32_16x16x32_bf16 v[112:115], v[44:47], v[80:83], v[112:115]
    ds_read_b64_tr_b16 v[60:61], v4 offset:12288
    v_mfma_f32_16x16x32_bf16 v[116:119], v[44:47], v[84:87], v[116:119]
    ds_read_b64_tr_b16 v[62:63], v4 offset:13312
    v_mfma_f32_16x16x32_bf16 v[120:123], v[44:47], v[88:91], v[120:123]
    v_mfma_f32_16x16x32_bf16 v[124:127], v[44:47], v[92:95], v[124:127]
    v_mfma_f32_16x16x32_bf16 v[128:131], v[48:51], a[160:163], v[128:131]
    ds_read_b64_tr_b16 v[40:41], v4 offset:16384
    v_mfma_f32_16x16x32_bf16 v[132:135], v[48:51], a[164:167], v[132:135]
    ds_read_b64_tr_b16 v[42:43], v4 offset:17408
    v_mul_f32 v112, v96, v112
    v_mfma_f32_16x16x32_bf16 v[136:139], v[48:51], a[168:171], v[136:139]
    v_mul_f32 v96, s56, v96
    v_mul_f32 v116, v100, v116
    v_mfma_f32_16x16x32_bf16 v[140:143], v[48:51], a[172:175], v[140:143]
    v_exp_f32 v96, v96
    v_mfma_f32_16x16x32_bf16 v[144:147], v[52:55], a[160:163], v[144:147]
    ds_read_b64_tr_b16 v[44:45], v4 offset:24576
    v_add_f32 v96, 1.0, v96
    v_mfma_f32_16x16x32_bf16 v[148:151], v[52:55], a[164:167], v[148:151]
    ds_read_b64_tr_b16 v[46:47], v4 offset:25600
    v_mul_f32 v100, s56, v100
    v_mfma_f32_16x16x32_bf16 v[152:155], v[52:55], a[168:171], v[152:155]
    v_rcp_f32 v96, v96
    v_mfma_f32_16x16x32_bf16 v[156:159], v[52:55], a[172:175], v[156:159]
    s_waitcnt lgkmcnt(2)
    v_exp_f32 v100, v100
    v_mfma_f32_16x16x32_bf16 v[128:131], v[56:59], a[176:179], v[128:131]
    ds_read_b64_tr_b16 v[48:49], v4 offset:20480
    v_mul_f32 v96, v96, v112
    v_mfma_f32_16x16x32_bf16 v[132:135], v[56:59], a[180:183], v[132:135]
    ds_read_b64_tr_b16 v[50:51], v4 offset:21504
    v_mul_f32 v113, v97, v113
    v_mfma_f32_16x16x32_bf16 v[136:139], v[56:59], a[184:187], v[136:139]
    v_mul_f32 v97, s56, v97
    v_add_f32 v100, 1.0, v100
    v_mfma_f32_16x16x32_bf16 v[140:143], v[56:59], a[188:191], v[140:143]
    v_exp_f32 v97, v97
    v_mfma_f32_16x16x32_bf16 v[144:147], v[60:63], a[176:179], v[144:147]
    ds_read_b64_tr_b16 v[52:53], v4 offset:28672
    v_add_f32 v97, 1.0, v97
    v_mfma_f32_16x16x32_bf16 v[148:151], v[60:63], a[180:183], v[148:151]
    ds_read_b64_tr_b16 v[54:55], v4 offset:29696
    v_mul_f32 v120, v104, v120
    v_mfma_f32_16x16x32_bf16 v[152:155], v[60:63], a[184:187], v[152:155]
    v_rcp_f32 v97, v97
    v_mfma_f32_16x16x32_bf16 v[156:159], v[60:63], a[188:191], v[156:159]
    v_rcp_f32 v100, v100
    v_mfma_f32_16x16x32_bf16 v[128:131], v[40:43], a[192:195], v[128:131]
    ds_read_b64_tr_b16 v[56:57], v4 offset:32768
    v_mul_f32 v97, v97, v113
    v_mfma_f32_16x16x32_bf16 v[132:135], v[40:43], a[196:199], v[132:135]
    ds_read_b64_tr_b16 v[58:59], v4 offset:33792
    v_cvt_pk_bf16_f32 v208, v96, v97
    v_mfma_f32_16x16x32_bf16 v[136:139], v[40:43], a[200:203], v[136:139]
    v_mul_f32 v114, v98, v114
    v_mul_f32 v98, s56, v98
    v_mfma_f32_16x16x32_bf16 v[140:143], v[40:43], a[204:207], v[140:143]
    s_waitcnt lgkmcnt(2)
    v_exp_f32 v98, v98
    v_mfma_f32_16x16x32_bf16 v[144:147], v[44:47], a[192:195], v[144:147]
    ds_read_b64_tr_b16 v[60:61], v4 offset:40960
    v_add_f32 v98, 1.0, v98
    v_mfma_f32_16x16x32_bf16 v[148:151], v[44:47], a[196:199], v[148:151]
    ds_read_b64_tr_b16 v[62:63], v4 offset:41984
    v_mul_f32 v100, v100, v116
    v_mfma_f32_16x16x32_bf16 v[152:155], v[44:47], a[200:203], v[152:155]
    v_rcp_f32 v98, v98
    v_mfma_f32_16x16x32_bf16 v[156:159], v[44:47], a[204:207], v[156:159]
    v_mul_f32 v98, v98, v114
    v_mul_f32 v115, v99, v115
    v_mfma_f32_16x16x32_bf16 v[128:131], v[48:51], a[208:211], v[128:131]
    ds_read_b64_tr_b16 v[40:41], v4 offset:36864
    v_mul_f32 v99, s56, v99
    v_mfma_f32_16x16x32_bf16 v[132:135], v[48:51], a[212:215], v[132:135]
    ds_read_b64_tr_b16 v[42:43], v4 offset:37888
    v_mul_f32 v117, v101, v117
    v_mfma_f32_16x16x32_bf16 v[136:139], v[48:51], a[216:219], v[136:139]
    v_exp_f32 v99, v99
    v_mfma_f32_16x16x32_bf16 v[140:143], v[48:51], a[220:223], v[140:143]
    v_add_f32 v99, 1.0, v99
    v_mul_f32 v101, s56, v101
    v_mfma_f32_16x16x32_bf16 v[144:147], v[52:55], a[208:211], v[144:147]
    ds_read_b64_tr_b16 v[44:45], v4 offset:45056
    v_mul_f32 v104, s56, v104
    v_mfma_f32_16x16x32_bf16 v[148:151], v[52:55], a[212:215], v[148:151]
    ds_read_b64_tr_b16 v[46:47], v4 offset:46080
    v_mul_f32 v124, v108, v124
    v_mfma_f32_16x16x32_bf16 v[152:155], v[52:55], a[216:219], v[152:155]
    v_rcp_f32 v99, v99
    v_mfma_f32_16x16x32_bf16 v[156:159], v[52:55], a[220:223], v[156:159]
    s_waitcnt lgkmcnt(2)
    v_exp_f32 v101, v101
    v_mfma_f32_16x16x32_bf16 v[128:131], v[56:59], a[224:227], v[128:131]
    ds_read_b64_tr_b16 v[48:49], v4 offset:49152
    v_mul_f32 v99, v99, v115
    v_mfma_f32_16x16x32_bf16 v[132:135], v[56:59], a[228:231], v[132:135]
    ds_read_b64_tr_b16 v[50:51], v4 offset:50176
    v_cvt_pk_bf16_f32 v209, v98, v99
    v_mfma_f32_16x16x32_bf16 v[136:139], v[56:59], a[232:235], v[136:139]
    v_exp_f32 v104, v104
    v_mfma_f32_16x16x32_bf16 v[140:143], v[56:59], a[236:239], v[140:143]
    v_add_f32 v101, 1.0, v101
    v_add_f32 v104, 1.0, v104
    v_mfma_f32_16x16x32_bf16 v[144:147], v[60:63], a[224:227], v[144:147]
    ds_read_b64_tr_b16 v[52:53], v4 offset:57344
    v_mul_f32 v108, s56, v108
    v_mfma_f32_16x16x32_bf16 v[148:151], v[60:63], a[228:231], v[148:151]
    ds_read_b64_tr_b16 v[54:55], v4 offset:58368
    v_mfma_f32_16x16x32_bf16 v[152:155], v[60:63], a[232:235], v[152:155]
    v_rcp_f32 v101, v101
    v_mfma_f32_16x16x32_bf16 v[156:159], v[60:63], a[236:239], v[156:159]
    v_rcp_f32 v104, v104
    v_mfma_f32_16x16x32_bf16 v[128:131], v[40:43], a[240:243], v[128:131]
    ds_read_b64_tr_b16 v[56:57], v4 offset:53248
    v_mul_f32 v101, v101, v117
    v_mfma_f32_16x16x32_bf16 v[132:135], v[40:43], a[244:247], v[132:135]
    ds_read_b64_tr_b16 v[58:59], v4 offset:54272
    v_cvt_pk_bf16_f32 v212, v100, v101
    v_mfma_f32_16x16x32_bf16 v[136:139], v[40:43], a[248:251], v[136:139]
    v_exp_f32 v108, v108
    v_mfma_f32_16x16x32_bf16 v[140:143], v[40:43], a[252:255], v[140:143]
    s_waitcnt lgkmcnt(2)
    v_mul_f32 v118, v102, v118
    v_mul_f32 v102, s56, v102
    v_mfma_f32_16x16x32_bf16 v[144:147], v[44:47], a[240:243], v[144:147]
    ds_read_b64_tr_b16 v[60:61], v4 offset:61440
    v_mul_f32 v104, v104, v120
    v_mfma_f32_16x16x32_bf16 v[148:151], v[44:47], a[244:247], v[148:151]
    ds_read_b64_tr_b16 v[62:63], v4 offset:62464
    v_mul_f32 v121, v105, v121
    v_mfma_f32_16x16x32_bf16 v[152:155], v[44:47], a[248:251], v[152:155]
    v_exp_f32 v102, v102
    v_mfma_f32_16x16x32_bf16 v[156:159], v[44:47], a[252:255], v[156:159]
    v_add_f32 v102, 1.0, v102
    v_mul_f32 v105, s56, v105
    v_mfma_f32_16x16x32_bf16 v[128:131], v[48:51], v[64:67], v[128:131]
    v_xor_b32 v3, 64, v3
    v_add_f32 v108, 1.0, v108
    v_mfma_f32_16x16x32_bf16 v[132:135], v[48:51], v[68:71], v[132:135]
    v_add_u32 v3, 0x10000, v3
    v_mfma_f32_16x16x32_bf16 v[136:139], v[48:51], v[72:75], v[136:139]
    ds_read_b64_tr_b16 v[40:41], v3 offset:0
    v_mfma_f32_16x16x32_bf16 v[140:143], v[48:51], v[76:79], v[140:143]
    ds_read_b64_tr_b16 v[42:43], v3 offset:1024
    v_mfma_f32_16x16x32_bf16 v[144:147], v[52:55], v[64:67], v[144:147]
    buffer_load_dword v23, v22, s[20:23], s73 offen sc1
    v_mfma_f32_16x16x32_bf16 v[148:151], v[52:55], v[68:71], v[148:151]
    ds_read_b64_tr_b16 v[44:45], v3 offset:8192
    v_mfma_f32_16x16x32_bf16 v[152:155], v[52:55], v[72:75], v[152:155]
    s_waitcnt vmcnt(1)
    ds_read_b64_tr_b16 v[46:47], v3 offset:9216
    v_mfma_f32_16x16x32_bf16 v[156:159], v[52:55], v[76:79], v[156:159]
    s_waitcnt lgkmcnt(4)
    v_rcp_f32 v102, v102
    v_mfma_f32_16x16x32_bf16 v[128:131], v[56:59], v[80:83], v[128:131]
    buffer_store_dword v4, v6, s[20:23], s61 offen offset:256 sc1
    v_mfma_f32_16x16x32_bf16 v[132:135], v[56:59], v[84:87], v[132:135]
    ds_read_b64_tr_b16 v[48:49], v3 offset:4096
    v_mul_f32 v102, v102, v118
    v_mfma_f32_16x16x32_bf16 v[136:139], v[56:59], v[88:91], v[136:139]
    ds_read_b64_tr_b16 v[50:51], v3 offset:5120
    v_mul_f32 v119, v103, v119
    v_mfma_f32_16x16x32_bf16 v[140:143], v[56:59], v[92:95], v[140:143]
    v_exp_f32 v105, v105
    v_mfma_f32_16x16x32_bf16 v[144:147], v[60:63], v[80:83], v[144:147]
    ds_read_b64_tr_b16 v[52:53], v3 offset:12288
    v_mul_f32 v103, s56, v103
    v_mfma_f32_16x16x32_bf16 v[148:151], v[60:63], v[84:87], v[148:151]
    ds_read_b64_tr_b16 v[54:55], v3 offset:13312
    v_add_f32 v105, 1.0, v105
    v_mfma_f32_16x16x32_bf16 v[152:155], v[60:63], v[88:91], v[152:155]
    v_exp_f32 v103, v103
    v_mfma_f32_16x16x32_bf16 v[156:159], v[60:63], v[92:95], v[156:159]
    s_waitcnt lgkmcnt(3)
    v_rcp_f32 v105, v105
    v_mfma_f32_16x16x32_bf16 v[160:163], v[40:43], a[0:3], 0
    v_xor_b32 v4, 64, v4
    v_add_f32 v103, 1.0, v103
    v_mfma_f32_16x16x32_bf16 v[164:167], v[40:43], a[4:7], 0
    v_add_u32 v4, 0x10000, v4
    v_mul_f32 v105, v105, v121
    v_mfma_f32_16x16x32_bf16 v[168:171], v[40:43], a[8:11], 0
    ds_read_b64_tr_b16 v[56:57], v4 offset:0
    v_cvt_pk_bf16_f32 v216, v104, v105
    v_mfma_f32_16x16x32_bf16 v[172:175], v[40:43], a[12:15], 0
    ds_read_b64_tr_b16 v[58:59], v4 offset:1024
    v_mul_f32 v122, v106, v122
    v_mfma_f32_16x16x32_bf16 v[176:179], v[44:47], a[0:3], 0
    ds_read_b64_tr_b16 v[60:61], v4 offset:8192
    v_mul_f32 v106, s56, v106
    v_mfma_f32_16x16x32_bf16 v[180:183], v[44:47], a[4:7], 0
    ds_read_b64_tr_b16 v[62:63], v4 offset:9216
    v_mul_f32 v144, v128, v144
    v_mfma_f32_16x16x32_bf16 v[184:187], v[44:47], a[8:11], 0
    v_rcp_f32 v103, v103
    v_mfma_f32_16x16x32_bf16 v[188:191], v[44:47], a[12:15], 0
    s_waitcnt lgkmcnt(4)
    v_exp_f32 v106, v106
    v_mfma_f32_16x16x32_bf16 v[160:163], v[48:51], a[16:19], v[160:163]
    ds_read_b64_tr_b16 v[40:41], v4 offset:4096
    v_mul_f32 v103, v103, v119
    v_mfma_f32_16x16x32_bf16 v[164:167], v[48:51], a[20:23], v[164:167]
    ds_read_b64_tr_b16 v[42:43], v4 offset:5120
    v_cvt_pk_bf16_f32 v213, v102, v103
    v_mfma_f32_16x16x32_bf16 v[168:171], v[48:51], a[24:27], v[168:171]
    v_rcp_f32 v108, v108
    v_mfma_f32_16x16x32_bf16 v[172:175], v[48:51], a[28:31], v[172:175]
    v_add_f32 v106, 1.0, v106
    v_mul_f32 v108, v108, v124
    v_mfma_f32_16x16x32_bf16 v[176:179], v[52:55], a[16:19], v[176:179]
    ds_read_b64_tr_b16 v[44:45], v4 offset:12288
    v_mul_f32 v125, v109, v125
    v_mfma_f32_16x16x32_bf16 v[180:183], v[52:55], a[20:23], v[180:183]
    ds_read_b64_tr_b16 v[46:47], v4 offset:13312
    v_mul_f32 v109, s56, v109
    v_mfma_f32_16x16x32_bf16 v[184:187], v[52:55], a[24:27], v[184:187]
    v_rcp_f32 v106, v106
    v_mfma_f32_16x16x32_bf16 v[188:191], v[52:55], a[28:31], v[188:191]
    s_waitcnt lgkmcnt(2)
    v_exp_f32 v109, v109
    v_mfma_f32_16x16x32_bf16 v[224:227], v[56:59], a[0:3], 0
    ds_read_b64_tr_b16 v[48:49], v3 offset:16384
    v_mul_f32 v106, v106, v122
    v_mfma_f32_16x16x32_bf16 v[228:231], v[56:59], a[4:7], 0
    ds_read_b64_tr_b16 v[50:51], v3 offset:17408
    v_mul_f32 v123, v107, v123
    v_mfma_f32_16x16x32_bf16 v[232:235], v[56:59], a[8:11], 0
    v_mul_f32 v107, s56, v107
    v_add_f32 v109, 1.0, v109
    v_mfma_f32_16x16x32_bf16 v[236:239], v[56:59], a[12:15], 0
    v_exp_f32 v107, v107
    v_mfma_f32_16x16x32_bf16 v[240:243], v[60:63], a[0:3], 0
    ds_read_b64_tr_b16 v[52:53], v3 offset:24576
    v_add_f32 v107, 1.0, v107
    v_mfma_f32_16x16x32_bf16 v[244:247], v[60:63], a[4:7], 0
    ds_read_b64_tr_b16 v[54:55], v3 offset:25600
    v_mul_f32 v128, s56, v128
    v_mfma_f32_16x16x32_bf16 v[248:251], v[60:63], a[8:11], 0
    v_rcp_f32 v107, v107
    v_mfma_f32_16x16x32_bf16 v[252:255], v[60:63], a[12:15], 0
    v_rcp_f32 v109, v109
    v_mfma_f32_16x16x32_bf16 v[224:227], v[40:43], a[16:19], v[224:227]
    ds_read_b64_tr_b16 v[56:57], v3 offset:20480
    v_mul_f32 v107, v107, v123
    v_mfma_f32_16x16x32_bf16 v[228:231], v[40:43], a[20:23], v[228:231]
    ds_read_b64_tr_b16 v[58:59], v3 offset:21504
    v_cvt_pk_bf16_f32 v217, v106, v107
    v_mfma_f32_16x16x32_bf16 v[232:235], v[40:43], a[24:27], v[232:235]
    v_exp_f32 v128, v128
    v_mfma_f32_16x16x32_bf16 v[236:239], v[40:43], a[28:31], v[236:239]
    s_waitcnt lgkmcnt(2)
    v_mul_f32 v109, v109, v125
    v_cvt_pk_bf16_f32 v220, v108, v109
    v_mfma_f32_16x16x32_bf16 v[240:243], v[44:47], a[16:19], v[240:243]
    s_branch gated_mix__ssm_conv_s5__swiglu_ffn__prompt_kernel_B_sk6
.p2align 12
gated_mix__ssm_conv_s5__swiglu_ffn__prompt_kernel_B_pg1_6:
    s_branch gated_mix__ssm_conv_s5__swiglu_ffn__prompt_kernel_B_pr1
gated_mix__ssm_conv_s5__swiglu_ffn__prompt_kernel_B_pg3_6:
    s_branch gated_mix__ssm_conv_s5__swiglu_ffn__prompt_kernel_B_pr3
gated_mix__ssm_conv_s5__swiglu_ffn__prompt_kernel_B_sk6:
    s_waitcnt vmcnt(1)
    ds_read_b64_tr_b16 v[60:61], v3 offset:28672
    v_cmp_eq_u32 s[76:77], 0, v23
    v_mfma_f32_16x16x32_bf16 v[244:247], v[44:47], a[20:23], v[244:247]
    ds_read_b64_tr_b16 v[62:63], v3 offset:29696
    v_mul_f32 v126, v110, v126
    v_mfma_f32_16x16x32_bf16 v[248:251], v[44:47], a[24:27], v[248:251]
    s_cmp_lg_u64 s[76:77], 0
    s_cbranch_scc1 gated_mix__ssm_conv_s5__swiglu_ffn__prompt_kernel_sp_s
gated_mix__ssm_conv_s5__swiglu_ffn__prompt_kernel_sp:
    v_mul_f32 v110, s56, v110
    v_add_f32 v128, 1.0, v128
    v_mfma_f32_16x16x32_bf16 v[252:255], v[44:47], a[28:31], v[252:255]
    v_exp_f32 v110, v110
    v_mfma_f32_16x16x32_bf16 v[160:163], v[48:51], a[32:35], v[160:163]
    s_add_u32 s84, s81, s89
    ds_read_b64_tr_b16 v[40:41], v4 offset:16384
    v_add_f32 v110, 1.0, v110
    v_mfma_f32_16x16x32_bf16 v[164:167], v[48:51], a[36:39], v[164:167]
    s_add_u32 s89, s89, 4096
    ds_read_b64_tr_b16 v[42:43], v4 offset:17408
    v_mul_f32 v148, v132, v148
    v_mfma_f32_16x16x32_bf16 v[168:171], v[48:51], a[40:43], v[168:171]
    buffer_load_dwordx4 a[0:3], v5, s[20:23], s84 offen offset:0 sc1
    v_mfma_f32_16x16x32_bf16 v[172:175], v[48:51], a[44:47], v[172:175]
    v_rcp_f32 v110, v110
    v_mfma_f32_16x16x32_bf16 v[176:179], v[52:55], a[32:35], v[176:179]
    ds_read_b64_tr_b16 v[44:45], v4 offset:24576
    v_mul_f32 v110, v110, v126
    v_mfma_f32_16x16x32_bf16 v[180:183], v[52:55], a[36:39], v[180:183]
    ds_read_b64_tr_b16 v[46:47], v4 offset:25600
    v_mul_f32 v127, v111, v127
    v_mfma_f32_16x16x32_bf16 v[184:187], v[52:55], a[40:43], v[184:187]
    buffer_load_dwordx4 a[4:7], v5, s[20:23], s84 offen offset:1024 sc1
    v_mfma_f32_16x16x32_bf16 v[188:191], v[52:55], a[44:47], v[188:191]
    s_waitcnt lgkmcnt(2)
    v_rcp_f32 v128, v128
    v_mfma_f32_16x16x32_bf16 v[160:163], v[56:59], a[48:51], v[160:163]
    s_add_u32 s84, s81, s89
    ds_read_b64_tr_b16 v[48:49], v4 offset:20480
    v_mul_f32 v111, s56, v111
    v_mfma_f32_16x16x32_bf16 v[164:167], v[56:59], a[52:55], v[164:167]
    s_add_u32 s89, s89, 4096
    ds_read_b64_tr_b16 v[50:51], v4 offset:21504
    v_mul_f32 v128, v128, v144
    v_mfma_f32_16x16x32_bf16 v[168:171], v[56:59], a[56:59], v[168:171]
    buffer_load_dwordx4 a[8:11], v5, s[20:23], s84 offen offset:0 sc1
    v_mfma_f32_16x16x32_bf16 v[172:175], v[56:59], a[60:63], v[172:175]
    v_exp_f32 v111, v111
    v_mfma_f32_16x16x32_bf16 v[176:179], v[60:63], a[48:51], v[176:179]
    ds_read_b64_tr_b16 v[52:53], v4 offset:28672
    v_add_f32 v111, 1.0, v111
    v_mfma_f32_16x16x32_bf16 v[180:183], v[60:63], a[52:55], v[180:183]
    ds_read_b64_tr_b16 v[54:55], v4 offset:29696
    v_mul_f32 v145, v129, v145
    v_mfma_f32_16x16x32_bf16 v[184:187], v[60:63], a[56:59], v[184:187]
    buffer_load_dwordx4 a[12:15], v5, s[20:23], s84 offen offset:1024 sc1
    v_mfma_f32_16x16x32_bf16 v[188:191], v[60:63], a[60:63], v[188:191]
    s_add_u32 s84, s81, s89
    v_rcp_f32 v111, v111
    v_mfma_f32_16x16x32_bf16 v[224:227], v[40:43], a[32:35], v[224:227]
    s_add_u32 s89, s89, 4096
    ds_read_b64_tr_b16 v[56:57], v3 offset:32768
    v_mul_f32 v111, v111, v127
    v_mfma_f32_16x16x32_bf16 v[228:231], v[40:43], a[36:39], v[228:231]
    ds_read_b64_tr_b16 v[58:59], v3 offset:33792
    v_cvt_pk_bf16_f32 v221, v110, v111
    v_mfma_f32_16x16x32_bf16 v[232:235], v[40:43], a[40:43], v[232:235]
    buffer_load_dwordx4 a[16:19], v5, s[20:23], s84 offen offset:0 sc1
    v_mfma_f32_16x16x32_bf16 v[236:239], v[40:43], a[44:47], v[236:239]
    s_waitcnt lgkmcnt(2)
    v_mul_f32 v129, s56, v129
    v_mul_f32 v132, s56, v132
    v_mfma_f32_16x16x32_bf16 v[240:243], v[44:47], a[32:35], v[240:243]
    ds_read_b64_tr_b16 v[60:61], v3 offset:40960
    v_mul_f32 v152, v136, v152
    v_mfma_f32_16x16x32_bf16 v[244:247], v[44:47], a[36:39], v[244:247]
    ds_read_b64_tr_b16 v[62:63], v3 offset:41984
    v_mul_f32 v136, s56, v136
    v_mfma_f32_16x16x32_bf16 v[248:251], v[44:47], a[40:43], v[248:251]
    buffer_load_dwordx4 a[20:23], v5, s[20:23], s84 offen offset:1024 sc1
    v_mfma_f32_16x16x32_bf16 v[252:255], v[44:47], a[44:47], v[252:255]
    s_add_u32 s84, s81, s89
    v_exp_f32 v129, v129
    v_mfma_f32_16x16x32_bf16 v[224:227], v[48:51], a[48:51], v[224:227]
    s_add_u32 s89, s89, 4096
    ds_read_b64_tr_b16 v[40:41], v3 offset:36864
    v_add_f32 v129, 1.0, v129
    v_mfma_f32_16x16x32_bf16 v[228:231], v[48:51], a[52:55], v[228:231]
    s_cmp_lg_u32 s89, 147456
    s_cselect_b32 s89, s89, 0
    ds_read_b64_tr_b16 v[42:43], v3 offset:37888
    v_mul_f32 v156, v140, v156
    v_mfma_f32_16x16x32_bf16 v[232:235], v[48:51], a[56:59], v[232:235]
    buffer_load_dwordx4 a[24:27], v5, s[20:23], s84 offen offset:0 sc1
    v_mfma_f32_16x16x32_bf16 v[236:239], v[48:51], a[60:63], v[236:239]
    v_rcp_f32 v129, v129
    v_mfma_f32_16x16x32_bf16 v[240:243], v[52:55], a[48:51], v[240:243]
    ds_read_b64_tr_b16 v[44:45], v3 offset:45056
    v_mul_f32 v129, v129, v145
    v_mfma_f32_16x16x32_bf16 v[244:247], v[52:55], a[52:55], v[244:247]
    ds_read_b64_tr_b16 v[46:47], v3 offset:46080
    v_cvt_pk_bf16_f32 v210, v128, v129
    v_mfma_f32_16x16x32_bf16 v[248:251], v[52:55], a[56:59], v[248:251]
    buffer_load_dwordx4 a[28:31], v5, s[20:23], s84 offen offset:1024 sc1
    v_mfma_f32_16x16x32_bf16 v[252:255], v[52:55], a[60:63], v[252:255]
    s_waitcnt lgkmcnt(2)
    v_exp_f32 v132, v132
    v_mfma_f32_16x16x32_bf16 v[160:163], v[56:59], a[64:67], v[160:163]
    s_add_u32 s84, s81, s89
    ds_read_b64_tr_b16 v[48:49], v4 offset:32768
    v_mul_f32 v146, v130, v146
    v_mfma_f32_16x16x32_bf16 v[164:167], v[56:59], a[68:71], v[164:167]
    s_add_u32 s89, s89, 4096
    ds_read_b64_tr_b16 v[50:51], v4 offset:33792
    v_mul_f32 v130, s56, v130
    v_mfma_f32_16x16x32_bf16 v[168:171], v[56:59], a[72:75], v[168:171]
    buffer_load_dwordx4 a[32:35], v5, s[20:23], s84 offen offset:0 sc1
    v_mfma_f32_16x16x32_bf16 v[172:175], v[56:59], a[76:79], v[172:175]
    v_exp_f32 v130, v130
    v_mfma_f32_16x16x32_bf16 v[176:179], v[60:63], a[64:67], v[176:179]
    ds_read_b64_tr_b16 v[52:53], v4 offset:40960
    v_add_f32 v130, 1.0, v130
    v_mfma_f32_16x16x32_bf16 v[180:183], v[60:63], a[68:71], v[180:183]
    ds_read_b64_tr_b16 v[54:55], v4 offset:41984
    v_add_f32 v132, 1.0, v132
    v_mfma_f32_16x16x32_bf16 v[184:187], v[60:63], a[72:75], v[184:187]
    buffer_load_dwordx4 a[36:39], v5, s[20:23], s84 offen offset:1024 sc1
    v_mfma_f32_16x16x32_bf16 v[188:191], v[60:63], a[76:79], v[188:191]
    s_add_u32 s84, s81, s89
    v_rcp_f32 v130, v130
    v_mfma_f32_16x16x32_bf16 v[160:163], v[40:43], a[80:83], v[160:163]
    s_add_u32 s89, s89, 4096
    ds_read_b64_tr_b16 v[56:57], v4 offset:36864
    v_mul_f32 v130, v130, v146
    v_mfma_f32_16x16x32_bf16 v[164:167], v[40:43], a[84:87], v[164:167]
    ds_read_b64_tr_b16 v[58:59], v4 offset:37888
    v_mul_f32 v147, v131, v147
    v_mfma_f32_16x16x32_bf16 v[168:171], v[40:43], a[88:91], v[168:171]
    buffer_load_dwordx4 a[40:43], v5, s[20:23], s84 offen offset:0 sc1
    v_mfma_f32_16x16x32_bf16 v[172:175], v[40:43], a[92:95], v[172:175]
    s_waitcnt lgkmcnt(2)
    v_rcp_f32 v132, v132
    v_mfma_f32_16x16x32_bf16 v[176:179], v[44:47], a[80:83], v[176:179]
    ds_read_b64_tr_b16 v[60:61], v4 offset:45056
    v_mul_f32 v131, s56, v131
    v_mfma_f32_16x16x32_bf16 v[180:183], v[44:47], a[84:87], v[180:183]
    ds_read_b64_tr_b16 v[62:63], v4 offset:46080
    v_mul_f32 v132, v132, v148
    v_mfma_f32_16x16x32_bf16 v[184:187], v[44:47], a[88:91], v[184:187]
    buffer_load_dwordx4 a[44:47], v5, s[20:23], s84 offen offset:1024 sc1
    v_mfma_f32_16x16x32_bf16 v[188:191], v[44:47], a[92:95], v[188:191]
    s_add_u32 s84, s81, s89
    v_exp_f32 v131, v131
    v_mfma_f32_16x16x32_bf16 v[224:227], v[48:51], a[64:67], v[224:227]
    s_add_u32 s89, s89, 4096
    ds_read_b64_tr_b16 v[40:41], v3 offset:49152
    v_add_f32 v131, 1.0, v131
    v_mfma_f32_16x16x32_bf16 v[228:231], v[48:51], a[68:71], v[228:231]
    ds_read_b64_tr_b16 v[42:43], v3 offset:50176
    v_mul_f32 v149, v133, v149
    v_mfma_f32_16x16x32_bf16 v[232:235], v[48:51], a[72:75], v[232:235]
    buffer_load_dwordx4 a[48:51], v5, s[20:23], s84 offen offset:0 sc1
    v_mfma_f32_16x16x32_bf16 v[236:239], v[48:51], a[76:79], v[236:239]
    v_rcp_f32 v131, v131
    v_mfma_f32_16x16x32_bf16 v[240:243], v[52:55], a[64:67], v[240:243]
    ds_read_b64_tr_b16 v[44:45], v3 offset:57344
    v_mul_f32 v131, v131, v147
    v_mfma_f32_16x16x32_bf16 v[244:247], v[52:55], a[68:71], v[244:247]
    ds_read_b64_tr_b16 v[46:47], v3 offset:58368
    v_cvt_pk_bf16_f32 v211, v130, v131
    v_mfma_f32_16x16x32_bf16 v[248:251], v[52:55], a[72:75], v[248:251]
    buffer_load_dwordx4 a[52:55], v5, s[20:23], s84 offen offset:1024 sc1
    v_mfma_f32_16x16x32_bf16 v[252:255], v[52:55], a[76:79], v[252:255]
    s_waitcnt lgkmcnt(2)
    v_exp_f32 v136, v136
    v_mfma_f32_16x16x32_bf16 v[224:227], v[56:59], a[80:83], v[224:227]
    s_add_u32 s84, s81, s89
    ds_read_b64_tr_b16 v[48:49], v3 offset:53248
    v_mul_f32 v133, s56, v133
    v_mfma_f32_16x16x32_bf16 v[228:231], v[56:59], a[84:87], v[228:231]
    s_add_u32 s89, s89, 4096
    ds_read_b64_tr_b16 v[50:51], v3 offset:54272
    v_add_f32 v136, 1.0, v136
    v_mfma_f32_16x16x32_bf16 v[232:235], v[56:59], a[88:91], v[232:235]
    s_cmp_lg_u32 s89, 147456
    s_cselect_b32 s89, s89, 0
    v_exp_f32 v133, v133
    v_mfma_f32_16x16x32_bf16 v[236:239], v[56:59], a[92:95], v[236:239]
    buffer_load_dwordx4 a[56:59], v5, s[20:23], s84 offen offset:0 sc1
    v_mfma_f32_16x16x32_bf16 v[240:243], v[60:63], a[80:83], v[240:243]
    ds_read_b64_tr_b16 v[52:53], v3 offset:61440
    v_add_f32 v133, 1.0, v133
    v_mfma_f32_16x16x32_bf16 v[244:247], v[60:63], a[84:87], v[244:247]
    ds_read_b64_tr_b16 v[54:55], v3 offset:62464
    v_mul_f32 v140, s56, v140
    v_mfma_f32_16x16x32_bf16 v[248:251], v[60:63], a[88:91], v[248:251]
    v_rcp_f32 v133, v133
    v_mfma_f32_16x16x32_bf16 v[252:255], v[60:63], a[92:95], v[252:255]
    s_waitcnt lgkmcnt(2)
    s_barrier
    v_mul_f32 v133, v133, v149
    v_mfma_f32_16x16x32_bf16 v[160:163], v[40:43], a[96:99], v[160:163]
    buffer_load_dwordx4 a[60:63], v5, s[20:23], s84 offen offset:1024 sc1
    v_mfma_f32_16x16x32_bf16 v[164:167], v[40:43], a[100:103], v[164:167]
    s_add_u32 m0, s72, 73728
    ds_read_b64_tr_b16 v[56:57], v4 offset:49152
    v_cvt_pk_bf16_f32 v214, v132, v133
    v_mfma_f32_16x16x32_bf16 v[168:171], v[40:43], a[104:107], v[168:171]
    s_add_u32 s49, s88, 0
    ds_read_b64_tr_b16 v[58:59], v4 offset:50176
    v_mul_f32 v150, v134, v150
    v_mfma_f32_16x16x32_bf16 v[172:175], v[40:43], a[108:111], v[172:175]
    s_add_u32 s84, s81, s89
    v_rcp_f32 v136, v136
    v_mfma_f32_16x16x32_bf16 v[176:179], v[44:47], a[96:99], v[176:179]
    buffer_load_dwordx4 v18, s[24:27], s49 offen offset:0 lds
    v_mfma_f32_16x16x32_bf16 v[180:183], v[44:47], a[100:103], v[180:183]
    s_add_u32 s89, s89, 4096
    ds_read_b64_tr_b16 v[60:61], v4 offset:57344
    v_mul_f32 v134, s56, v134
    v_mfma_f32_16x16x32_bf16 v[184:187], v[44:47], a[104:107], v[184:187]
    ds_read_b64_tr_b16 v[62:63], v4 offset:58368
    v_mul_f32 v136, v136, v152
    v_mfma_f32_16x16x32_bf16 v[188:191], v[44:47], a[108:111], v[188:191]
    v_exp_f32 v134, v134
    v_mfma_f32_16x16x32_bf16 v[160:163], v[48:51], a[112:115], v[160:163]
    buffer_load_dwordx4 v19, s[24:27], s49 offen offset:1024 lds
    v_mfma_f32_16x16x32_bf16 v[164:167], v[48:51], a[116:119], v[164:167]
    ds_read_b64_tr_b16 v[40:41], v4 offset:53248
    v_add_f32 v134, 1.0, v134
    v_mfma_f32_16x16x32_bf16 v[168:171], v[48:51], a[120:123], v[168:171]
    ds_read_b64_tr_b16 v[42:43], v4 offset:54272
    v_mul_f32 v153, v137, v153
    v_mfma_f32_16x16x32_bf16 v[172:175], v[48:51], a[124:127], v[172:175]
    s_waitcnt lgkmcnt(3)
    v_rcp_f32 v134, v134
    v_mfma_f32_16x16x32_bf16 v[176:179], v[52:55], a[112:115], v[176:179]
    buffer_load_dwordx4 v20, s[24:27], s49 offen offset:2048 lds
    v_mfma_f32_16x16x32_bf16 v[180:183], v[52:55], a[116:119], v[180:183]
    ds_read_b64_tr_b16 v[44:45], v4 offset:61440
    v_mul_f32 v134, v134, v150
    v_mfma_f32_16x16x32_bf16 v[184:187], v[52:55], a[120:123], v[184:187]
    ds_read_b64_tr_b16 v[46:47], v4 offset:62464
    v_mul_f32 v151, v135, v151
    v_mfma_f32_16x16x32_bf16 v[188:191], v[52:55], a[124:127], v[188:191]
    v_exp_f32 v140, v140
    v_mfma_f32_16x16x32_bf16 v[224:227], v[56:59], a[96:99], v[224:227]
    buffer_load_dwordx4 v21, s[24:27], s49 offen offset:3072 lds
    v_mfma_f32_16x16x32_bf16 v[228:231], v[56:59], a[100:103], v[228:231]
    s_add_u32 m0, s72, 77824
    v_add_u32 v3, 0x10000, v3
    v_mul_f32 v135, s56, v135
    v_mfma_f32_16x16x32_bf16 v[232:235], v[56:59], a[104:107], v[232:235]
    s_add_u32 s49, s88, 36864
    ds_read_b64_tr_b16 v[48:49], v3 offset:0
    v_mul_f32 v137, s56, v137
    v_mfma_f32_16x16x32_bf16 v[236:239], v[56:59], a[108:111], v[236:239]
    s_waitcnt lgkmcnt(2)
    ds_read_b64_tr_b16 v[50:51], v3 offset:1024
    v_add_f32 v140, 1.0, v140
    v_mfma_f32_16x16x32_bf16 v[240:243], v[60:63], a[96:99], v[240:243]
    buffer_load_dwordx4 v18, s[24:27], s49 offen offset:0 lds
    v_mfma_f32_16x16x32_bf16 v[244:247], v[60:63], a[100:103], v[244:247]
    ds_read_b64_tr_b16 v[52:53], v3 offset:8192
    v_mfma_f32_16x16x32_bf16 v[248:251], v[60:63], a[104:107], v[248:251]
    ds_read_b64_tr_b16 v[54:55], v3 offset:9216
    v_mfma_f32_16x16x32_bf16 v[252:255], v[60:63], a[108:111], v[252:255]
    v_exp_f32 v135, v135
    v_mfma_f32_16x16x32_bf16 v[224:227], v[40:43], a[112:115], v[224:227]
    buffer_load_dwordx4 v19, s[24:27], s49 offen offset:1024 lds
    v_mfma_f32_16x16x32_bf16 v[228:231], v[40:43], a[116:119], v[228:231]
    ds_read_b64_tr_b16 v[56:57], v3 offset:4096
    v_add_f32 v135, 1.0, v135
    v_mfma_f32_16x16x32_bf16 v[232:235], v[40:43], a[120:123], v[232:235]
    ds_read_b64_tr_b16 v[58:59], v3 offset:5120
    v_mfma_f32_16x16x32_bf16 v[236:239], v[40:43], a[124:127], v[236:239]
    s_waitcnt lgkmcnt(3)
    v_rcp_f32 v135, v135
    v_mfma_f32_16x16x32_bf16 v[240:243], v[44:47], a[112:115], v[240:243]
    buffer_load_dwordx4 v20, s[24:27], s49 offen offset:2048 lds
    v_mfma_f32_16x16x32_bf16 v[244:247], v[44:47], a[116:119], v[244:247]
    ds_read_b64_tr_b16 v[60:61], v3 offset:12288
    v_mul_f32 v135, v135, v151
    v_mfma_f32_16x16x32_bf16 v[248:251], v[44:47], a[120:123], v[248:251]
    ds_read_b64_tr_b16 v[62:63], v3 offset:13312
    v_cvt_pk_bf16_f32 v215, v134, v135
    v_mfma_f32_16x16x32_bf16 v[252:255], v[44:47], a[124:127], v[252:255]
    v_exp_f32 v137, v137
    v_mfma_f32_16x16x32_bf16 v[160:163], v[48:51], a[128:131], v[160:163]
    buffer_load_dwordx4 v21, s[24:27], s49 offen offset:3072 lds
    v_mfma_f32_16x16x32_bf16 v[164:167], v[48:51], a[132:135], v[164:167]
    s_add_u32 m0, s72, 81920
    v_add_u32 v4, 0x10000, v4
    v_add_f32 v137, 1.0, v137
    v_mfma_f32_16x16x32_bf16 v[168:171], v[48:51], a[136:139], v[168:171]
    s_add_u32 s49, s88, 73728
    ds_read_b64_tr_b16 v[40:41], v4 offset:0
    v_mfma_f32_16x16x32_bf16 v[172:175], v[48:51], a[140:143], v[172:175]
    s_waitcnt lgkmcnt(2)
    ds_read_b64_tr_b16 v[42:43], v4 offset:1024
    v_mfma_f32_16x16x32_bf16 v[176:179], v[52:55], a[128:131], v[176:179]
    buffer_load_dwordx4 v18, s[24:27], s49 offen offset:0 lds
    v_mfma_f32_16x16x32_bf16 v[180:183], v[52:55], a[132:135], v[180:183]
    s_add_u32 s88, s88, 128
    ds_read_b64_tr_b16 v[44:45], v4 offset:8192
    v_mfma_f32_16x16x32_bf16 v[184:187], v[52:55], a[136:139], v[184:187]
    s_cmp_lg_u32 s88, 1152
    s_cselect_b32 s88, s88, 0
    ds_read_b64_tr_b16 v[46:47], v4 offset:9216
    v_mfma_f32_16x16x32_bf16 v[188:191], v[52:55], a[140:143], v[188:191]
    v_rcp_f32 v137, v137
    v_mfma_f32_16x16x32_bf16 v[160:163], v[56:59], a[144:147], v[160:163]
    buffer_load_dwordx4 a[64:67], v5, s[20:23], s84 offen offset:0 sc1
    v_mfma_f32_16x16x32_bf16 v[164:167], v[56:59], a[148:151], v[164:167]
    ds_read_b64_tr_b16 v[48:49], v4 offset:4096
    v_mul_f32 v137, v137, v153
    v_mfma_f32_16x16x32_bf16 v[168:171], v[56:59], a[152:155], v[168:171]
    ds_read_b64_tr_b16 v[50:51], v4 offset:5120
    v_cvt_pk_bf16_f32 v218, v136, v137
    v_mfma_f32_16x16x32_bf16 v[172:175], v[56:59], a[156:159], v[172:175]
    s_waitcnt lgkmcnt(3)
    v_rcp_f32 v140, v140
    v_mfma_f32_16x16x32_bf16 v[176:179], v[60:63], a[144:147], v[176:179]
    buffer_load_dwordx4 a[68:71], v5, s[20:23], s84 offen offset:1024 sc1
    v_mfma_f32_16x16x32_bf16 v[180:183], v[60:63], a[148:151], v[180:183]
    s_add_u32 s84, s81, s89
    ds_read_b64_tr_b16 v[52:53], v4 offset:12288
    v_mul_f32 v154, v138, v154
    v_mfma_f32_16x16x32_bf16 v[184:187], v[60:63], a[152:155], v[184:187]
    s_add_u32 s89, s89, 4096
    ds_read_b64_tr_b16 v[54:55], v4 offset:13312
    v_mul_f32 v138, s56, v138
    v_mfma_f32_16x16x32_bf16 v[188:191], v[60:63], a[156:159], v[188:191]
    v_exp_f32 v138, v138
    v_mfma_f32_16x16x32_bf16 v[224:227], v[40:43], a[128:131], v[224:227]
    buffer_load_dwordx4 a[72:75], v5, s[20:23], s84 offen offset:0 sc1
    v_mfma_f32_16x16x32_bf16 v[228:231], v[40:43], a[132:135], v[228:231]
    v_add_u32 v3, 0xfffe0000, v3
    v_add_f32 v138, 1.0, v138
    v_mfma_f32_16x16x32_bf16 v[232:235], v[40:43], a[136:139], v[232:235]
    ds_read_b64_tr_b16 v[56:57], v3 offset:0
    v_mul_f32 v140, v140, v156
    v_mfma_f32_16x16x32_bf16 v[236:239], v[40:43], a[140:143], v[236:239]
    s_waitcnt lgkmcnt(2)
    ds_read_b64_tr_b16 v[58:59], v3 offset:1024
    v_mul_f32 v157, v141, v157
    v_mfma_f32_16x16x32_bf16 v[240:243], v[44:47], a[128:131], v[240:243]
    buffer_load_dwordx4 a[76:79], v5, s[20:23], s84 offen offset:1024 sc1
    v_mfma_f32_16x16x32_bf16 v[244:247], v[44:47], a[132:135], v[244:247]
    s_add_u32 s84, s81, s89
    ds_read_b64_tr_b16 v[60:61], v3 offset:8192
    v_mul_f32 v141, s56, v141
    v_mfma_f32_16x16x32_bf16 v[248:251], v[44:47], a[136:139], v[248:251]
    s_add_u32 s89, s89, 4096
    ds_read_b64_tr_b16 v[62:63], v3 offset:9216
    v_mfma_f32_16x16x32_bf16 v[252:255], v[44:47], a[140:143], v[252:255]
    v_rcp_f32 v138, v138
    v_mfma_f32_16x16x32_bf16 v[224:227], v[48:51], a[144:147], v[224:227]
    buffer_load_dwordx4 a[80:83], v5, s[20:23], s84 offen offset:0 sc1
    v_mfma_f32_16x16x32_bf16 v[228:231], v[48:51], a[148:151], v[228:231]
    ds_read_b64_tr_b16 v[40:41], v3 offset:4096
    v_mul_f32 v138, v138, v154
    v_mfma_f32_16x16x32_bf16 v[232:235], v[48:51], a[152:155], v[232:235]
    ds_read_b64_tr_b16 v[42:43], v3 offset:5120
    v_mul_f32 v155, v139, v155
    v_mfma_f32_16x16x32_bf16 v[236:239], v[48:51], a[156:159], v[236:239]
    s_waitcnt lgkmcnt(3)
    v_exp_f32 v141, v141
    v_mfma_f32_16x16x32_bf16 v[240:243], v[52:55], a[144:147], v[240:243]
    buffer_load_dwordx4 a[84:87], v5, s[20:23], s84 offen offset:1024 sc1
    v_mfma_f32_16x16x32_bf16 v[244:247], v[52:55], a[148:151], v[244:247]
    s_add_u32 s84, s81, s89
    ds_read_b64_tr_b16 v[44:45], v3 offset:12288
    v_mul_f32 v139, s56, v139
    v_mfma_f32_16x16x32_bf16 v[248:251], v[52:55], a[152:155], v[248:251]
    s_add_u32 s89, s89, 4096
    ds_read_b64_tr_b16 v[46:47], v3 offset:13312
    v_add_f32 v141, 1.0, v141
    v_mfma_f32_16x16x32_bf16 v[252:255], v[52:55], a[156:159], v[252:255]
    s_waitcnt lgkmcnt(3)
    s_barrier
    v_mfma_f32_16x16x32_bf16 v[160:163], v[56:59], a[160:163], v[160:163]
    s_add_u32 m0, s72, 110592
    ds_read_b64_tr_b16 v[48:49], v3 offset:16384
    v_mfma_f32_16x16x32_bf16 v[164:167], v[56:59], a[164:167], v[164:167]
    s_add_u32 s49, s88, 0
    ds_read_b64_tr_b16 v[50:51], v3 offset:17408
    v_mfma_f32_16x16x32_bf16 v[168:171], v[56:59], a[168:171], v[168:171]
    buffer_load_dwordx4 v18, s[24:27], s49 offen offset:0 lds
    v_mfma_f32_16x16x32_bf16 v[172:175], v[56:59], a[172:175], v[172:175]
    s_cmp_lg_u32 s89, 147456
    s_cselect_b32 s89, s89, 0
    v_exp_f32 v139, v139
    v_mfma_f32_16x16x32_bf16 v[176:179], v[60:63], a[160:163], v[176:179]
    ds_read_b64_tr_b16 v[52:53], v3 offset:24576
    v_add_f32 v139, 1.0, v139
    v_mfma_f32_16x16x32_bf16 v[180:183], v[60:63], a[164:167], v[180:183]
    ds_read_b64_tr_b16 v[54:55], v3 offset:25600
    v_mfma_f32_16x16x32_bf16 v[184:187], v[60:63], a[168:171], v[184:187]
    buffer_load_dwordx4 v19, s[24:27], s49 offen offset:1024 lds
    v_mfma_f32_16x16x32_bf16 v[188:191], v[60:63], a[172:175], v[188:191]
    s_waitcnt lgkmcnt(2)
    v_rcp_f32 v139, v139
    v_mfma_f32_16x16x32_bf16 v[160:163], v[40:43], a[176:179], v[160:163]
    ds_read_b64_tr_b16 v[56:57], v3 offset:20480
    v_mul_f32 v139, v139, v155
    v_mfma_f32_16x16x32_bf16 v[164:167], v[40:43], a[180:183], v[164:167]
    ds_read_b64_tr_b16 v[58:59], v3 offset:21504
    v_cvt_pk_bf16_f32 v219, v138, v139
    v_mfma_f32_16x16x32_bf16 v[168:171], v[40:43], a[184:187], v[168:171]
    buffer_load_dwordx4 v20, s[24:27], s49 offen offset:2048 lds
    v_mfma_f32_16x16x32_bf16 v[172:175], v[40:43], a[188:191], v[172:175]
    v_rcp_f32 v141, v141
    v_mfma_f32_16x16x32_bf16 v[176:179], v[44:47], a[176:179], v[176:179]
    ds_read_b64_tr_b16 v[60:61], v3 offset:28672
    v_mul_f32 v141, v141, v157
    v_mfma_f32_16x16x32_bf16 v[180:183], v[44:47], a[180:183], v[180:183]
    ds_read_b64_tr_b16 v[62:63], v3 offset:29696
    v_cvt_pk_bf16_f32 v222, v140, v141
    v_mfma_f32_16x16x32_bf16 v[184:187], v[44:47], a[184:187], v[184:187]
    buffer_load_dwordx4 v21, s[24:27], s49 offen offset:3072 lds
    v_mfma_f32_16x16x32_bf16 v[188:191], v[44:47], a[188:191], v[188:191]
    s_add_u32 m0, s72, 114688
    v_mul_f32 v158, v142, v158
    s_add_u32 s49, s88, 36864
    v_mfma_f32_16x16x32_bf16 v[160:163], v[48:51], a[192:195], v[160:163]
    ds_read_b64_tr_b16 v[40:41], v3 offset:32768
    v_mul_f32 v142, s56, v142
    v_mfma_f32_16x16x32_bf16 v[164:167], v[48:51], a[196:199], v[164:167]
    ds_read_b64_tr_b16 v[42:43], v3 offset:33792
    v_mfma_f32_16x16x32_bf16 v[168:171], v[48:51], a[200:203], v[168:171]
    buffer_load_dwordx4 v18, s[24:27], s49 offen offset:0 lds
    v_mfma_f32_16x16x32_bf16 v[172:175], v[48:51], a[204:207], v[172:175]
    s_waitcnt lgkmcnt(2)
    v_exp_f32 v142, v142
    v_mfma_f32_16x16x32_bf16 v[176:179], v[52:55], a[192:195], v[176:179]
    ds_read_b64_tr_b16 v[44:45], v3 offset:40960
    v_add_f32 v142, 1.0, v142
    v_mfma_f32_16x16x32_bf16 v[180:183], v[52:55], a[196:199], v[180:183]
    ds_read_b64_tr_b16 v[46:47], v3 offset:41984
    v_mfma_f32_16x16x32_bf16 v[184:187], v[52:55], a[200:203], v[184:187]
    buffer_load_dwordx4 v19, s[24:27], s49 offen offset:1024 lds
    v_mfma_f32_16x16x32_bf16 v[188:191], v[52:55], a[204:207], v[188:191]
    v_rcp_f32 v142, v142
    v_mfma_f32_16x16x32_bf16 v[160:163], v[56:59], a[208:211], v[160:163]
    ds_read_b64_tr_b16 v[48:49], v3 offset:36864
    v_mul_f32 v142, v142, v158
    v_mfma_f32_16x16x32_bf16 v[164:167], v[56:59], a[212:215], v[164:167]
    ds_read_b64_tr_b16 v[50:51], v3 offset:37888
    v_mul_f32 v159, v143, v159
    v_mfma_f32_16x16x32_bf16 v[168:171], v[56:59], a[216:219], v[168:171]
    buffer_load_dwordx4 v20, s[24:27], s49 offen offset:2048 lds
    v_mfma_f32_16x16x32_bf16 v[172:175], v[56:59], a[220:223], v[172:175]
    v_mul_f32 v143, s56, v143
    v_mfma_f32_16x16x32_bf16 v[176:179], v[60:63], a[208:211], v[176:179]
    ds_read_b64_tr_b16 v[52:53], v3 offset:45056
    v_mfma_f32_16x16x32_bf16 v[180:183], v[60:63], a[212:215], v[180:183]
    ds_read_b64_tr_b16 v[54:55], v3 offset:46080
    v_mfma_f32_16x16x32_bf16 v[184:187], v[60:63], a[216:219], v[184:187]
    buffer_load_dwordx4 v21, s[24:27], s49 offen offset:3072 lds
    v_mfma_f32_16x16x32_bf16 v[188:191], v[60:63], a[220:223], v[188:191]
    s_waitcnt lgkmcnt(2)
    v_exp_f32 v143, v143
    v_mfma_f32_16x16x32_bf16 v[160:163], v[40:43], a[224:227], v[160:163]
    s_add_u32 m0, s72, 118784
    ds_read_b64_tr_b16 v[56:57], v3 offset:49152
    v_add_f32 v143, 1.0, v143
    v_mfma_f32_16x16x32_bf16 v[164:167], v[40:43], a[228:231], v[164:167]
    s_add_u32 s49, s88, 73728
    ds_read_b64_tr_b16 v[58:59], v3 offset:50176
    v_mfma_f32_16x16x32_bf16 v[168:171], v[40:43], a[232:235], v[168:171]
    buffer_load_dwordx4 v18, s[24:27], s49 offen offset:0 lds
    v_mfma_f32_16x16x32_bf16 v[172:175], v[40:43], a[236:239], v[172:175]
    s_add_u32 s88, s88, 128
    v_rcp_f32 v143, v143
    v_mfma_f32_16x16x32_bf16 v[176:179], v[44:47], a[224:227], v[176:179]
    s_cmp_lg_u32 s88, 1152
    s_cselect_b32 s88, s88, 0
    ds_read_b64_tr_b16 v[60:61], v3 offset:57344
    v_mul_f32 v143, v143, v159
    v_mfma_f32_16x16x32_bf16 v[180:183], v[44:47], a[228:231], v[180:183]
    ds_read_b64_tr_b16 v[62:63], v3 offset:58368
    v_cvt_pk_bf16_f32 v223, v142, v143
    v_mfma_f32_16x16x32_bf16 v[184:187], v[44:47], a[232:235], v[184:187]
    v_mfma_f32_16x16x32_bf16 v[188:191], v[44:47], a[236:239], v[188:191]
    v_mfma_f32_16x16x32_bf16 v[160:163], v[48:51], a[240:243], v[160:163]
    ds_read_b64_tr_b16 v[40:41], v3 offset:53248
    v_mfma_f32_16x16x32_bf16 v[164:167], v[48:51], a[244:247], v[164:167]
    ds_read_b64_tr_b16 v[42:43], v3 offset:54272
    v_mfma_f32_16x16x32_bf16 v[168:171], v[48:51], a[248:251], v[168:171]
    v_mfma_f32_16x16x32_bf16 v[172:175], v[48:51], a[252:255], v[172:175]
    s_waitcnt lgkmcnt(2)
    v_mfma_f32_16x16x32_bf16 v[176:179], v[52:55], a[240:243], v[176:179]
    ds_read_b64_tr_b16 v[44:45], v3 offset:61440
    v_mfma_f32_16x16x32_bf16 v[180:183], v[52:55], a[244:247], v[180:183]
    ds_read_b64_tr_b16 v[46:47], v3 offset:62464
    v_mfma_f32_16x16x32_bf16 v[184:187], v[52:55], a[248:251], v[184:187]
    buffer_store_dwordx4 v[208:211], v5, s[20:23], s58 offen offset:0 sc1
    v_mfma_f32_16x16x32_bf16 v[188:191], v[52:55], a[252:255], v[188:191]
    v_mfma_f32_16x16x32_bf16 v[160:163], v[56:59], v[64:67], v[160:163]
    v_add_u32 v4, 0xfffe0000, v4
    v_mfma_f32_16x16x32_bf16 v[164:167], v[56:59], v[68:71], v[164:167]
    ds_read_b64_tr_b16 v[48:49], v4 offset:0
    v_mfma_f32_16x16x32_bf16 v[168:171], v[56:59], v[72:75], v[168:171]
    buffer_store_dwordx4 v[212:215], v5, s[20:23], s58 offen offset:1024 sc1
    v_mfma_f32_16x16x32_bf16 v[172:175], v[56:59], v[76:79], v[172:175]
    ds_read_b64_tr_b16 v[50:51], v4 offset:1024
    v_mfma_f32_16x16x32_bf16 v[176:179], v[60:63], v[64:67], v[176:179]
    ds_read_b64_tr_b16 v[52:53], v4 offset:8192
    v_mfma_f32_16x16x32_bf16 v[180:183], v[60:63], v[68:71], v[180:183]
    ds_read_b64_tr_b16 v[54:55], v4 offset:9216
    v_mfma_f32_16x16x32_bf16 v[184:187], v[60:63], v[72:75], v[184:187]
    buffer_store_dwordx4 v[216:219], v5, s[20:23], s58 offen offset:2048 sc1
    v_mfma_f32_16x16x32_bf16 v[188:191], v[60:63], v[76:79], v[188:191]
    s_waitcnt lgkmcnt(3)
    v_mfma_f32_16x16x32_bf16 v[160:163], v[40:43], v[80:83], v[160:163]
    ds_read_b64_tr_b16 v[56:57], v4 offset:4096
    v_mfma_f32_16x16x32_bf16 v[164:167], v[40:43], v[84:87], v[164:167]
    ds_read_b64_tr_b16 v[58:59], v4 offset:5120
    v_mfma_f32_16x16x32_bf16 v[168:171], v[40:43], v[88:91], v[168:171]
    buffer_store_dwordx4 v[220:223], v5, s[20:23], s58 offen offset:3072 sc1
    v_mfma_f32_16x16x32_bf16 v[172:175], v[40:43], v[92:95], v[172:175]
    buffer_load_dwordx4 a[88:91], v5, s[20:23], s84 offen offset:0 sc1
    v_mfma_f32_16x16x32_bf16 v[176:179], v[44:47], v[80:83], v[176:179]
    ds_read_b64_tr_b16 v[60:61], v4 offset:12288
    v_mfma_f32_16x16x32_bf16 v[180:183], v[44:47], v[84:87], v[180:183]
    ds_read_b64_tr_b16 v[62:63], v4 offset:13312
    v_mfma_f32_16x16x32_bf16 v[184:187], v[44:47], v[88:91], v[184:187]
    v_mfma_f32_16x16x32_bf16 v[188:191], v[44:47], v[92:95], v[188:191]
    s_waitcnt lgkmcnt(2)
    v_mfma_f32_16x16x32_bf16 v[224:227], v[48:51], a[160:163], v[224:227]
    buffer_load_dwordx4 a[92:95], v5, s[20:23], s84 offen offset:1024 sc1
    v_mfma_f32_16x16x32_bf16 v[228:231], v[48:51], a[164:167], v[228:231]
    s_add_u32 s84, s81, s89
    ds_read_b64_tr_b16 v[40:41], v4 offset:16384
    v_mul_f32 v176, v160, v176
    v_mfma_f32_16x16x32_bf16 v[232:235], v[48:51], a[168:171], v[232:235]
    s_add_u32 s89, s89, 4096
    ds_read_b64_tr_b16 v[42:43], v4 offset:17408
    v_mul_f32 v160, s56, v160
    v_mfma_f32_16x16x32_bf16 v[236:239], v[48:51], a[172:175], v[236:239]
    v_exp_f32 v160, v160
    v_mfma_f32_16x16x32_bf16 v[240:243], v[52:55], a[160:163], v[240:243]
    buffer_load_dwordx4 a[96:99], v5, s[20:23], s84 offen offset:0 sc1
    v_mfma_f32_16x16x32_bf16 v[244:247], v[52:55], a[164:167], v[244:247]
    ds_read_b64_tr_b16 v[44:45], v4 offset:24576
    v_add_f32 v160, 1.0, v160
    v_mfma_f32_16x16x32_bf16 v[248:251], v[52:55], a[168:171], v[248:251]
    ds_read_b64_tr_b16 v[46:47], v4 offset:25600
    v_mul_f32 v180, v164, v180
    v_mfma_f32_16x16x32_bf16 v[252:255], v[52:55], a[172:175], v[252:255]
    v_rcp_f32 v160, v160
    v_mfma_f32_16x16x32_bf16 v[224:227], v[56:59], a[176:179], v[224:227]
    buffer_load_dwordx4 a[100:103], v5, s[20:23], s84 offen offset:1024 sc1
    v_mfma_f32_16x16x32_bf16 v[228:231], v[56:59], a[180:183], v[228:231]
    s_add_u32 s84, s81, s89
    ds_read_b64_tr_b16 v[48:49], v4 offset:20480
    v_mul_f32 v160, v160, v176
    v_mfma_f32_16x16x32_bf16 v[232:235], v[56:59], a[184:187], v[232:235]
    s_add_u32 s89, s89, 4096
    ds_read_b64_tr_b16 v[50:51], v4 offset:21504
    v_mul_f32 v177, v161, v177
    v_mfma_f32_16x16x32_bf16 v[236:239], v[56:59], a[188:191], v[236:239]
    s_waitcnt lgkmcnt(3)
    v_mul_f32 v161, s56, v161
    v_mul_f32 v164, s56, v164
    v_mfma_f32_16x16x32_bf16 v[240:243], v[60:63], a[176:179], v[240:243]
    ds_read_b64_tr_b16 v[52:53], v4 offset:28672
    v_mul_f32 v184, v168, v184
    v_mfma_f32_16x16x32_bf16 v[244:247], v[60:63], a[180:183], v[244:247]
    ds_read_b64_tr_b16 v[54:55], v4 offset:29696
    v_mul_f32 v168, s56, v168
    v_mfma_f32_16x16x32_bf16 v[248:251], v[60:63], a[184:187], v[248:251]
    v_exp_f32 v161, v161
    v_mfma_f32_16x16x32_bf16 v[252:255], v[60:63], a[188:191], v[252:255]
    v_exp_f32 v164, v164
    v_mfma_f32_16x16x32_bf16 v[224:227], v[40:43], a[192:195], v[224:227]
    ds_read_b64_tr_b16 v[56:57], v4 offset:32768
    v_add_f32 v161, 1.0, v161
    v_mfma_f32_16x16x32_bf16 v[228:231], v[40:43], a[196:199], v[228:231]
    ds_read_b64_tr_b16 v[58:59], v4 offset:33792
    v_add_f32 v164, 1.0, v164
    v_mfma_f32_16x16x32_bf16 v[232:235], v[40:43], a[200:203], v[232:235]
    v_rcp_f32 v161, v161
    v_mfma_f32_16x16x32_bf16 v[236:239], v[40:43], a[204:207], v[236:239]
    s_waitcnt lgkmcnt(2)
    v_rcp_f32 v164, v164
    v_mfma_f32_16x16x32_bf16 v[240:243], v[44:47], a[192:195], v[240:243]
    ds_read_b64_tr_b16 v[60:61], v4 offset:40960
    v_mul_f32 v161, v161, v177
    v_mfma_f32_16x16x32_bf16 v[244:247], v[44:47], a[196:199], v[244:247]
    ds_read_b64_tr_b16 v[62:63], v4 offset:41984
    v_cvt_pk_bf16_f32 v208, v160, v161
    v_mfma_f32_16x16x32_bf16 v[248:251], v[44:47], a[200:203], v[248:251]
    v_exp_f32 v168, v168
    v_mfma_f32_16x16x32_bf16 v[252:255], v[44:47], a[204:207], v[252:255]
    s_branch gated_mix__ssm_conv_s5__swiglu_ffn__prompt_kernel_B_sk7
.p2align 12
gated_mix__ssm_conv_s5__swiglu_ffn__prompt_kernel_B_pg0_7:
    s_branch gated_mix__ssm_conv_s5__swiglu_ffn__prompt_kernel_B_pr0
gated_mix__ssm_conv_s5__swiglu_ffn__prompt_kernel_B_pg3_7:
    s_branch gated_mix__ssm_conv_s5__swiglu_ffn__prompt_kernel_B_pr3
gated_mix__ssm_conv_s5__swiglu_ffn__prompt_kernel_B_sk7:
    v_mul_f32 v178, v162, v178
    v_mul_f32 v162, s56, v162
    v_mfma_f32_16x16x32_bf16 v[224:227], v[48:51], a[208:211], v[224:227]
    ds_read_b64_tr_b16 v[40:41], v4 offset:36864
    v_mul_f32 v164, v164, v180
    v_mfma_f32_16x16x32_bf16 v[228:231], v[48:51], a[212:215], v[228:231]
    ds_read_b64_tr_b16 v[42:43], v4 offset:37888
    v_mul_f32 v181, v165, v181
    v_mfma_f32_16x16x32_bf16 v[232:235], v[48:51], a[216:219], v[232:235]
    v_exp_f32 v162, v162
    v_mfma_f32_16x16x32_bf16 v[236:239], v[48:51], a[220:223], v[236:239]
    v_add_f32 v162, 1.0, v162
    v_mul_f32 v165, s56, v165
    v_mfma_f32_16x16x32_bf16 v[240:243], v[52:55], a[208:211], v[240:243]
    ds_read_b64_tr_b16 v[44:45], v4 offset:45056
    v_add_f32 v168, 1.0, v168
    v_mfma_f32_16x16x32_bf16 v[244:247], v[52:55], a[212:215], v[244:247]
    ds_read_b64_tr_b16 v[46:47], v4 offset:46080
    v_mul_f32 v188, v172, v188
    v_mfma_f32_16x16x32_bf16 v[248:251], v[52:55], a[216:219], v[248:251]
    v_rcp_f32 v162, v162
    v_mfma_f32_16x16x32_bf16 v[252:255], v[52:55], a[220:223], v[252:255]
    s_waitcnt lgkmcnt(2)
    v_exp_f32 v165, v165
    v_mfma_f32_16x16x32_bf16 v[224:227], v[56:59], a[224:227], v[224:227]
    buffer_load_dwordx4 a[104:107], v5, s[20:23], s84 offen offset:0 sc1
    v_mfma_f32_16x16x32_bf16 v[228:231], v[56:59], a[228:231], v[228:231]
    ds_read_b64_tr_b16 v[48:49], v4 offset:49152
    v_mul_f32 v162, v162, v178
    v_mfma_f32_16x16x32_bf16 v[232:235], v[56:59], a[232:235], v[232:235]
    ds_read_b64_tr_b16 v[50:51], v4 offset:50176
    v_mul_f32 v179, v163, v179
    v_mfma_f32_16x16x32_bf16 v[236:239], v[56:59], a[236:239], v[236:239]
    v_rcp_f32 v168, v168
    v_mfma_f32_16x16x32_bf16 v[240:243], v[60:63], a[224:227], v[240:243]
    buffer_load_dwordx4 a[108:111], v5, s[20:23], s84 offen offset:1024 sc1
    v_mfma_f32_16x16x32_bf16 v[244:247], v[60:63], a[228:231], v[244:247]
    s_add_u32 s84, s81, s89
    ds_read_b64_tr_b16 v[52:53], v4 offset:57344
    v_mul_f32 v163, s56, v163
    v_mfma_f32_16x16x32_bf16 v[248:251], v[60:63], a[232:235], v[248:251]
    s_add_u32 s89, s89, 4096
    ds_read_b64_tr_b16 v[54:55], v4 offset:58368
    v_add_f32 v165, 1.0, v165
    v_mfma_f32_16x16x32_bf16 v[252:255], v[60:63], a[236:239], v[252:255]
    v_exp_f32 v163, v163
    v_mfma_f32_16x16x32_bf16 v[224:227], v[40:43], a[240:243], v[224:227]
    buffer_load_dwordx4 a[112:115], v5, s[20:23], s84 offen offset:0 sc1
    v_mfma_f32_16x16x32_bf16 v[228:231], v[40:43], a[244:247], v[228:231]
    ds_read_b64_tr_b16 v[56:57], v4 offset:53248
    v_add_f32 v163, 1.0, v163
    v_mfma_f32_16x16x32_bf16 v[232:235], v[40:43], a[248:251], v[232:235]
    ds_read_b64_tr_b16 v[58:59], v4 offset:54272
    v_mul_f32 v168, v168, v184
    v_mfma_f32_16x16x32_bf16 v[236:239], v[40:43], a[252:255], v[236:239]
    s_waitcnt lgkmcnt(3)
    v_rcp_f32 v163, v163
    v_mfma_f32_16x16x32_bf16 v[240:243], v[44:47], a[240:243], v[240:243]
    buffer_load_dwordx4 a[116:119], v5, s[20:23], s84 offen offset:1024 sc1
    v_mfma_f32_16x16x32_bf16 v[244:247], v[44:47], a[244:247], v[244:247]
    s_add_u32 s84, s81, s89
    ds_read_b64_tr_b16 v[60:61], v4 offset:61440
    v_mul_f32 v163, v163, v179
    v_mfma_f32_16x16x32_bf16 v[248:251], v[44:47], a[248:251], v[248:251]
    s_add_u32 s89, s89, 4096
    ds_read_b64_tr_b16 v[62:63], v4 offset:62464
    v_cvt_pk_bf16_f32 v209, v162, v163
    v_mfma_f32_16x16x32_bf16 v[252:255], v[44:47], a[252:255], v[252:255]
    s_cmp_lg_u32 s89, 147456
    s_cselect_b32 s89, s89, 0
    v_rcp_f32 v165, v165
    v_mfma_f32_16x16x32_bf16 v[224:227], v[48:51], v[64:67], v[224:227]
    s_waitcnt vmcnt(27) lgkmcnt(2)
    s_barrier
    v_mul_f32 v165, v165, v181
    v_mfma_f32_16x16x32_bf16 v[228:231], v[48:51], v[68:71], v[228:231]
    buffer_load_dwordx4 a[120:123], v5, s[20:23], s84 offen offset:0 sc1
    v_mfma_f32_16x16x32_bf16 v[232:235], v[48:51], v[72:75], v[232:235]
    s_add_u32 m0, s72, 0
    ds_read_b128 a[128:131], v12 offset:0
    v_cvt_pk_bf16_f32 v212, v164, v165
    v_mfma_f32_16x16x32_bf16 v[236:239], v[48:51], v[76:79], v[236:239]
    s_add_u32 s49, s88, 0
    ds_read_b128 a[132:135], v12 offset:2048
    v_mul_f32 v182, v166, v182
    v_mfma_f32_16x16x32_bf16 v[240:243], v[52:55], v[64:67], v[240:243]
    ds_read_b128 a[136:139], v12 offset:4096
    v_mul_f32 v166, s56, v166
    v_mfma_f32_16x16x32_bf16 v[244:247], v[52:55], v[68:71], v[244:247]
    buffer_load_dwordx4 v18, s[24:27], s49 offen offset:0 lds
    v_mfma_f32_16x16x32_bf16 v[248:251], v[52:55], v[72:75], v[248:251]
    ds_read_b128 a[140:143], v12 offset:6144
    v_mul_f32 v185, v169, v185
    v_mfma_f32_16x16x32_bf16 v[252:255], v[52:55], v[76:79], v[252:255]
    v_exp_f32 v166, v166
    v_mfma_f32_16x16x32_bf16 v[224:227], v[56:59], v[80:83], v[224:227]
    ds_read_b128 a[144:147], v12 offset:8192
    v_add_f32 v166, 1.0, v166
    v_mfma_f32_16x16x32_bf16 v[228:231], v[56:59], v[84:87], v[228:231]
    buffer_load_dwordx4 v19, s[24:27], s49 offen offset:1024 lds
    v_mfma_f32_16x16x32_bf16 v[232:235], v[56:59], v[88:91], v[232:235]
    ds_read_b128 a[148:151], v12 offset:10240
    v_mul_f32 v169, s56, v169
    v_mfma_f32_16x16x32_bf16 v[236:239], v[56:59], v[92:95], v[236:239]
    s_waitcnt lgkmcnt(3)
    v_rcp_f32 v166, v166
    v_mfma_f32_16x16x32_bf16 v[240:243], v[60:63], v[80:83], v[240:243]
    ds_read_b128 a[152:155], v12 offset:12288
    v_mul_f32 v166, v166, v182
    v_mfma_f32_16x16x32_bf16 v[244:247], v[60:63], v[84:87], v[244:247]
    buffer_load_dwordx4 v20, s[24:27], s49 offen offset:2048 lds
    v_mfma_f32_16x16x32_bf16 v[248:251], v[60:63], v[88:91], v[248:251]
    ds_read_b128 a[156:159], v12 offset:14336
    v_mul_f32 v183, v167, v183
    v_mfma_f32_16x16x32_bf16 v[252:255], v[60:63], v[92:95], v[252:255]
    v_exp_f32 v169, v169
    v_mfma_f32_16x16x32_bf16 v[64:67], a[128:131], a[0:3], 0
    s_waitcnt vmcnt(12)
    ds_read_b128 a[160:163], v12 offset:16384
    v_mul_f32 v167, s56, v167
    v_exp_f32 v167, v167
    v_mfma_f32_16x16x32_bf16 v[100:103], a[128:131], a[4:7], 0
    buffer_store_dword v4, v6, s[20:23], s61 offen offset:384 sc1
    v_add_f32 v167, 1.0, v167
    v_mfma_f32_16x16x32_bf16 v[68:71], a[132:135], a[0:3], 0
    buffer_load_dwordx4 v21, s[24:27], s49 offen offset:3072 lds
    v_rcp_f32 v167, v167
    v_mfma_f32_16x16x32_bf16 v[104:107], a[132:135], a[4:7], 0
    s_add_u32 m0, s72, 4096
    ds_read_b128 a[164:167], v13 offset:0
    v_mul_f32 v167, v167, v183
    v_cvt_pk_bf16_f32 v213, v166, v167
    v_mfma_f32_16x16x32_bf16 v[72:75], a[136:139], a[0:3], 0
    s_waitcnt lgkmcnt(2)
    s_barrier
    v_add_f32 v169, 1.0, v169
    v_rcp_f32 v169, v169
    v_mfma_f32_16x16x32_bf16 v[108:111], a[136:139], a[4:7], 0
    s_add_u32 s49, s88, 36864
    ds_read_b128 a[168:171], v13 offset:2048
    v_mul_f32 v169, v169, v185
    v_cvt_pk_bf16_f32 v216, v168, v169
    v_mfma_f32_16x16x32_bf16 v[76:79], a[140:143], a[0:3], 0
    buffer_load_dwordx4 v18, s[24:27], s49 offen offset:0 lds
    v_mul_f32 v186, v170, v186
    v_mfma_f32_16x16x32_bf16 v[112:115], a[140:143], a[4:7], 0
    ds_read_b128 a[172:175], v13 offset:4096
    v_mul_f32 v170, s56, v170
    v_exp_f32 v170, v170
    v_mfma_f32_16x16x32_bf16 v[80:83], a[144:147], a[0:3], 0
    ds_read_b128 a[128:131], v13 offset:6144
    v_add_f32 v170, 1.0, v170
    v_rcp_f32 v170, v170
    v_mfma_f32_16x16x32_bf16 v[116:119], a[144:147], a[4:7], 0
    v_mul_f32 v170, v170, v186
    v_mul_f32 v187, v171, v187
    v_mul_f32 v171, s56, v171
    v_mfma_f32_16x16x32_bf16 v[84:87], a[148:151], a[0:3], 0
    buffer_load_dwordx4 v19, s[24:27], s49 offen offset:1024 lds
    v_exp_f32 v171, v171
    v_mfma_f32_16x16x32_bf16 v[120:123], a[148:151], a[4:7], 0
    ds_read_b128 a[132:135], v13 offset:8192
    v_add_f32 v171, 1.0, v171
    v_rcp_f32 v171, v171
    v_mfma_f32_16x16x32_bf16 v[88:91], a[152:155], a[0:3], 0
    ds_read_b128 a[136:139], v13 offset:10240
    v_mul_f32 v171, v171, v187
    v_cvt_pk_bf16_f32 v217, v170, v171
    v_mfma_f32_16x16x32_bf16 v[124:127], a[152:155], a[4:7], 0
    v_mul_f32 v172, s56, v172
    v_mul_f32 v240, v224, v240
    v_exp_f32 v172, v172
    v_mfma_f32_16x16x32_bf16 v[92:95], a[156:159], a[0:3], 0
    buffer_load_dwordx4 v20, s[24:27], s49 offen offset:2048 lds
    v_add_f32 v172, 1.0, v172
    v_mfma_f32_16x16x32_bf16 v[128:131], a[156:159], a[4:7], 0
    s_waitcnt lgkmcnt(2)
    ds_read_b128 a[140:143], v13 offset:12288
    v_mul_f32 v224, s56, v224
    v_rcp_f32 v172, v172
    v_mfma_f32_16x16x32_bf16 v[96:99], a[160:163], a[0:3], 0
    ds_read_b128 a[144:147], v13 offset:14336
    v_mul_f32 v172, v172, v188
    v_mul_f32 v189, v173, v189
    v_mfma_f32_16x16x32_bf16 v[132:135], a[160:163], a[4:7], 0
    v_exp_f32 v224, v224
    v_mul_f32 v173, s56, v173
    v_mfma_f32_16x16x32_bf16 v[64:67], a[164:167], a[8:11], v[64:67]
    buffer_load_dwordx4 v21, s[24:27], s49 offen offset:3072 lds
    v_exp_f32 v173, v173
    v_mfma_f32_16x16x32_bf16 v[100:103], a[164:167], a[12:15], v[100:103]
    s_add_u32 m0, s72, 8192
    ds_read_b128 a[148:151], v13 offset:16384
    v_add_f32 v173, 1.0, v173
    v_rcp_f32 v173, v173
    v_mfma_f32_16x16x32_bf16 v[68:71], a[168:171], a[8:11], v[68:71]
    s_add_u32 s49, s88, 73728
    ds_read_b128 a[152:155], v14 offset:0
    v_mul_f32 v173, v173, v189
    v_cvt_pk_bf16_f32 v220, v172, v173
    v_mfma_f32_16x16x32_bf16 v[104:107], a[168:171], a[12:15], v[104:107]
    v_mul_f32 v190, v174, v190
    v_mul_f32 v174, s56, v174
    v_exp_f32 v174, v174
    v_mfma_f32_16x16x32_bf16 v[72:75], a[172:175], a[8:11], v[72:75]
    buffer_load_dwordx4 v18, s[24:27], s49 offen offset:0 lds
    v_add_f32 v174, 1.0, v174
    v_mfma_f32_16x16x32_bf16 v[108:111], a[172:175], a[12:15], v[108:111]
    s_add_u32 s88, s88, 128
    ds_read_b128 a[156:159], v14 offset:2048
    v_add_f32 v224, 1.0, v224
    v_rcp_f32 v174, v174
    v_mfma_f32_16x16x32_bf16 v[76:79], a[128:131], a[8:11], v[76:79]
    s_cmp_lg_u32 s88, 1152
    s_cselect_b32 s88, s88, 0
    ds_read_b128 a[160:163], v14 offset:4096
    v_mul_f32 v174, v174, v190
    v_mul_f32 v191, v175, v191
    v_mfma_f32_16x16x32_bf16 v[112:115], a[128:131], a[12:15], v[112:115]
    s_waitcnt lgkmcnt(3)
    v_rcp_f32 v224, v224
    v_mul_f32 v175, s56, v175
    v_mfma_f32_16x16x32_bf16 v[80:83], a[132:135], a[8:11], v[80:83]
    buffer_load_dwordx4 a[124:127], v5, s[20:23], s84 offen offset:1024 sc1
    v_exp_f32 v175, v175
    v_mfma_f32_16x16x32_bf16 v[116:119], a[132:135], a[12:15], v[116:119]
    s_add_u32 m0, s72, 36864
    ds_read_b128 a[164:167], v14 offset:6144
    v_add_f32 v175, 1.0, v175
    v_rcp_f32 v175, v175
    v_mfma_f32_16x16x32_bf16 v[84:87], a[136:139], a[8:11], v[84:87]
    s_add_u32 s49, s88, 0
    ds_read_b128 a[168:171], v14 offset:8192
    v_mul_f32 v175, v175, v191
    v_cvt_pk_bf16_f32 v221, v174, v175
    v_mfma_f32_16x16x32_bf16 v[120:123], a[136:139], a[12:15], v[120:123]
    s_add_u32 s84, s81, s89
    v_mul_f32 v224, v224, v240
    s_add_u32 s89, s89, 4096
    v_mul_f32 v241, v225, v241
    v_mfma_f32_16x16x32_bf16 v[88:91], a[140:143], a[8:11], v[88:91]
    ds_read_b128 a[172:175], v14 offset:10240
    v_mul_f32 v225, s56, v225
    v_exp_f32 v225, v225
    v_mfma_f32_16x16x32_bf16 v[124:127], a[140:143], a[12:15], v[124:127]
    v_add_f32 v225, 1.0, v225
    v_mul_f32 v244, v228, v244
    v_rcp_f32 v225, v225
    v_mfma_f32_16x16x32_bf16 v[92:95], a[144:147], a[8:11], v[92:95]
    ds_read_b128 a[128:131], v14 offset:12288
    v_mul_f32 v225, v225, v241
    v_cvt_pk_bf16_f32 v210, v224, v225
    v_mfma_f32_16x16x32_bf16 v[128:131], a[144:147], a[12:15], v[128:131]
    v_mul_f32 v242, v226, v242
    v_mul_f32 v226, s56, v226
    v_exp_f32 v226, v226
    v_mfma_f32_16x16x32_bf16 v[96:99], a[148:151], a[8:11], v[96:99]
    ds_read_b128 a[132:135], v14 offset:14336
    v_add_f32 v226, 1.0, v226
    v_rcp_f32 v226, v226
    v_mfma_f32_16x16x32_bf16 v[132:135], a[148:151], a[12:15], v[132:135]
    s_waitcnt lgkmcnt(3)
    v_mul_f32 v226, v226, v242
    v_mul_f32 v243, v227, v243
    v_mul_f32 v227, s56, v227
    v_mfma_f32_16x16x32_bf16 v[64:67], a[152:155], a[16:19], v[64:67]
    ds_read_b128 a[136:139], v14 offset:16384
    v_mul_f32 v228, s56, v228
    v_exp_f32 v227, v227
    v_mfma_f32_16x16x32_bf16 v[100:103], a[152:155], a[20:23], v[100:103]
    v_exp_f32 v228, v228
    v_add_f32 v227, 1.0, v227
    v_mfma_f32_16x16x32_bf16 v[68:71], a[156:159], a[16:19], v[68:71]
    ds_read_b128 a[140:143], v15 offset:0
    v_add_f32 v228, 1.0, v228
    v_rcp_f32 v227, v227
    v_mfma_f32_16x16x32_bf16 v[104:107], a[156:159], a[20:23], v[104:107]
    v_rcp_f32 v228, v228
    v_mul_f32 v227, v227, v243
    v_mfma_f32_16x16x32_bf16 v[72:75], a[160:163], a[16:19], v[72:75]
    s_lshl3_add_u32 s36, s4, s5
    ds_read_b128 a[144:147], v15 offset:2048
    v_cvt_pk_bf16_f32 v211, v226, v227
    v_mul_f32 v228, v228, v244
    v_mfma_f32_16x16x32_bf16 v[108:111], a[160:163], a[20:23], v[108:111]
    s_sub_u32 s36, s36, 24
    v_mul_f32 v245, v229, v245
    s_lshr_b32 s32, s6, 1
    v_mul_f32 v229, s56, v229
    v_mfma_f32_16x16x32_bf16 v[76:79], a[164:167], a[16:19], v[76:79]
    s_lshl1_add_u32 s32, s36, s32
    ds_read_b128 a[148:151], v15 offset:4096
    v_mul_f32 v248, v232, v248
    v_exp_f32 v229, v229
    v_mfma_f32_16x16x32_bf16 v[112:115], a[164:167], a[20:23], v[112:115]
    s_lshl2_add_u32 s32, s32, s3
    v_add_f32 v229, 1.0, v229
    s_mul_i32 s32, s32, 3
    v_rcp_f32 v229, v229
    v_mfma_f32_16x16x32_bf16 v[80:83], a[168:171], a[16:19], v[80:83]
    s_and_b32 s35, s6, 1
    ds_read_b128 a[152:155], v15 offset:6144
    v_mul_f32 v229, v229, v245
    v_cvt_pk_bf16_f32 v214, v228, v229
    v_mfma_f32_16x16x32_bf16 v[116:119], a[168:171], a[20:23], v[116:119]
    s_waitcnt lgkmcnt(3)
    v_mul_f32 v246, v230, v246
    s_add_u32 s32, s32, s35
    v_mul_f32 v230, s56, v230
    v_mfma_f32_16x16x32_bf16 v[84:87], a[172:175], a[16:19], v[84:87]
    s_mul_i32 s32, s32, 49152
    ds_read_b128 a[156:159], v15 offset:8192
    v_mul_f32 v232, s56, v232
    v_exp_f32 v230, v230
    v_mfma_f32_16x16x32_bf16 v[120:123], a[172:175], a[20:23], v[120:123]
    s_add_u32 s32, s32, 8192
    v_exp_f32 v232, v232
    v_add_f32 v230, 1.0, v230
    v_mfma_f32_16x16x32_bf16 v[88:91], a[128:131], a[16:19], v[88:91]
    s_add_u32 s33, s32, 16384
    ds_read_b128 a[160:163], v15 offset:10240
    v_add_f32 v232, 1.0, v232
    v_rcp_f32 v230, v230
    v_mfma_f32_16x16x32_bf16 v[124:127], a[128:131], a[20:23], v[124:127]
    s_add_u32 s34, s32, 32768
    v_rcp_f32 v232, v232
    v_mul_f32 v230, v230, v246
    v_mfma_f32_16x16x32_bf16 v[92:95], a[132:135], a[16:19], v[92:95]
    s_mul_i32 s35, s3, 12
    ds_read_b128 a[164:167], v15 offset:12288
    v_mul_f32 v247, v231, v247
    v_mul_f32 v231, s56, v231
    v_mfma_f32_16x16x32_bf16 v[128:131], a[132:135], a[20:23], v[128:131]
    buffer_store_dwordx4 v[208:211], v5, s[20:23], s59 offen offset:0 sc1
    v_exp_f32 v231, v231
    v_mfma_f32_16x16x32_bf16 v[96:99], a[136:139], a[16:19], v[96:99]
    buffer_load_dwordx4 v18, s[24:27], s49 offen offset:0 lds
    v_add_f32 v231, 1.0, v231
    v_mfma_f32_16x16x32_bf16 v[132:135], a[136:139], a[20:23], v[132:135]
    s_lshl_b32 s36, s36, 8
    ds_read_b128 a[168:171], v15 offset:14336
    v_mul_f32 v232, v232, v248
    v_rcp_f32 v231, v231
    v_mfma_f32_16x16x32_bf16 v[64:67], a[140:143], a[24:27], v[64:67]
    s_add_u32 s35, s35, s36
    ds_read_b128 a[172:175], v15 offset:16384
    v_mul_f32 v231, v231, v247
    v_cvt_pk_bf16_f32 v215, v230, v231
    v_mfma_f32_16x16x32_bf16 v[100:103], a[140:143], a[28:31], v[100:103]
    s_waitcnt lgkmcnt(3)
    s_barrier
    v_mul_f32 v249, v233, v249
    v_mul_f32 v233, s56, v233
    v_mfma_f32_16x16x32_bf16 v[68:71], a[144:147], a[24:27], v[68:71]
    buffer_store_dwordx4 v[212:215], v5, s[20:23], s59 offen offset:1024 sc1
    v_exp_f32 v233, v233
    v_mfma_f32_16x16x32_bf16 v[104:107], a[144:147], a[28:31], v[104:107]
    buffer_load_dwordx4 v19, s[24:27], s49 offen offset:1024 lds
    v_add_f32 v233, 1.0, v233
    v_mfma_f32_16x16x32_bf16 v[72:75], a[148:151], a[24:27], v[72:75]
    s_add_u32 s35, s35, 23724160
    ds_read_b128 a[128:131], v12 offset:36864
    v_min_u32 v28, 2, v0
    v_lshlrev_b32 v28, 2, v28
    v_mfma_f32_16x16x32_bf16 v[108:111], a[148:151], a[28:31], v[108:111]
    ds_read_b128 a[132:135], v12 offset:38912
    v_mul_f32 v252, v236, v252
    v_rcp_f32 v233, v233
    v_mfma_f32_16x16x32_bf16 v[76:79], a[152:155], a[24:27], v[76:79]
    ds_read_b128 a[136:139], v12 offset:40960
    v_mul_f32 v233, v233, v249
    v_cvt_pk_bf16_f32 v218, v232, v233
    v_mfma_f32_16x16x32_bf16 v[112:115], a[152:155], a[28:31], v[112:115]
    buffer_load_dwordx4 v20, s[24:27], s49 offen offset:2048 lds
    v_mul_f32 v250, v234, v250
    v_mfma_f32_16x16x32_bf16 v[80:83], a[156:159], a[24:27], v[80:83]
    ds_read_b128 a[140:143], v12 offset:43008
    v_mul_f32 v234, s56, v234
    v_exp_f32 v234, v234
    v_mfma_f32_16x16x32_bf16 v[116:119], a[156:159], a[28:31], v[116:119]
    v_add_f32 v234, 1.0, v234
    v_mul_f32 v236, s56, v236
    v_rcp_f32 v234, v234
    v_mfma_f32_16x16x32_bf16 v[84:87], a[160:163], a[24:27], v[84:87]
    ds_read_b128 a[144:147], v12 offset:45056
    v_mul_f32 v234, v234, v250
    v_mul_f32 v251, v235, v251
    v_mfma_f32_16x16x32_bf16 v[120:123], a[160:163], a[28:31], v[120:123]
    s_waitcnt lgkmcnt(3)
    v_exp_f32 v236, v236
    v_mul_f32 v235, s56, v235
    v_mfma_f32_16x16x32_bf16 v[88:91], a[164:167], a[24:27], v[88:91]
    buffer_load_dwordx4 v21, s[24:27], s49 offen offset:3072 lds
    v_exp_f32 v235, v235
    v_mfma_f32_16x16x32_bf16 v[124:127], a[164:167], a[28:31], v[124:127]
    s_add_u32 m0, s72, 40960
    ds_read_b128 a[148:151], v12 offset:47104
    v_add_f32 v235, 1.0, v235
    v_rcp_f32 v235, v235
    v_mfma_f32_16x16x32_bf16 v[92:95], a[168:171], a[24:27], v[92:95]
    s_add_u32 s49, s88, 36864
    ds_read_b128 a[152:155], v12 offset:49152
    v_mul_f32 v235, v235, v251
    v_cvt_pk_bf16_f32 v219, v234, v235
    v_mfma_f32_16x16x32_bf16 v[128:131], a[168:171], a[28:31], v[128:131]
    buffer_store_dwordx4 v[216:219], v5, s[20:23], s59 offen offset:2048 sc1
    v_add_f32 v236, 1.0, v236
    v_mfma_f32_16x16x32_bf16 v[96:99], a[172:175], a[24:27], v[96:99]
    buffer_load_dwordx4 v18, s[24:27], s49 offen offset:0 lds
    v_rcp_f32 v236, v236
    v_mfma_f32_16x16x32_bf16 v[132:135], a[172:175], a[28:31], v[132:135]
    ds_read_b128 a[156:159], v12 offset:51200
    v_mul_f32 v236, v236, v252
    v_mul_f32 v253, v237, v253
    v_mfma_f32_16x16x32_bf16 v[64:67], a[128:131], a[32:35], v[64:67]
    ds_read_b128 a[160:163], v12 offset:53248
    v_mul_f32 v237, s56, v237
    v_exp_f32 v237, v237
    v_mfma_f32_16x16x32_bf16 v[100:103], a[128:131], a[36:39], v[100:103]
    v_add_f32 v237, 1.0, v237
    v_rcp_f32 v237, v237
    v_mfma_f32_16x16x32_bf16 v[68:71], a[132:135], a[32:35], v[68:71]
    ds_read_b128 a[164:167], v13 offset:36864
    v_mul_f32 v237, v237, v253
    v_cvt_pk_bf16_f32 v222, v236, v237
    v_mfma_f32_16x16x32_bf16 v[104:107], a[132:135], a[36:39], v[104:107]
    s_waitcnt lgkmcnt(3)
    s_barrier
    v_mul_f32 v254, v238, v254
    v_mul_f32 v238, s56, v238
    v_mfma_f32_16x16x32_bf16 v[72:75], a[136:139], a[32:35], v[72:75]
    ds_read_b128 a[168:171], v13 offset:38912
    v_exp_f32 v238, v238
    s_nop 0
    v_add_f32 v238, 1.0, v238
    v_mfma_f32_16x16x32_bf16 v[108:111], a[136:139], a[36:39], v[108:111]
    v_rcp_f32 v238, v238
    s_nop 0
    v_mul_f32 v238, v238, v254
    v_mfma_f32_16x16x32_bf16 v[76:79], a[140:143], a[32:35], v[76:79]
    ds_read_b128 a[172:175], v13 offset:40960
    v_mul_f32 v255, v239, v255
    v_mul_f32 v239, s56, v239
    v_mfma_f32_16x16x32_bf16 v[112:115], a[140:143], a[36:39], v[112:115]
    v_exp_f32 v239, v239
    s_nop 0
    v_add_f32 v239, 1.0, v239
    v_mfma_f32_16x16x32_bf16 v[80:83], a[144:147], a[32:35], v[80:83]
    ds_read_b128 a[128:131], v13 offset:43008
    v_rcp_f32 v239, v239
    s_nop 0
    v_mul_f32 v239, v239, v255
    v_mfma_f32_16x16x32_bf16 v[116:119], a[144:147], a[36:39], v[116:119]
    v_cvt_pk_bf16_f32 v223, v238, v239
    v_mfma_f32_16x16x32_bf16 v[84:87], a[148:151], a[32:35], v[84:87]
    ds_read_b128 a[132:135], v13 offset:45056
    v_mfma_f32_16x16x32_bf16 v[120:123], a[148:151], a[36:39], v[120:123]
    v_mfma_f32_16x16x32_bf16 v[88:91], a[152:155], a[32:35], v[88:91]
    ds_read_b128 a[136:139], v13 offset:47104
    v_mfma_f32_16x16x32_bf16 v[124:127], a[152:155], a[36:39], v[124:127]
    s_waitcnt lgkmcnt(3)
    v_mfma_f32_16x16x32_bf16 v[92:95], a[156:159], a[32:35], v[92:95]
    ds_read_b128 a[140:143], v13 offset:49152
    v_mfma_f32_16x16x32_bf16 v[128:131], a[156:159], a[36:39], v[128:131]
    v_mfma_f32_16x16x32_bf16 v[96:99], a[160:163], a[32:35], v[96:99]
    ds_read_b128 a[144:147], v13 offset:51200
    v_mfma_f32_16x16x32_bf16 v[132:135], a[160:163], a[36:39], v[132:135]
    v_mfma_f32_16x16x32_bf16 v[64:67], a[164:167], a[40:43], v[64:67]
    ds_read_b128 a[148:151], v13 offset:53248
    v_mfma_f32_16x16x32_bf16 v[100:103], a[164:167], a[44:47], v[100:103]
    v_mfma_f32_16x16x32_bf16 v[68:71], a[168:171], a[40:43], v[68:71]
    ds_read_b128 a[152:155], v14 offset:36864
    v_mfma_f32_16x16x32_bf16 v[104:107], a[168:171], a[44:47], v[104:107]
    v_mfma_f32_16x16x32_bf16 v[72:75], a[172:175], a[40:43], v[72:75]
    ds_read_b128 a[156:159], v14 offset:38912
    v_mfma_f32_16x16x32_bf16 v[108:111], a[172:175], a[44:47], v[108:111]
    s_waitcnt lgkmcnt(3)
    v_mfma_f32_16x16x32_bf16 v[76:79], a[128:131], a[40:43], v[76:79]
    ds_read_b128 a[160:163], v14 offset:40960
    v_mfma_f32_16x16x32_bf16 v[112:115], a[128:131], a[44:47], v[112:115]
    v_mfma_f32_16x16x32_bf16 v[80:83], a[132:135], a[40:43], v[80:83]
    ds_read_b128 a[164:167], v14 offset:43008
    v_mfma_f32_16x16x32_bf16 v[116:119], a[132:135], a[44:47], v[116:119]
    v_mfma_f32_16x16x32_bf16 v[84:87], a[136:139], a[40:43], v[84:87]
    ds_read_b128 a[168:171], v14 offset:45056
    v_mfma_f32_16x16x32_bf16 v[120:123], a[136:139], a[44:47], v[120:123]
    buffer_store_dwordx4 v[220:223], v5, s[20:23], s59 offen offset:3072 sc1
    v_mfma_f32_16x16x32_bf16 v[88:91], a[140:143], a[40:43], v[88:91]
    buffer_load_dwordx4 v19, s[24:27], s49 offen offset:1024 lds
    v_mfma_f32_16x16x32_bf16 v[124:127], a[140:143], a[44:47], v[124:127]
    ds_read_b128 a[172:175], v14 offset:47104
    v_mfma_f32_16x16x32_bf16 v[92:95], a[144:147], a[40:43], v[92:95]
    ds_read_b128 a[128:131], v14 offset:49152
    v_mfma_f32_16x16x32_bf16 v[128:131], a[144:147], a[44:47], v[128:131]
    s_waitcnt lgkmcnt(3)
    v_mfma_f32_16x16x32_bf16 v[96:99], a[148:151], a[40:43], v[96:99]
    buffer_load_dwordx4 v20, s[24:27], s49 offen offset:2048 lds
    v_mfma_f32_16x16x32_bf16 v[132:135], a[148:151], a[44:47], v[132:135]
    ds_read_b128 a[132:135], v14 offset:51200
    v_mfma_f32_16x16x32_bf16 v[64:67], a[152:155], a[48:51], v[64:67]
    ds_read_b128 a[136:139], v14 offset:53248
    v_mfma_f32_16x16x32_bf16 v[100:103], a[152:155], a[52:55], v[100:103]
    v_mfma_f32_16x16x32_bf16 v[68:71], a[156:159], a[48:51], v[68:71]
    buffer_load_dwordx4 v21, s[24:27], s49 offen offset:3072 lds
    v_mfma_f32_16x16x32_bf16 v[104:107], a[156:159], a[52:55], v[104:107]
    s_add_u32 m0, s72, 45056
    ds_read_b128 a[140:143], v15 offset:36864
    v_mfma_f32_16x16x32_bf16 v[72:75], a[160:163], a[48:51], v[72:75]
    s_add_u32 s49, s88, 73728
    ds_read_b128 a[144:147], v15 offset:38912
    v_mfma_f32_16x16x32_bf16 v[108:111], a[160:163], a[52:55], v[108:111]
    v_mfma_f32_16x16x32_bf16 v[76:79], a[164:167], a[48:51], v[76:79]
    buffer_load_dwordx4 v18, s[24:27], s49 offen offset:0 lds
    v_mfma_f32_16x16x32_bf16 v[112:115], a[164:167], a[52:55], v[112:115]
    s_waitcnt lgkmcnt(2)
    ds_read_b128 a[148:151], v15 offset:40960
    v_mfma_f32_16x16x32_bf16 v[80:83], a[168:171], a[48:51], v[80:83]
    s_add_u32 s88, s88, 128
    ds_read_b128 a[152:155], v15 offset:43008
    v_mfma_f32_16x16x32_bf16 v[116:119], a[168:171], a[52:55], v[116:119]
    s_cmp_lg_u32 s88, 1152
    s_cselect_b32 s88, s88, 0
    s_add_u32 m0, s72, 73728
    s_add_u32 s49, s88, 0
    v_mfma_f32_16x16x32_bf16 v[84:87], a[172:175], a[48:51], v[84:87]
    buffer_load_dwordx4 v18, s[24:27], s49 offen offset:0 lds
    v_mfma_f32_16x16x32_bf16 v[120:123], a[172:175], a[52:55], v[120:123]
    ds_read_b128 a[156:159], v15 offset:45056
    v_mfma_f32_16x16x32_bf16 v[88:91], a[128:131], a[48:51], v[88:91]
    ds_read_b128 a[160:163], v15 offset:47104
    v_mfma_f32_16x16x32_bf16 v[124:127], a[128:131], a[52:55], v[124:127]
    v_mfma_f32_16x16x32_bf16 v[92:95], a[132:135], a[48:51], v[92:95]
    buffer_load_dwordx4 v19, s[24:27], s49 offen offset:1024 lds
    v_mfma_f32_16x16x32_bf16 v[128:131], a[132:135], a[52:55], v[128:131]
    ds_read_b128 a[164:167], v15 offset:49152
    v_mfma_f32_16x16x32_bf16 v[96:99], a[136:139], a[48:51], v[96:99]
    ds_read_b128 a[168:171], v15 offset:51200
    v_mfma_f32_16x16x32_bf16 v[132:135], a[136:139], a[52:55], v[132:135]
    s_waitcnt lgkmcnt(3)
    v_mfma_f32_16x16x32_bf16 v[64:67], a[140:143], a[56:59], v[64:67]
    buffer_load_dwordx4 v20, s[24:27], s49 offen offset:2048 lds
    v_mfma_f32_16x16x32_bf16 v[100:103], a[140:143], a[60:63], v[100:103]
    ds_read_b128 a[172:175], v15 offset:53248
    v_mfma_f32_16x16x32_bf16 v[68:71], a[144:147], a[56:59], v[68:71]
    s_waitcnt vmcnt(17) lgkmcnt(3)
    s_barrier
    v_mfma_f32_16x16x32_bf16 v[104:107], a[144:147], a[60:63], v[104:107]
    ds_read_b128 a[128:131], v8 offset:0
    v_mfma_f32_16x16x32_bf16 v[72:75], a[148:151], a[56:59], v[72:75]
    ds_read_b128 a[132:135], v8 offset:2048
    v_mfma_f32_16x16x32_bf16 v[108:111], a[148:151], a[60:63], v[108:111]
    v_mfma_f32_16x16x32_bf16 v[76:79], a[152:155], a[56:59], v[76:79]
    ds_read_b128 a[136:139], v8 offset:4096
    v_mfma_f32_16x16x32_bf16 v[112:115], a[152:155], a[60:63], v[112:115]
    v_mfma_f32_16x16x32_bf16 v[80:83], a[156:159], a[56:59], v[80:83]
    ds_read_b128 a[140:143], v8 offset:6144
    v_mfma_f32_16x16x32_bf16 v[116:119], a[156:159], a[60:63], v[116:119]
    v_mfma_f32_16x16x32_bf16 v[84:87], a[160:163], a[56:59], v[84:87]
    ds_read_b128 a[144:147], v8 offset:8192
    v_mfma_f32_16x16x32_bf16 v[120:123], a[160:163], a[60:63], v[120:123]
    s_waitcnt lgkmcnt(3)
    v_mfma_f32_16x16x32_bf16 v[88:91], a[164:167], a[56:59], v[88:91]
    ds_read_b128 a[148:151], v8 offset:10240
    v_mfma_f32_16x16x32_bf16 v[124:127], a[164:167], a[60:63], v[124:127]
    v_mfma_f32_16x16x32_bf16 v[92:95], a[168:171], a[56:59], v[92:95]
    ds_read_b128 a[152:155], v8 offset:12288
    v_mfma_f32_16x16x32_bf16 v[128:131], a[168:171], a[60:63], v[128:131]
    v_mfma_f32_16x16x32_bf16 v[96:99], a[172:175], a[56:59], v[96:99]
    ds_read_b128 a[156:159], v8 offset:14336
    v_mfma_f32_16x16x32_bf16 v[132:135], a[172:175], a[60:63], v[132:135]
    v_mfma_f32_16x16x32_bf16 v[64:67], a[128:131], a[64:67], v[64:67]
    ds_read_b128 a[160:163], v8 offset:16384
    v_mfma_f32_16x16x32_bf16 v[100:103], a[128:131], a[68:71], v[100:103]
    v_mfma_f32_16x16x32_bf16 v[68:71], a[132:135], a[64:67], v[68:71]
    ds_read_b128 a[164:167], v9 offset:0
    v_mfma_f32_16x16x32_bf16 v[104:107], a[132:135], a[68:71], v[104:107]
    s_waitcnt lgkmcnt(3)
    s_barrier
    v_mfma_f32_16x16x32_bf16 v[72:75], a[136:139], a[64:67], v[72:75]
    ds_read_b128 a[168:171], v9 offset:2048
    v_mfma_f32_16x16x32_bf16 v[108:111], a[136:139], a[68:71], v[108:111]
    v_mfma_f32_16x16x32_bf16 v[76:79], a[140:143], a[64:67], v[76:79]
    ds_read_b128 a[172:175], v9 offset:4096
    v_mfma_f32_16x16x32_bf16 v[112:115], a[140:143], a[68:71], v[112:115]
    buffer_load_dwordx4 v21, s[24:27], s49 offen offset:3072 lds
    v_mfma_f32_16x16x32_bf16 v[80:83], a[144:147], a[64:67], v[80:83]
    s_add_u32 m0, s72, 77824
    ds_read_b128 a[128:131], v9 offset:6144
    v_mfma_f32_16x16x32_bf16 v[116:119], a[144:147], a[68:71], v[116:119]
    s_add_u32 s49, s88, 36864
    v_mfma_f32_16x16x32_bf16 v[84:87], a[148:151], a[64:67], v[84:87]
    ds_read_b128 a[132:135], v9 offset:8192
    v_mfma_f32_16x16x32_bf16 v[120:123], a[148:151], a[68:71], v[120:123]
    buffer_load_dwordx4 v18, s[24:27], s49 offen offset:0 lds
    v_mfma_f32_16x16x32_bf16 v[88:91], a[152:155], a[64:67], v[88:91]
    ds_read_b128 a[136:139], v9 offset:10240
    v_mfma_f32_16x16x32_bf16 v[124:127], a[152:155], a[68:71], v[124:127]
    s_waitcnt lgkmcnt(3)
    v_mfma_f32_16x16x32_bf16 v[92:95], a[156:159], a[64:67], v[92:95]
    ds_read_b128 a[140:143], v9 offset:12288
    v_mfma_f32_16x16x32_bf16 v[128:131], a[156:159], a[68:71], v[128:131]
    buffer_load_dwordx4 v19, s[24:27], s49 offen offset:1024 lds
    v_mfma_f32_16x16x32_bf16 v[96:99], a[160:163], a[64:67], v[96:99]
    ds_read_b128 a[144:147], v9 offset:14336
    v_mfma_f32_16x16x32_bf16 v[132:135], a[160:163], a[68:71], v[132:135]
    v_mfma_f32_16x16x32_bf16 v[64:67], a[164:167], a[72:75], v[64:67]
    ds_read_b128 a[148:151], v9 offset:16384
    v_mfma_f32_16x16x32_bf16 v[100:103], a[164:167], a[76:79], v[100:103]
    buffer_load_dwordx4 v20, s[24:27], s49 offen offset:2048 lds
    v_mfma_f32_16x16x32_bf16 v[68:71], a[168:171], a[72:75], v[68:71]
    ds_read_b128 a[152:155], v10 offset:0
    v_mfma_f32_16x16x32_bf16 v[104:107], a[168:171], a[76:79], v[104:107]
    v_mfma_f32_16x16x32_bf16 v[72:75], a[172:175], a[72:75], v[72:75]
    ds_read_b128 a[156:159], v10 offset:2048
    v_mfma_f32_16x16x32_bf16 v[108:111], a[172:175], a[76:79], v[108:111]
    s_waitcnt lgkmcnt(3)
    v_mfma_f32_16x16x32_bf16 v[76:79], a[128:131], a[72:75], v[76:79]
    buffer_load_dwordx4 v21, s[24:27], s49 offen offset:3072 lds
    v_mfma_f32_16x16x32_bf16 v[112:115], a[128:131], a[76:79], v[112:115]
    s_add_u32 m0, s72, 81920
    ds_read_b128 a[160:163], v10 offset:4096
    v_mfma_f32_16x16x32_bf16 v[80:83], a[132:135], a[72:75], v[80:83]
    s_branch gated_mix__ssm_conv_s5__swiglu_ffn__prompt_kernel_B_sk8
.p2align 12
gated_mix__ssm_conv_s5__swiglu_ffn__prompt_kernel_B_pg0_8:
    s_branch gated_mix__ssm_conv_s5__swiglu_ffn__prompt_kernel_B_pr0
gated_mix__ssm_conv_s5__swiglu_ffn__prompt_kernel_B_pg3_8:
    s_branch gated_mix__ssm_conv_s5__swiglu_ffn__prompt_kernel_B_pr3
gated_mix__ssm_conv_s5__swiglu_ffn__prompt_kernel_B_sk8:
    s_add_u32 s49, s88, 73728
    ds_read_b128 a[164:167], v10 offset:6144
    v_mfma_f32_16x16x32_bf16 v[116:119], a[132:135], a[76:79], v[116:119]
    s_waitcnt vmcnt(12)
    v_mfma_f32_16x16x32_bf16 v[84:87], a[136:139], a[72:75], v[84:87]
    buffer_store_dword v4, v6, s[20:23], s61 offen offset:512 sc1
    v_mfma_f32_16x16x32_bf16 v[120:123], a[136:139], a[76:79], v[120:123]
    buffer_load_dwordx4 v18, s[24:27], s49 offen offset:0 lds
    v_mfma_f32_16x16x32_bf16 v[88:91], a[140:143], a[72:75], v[88:91]
    s_add_u32 s88, s88, 128
    ds_read_b128 a[168:171], v10 offset:8192
    v_mfma_f32_16x16x32_bf16 v[124:127], a[140:143], a[76:79], v[124:127]
    s_cmp_lg_u32 s88, 1152
    s_cselect_b32 s88, s88, 0
    ds_read_b128 a[172:175], v10 offset:10240
    v_mfma_f32_16x16x32_bf16 v[92:95], a[144:147], a[72:75], v[92:95]
    s_add_u32 m0, s72, 110592
    ds_read_b128 a[128:131], v10 offset:12288
    v_mfma_f32_16x16x32_bf16 v[128:131], a[144:147], a[76:79], v[128:131]
    s_waitcnt lgkmcnt(3)
    s_add_u32 s49, s88, 0
    v_mfma_f32_16x16x32_bf16 v[96:99], a[148:151], a[72:75], v[96:99]
    buffer_load_dwordx4 a[0:3], v5, s[20:23], s84 offen offset:0 sc1
    v_mfma_f32_16x16x32_bf16 v[132:135], a[148:151], a[76:79], v[132:135]
    ds_read_b128 a[132:135], v10 offset:14336
    v_mfma_f32_16x16x32_bf16 v[64:67], a[152:155], a[80:83], v[64:67]
    ds_read_b128 a[136:139], v10 offset:16384
    v_mfma_f32_16x16x32_bf16 v[100:103], a[152:155], a[84:87], v[100:103]
    v_mfma_f32_16x16x32_bf16 v[68:71], a[156:159], a[80:83], v[68:71]
    buffer_load_dwordx4 a[4:7], v5, s[20:23], s84 offen offset:1024 sc1
    v_mfma_f32_16x16x32_bf16 v[104:107], a[156:159], a[84:87], v[104:107]
    s_add_u32 s84, s81, s89
    ds_read_b128 a[140:143], v11 offset:0
    v_mfma_f32_16x16x32_bf16 v[72:75], a[160:163], a[80:83], v[72:75]
    s_add_u32 s89, s89, 4096
    ds_read_b128 a[144:147], v11 offset:2048
    v_mfma_f32_16x16x32_bf16 v[108:111], a[160:163], a[84:87], v[108:111]
    v_mfma_f32_16x16x32_bf16 v[76:79], a[164:167], a[80:83], v[76:79]
    buffer_load_dwordx4 a[8:11], v5, s[20:23], s84 offen offset:0 sc1
    v_mfma_f32_16x16x32_bf16 v[112:115], a[164:167], a[84:87], v[112:115]
    s_waitcnt lgkmcnt(2)
    ds_read_b128 a[148:151], v11 offset:4096
    v_mfma_f32_16x16x32_bf16 v[80:83], a[168:171], a[80:83], v[80:83]
    ds_read_b128 a[152:155], v11 offset:6144
    v_mfma_f32_16x16x32_bf16 v[116:119], a[168:171], a[84:87], v[116:119]
    v_mfma_f32_16x16x32_bf16 v[84:87], a[172:175], a[80:83], v[84:87]
    buffer_load_dwordx4 a[12:15], v5, s[20:23], s84 offen offset:1024 sc1
    v_mfma_f32_16x16x32_bf16 v[120:123], a[172:175], a[84:87], v[120:123]
    s_add_u32 s84, s81, s89
    ds_read_b128 a[156:159], v11 offset:8192
    v_mfma_f32_16x16x32_bf16 v[88:91], a[128:131], a[80:83], v[88:91]
    s_add_u32 s89, s89, 4096
    ds_read_b128 a[160:163], v11 offset:10240
    v_mfma_f32_16x16x32_bf16 v[124:127], a[128:131], a[84:87], v[124:127]
    v_mfma_f32_16x16x32_bf16 v[92:95], a[132:135], a[80:83], v[92:95]
    buffer_load_dwordx4 a[16:19], v5, s[20:23], s84 offen offset:0 sc1
    v_mfma_f32_16x16x32_bf16 v[128:131], a[132:135], a[84:87], v[128:131]
    ds_read_b128 a[164:167], v11 offset:12288
    v_mfma_f32_16x16x32_bf16 v[96:99], a[136:139], a[80:83], v[96:99]
    ds_read_b128 a[168:171], v11 offset:14336
    v_mfma_f32_16x16x32_bf16 v[132:135], a[136:139], a[84:87], v[132:135]
    s_waitcnt lgkmcnt(3)
    v_mfma_f32_16x16x32_bf16 v[64:67], a[140:143], a[88:91], v[64:67]
    buffer_load_dwordx4 a[20:23], v5, s[20:23], s84 offen offset:1024 sc1
    v_mfma_f32_16x16x32_bf16 v[100:103], a[140:143], a[92:95], v[100:103]
    s_add_u32 s84, s81, s89
    ds_read_b128 a[172:175], v11 offset:16384
    v_mfma_f32_16x16x32_bf16 v[68:71], a[144:147], a[88:91], v[68:71]
    s_waitcnt vmcnt(16) lgkmcnt(3)
    s_barrier
    v_mfma_f32_16x16x32_bf16 v[104:107], a[144:147], a[92:95], v[104:107]
    s_add_u32 s89, s89, 4096
    ds_read_b128 a[128:131], v8 offset:36864
    v_mfma_f32_16x16x32_bf16 v[72:75], a[148:151], a[88:91], v[72:75]
    s_cmp_lg_u32 s89, 147456
    s_cselect_b32 s89, s89, 0
    ds_read_b128 a[132:135], v8 offset:38912
    v_mfma_f32_16x16x32_bf16 v[108:111], a[148:151], a[92:95], v[108:111]
    v_mfma_f32_16x16x32_bf16 v[76:79], a[152:155], a[88:91], v[76:79]
    ds_read_b128 a[136:139], v8 offset:40960
    v_mfma_f32_16x16x32_bf16 v[112:115], a[152:155], a[92:95], v[112:115]
    v_mfma_f32_16x16x32_bf16 v[80:83], a[156:159], a[88:91], v[80:83]
    ds_read_b128 a[140:143], v8 offset:43008
    v_mfma_f32_16x16x32_bf16 v[116:119], a[156:159], a[92:95], v[116:119]
    v_mfma_f32_16x16x32_bf16 v[84:87], a[160:163], a[88:91], v[84:87]
    ds_read_b128 a[144:147], v8 offset:45056
    v_mfma_f32_16x16x32_bf16 v[120:123], a[160:163], a[92:95], v[120:123]
    s_waitcnt lgkmcnt(3)
    v_mfma_f32_16x16x32_bf16 v[88:91], a[164:167], a[88:91], v[88:91]
    ds_read_b128 a[148:151], v8 offset:47104
    v_mfma_f32_16x16x32_bf16 v[124:127], a[164:167], a[92:95], v[124:127]
    v_mfma_f32_16x16x32_bf16 v[92:95], a[168:171], a[88:91], v[92:95]
    ds_read_b128 a[152:155], v8 offset:49152
    v_mfma_f32_16x16x32_bf16 v[128:131], a[168:171], a[92:95], v[128:131]
    v_mfma_f32_16x16x32_bf16 v[96:99], a[172:175], a[88:91], v[96:99]
    ds_read_b128 a[156:159], v8 offset:51200
    v_mfma_f32_16x16x32_bf16 v[132:135], a[172:175], a[92:95], v[132:135]
    v_mfma_f32_16x16x32_bf16 v[64:67], a[128:131], a[96:99], v[64:67]
    ds_read_b128 a[160:163], v8 offset:53248
    v_mfma_f32_16x16x32_bf16 v[100:103], a[128:131], a[100:103], v[100:103]
    v_mfma_f32_16x16x32_bf16 v[68:71], a[132:135], a[96:99], v[68:71]
    ds_read_b128 a[164:167], v9 offset:36864
    v_mfma_f32_16x16x32_bf16 v[104:107], a[132:135], a[100:103], v[104:107]
    s_waitcnt lgkmcnt(3)
    s_barrier
    v_mfma_f32_16x16x32_bf16 v[72:75], a[136:139], a[96:99], v[72:75]
    ds_read_b128 a[168:171], v9 offset:38912
    v_mfma_f32_16x16x32_bf16 v[108:111], a[136:139], a[100:103], v[108:111]
    v_mfma_f32_16x16x32_bf16 v[76:79], a[140:143], a[96:99], v[76:79]
    buffer_load_dwordx4 a[24:27], v5, s[20:23], s84 offen offset:0 sc1
    v_mfma_f32_16x16x32_bf16 v[112:115], a[140:143], a[100:103], v[112:115]
    ds_read_b128 a[172:175], v9 offset:40960
    v_mfma_f32_16x16x32_bf16 v[80:83], a[144:147], a[96:99], v[80:83]
    ds_read_b128 a[128:131], v9 offset:43008
    v_mfma_f32_16x16x32_bf16 v[116:119], a[144:147], a[100:103], v[116:119]
    v_mfma_f32_16x16x32_bf16 v[84:87], a[148:151], a[96:99], v[84:87]
    buffer_load_dwordx4 a[28:31], v5, s[20:23], s84 offen offset:1024 sc1
    v_mfma_f32_16x16x32_bf16 v[120:123], a[148:151], a[100:103], v[120:123]
    s_add_u32 s84, s81, s89
    ds_read_b128 a[132:135], v9 offset:45056
    v_mfma_f32_16x16x32_bf16 v[88:91], a[152:155], a[96:99], v[88:91]
    s_add_u32 s89, s89, 4096
    ds_read_b128 a[136:139], v9 offset:47104
    v_mfma_f32_16x16x32_bf16 v[124:127], a[152:155], a[100:103], v[124:127]
    s_waitcnt lgkmcnt(3)
    v_mfma_f32_16x16x32_bf16 v[92:95], a[156:159], a[96:99], v[92:95]
    buffer_load_dwordx4 v18, s[24:27], s49 offen offset:0 lds
    v_mfma_f32_16x16x32_bf16 v[128:131], a[156:159], a[100:103], v[128:131]
    ds_read_b128 a[140:143], v9 offset:49152
    v_mfma_f32_16x16x32_bf16 v[96:99], a[160:163], a[96:99], v[96:99]
    ds_read_b128 a[144:147], v9 offset:51200
    v_mfma_f32_16x16x32_bf16 v[132:135], a[160:163], a[100:103], v[132:135]
    v_mfma_f32_16x16x32_bf16 v[64:67], a[164:167], a[104:107], v[64:67]
    buffer_load_dwordx4 v19, s[24:27], s49 offen offset:1024 lds
    v_mfma_f32_16x16x32_bf16 v[100:103], a[164:167], a[108:111], v[100:103]
    ds_read_b128 a[148:151], v9 offset:53248
    v_mfma_f32_16x16x32_bf16 v[68:71], a[168:171], a[104:107], v[68:71]
    ds_read_b128 a[152:155], v10 offset:36864
    v_mfma_f32_16x16x32_bf16 v[104:107], a[168:171], a[108:111], v[104:107]
    v_mfma_f32_16x16x32_bf16 v[72:75], a[172:175], a[104:107], v[72:75]
    buffer_load_dwordx4 v20, s[24:27], s49 offen offset:2048 lds
    v_mfma_f32_16x16x32_bf16 v[108:111], a[172:175], a[108:111], v[108:111]
    s_waitcnt lgkmcnt(2)
    ds_read_b128 a[156:159], v10 offset:38912
    v_mfma_f32_16x16x32_bf16 v[76:79], a[128:131], a[104:107], v[76:79]
    ds_read_b128 a[160:163], v10 offset:40960
    v_mfma_f32_16x16x32_bf16 v[112:115], a[128:131], a[108:111], v[112:115]
    v_mfma_f32_16x16x32_bf16 v[80:83], a[132:135], a[104:107], v[80:83]
    buffer_load_dwordx4 v21, s[24:27], s49 offen offset:3072 lds
    v_mfma_f32_16x16x32_bf16 v[116:119], a[132:135], a[108:111], v[116:119]
    s_add_u32 m0, s72, 114688
    ds_read_b128 a[164:167], v10 offset:43008
    v_mfma_f32_16x16x32_bf16 v[84:87], a[136:139], a[104:107], v[84:87]
    s_add_u32 s49, s88, 36864
    ds_read_b128 a[168:171], v10 offset:45056
    v_mfma_f32_16x16x32_bf16 v[120:123], a[136:139], a[108:111], v[120:123]
    v_mfma_f32_16x16x32_bf16 v[88:91], a[140:143], a[104:107], v[88:91]
    buffer_load_dwordx4 v18, s[24:27], s49 offen offset:0 lds
    v_mfma_f32_16x16x32_bf16 v[124:127], a[140:143], a[108:111], v[124:127]
    ds_read_b128 a[172:175], v10 offset:47104
    v_mfma_f32_16x16x32_bf16 v[92:95], a[144:147], a[104:107], v[92:95]
    ds_read_b128 a[128:131], v10 offset:49152
    v_mfma_f32_16x16x32_bf16 v[128:131], a[144:147], a[108:111], v[128:131]
    s_waitcnt lgkmcnt(3)
    v_mfma_f32_16x16x32_bf16 v[96:99], a[148:151], a[104:107], v[96:99]
    buffer_load_dwordx4 v19, s[24:27], s49 offen offset:1024 lds
    v_mfma_f32_16x16x32_bf16 v[132:135], a[148:151], a[108:111], v[132:135]
    ds_read_b128 a[132:135], v10 offset:51200
    v_mfma_f32_16x16x32_bf16 v[64:67], a[152:155], a[112:115], v[64:67]
    ds_read_b128 a[136:139], v10 offset:53248
    v_mfma_f32_16x16x32_bf16 v[100:103], a[152:155], a[116:119], v[100:103]
    v_mfma_f32_16x16x32_bf16 v[68:71], a[156:159], a[112:115], v[68:71]
    buffer_load_dwordx4 v20, s[24:27], s49 offen offset:2048 lds
    v_mfma_f32_16x16x32_bf16 v[104:107], a[156:159], a[116:119], v[104:107]
    ds_read_b128 a[140:143], v11 offset:36864
    v_mfma_f32_16x16x32_bf16 v[72:75], a[160:163], a[112:115], v[72:75]
    ds_read_b128 a[144:147], v11 offset:38912
    v_mfma_f32_16x16x32_bf16 v[108:111], a[160:163], a[116:119], v[108:111]
    v_mfma_f32_16x16x32_bf16 v[76:79], a[164:167], a[112:115], v[76:79]
    buffer_load_dwordx4 v21, s[24:27], s49 offen offset:3072 lds
    v_mfma_f32_16x16x32_bf16 v[112:115], a[164:167], a[116:119], v[112:115]
    s_waitcnt lgkmcnt(2)
    ds_read_b128 a[148:151], v11 offset:40960
    v_mfma_f32_16x16x32_bf16 v[80:83], a[168:171], a[112:115], v[80:83]
    s_add_u32 m0, s72, 118784
    ds_read_b128 a[152:155], v11 offset:43008
    v_mfma_f32_16x16x32_bf16 v[116:119], a[168:171], a[116:119], v[116:119]
    s_add_u32 s49, s88, 73728
    v_mfma_f32_16x16x32_bf16 v[84:87], a[172:175], a[112:115], v[84:87]
    buffer_load_dwordx4 v18, s[24:27], s49 offen offset:0 lds
    v_mfma_f32_16x16x32_bf16 v[120:123], a[172:175], a[116:119], v[120:123]
    s_add_u32 s88, s88, 128
    ds_read_b128 a[156:159], v11 offset:45056
    v_mfma_f32_16x16x32_bf16 v[88:91], a[128:131], a[112:115], v[88:91]
    s_cmp_lg_u32 s88, 1152
    s_cselect_b32 s88, s88, 0
    ds_read_b128 a[160:163], v11 offset:47104
    v_mfma_f32_16x16x32_bf16 v[124:127], a[128:131], a[116:119], v[124:127]
    s_add_u32 m0, s72, 0
    s_add_u32 s49, s88, 0
    v_mfma_f32_16x16x32_bf16 v[92:95], a[132:135], a[112:115], v[92:95]
    buffer_load_dwordx4 a[32:35], v5, s[20:23], s84 offen offset:0 sc1
    v_mfma_f32_16x16x32_bf16 v[128:131], a[132:135], a[116:119], v[128:131]
    ds_read_b128 a[164:167], v11 offset:49152
    v_mfma_f32_16x16x32_bf16 v[96:99], a[136:139], a[112:115], v[96:99]
    ds_read_b128 a[168:171], v11 offset:51200
    v_mfma_f32_16x16x32_bf16 v[132:135], a[136:139], a[116:119], v[132:135]
    s_waitcnt lgkmcnt(3)
    v_mfma_f32_16x16x32_bf16 v[64:67], a[140:143], a[120:123], v[64:67]
    buffer_load_dwordx4 a[36:39], v5, s[20:23], s84 offen offset:1024 sc1
    v_mfma_f32_16x16x32_bf16 v[100:103], a[140:143], a[124:127], v[100:103]
    s_add_u32 s84, s81, s89
    ds_read_b128 a[172:175], v11 offset:53248
    v_mfma_f32_16x16x32_bf16 v[68:71], a[144:147], a[120:123], v[68:71]
    s_waitcnt vmcnt(19) lgkmcnt(3)
    s_barrier
    v_mfma_f32_16x16x32_bf16 v[104:107], a[144:147], a[124:127], v[104:107]
    s_add_u32 s89, s89, 4096
    ds_read_b128 a[128:131], v12 offset:0
    v_mfma_f32_16x16x32_bf16 v[72:75], a[148:151], a[120:123], v[72:75]
    buffer_load_dwordx4 a[40:43], v5, s[20:23], s84 offen offset:0 sc1
    v_mfma_f32_16x16x32_bf16 v[108:111], a[148:151], a[124:127], v[108:111]
    ds_read_b128 a[132:135], v12 offset:2048
    v_mfma_f32_16x16x32_bf16 v[76:79], a[152:155], a[120:123], v[76:79]
    ds_read_b128 a[136:139], v12 offset:4096
    v_mfma_f32_16x16x32_bf16 v[112:115], a[152:155], a[124:127], v[112:115]
    v_mfma_f32_16x16x32_bf16 v[80:83], a[156:159], a[120:123], v[80:83]
    buffer_load_dwordx4 a[44:47], v5, s[20:23], s84 offen offset:1024 sc1
    v_mfma_f32_16x16x32_bf16 v[116:119], a[156:159], a[124:127], v[116:119]
    s_add_u32 s84, s81, s89
    ds_read_b128 a[140:143], v12 offset:6144
    v_mfma_f32_16x16x32_bf16 v[84:87], a[160:163], a[120:123], v[84:87]
    s_add_u32 s89, s89, 4096
    ds_read_b128 a[144:147], v12 offset:8192
    v_mfma_f32_16x16x32_bf16 v[120:123], a[160:163], a[124:127], v[120:123]
    s_waitcnt lgkmcnt(3)
    v_mfma_f32_16x16x32_bf16 v[88:91], a[164:167], a[120:123], v[88:91]
    buffer_load_dwordx4 a[48:51], v5, s[20:23], s84 offen offset:0 sc1
    v_mfma_f32_16x16x32_bf16 v[124:127], a[164:167], a[124:127], v[124:127]
    ds_read_b128 a[148:151], v12 offset:10240
    v_mfma_f32_16x16x32_bf16 v[92:95], a[168:171], a[120:123], v[92:95]
    ds_read_b128 a[152:155], v12 offset:12288
    v_mfma_f32_16x16x32_bf16 v[128:131], a[168:171], a[124:127], v[128:131]
    v_mfma_f32_16x16x32_bf16 v[96:99], a[172:175], a[120:123], v[96:99]
    buffer_load_dwordx4 a[52:55], v5, s[20:23], s84 offen offset:1024 sc1
    v_mfma_f32_16x16x32_bf16 v[132:135], a[172:175], a[124:127], v[132:135]
    s_add_u32 s84, s81, s89
    ds_read_b128 a[156:159], v12 offset:14336
    s_waitcnt vmcnt(21)
    v_mfma_f32_16x16x32_bf16 v[64:67], a[128:131], a[0:3], v[64:67]
    s_add_u32 s89, s89, 4096
    ds_read_b128 a[160:163], v12 offset:16384
    v_mfma_f32_16x16x32_bf16 v[100:103], a[128:131], a[4:7], v[100:103]
    s_cmp_lg_u32 s89, 147456
    s_cselect_b32 s89, s89, 0
    v_mfma_f32_16x16x32_bf16 v[68:71], a[132:135], a[0:3], v[68:71]
    buffer_load_dwordx4 a[56:59], v5, s[20:23], s84 offen offset:0 sc1
    v_mfma_f32_16x16x32_bf16 v[104:107], a[132:135], a[4:7], v[104:107]
    s_waitcnt lgkmcnt(2)
    ds_read_b128 a[164:167], v13 offset:0
    v_mfma_f32_16x16x32_bf16 v[72:75], a[136:139], a[0:3], v[72:75]
    s_barrier
    v_mfma_f32_16x16x32_bf16 v[108:111], a[136:139], a[4:7], v[108:111]
    ds_read_b128 a[168:171], v13 offset:2048
    v_mfma_f32_16x16x32_bf16 v[76:79], a[140:143], a[0:3], v[76:79]
    buffer_load_dwordx4 a[60:63], v5, s[20:23], s84 offen offset:1024 sc1
    v_mfma_f32_16x16x32_bf16 v[112:115], a[140:143], a[4:7], v[112:115]
    s_add_u32 s84, s81, s89
    ds_read_b128 a[172:175], v13 offset:4096
    v_mfma_f32_16x16x32_bf16 v[80:83], a[144:147], a[0:3], v[80:83]
    s_add_u32 s89, s89, 4096
    ds_read_b128 a[128:131], v13 offset:6144
    v_mfma_f32_16x16x32_bf16 v[116:119], a[144:147], a[4:7], v[116:119]
    v_mfma_f32_16x16x32_bf16 v[84:87], a[148:151], a[0:3], v[84:87]
    buffer_load_dwordx4 v18, s[24:27], s49 offen offset:0 lds
    v_mfma_f32_16x16x32_bf16 v[120:123], a[148:151], a[4:7], v[120:123]
    ds_read_b128 a[132:135], v13 offset:8192
    v_mfma_f32_16x16x32_bf16 v[88:91], a[152:155], a[0:3], v[88:91]
    ds_read_b128 a[136:139], v13 offset:10240
    v_mfma_f32_16x16x32_bf16 v[124:127], a[152:155], a[4:7], v[124:127]
    s_waitcnt lgkmcnt(3)
    v_mfma_f32_16x16x32_bf16 v[92:95], a[156:159], a[0:3], v[92:95]
    buffer_load_dwordx4 v19, s[24:27], s49 offen offset:1024 lds
    v_mfma_f32_16x16x32_bf16 v[128:131], a[156:159], a[4:7], v[128:131]
    ds_read_b128 a[140:143], v13 offset:12288
    v_mfma_f32_16x16x32_bf16 v[96:99], a[160:163], a[0:3], v[96:99]
    ds_read_b128 a[144:147], v13 offset:14336
    v_mfma_f32_16x16x32_bf16 v[132:135], a[160:163], a[4:7], v[132:135]
    s_waitcnt vmcnt(23)
    v_mfma_f32_16x16x32_bf16 v[64:67], a[164:167], a[8:11], v[64:67]
    buffer_load_dwordx4 v20, s[24:27], s49 offen offset:2048 lds
    v_mfma_f32_16x16x32_bf16 v[100:103], a[164:167], a[12:15], v[100:103]
    ds_read_b128 a[148:151], v13 offset:16384
    v_mfma_f32_16x16x32_bf16 v[68:71], a[168:171], a[8:11], v[68:71]
    ds_read_b128 a[152:155], v14 offset:0
    v_mfma_f32_16x16x32_bf16 v[104:107], a[168:171], a[12:15], v[104:107]
    v_mfma_f32_16x16x32_bf16 v[72:75], a[172:175], a[8:11], v[72:75]
    buffer_load_dwordx4 v21, s[24:27], s49 offen offset:3072 lds
    v_mfma_f32_16x16x32_bf16 v[108:111], a[172:175], a[12:15], v[108:111]
    s_waitcnt lgkmcnt(2)
    ds_read_b128 a[156:159], v14 offset:2048
    v_mfma_f32_16x16x32_bf16 v[76:79], a[128:131], a[8:11], v[76:79]
    s_add_u32 m0, s72, 4096
    ds_read_b128 a[160:163], v14 offset:4096
    v_mfma_f32_16x16x32_bf16 v[112:115], a[128:131], a[12:15], v[112:115]
    s_add_u32 s49, s88, 36864
    v_mfma_f32_16x16x32_bf16 v[80:83], a[132:135], a[8:11], v[80:83]
    buffer_load_dwordx4 v18, s[24:27], s49 offen offset:0 lds
    v_mfma_f32_16x16x32_bf16 v[116:119], a[132:135], a[12:15], v[116:119]
    ds_read_b128 a[164:167], v14 offset:6144
    v_mfma_f32_16x16x32_bf16 v[84:87], a[136:139], a[8:11], v[84:87]
    ds_read_b128 a[168:171], v14 offset:8192
    v_mfma_f32_16x16x32_bf16 v[120:123], a[136:139], a[12:15], v[120:123]
    v_mfma_f32_16x16x32_bf16 v[88:91], a[140:143], a[8:11], v[88:91]
    buffer_load_dwordx4 v19, s[24:27], s49 offen offset:1024 lds
    v_mfma_f32_16x16x32_bf16 v[124:127], a[140:143], a[12:15], v[124:127]
    ds_read_b128 a[172:175], v14 offset:10240
    v_mfma_f32_16x16x32_bf16 v[92:95], a[144:147], a[8:11], v[92:95]
    ds_read_b128 a[128:131], v14 offset:12288
    v_mfma_f32_16x16x32_bf16 v[128:131], a[144:147], a[12:15], v[128:131]
    s_waitcnt lgkmcnt(3)
    v_mfma_f32_16x16x32_bf16 v[96:99], a[148:151], a[8:11], v[96:99]
    buffer_load_dwordx4 v20, s[24:27], s49 offen offset:2048 lds
    v_mfma_f32_16x16x32_bf16 v[132:135], a[148:151], a[12:15], v[132:135]
    ds_read_b128 a[132:135], v14 offset:14336
    s_waitcnt vmcnt(26)
    v_mfma_f32_16x16x32_bf16 v[64:67], a[152:155], a[16:19], v[64:67]
    ds_read_b128 a[136:139], v14 offset:16384
    v_mfma_f32_16x16x32_bf16 v[100:103], a[152:155], a[20:23], v[100:103]
    v_mfma_f32_16x16x32_bf16 v[68:71], a[156:159], a[16:19], v[68:71]
    buffer_load_dwordx4 v21, s[24:27], s49 offen offset:3072 lds
    v_mfma_f32_16x16x32_bf16 v[104:107], a[156:159], a[20:23], v[104:107]
    s_add_u32 m0, s72, 8192
    ds_read_b128 a[140:143], v15 offset:0
    v_mfma_f32_16x16x32_bf16 v[72:75], a[160:163], a[16:19], v[72:75]
    s_add_u32 s49, s88, 73728
    ds_read_b128 a[144:147], v15 offset:2048
    v_mfma_f32_16x16x32_bf16 v[108:111], a[160:163], a[20:23], v[108:111]
    v_mfma_f32_16x16x32_bf16 v[76:79], a[164:167], a[16:19], v[76:79]
    buffer_load_dwordx4 v18, s[24:27], s49 offen offset:0 lds
    v_mfma_f32_16x16x32_bf16 v[112:115], a[164:167], a[20:23], v[112:115]
    s_waitcnt lgkmcnt(2)
    ds_read_b128 a[148:151], v15 offset:4096
    v_mfma_f32_16x16x32_bf16 v[80:83], a[168:171], a[16:19], v[80:83]
    s_add_u32 s88, s88, 128
    ds_read_b128 a[152:155], v15 offset:6144
    v_mfma_f32_16x16x32_bf16 v[116:119], a[168:171], a[20:23], v[116:119]
    s_cmp_lg_u32 s88, 1152
    s_cselect_b32 s88, s88, 0
    s_add_u32 m0, s72, 36864
    s_add_u32 s49, s88, 0
    v_mfma_f32_16x16x32_bf16 v[84:87], a[172:175], a[16:19], v[84:87]
    buffer_load_dwordx4 a[64:67], v5, s[20:23], s84 offen offset:0 sc1
    v_mfma_f32_16x16x32_bf16 v[120:123], a[172:175], a[20:23], v[120:123]
    ds_read_b128 a[156:159], v15 offset:8192
    v_mfma_f32_16x16x32_bf16 v[88:91], a[128:131], a[16:19], v[88:91]
    ds_read_b128 a[160:163], v15 offset:10240
    v_mfma_f32_16x16x32_bf16 v[124:127], a[128:131], a[20:23], v[124:127]
    v_mfma_f32_16x16x32_bf16 v[92:95], a[132:135], a[16:19], v[92:95]
    buffer_load_dwordx4 a[68:71], v5, s[20:23], s84 offen offset:1024 sc1
    v_mfma_f32_16x16x32_bf16 v[128:131], a[132:135], a[20:23], v[128:131]
    s_add_u32 s84, s81, s89
    ds_read_b128 a[164:167], v15 offset:12288
    v_mfma_f32_16x16x32_bf16 v[96:99], a[136:139], a[16:19], v[96:99]
    s_add_u32 s89, s89, 4096
    ds_read_b128 a[168:171], v15 offset:14336
    v_mfma_f32_16x16x32_bf16 v[132:135], a[136:139], a[20:23], v[132:135]
    s_waitcnt lgkmcnt(3)
    s_waitcnt vmcnt(28)
    v_mfma_f32_16x16x32_bf16 v[64:67], a[140:143], a[24:27], v[64:67]
    buffer_load_dwordx4 a[72:75], v5, s[20:23], s84 offen offset:0 sc1
    v_mfma_f32_16x16x32_bf16 v[100:103], a[140:143], a[28:31], v[100:103]
    ds_read_b128 a[172:175], v15 offset:16384
    v_mfma_f32_16x16x32_bf16 v[68:71], a[144:147], a[24:27], v[68:71]
    s_waitcnt vmcnt(20) lgkmcnt(3)
    s_barrier
    v_mfma_f32_16x16x32_bf16 v[104:107], a[144:147], a[28:31], v[104:107]
    ds_read_b128 a[128:131], v12 offset:36864
    v_mfma_f32_16x16x32_bf16 v[72:75], a[148:151], a[24:27], v[72:75]
    buffer_load_dwordx4 a[76:79], v5, s[20:23], s84 offen offset:1024 sc1
    v_mfma_f32_16x16x32_bf16 v[108:111], a[148:151], a[28:31], v[108:111]
    s_add_u32 s84, s81, s89
    ds_read_b128 a[132:135], v12 offset:38912
    v_mfma_f32_16x16x32_bf16 v[76:79], a[152:155], a[24:27], v[76:79]
    s_add_u32 s89, s89, 4096
    ds_read_b128 a[136:139], v12 offset:40960
    v_mfma_f32_16x16x32_bf16 v[112:115], a[152:155], a[28:31], v[112:115]
    v_mfma_f32_16x16x32_bf16 v[80:83], a[156:159], a[24:27], v[80:83]
    buffer_load_dwordx4 a[80:83], v5, s[20:23], s84 offen offset:0 sc1
    v_mfma_f32_16x16x32_bf16 v[116:119], a[156:159], a[28:31], v[116:119]
    ds_read_b128 a[140:143], v12 offset:43008
    v_mfma_f32_16x16x32_bf16 v[84:87], a[160:163], a[24:27], v[84:87]
    ds_read_b128 a[144:147], v12 offset:45056
    v_mfma_f32_16x16x32_bf16 v[120:123], a[160:163], a[28:31], v[120:123]
    s_waitcnt lgkmcnt(3)
    v_mfma_f32_16x16x32_bf16 v[88:91], a[164:167], a[24:27], v[88:91]
    buffer_load_dwordx4 a[84:87], v5, s[20:23], s84 offen offset:1024 sc1
    v_mfma_f32_16x16x32_bf16 v[124:127], a[164:167], a[28:31], v[124:127]
    s_add_u32 s84, s81, s89
    ds_read_b128 a[148:151], v12 offset:47104
    v_mfma_f32_16x16x32_bf16 v[92:95], a[168:171], a[24:27], v[92:95]
    s_add_u32 s89, s89, 4096
    ds_read_b128 a[152:155], v12 offset:49152
    v_mfma_f32_16x16x32_bf16 v[128:131], a[168:171], a[28:31], v[128:131]
    s_cmp_lg_u32 s89, 147456
    s_cselect_b32 s89, s89, 0
    v_mfma_f32_16x16x32_bf16 v[96:99], a[172:175], a[24:27], v[96:99]
    buffer_load_dwordx4 a[88:91], v5, s[20:23], s84 offen offset:0 sc1
    v_mfma_f32_16x16x32_bf16 v[132:135], a[172:175], a[28:31], v[132:135]
    ds_read_b128 a[156:159], v12 offset:51200
    s_waitcnt vmcnt(22)
    v_mfma_f32_16x16x32_bf16 v[64:67], a[128:131], a[32:35], v[64:67]
    ds_read_b128 a[160:163], v12 offset:53248
    v_mfma_f32_16x16x32_bf16 v[100:103], a[128:131], a[36:39], v[100:103]
    v_mfma_f32_16x16x32_bf16 v[68:71], a[132:135], a[32:35], v[68:71]
    buffer_load_dwordx4 a[92:95], v5, s[20:23], s84 offen offset:1024 sc1
    v_mfma_f32_16x16x32_bf16 v[104:107], a[132:135], a[36:39], v[104:107]
    s_waitcnt lgkmcnt(2)
    ds_read_b128 a[164:167], v13 offset:36864
    v_mfma_f32_16x16x32_bf16 v[72:75], a[136:139], a[32:35], v[72:75]
    s_barrier
    v_mfma_f32_16x16x32_bf16 v[108:111], a[136:139], a[36:39], v[108:111]
    s_add_u32 s84, s81, s89
    ds_read_b128 a[168:171], v13 offset:38912
    v_mfma_f32_16x16x32_bf16 v[76:79], a[140:143], a[32:35], v[76:79]
    buffer_load_dwordx4 v18, s[24:27], s49 offen offset:0 lds
    v_mfma_f32_16x16x32_bf16 v[112:115], a[140:143], a[36:39], v[112:115]
    s_add_u32 s89, s89, 4096
    ds_read_b128 a[172:175], v13 offset:40960
    v_mfma_f32_16x16x32_bf16 v[80:83], a[144:147], a[32:35], v[80:83]
    ds_read_b128 a[128:131], v13 offset:43008
    v_mfma_f32_16x16x32_bf16 v[116:119], a[144:147], a[36:39], v[116:119]
    v_mfma_f32_16x16x32_bf16 v[84:87], a[148:151], a[32:35], v[84:87]
    buffer_load_dwordx4 v19, s[24:27], s49 offen offset:1024 lds
    v_mfma_f32_16x16x32_bf16 v[120:123], a[148:151], a[36:39], v[120:123]
    ds_read_b128 a[132:135], v13 offset:45056
    v_mfma_f32_16x16x32_bf16 v[88:91], a[152:155], a[32:35], v[88:91]
    ds_read_b128 a[136:139], v13 offset:47104
    v_mfma_f32_16x16x32_bf16 v[124:127], a[152:155], a[36:39], v[124:127]
    s_waitcnt lgkmcnt(3)
    v_mfma_f32_16x16x32_bf16 v[92:95], a[156:159], a[32:35], v[92:95]
    buffer_load_dwordx4 v20, s[24:27], s49 offen offset:2048 lds
    v_mfma_f32_16x16x32_bf16 v[128:131], a[156:159], a[36:39], v[128:131]
    ds_read_b128 a[140:143], v13 offset:49152
    v_mfma_f32_16x16x32_bf16 v[96:99], a[160:163], a[32:35], v[96:99]
    ds_read_b128 a[144:147], v13 offset:51200
    v_mfma_f32_16x16x32_bf16 v[132:135], a[160:163], a[36:39], v[132:135]
    s_waitcnt vmcnt(24)
    v_mfma_f32_16x16x32_bf16 v[64:67], a[164:167], a[40:43], v[64:67]
    buffer_load_dwordx4 v21, s[24:27], s49 offen offset:3072 lds
    v_mfma_f32_16x16x32_bf16 v[100:103], a[164:167], a[44:47], v[100:103]
    s_add_u32 m0, s72, 40960
    ds_read_b128 a[148:151], v13 offset:53248
    v_mfma_f32_16x16x32_bf16 v[68:71], a[168:171], a[40:43], v[68:71]
    s_add_u32 s49, s88, 36864
    ds_read_b128 a[152:155], v14 offset:36864
    v_mfma_f32_16x16x32_bf16 v[104:107], a[168:171], a[44:47], v[104:107]
    v_mfma_f32_16x16x32_bf16 v[72:75], a[172:175], a[40:43], v[72:75]
    buffer_load_dwordx4 v18, s[24:27], s49 offen offset:0 lds
    v_mfma_f32_16x16x32_bf16 v[108:111], a[172:175], a[44:47], v[108:111]
    s_waitcnt lgkmcnt(2)
    ds_read_b128 a[156:159], v14 offset:38912
    v_mfma_f32_16x16x32_bf16 v[76:79], a[128:131], a[40:43], v[76:79]
    ds_read_b128 a[160:163], v14 offset:40960
    v_mfma_f32_16x16x32_bf16 v[112:115], a[128:131], a[44:47], v[112:115]
    v_mfma_f32_16x16x32_bf16 v[80:83], a[132:135], a[40:43], v[80:83]
    buffer_load_dwordx4 v19, s[24:27], s49 offen offset:1024 lds
    v_mfma_f32_16x16x32_bf16 v[116:119], a[132:135], a[44:47], v[116:119]
    ds_read_b128 a[164:167], v14 offset:43008
    v_mfma_f32_16x16x32_bf16 v[84:87], a[136:139], a[40:43], v[84:87]
    ds_read_b128 a[168:171], v14 offset:45056
    v_mfma_f32_16x16x32_bf16 v[120:123], a[136:139], a[44:47], v[120:123]
    v_mfma_f32_16x16x32_bf16 v[88:91], a[140:143], a[40:43], v[88:91]
    buffer_load_dwordx4 v20, s[24:27], s49 offen offset:2048 lds
    v_mfma_f32_16x16x32_bf16 v[124:127], a[140:143], a[44:47], v[124:127]
    ds_read_b128 a[172:175], v14 offset:47104
    v_mfma_f32_16x16x32_bf16 v[92:95], a[144:147], a[40:43], v[92:95]
    ds_read_b128 a[128:131], v14 offset:49152
    v_mfma_f32_16x16x32_bf16 v[128:131], a[144:147], a[44:47], v[128:131]
    s_waitcnt lgkmcnt(3)
    v_mfma_f32_16x16x32_bf16 v[96:99], a[148:151], a[40:43], v[96:99]
    buffer_load_dwordx4 v21, s[24:27], s49 offen offset:3072 lds
    v_mfma_f32_16x16x32_bf16 v[132:135], a[148:151], a[44:47], v[132:135]
    s_add_u32 m0, s72, 45056
    ds_read_b128 a[132:135], v14 offset:51200
    s_waitcnt vmcnt(27)
    v_mfma_f32_16x16x32_bf16 v[64:67], a[152:155], a[48:51], v[64:67]
    s_add_u32 s49, s88, 73728
    ds_read_b128 a[136:139], v14 offset:53248
    v_mfma_f32_16x16x32_bf16 v[100:103], a[152:155], a[52:55], v[100:103]
    v_mfma_f32_16x16x32_bf16 v[68:71], a[156:159], a[48:51], v[68:71]
    buffer_load_dwordx4 v18, s[24:27], s49 offen offset:0 lds
    v_mfma_f32_16x16x32_bf16 v[104:107], a[156:159], a[52:55], v[104:107]
    s_add_u32 s88, s88, 128
    ds_read_b128 a[140:143], v15 offset:36864
    v_mfma_f32_16x16x32_bf16 v[72:75], a[160:163], a[48:51], v[72:75]
    s_cmp_lg_u32 s88, 1152
    s_cselect_b32 s88, s88, 0
    ds_read_b128 a[144:147], v15 offset:38912
    v_mfma_f32_16x16x32_bf16 v[108:111], a[160:163], a[52:55], v[108:111]
    s_add_u32 m0, s72, 73728
    s_add_u32 s49, s88, 0
    v_mfma_f32_16x16x32_bf16 v[76:79], a[164:167], a[48:51], v[76:79]
    buffer_load_dwordx4 a[96:99], v5, s[20:23], s84 offen offset:0 sc1
    v_mfma_f32_16x16x32_bf16 v[112:115], a[164:167], a[52:55], v[112:115]
    s_waitcnt lgkmcnt(2)
    ds_read_b128 a[148:151], v15 offset:40960
    v_mfma_f32_16x16x32_bf16 v[80:83], a[168:171], a[48:51], v[80:83]
    ds_read_b128 a[152:155], v15 offset:43008
    v_mfma_f32_16x16x32_bf16 v[116:119], a[168:171], a[52:55], v[116:119]
    v_mfma_f32_16x16x32_bf16 v[84:87], a[172:175], a[48:51], v[84:87]
    buffer_load_dwordx4 a[100:103], v5, s[20:23], s84 offen offset:1024 sc1
    v_mfma_f32_16x16x32_bf16 v[120:123], a[172:175], a[52:55], v[120:123]
    s_add_u32 s84, s81, s89
    ds_read_b128 a[156:159], v15 offset:45056
    v_mfma_f32_16x16x32_bf16 v[88:91], a[128:131], a[48:51], v[88:91]
    s_add_u32 s89, s89, 4096
    ds_read_b128 a[160:163], v15 offset:47104
    v_mfma_f32_16x16x32_bf16 v[124:127], a[128:131], a[52:55], v[124:127]
    v_mfma_f32_16x16x32_bf16 v[92:95], a[132:135], a[48:51], v[92:95]
    buffer_load_dwordx4 a[104:107], v5, s[20:23], s84 offen offset:0 sc1
    v_mfma_f32_16x16x32_bf16 v[128:131], a[132:135], a[52:55], v[128:131]
    ds_read_b128 a[164:167], v15 offset:49152
    v_mfma_f32_16x16x32_bf16 v[96:99], a[136:139], a[48:51], v[96:99]
    ds_read_b128 a[168:171], v15 offset:51200
    v_mfma_f32_16x16x32_bf16 v[132:135], a[136:139], a[52:55], v[132:135]
    s_waitcnt lgkmcnt(3)
    s_waitcnt vmcnt(29)
    v_mfma_f32_16x16x32_bf16 v[64:67], a[140:143], a[56:59], v[64:67]
    buffer_load_dwordx4 a[108:111], v5, s[20:23], s84 offen offset:1024 sc1
    v_mfma_f32_16x16x32_bf16 v[100:103], a[140:143], a[60:63], v[100:103]
    s_add_u32 s84, s81, s89
    ds_read_b128 a[172:175], v15 offset:53248
    v_mfma_f32_16x16x32_bf16 v[68:71], a[144:147], a[56:59], v[68:71]
    s_waitcnt vmcnt(21) lgkmcnt(3)
    s_barrier
    v_mfma_f32_16x16x32_bf16 v[104:107], a[144:147], a[60:63], v[104:107]
    s_add_u32 s89, s89, 4096
    ds_read_b128 a[128:131], v8 offset:0
    v_mfma_f32_16x16x32_bf16 v[72:75], a[148:151], a[56:59], v[72:75]
    buffer_load_dwordx4 v18, s[24:27], s49 offen offset:0 lds
    v_mfma_f32_16x16x32_bf16 v[108:111], a[148:151], a[60:63], v[108:111]
    ds_read_b128 a[132:135], v8 offset:2048
    v_mfma_f32_16x16x32_bf16 v[76:79], a[152:155], a[56:59], v[76:79]
    s_branch gated_mix__ssm_conv_s5__swiglu_ffn__prompt_kernel_B_sk9
.p2align 12
gated_mix__ssm_conv_s5__swiglu_ffn__prompt_kernel_B_pg0_9:
    s_branch gated_mix__ssm_conv_s5__swiglu_ffn__prompt_kernel_B_pr0
gated_mix__ssm_conv_s5__swiglu_ffn__prompt_kernel_B_pg3_9:
    s_branch gated_mix__ssm_conv_s5__swiglu_ffn__prompt_kernel_B_pr3
gated_mix__ssm_conv_s5__swiglu_ffn__prompt_kernel_B_sk9:
    ds_read_b128 a[136:139], v8 offset:4096
    v_mfma_f32_16x16x32_bf16 v[112:115], a[152:155], a[60:63], v[112:115]
    v_mfma_f32_16x16x32_bf16 v[80:83], a[156:159], a[56:59], v[80:83]
    buffer_load_dwordx4 v19, s[24:27], s49 offen offset:1024 lds
    v_mfma_f32_16x16x32_bf16 v[116:119], a[156:159], a[60:63], v[116:119]
    ds_read_b128 a[140:143], v8 offset:6144
    v_mfma_f32_16x16x32_bf16 v[84:87], a[160:163], a[56:59], v[84:87]
    ds_read_b128 a[144:147], v8 offset:8192
    v_mfma_f32_16x16x32_bf16 v[120:123], a[160:163], a[60:63], v[120:123]
    s_waitcnt lgkmcnt(3)
    v_mfma_f32_16x16x32_bf16 v[88:91], a[164:167], a[56:59], v[88:91]
    buffer_load_dwordx4 v20, s[24:27], s49 offen offset:2048 lds
    v_mfma_f32_16x16x32_bf16 v[124:127], a[164:167], a[60:63], v[124:127]
    ds_read_b128 a[148:151], v8 offset:10240
    v_mfma_f32_16x16x32_bf16 v[92:95], a[168:171], a[56:59], v[92:95]
    ds_read_b128 a[152:155], v8 offset:12288
    v_mfma_f32_16x16x32_bf16 v[128:131], a[168:171], a[60:63], v[128:131]
    v_mfma_f32_16x16x32_bf16 v[96:99], a[172:175], a[56:59], v[96:99]
    buffer_load_dwordx4 v21, s[24:27], s49 offen offset:3072 lds
    v_mfma_f32_16x16x32_bf16 v[132:135], a[172:175], a[60:63], v[132:135]
    s_add_u32 m0, s72, 77824
    ds_read_b128 a[156:159], v8 offset:14336
    s_waitcnt vmcnt(23)
    v_mfma_f32_16x16x32_bf16 v[64:67], a[128:131], a[64:67], v[64:67]
    s_add_u32 s49, s88, 36864
    ds_read_b128 a[160:163], v8 offset:16384
    v_mfma_f32_16x16x32_bf16 v[100:103], a[128:131], a[68:71], v[100:103]
    v_mfma_f32_16x16x32_bf16 v[68:71], a[132:135], a[64:67], v[68:71]
    buffer_load_dwordx4 v18, s[24:27], s49 offen offset:0 lds
    v_mfma_f32_16x16x32_bf16 v[104:107], a[132:135], a[68:71], v[104:107]
    s_waitcnt lgkmcnt(2)
    ds_read_b128 a[164:167], v9 offset:0
    v_mfma_f32_16x16x32_bf16 v[72:75], a[136:139], a[64:67], v[72:75]
    ds_read_b128 a[168:171], v9 offset:2048
    v_mfma_f32_16x16x32_bf16 v[108:111], a[136:139], a[68:71], v[108:111]
    v_mfma_f32_16x16x32_bf16 v[76:79], a[140:143], a[64:67], v[76:79]
    buffer_load_dwordx4 v19, s[24:27], s49 offen offset:1024 lds
    v_mfma_f32_16x16x32_bf16 v[112:115], a[140:143], a[68:71], v[112:115]
    ds_read_b128 a[172:175], v9 offset:4096
    v_mfma_f32_16x16x32_bf16 v[80:83], a[144:147], a[64:67], v[80:83]
    ds_read_b128 a[128:131], v9 offset:6144
    v_mfma_f32_16x16x32_bf16 v[116:119], a[144:147], a[68:71], v[116:119]
    v_mfma_f32_16x16x32_bf16 v[84:87], a[148:151], a[64:67], v[84:87]
    buffer_load_dwordx4 v20, s[24:27], s49 offen offset:2048 lds
    v_mfma_f32_16x16x32_bf16 v[120:123], a[148:151], a[68:71], v[120:123]
    ds_read_b128 a[132:135], v9 offset:8192
    v_mfma_f32_16x16x32_bf16 v[88:91], a[152:155], a[64:67], v[88:91]
    ds_read_b128 a[136:139], v9 offset:10240
    v_mfma_f32_16x16x32_bf16 v[124:127], a[152:155], a[68:71], v[124:127]
    s_waitcnt lgkmcnt(3)
    v_mfma_f32_16x16x32_bf16 v[92:95], a[156:159], a[64:67], v[92:95]
    buffer_load_dwordx4 v21, s[24:27], s49 offen offset:3072 lds
    v_mfma_f32_16x16x32_bf16 v[128:131], a[156:159], a[68:71], v[128:131]
    s_add_u32 m0, s72, 81920
    ds_read_b128 a[140:143], v9 offset:12288
    v_mfma_f32_16x16x32_bf16 v[96:99], a[160:163], a[64:67], v[96:99]
    s_add_u32 s49, s88, 73728
    ds_read_b128 a[144:147], v9 offset:14336
    v_mfma_f32_16x16x32_bf16 v[132:135], a[160:163], a[68:71], v[132:135]
    s_waitcnt vmcnt(25)
    v_mfma_f32_16x16x32_bf16 v[64:67], a[164:167], a[72:75], v[64:67]
    buffer_load_dwordx4 v18, s[24:27], s49 offen offset:0 lds
    v_mfma_f32_16x16x32_bf16 v[100:103], a[164:167], a[76:79], v[100:103]
    s_add_u32 s88, s88, 128
    ds_read_b128 a[148:151], v9 offset:16384
    v_mfma_f32_16x16x32_bf16 v[68:71], a[168:171], a[72:75], v[68:71]
    s_cmp_lg_u32 s88, 1152
    s_cselect_b32 s88, s88, 0
    ds_read_b128 a[152:155], v10 offset:0
    v_mfma_f32_16x16x32_bf16 v[104:107], a[168:171], a[76:79], v[104:107]
    v_mfma_f32_16x16x32_bf16 v[72:75], a[172:175], a[72:75], v[72:75]
    buffer_load_dwordx4 a[112:115], v5, s[20:23], s84 offen offset:0 sc1
    v_mfma_f32_16x16x32_bf16 v[108:111], a[172:175], a[76:79], v[108:111]
    s_waitcnt lgkmcnt(2)
    ds_read_b128 a[156:159], v10 offset:2048
    v_mfma_f32_16x16x32_bf16 v[76:79], a[128:131], a[72:75], v[76:79]
    ds_read_b128 a[160:163], v10 offset:4096
    v_mfma_f32_16x16x32_bf16 v[112:115], a[128:131], a[76:79], v[112:115]
    v_mfma_f32_16x16x32_bf16 v[80:83], a[132:135], a[72:75], v[80:83]
    buffer_load_dwordx4 a[116:119], v5, s[20:23], s84 offen offset:1024 sc1
    v_mfma_f32_16x16x32_bf16 v[116:119], a[132:135], a[76:79], v[116:119]
    s_add_u32 s84, s81, s89
    ds_read_b128 a[164:167], v10 offset:6144
    v_mfma_f32_16x16x32_bf16 v[84:87], a[136:139], a[72:75], v[84:87]
    s_add_u32 s89, s89, 4096
    ds_read_b128 a[168:171], v10 offset:8192
    v_mfma_f32_16x16x32_bf16 v[120:123], a[136:139], a[76:79], v[120:123]
    s_cmp_lg_u32 s89, 147456
    s_cselect_b32 s89, s89, 0
    v_mfma_f32_16x16x32_bf16 v[88:91], a[140:143], a[72:75], v[88:91]
    buffer_load_dwordx4 a[120:123], v5, s[20:23], s84 offen offset:0 sc1
    v_mfma_f32_16x16x32_bf16 v[124:127], a[140:143], a[76:79], v[124:127]
    ds_read_b128 a[172:175], v10 offset:10240
    v_mfma_f32_16x16x32_bf16 v[92:95], a[144:147], a[72:75], v[92:95]
    ds_read_b128 a[128:131], v10 offset:12288
    v_mfma_f32_16x16x32_bf16 v[128:131], a[144:147], a[76:79], v[128:131]
    s_waitcnt lgkmcnt(3)
    v_mfma_f32_16x16x32_bf16 v[96:99], a[148:151], a[72:75], v[96:99]
    buffer_load_dwordx4 a[124:127], v5, s[20:23], s84 offen offset:1024 sc1
    v_mfma_f32_16x16x32_bf16 v[132:135], a[148:151], a[76:79], v[132:135]
    s_add_u32 s84, s81, s89
    ds_read_b128 a[132:135], v10 offset:14336
    s_waitcnt vmcnt(28)
    v_mfma_f32_16x16x32_bf16 v[64:67], a[152:155], a[80:83], v[64:67]
    s_add_u32 s89, s89, 4096
    ds_read_b128 a[136:139], v10 offset:16384
    v_mfma_f32_16x16x32_bf16 v[100:103], a[152:155], a[84:87], v[100:103]
    v_mfma_f32_16x16x32_bf16 v[68:71], a[156:159], a[80:83], v[68:71]
    buffer_load_dwordx4 a[0:3], v5, s[20:23], s84 offen offset:0 sc1
    v_mfma_f32_16x16x32_bf16 v[104:107], a[156:159], a[84:87], v[104:107]
    ds_read_b128 a[140:143], v11 offset:0
    v_mfma_f32_16x16x32_bf16 v[72:75], a[160:163], a[80:83], v[72:75]
    ds_read_b128 a[144:147], v11 offset:2048
    v_mfma_f32_16x16x32_bf16 v[108:111], a[160:163], a[84:87], v[108:111]
    v_mfma_f32_16x16x32_bf16 v[76:79], a[164:167], a[80:83], v[76:79]
    buffer_load_dwordx4 a[4:7], v5, s[20:23], s84 offen offset:1024 sc1
    v_mfma_f32_16x16x32_bf16 v[112:115], a[164:167], a[84:87], v[112:115]
    s_waitcnt lgkmcnt(2)
    ds_read_b128 a[148:151], v11 offset:4096
    v_mfma_f32_16x16x32_bf16 v[80:83], a[168:171], a[80:83], v[80:83]
    s_add_u32 s84, s81, s89
    ds_read_b128 a[152:155], v11 offset:6144
    v_mfma_f32_16x16x32_bf16 v[116:119], a[168:171], a[84:87], v[116:119]
    s_add_u32 s89, s89, 4096
    v_mfma_f32_16x16x32_bf16 v[84:87], a[172:175], a[80:83], v[84:87]
    buffer_load_dwordx4 a[8:11], v5, s[20:23], s84 offen offset:0 sc1
    v_mfma_f32_16x16x32_bf16 v[120:123], a[172:175], a[84:87], v[120:123]
    ds_read_b128 a[156:159], v11 offset:8192
    v_mfma_f32_16x16x32_bf16 v[88:91], a[128:131], a[80:83], v[88:91]
    buffer_load_dword v29, v28, s[20:23], s35 offen sc1
    v_mfma_f32_16x16x32_bf16 v[124:127], a[128:131], a[84:87], v[124:127]
    ds_read_b128 a[160:163], v11 offset:10240
    v_mfma_f32_16x16x32_bf16 v[92:95], a[132:135], a[80:83], v[92:95]
    buffer_load_dwordx4 a[12:15], v5, s[20:23], s84 offen offset:1024 sc1
    v_mfma_f32_16x16x32_bf16 v[128:131], a[132:135], a[84:87], v[128:131]
    s_add_u32 s84, s81, s89
    ds_read_b128 a[164:167], v11 offset:12288
    v_mfma_f32_16x16x32_bf16 v[96:99], a[136:139], a[80:83], v[96:99]
    s_add_u32 s89, s89, 4096
    ds_read_b128 a[168:171], v11 offset:14336
    v_mfma_f32_16x16x32_bf16 v[132:135], a[136:139], a[84:87], v[132:135]
    s_waitcnt lgkmcnt(3)
    s_waitcnt vmcnt(31)
    v_mfma_f32_16x16x32_bf16 v[64:67], a[140:143], a[88:91], v[64:67]
    buffer_load_dwordx4 a[16:19], v5, s[20:23], s84 offen offset:0 sc1
    v_mfma_f32_16x16x32_bf16 v[100:103], a[140:143], a[92:95], v[100:103]
    ds_read_b128 a[172:175], v11 offset:16384
    v_mfma_f32_16x16x32_bf16 v[68:71], a[144:147], a[88:91], v[68:71]
    s_waitcnt vmcnt(23) lgkmcnt(3)
    s_barrier
    v_mfma_f32_16x16x32_bf16 v[104:107], a[144:147], a[92:95], v[104:107]
    ds_read_b128 a[128:131], v8 offset:36864
    v_mfma_f32_16x16x32_bf16 v[72:75], a[148:151], a[88:91], v[72:75]
    buffer_load_dwordx4 a[20:23], v5, s[20:23], s84 offen offset:1024 sc1
    v_mfma_f32_16x16x32_bf16 v[108:111], a[148:151], a[92:95], v[108:111]
    s_add_u32 s84, s81, s89
    ds_read_b128 a[132:135], v8 offset:38912
    v_mfma_f32_16x16x32_bf16 v[76:79], a[152:155], a[88:91], v[76:79]
    s_add_u32 s89, s89, 4096
    ds_read_b128 a[136:139], v8 offset:40960
    v_mfma_f32_16x16x32_bf16 v[112:115], a[152:155], a[92:95], v[112:115]
    s_cmp_lg_u32 s89, 147456
    s_cselect_b32 s89, s89, 0
    v_mfma_f32_16x16x32_bf16 v[80:83], a[156:159], a[88:91], v[80:83]
    buffer_load_dwordx4 a[24:27], v5, s[20:23], s84 offen offset:0 sc1
    v_mfma_f32_16x16x32_bf16 v[116:119], a[156:159], a[92:95], v[116:119]
    ds_read_b128 a[140:143], v9 offset:36864
    v_mfma_f32_16x16x32_bf16 v[84:87], a[160:163], a[88:91], v[84:87]
    ds_read_b128 a[144:147], v9 offset:38912
    v_mfma_f32_16x16x32_bf16 v[120:123], a[160:163], a[92:95], v[120:123]
    s_waitcnt lgkmcnt(3)
    v_mfma_f32_16x16x32_bf16 v[88:91], a[164:167], a[88:91], v[88:91]
    buffer_load_dwordx4 a[28:31], v5, s[20:23], s84 offen offset:1024 sc1
    v_mfma_f32_16x16x32_bf16 v[124:127], a[164:167], a[92:95], v[124:127]
    ds_read_b128 a[148:151], v9 offset:40960
    v_mfma_f32_16x16x32_bf16 v[92:95], a[168:171], a[88:91], v[92:95]
    ds_read_b128 a[152:155], v10 offset:36864
    v_mfma_f32_16x16x32_bf16 v[128:131], a[168:171], a[92:95], v[128:131]
    v_mfma_f32_16x16x32_bf16 v[96:99], a[172:175], a[88:91], v[96:99]
    ds_read_b128 a[156:159], v10 offset:38912
    v_mfma_f32_16x16x32_bf16 v[132:135], a[172:175], a[92:95], v[132:135]
    s_waitcnt vmcnt(24)
    v_mfma_f32_16x16x32_bf16 v[64:67], a[128:131], a[96:99], v[64:67]
    ds_read_b128 a[160:163], v10 offset:40960
    v_mfma_f32_16x16x32_bf16 v[100:103], a[128:131], a[100:103], v[100:103]
    v_mfma_f32_16x16x32_bf16 v[68:71], a[132:135], a[96:99], v[68:71]
    ds_read_b128 a[164:167], v11 offset:36864
    v_mfma_f32_16x16x32_bf16 v[104:107], a[132:135], a[100:103], v[104:107]
    s_waitcnt lgkmcnt(3)
    v_mfma_f32_16x16x32_bf16 v[72:75], a[136:139], a[96:99], v[72:75]
    ds_read_b128 a[168:171], v11 offset:38912
    v_mfma_f32_16x16x32_bf16 v[108:111], a[136:139], a[100:103], v[108:111]
    s_waitcnt vmcnt(22)
    v_mfma_f32_16x16x32_bf16 v[64:67], a[140:143], a[104:107], v[64:67]
    ds_read_b128 a[172:175], v11 offset:40960
    v_mfma_f32_16x16x32_bf16 v[100:103], a[140:143], a[108:111], v[100:103]
    s_waitcnt vmcnt(13) lgkmcnt(3)
    s_barrier
    v_mfma_f32_16x16x32_bf16 v[68:71], a[144:147], a[104:107], v[68:71]
    ds_read_b128 a[128:131], v12 offset:0
    v_mfma_f32_16x16x32_bf16 v[104:107], a[144:147], a[108:111], v[104:107]
    v_mfma_f32_16x16x32_bf16 v[72:75], a[148:151], a[104:107], v[72:75]
    ds_read_b128 a[132:135], v12 offset:2048
    v_mfma_f32_16x16x32_bf16 v[108:111], a[148:151], a[108:111], v[108:111]
    s_waitcnt vmcnt(11)
    v_mfma_f32_16x16x32_bf16 v[64:67], a[152:155], a[112:115], v[64:67]
    ds_read_b128 a[136:139], v12 offset:4096
    v_mfma_f32_16x16x32_bf16 v[100:103], a[152:155], a[116:119], v[100:103]
    v_mfma_f32_16x16x32_bf16 v[68:71], a[156:159], a[112:115], v[68:71]
    ds_read_b128 a[140:143], v13 offset:0
    v_mfma_f32_16x16x32_bf16 v[104:107], a[156:159], a[116:119], v[104:107]
    v_mfma_f32_16x16x32_bf16 v[72:75], a[160:163], a[112:115], v[72:75]
    ds_read_b128 a[144:147], v13 offset:2048
    v_mfma_f32_16x16x32_bf16 v[108:111], a[160:163], a[116:119], v[108:111]
    s_waitcnt lgkmcnt(3)
    s_waitcnt vmcnt(9)
    v_mfma_f32_16x16x32_bf16 v[64:67], a[164:167], a[120:123], v[64:67]
    ds_read_b128 a[148:151], v13 offset:4096
    v_mfma_f32_16x16x32_bf16 v[100:103], a[164:167], a[124:127], v[100:103]
    v_mfma_f32_16x16x32_bf16 v[68:71], a[168:171], a[120:123], v[68:71]
    ds_read_b128 a[152:155], v14 offset:0
    v_mfma_f32_16x16x32_bf16 v[104:107], a[168:171], a[124:127], v[104:107]
    v_mfma_f32_16x16x32_bf16 v[72:75], a[172:175], a[120:123], v[72:75]
    ds_read_b128 a[156:159], v14 offset:2048
    v_mfma_f32_16x16x32_bf16 v[108:111], a[172:175], a[124:127], v[108:111]
    s_waitcnt vmcnt(7)
    v_mfma_f32_16x16x32_bf16 v[64:67], a[128:131], a[0:3], v[64:67]
    ds_read_b128 a[160:163], v14 offset:4096
    v_mfma_f32_16x16x32_bf16 v[100:103], a[128:131], a[4:7], v[100:103]
    v_mfma_f32_16x16x32_bf16 v[68:71], a[132:135], a[0:3], v[68:71]
    ds_read_b128 a[164:167], v15 offset:0
    v_mfma_f32_16x16x32_bf16 v[104:107], a[132:135], a[4:7], v[104:107]
    s_waitcnt lgkmcnt(3)
    v_mfma_f32_16x16x32_bf16 v[72:75], a[136:139], a[0:3], v[72:75]
    ds_read_b128 a[168:171], v15 offset:2048
    v_mfma_f32_16x16x32_bf16 v[108:111], a[136:139], a[4:7], v[108:111]
    s_waitcnt vmcnt(4)
    v_mfma_f32_16x16x32_bf16 v[64:67], a[140:143], a[8:11], v[64:67]
    ds_read_b128 a[172:175], v15 offset:4096
    v_cmp_eq_u32 s[76:77], 0, v29
    v_mfma_f32_16x16x32_bf16 v[100:103], a[140:143], a[12:15], v[100:103]
    v_mfma_f32_16x16x32_bf16 v[68:71], a[144:147], a[8:11], v[68:71]
    s_cmp_lg_u64 s[76:77], 0
    s_cbranch_scc1 gated_mix__ssm_conv_s5__swiglu_ffn__prompt_kernel_lkb_s
gated_mix__ssm_conv_s5__swiglu_ffn__prompt_kernel_lkb:
    ds_read_b128 a[128:131], v8 offset:43008
    v_mfma_f32_16x16x32_bf16 v[104:107], a[144:147], a[12:15], v[104:107]
    v_mfma_f32_16x16x32_bf16 v[72:75], a[148:151], a[8:11], v[72:75]
    ds_read_b128 a[132:135], v8 offset:45056
    v_mfma_f32_16x16x32_bf16 v[108:111], a[148:151], a[12:15], v[108:111]
    s_waitcnt vmcnt(2)
    v_mfma_f32_16x16x32_bf16 v[64:67], a[152:155], a[16:19], v[64:67]
    ds_read_b128 a[136:139], v8 offset:47104
    v_mfma_f32_16x16x32_bf16 v[100:103], a[152:155], a[20:23], v[100:103]
    s_waitcnt lgkmcnt(3)
    v_mfma_f32_16x16x32_bf16 v[68:71], a[156:159], a[16:19], v[68:71]
    ds_read_b128 a[140:143], v9 offset:43008
    v_mfma_f32_16x16x32_bf16 v[104:107], a[156:159], a[20:23], v[104:107]
    v_mfma_f32_16x16x32_bf16 v[72:75], a[160:163], a[16:19], v[72:75]
    ds_read_b128 a[144:147], v9 offset:45056
    v_mfma_f32_16x16x32_bf16 v[108:111], a[160:163], a[20:23], v[108:111]
    s_waitcnt vmcnt(0)
    v_mfma_f32_16x16x32_bf16 v[64:67], a[164:167], a[24:27], v[64:67]
    ds_read_b128 a[148:151], v9 offset:47104
    v_mfma_f32_16x16x32_bf16 v[100:103], a[164:167], a[28:31], v[100:103]
    v_mfma_f32_16x16x32_bf16 v[68:71], a[168:171], a[24:27], v[68:71]
    ds_read_b128 a[152:155], v10 offset:43008
    v_mfma_f32_16x16x32_bf16 v[104:107], a[168:171], a[28:31], v[104:107]
    v_mfma_f32_16x16x32_bf16 v[72:75], a[172:175], a[24:27], v[72:75]
    ds_read_b128 a[156:159], v10 offset:45056
    v_mfma_f32_16x16x32_bf16 v[108:111], a[172:175], a[28:31], v[108:111]
    s_waitcnt lgkmcnt(3)
    v_cvt_pk_bf16_f32 v64, v64, v65
    v_cvt_pk_bf16_f32 v65, v66, v67
    v_mfma_f32_16x16x32_bf16 v[76:79], a[128:131], a[96:99], v[76:79]
    ds_read_b128 a[160:163], v10 offset:47104
    v_mfma_f32_16x16x32_bf16 v[112:115], a[128:131], a[100:103], v[112:115]
    v_cvt_pk_bf16_f32 v66, v68, v69
    v_mov_b32 v67, -1
    v_mfma_f32_16x16x32_bf16 v[80:83], a[132:135], a[96:99], v[80:83]
    buffer_store_dwordx4 v[64:67], v5, s[20:23], s32 offen offset:0 sc1
    v_cvt_pk_bf16_f32 v100, v100, v101
    v_mfma_f32_16x16x32_bf16 v[116:119], a[132:135], a[100:103], v[116:119]
    ds_read_b128 a[164:167], v11 offset:43008
    v_cvt_pk_bf16_f32 v101, v102, v103
    v_cvt_pk_bf16_f32 v102, v104, v105
    v_mfma_f32_16x16x32_bf16 v[84:87], a[136:139], a[96:99], v[84:87]
    ds_read_b128 a[168:171], v11 offset:45056
    v_mov_b32 v103, -1
    v_mfma_f32_16x16x32_bf16 v[120:123], a[136:139], a[100:103], v[120:123]
    v_mfma_f32_16x16x32_bf16 v[76:79], a[140:143], a[104:107], v[76:79]
    buffer_store_dwordx4 v[100:103], v5, s[20:23], s32 offen offset:2048 sc1
    v_cvt_pk_bf16_f32 v68, v70, v71
    v_mfma_f32_16x16x32_bf16 v[112:115], a[140:143], a[108:111], v[112:115]
    ds_read_b128 a[172:175], v11 offset:47104
    v_cvt_pk_bf16_f32 v69, v72, v73
    v_cvt_pk_bf16_f32 v70, v74, v75
    v_mfma_f32_16x16x32_bf16 v[80:83], a[144:147], a[104:107], v[80:83]
    ds_read_b128 a[128:131], v12 offset:6144
    v_mov_b32 v71, -1
    v_mfma_f32_16x16x32_bf16 v[116:119], a[144:147], a[108:111], v[116:119]
    s_waitcnt lgkmcnt(3)
    v_mfma_f32_16x16x32_bf16 v[84:87], a[148:151], a[104:107], v[84:87]
    buffer_store_dwordx4 v[68:71], v5, s[20:23], s32 offen offset:1024 sc1
    v_cvt_pk_bf16_f32 v104, v106, v107
    v_mfma_f32_16x16x32_bf16 v[120:123], a[148:151], a[108:111], v[120:123]
    ds_read_b128 a[132:135], v12 offset:8192
    v_cvt_pk_bf16_f32 v105, v108, v109
    v_cvt_pk_bf16_f32 v106, v110, v111
    v_mfma_f32_16x16x32_bf16 v[76:79], a[152:155], a[112:115], v[76:79]
    ds_read_b128 a[136:139], v12 offset:10240
    v_mov_b32 v107, -1
    v_mfma_f32_16x16x32_bf16 v[112:115], a[152:155], a[116:119], v[112:115]
    v_mfma_f32_16x16x32_bf16 v[80:83], a[156:159], a[112:115], v[80:83]
    buffer_store_dwordx4 v[104:107], v5, s[20:23], s32 offen offset:3072 sc1
    v_mfma_f32_16x16x32_bf16 v[116:119], a[156:159], a[116:119], v[116:119]
    ds_read_b128 a[140:143], v13 offset:6144
    v_mfma_f32_16x16x32_bf16 v[84:87], a[160:163], a[112:115], v[84:87]
    ds_read_b128 a[144:147], v13 offset:8192
    v_mfma_f32_16x16x32_bf16 v[120:123], a[160:163], a[116:119], v[120:123]
    v_mfma_f32_16x16x32_bf16 v[76:79], a[164:167], a[120:123], v[76:79]
    ds_read_b128 a[148:151], v13 offset:10240
    v_mfma_f32_16x16x32_bf16 v[112:115], a[164:167], a[124:127], v[112:115]
    s_waitcnt lgkmcnt(3)
    v_mfma_f32_16x16x32_bf16 v[80:83], a[168:171], a[120:123], v[80:83]
    ds_read_b128 a[152:155], v14 offset:6144
    v_mfma_f32_16x16x32_bf16 v[116:119], a[168:171], a[124:127], v[116:119]
    v_mfma_f32_16x16x32_bf16 v[84:87], a[172:175], a[120:123], v[84:87]
    ds_read_b128 a[156:159], v14 offset:8192
    v_mfma_f32_16x16x32_bf16 v[120:123], a[172:175], a[124:127], v[120:123]
    v_mfma_f32_16x16x32_bf16 v[76:79], a[128:131], a[0:3], v[76:79]
    ds_read_b128 a[160:163], v14 offset:10240
    v_mfma_f32_16x16x32_bf16 v[112:115], a[128:131], a[4:7], v[112:115]
    v_mfma_f32_16x16x32_bf16 v[80:83], a[132:135], a[0:3], v[80:83]
    ds_read_b128 a[164:167], v15 offset:6144
    v_mfma_f32_16x16x32_bf16 v[116:119], a[132:135], a[4:7], v[116:119]
    v_mfma_f32_16x16x32_bf16 v[84:87], a[136:139], a[0:3], v[84:87]
    ds_read_b128 a[168:171], v15 offset:8192
    v_mfma_f32_16x16x32_bf16 v[120:123], a[136:139], a[4:7], v[120:123]
    s_waitcnt lgkmcnt(3)
    v_mfma_f32_16x16x32_bf16 v[76:79], a[140:143], a[8:11], v[76:79]
    ds_read_b128 a[172:175], v15 offset:10240
    v_mfma_f32_16x16x32_bf16 v[112:115], a[140:143], a[12:15], v[112:115]
    v_mfma_f32_16x16x32_bf16 v[80:83], a[144:147], a[8:11], v[80:83]
    ds_read_b128 a[128:131], v8 offset:49152
    v_mfma_f32_16x16x32_bf16 v[116:119], a[144:147], a[12:15], v[116:119]
    v_mfma_f32_16x16x32_bf16 v[84:87], a[148:151], a[8:11], v[84:87]
    ds_read_b128 a[132:135], v8 offset:51200
    v_mfma_f32_16x16x32_bf16 v[120:123], a[148:151], a[12:15], v[120:123]
    v_mfma_f32_16x16x32_bf16 v[76:79], a[152:155], a[16:19], v[76:79]
    ds_read_b128 a[136:139], v9 offset:49152
    v_mfma_f32_16x16x32_bf16 v[112:115], a[152:155], a[20:23], v[112:115]
    v_mfma_f32_16x16x32_bf16 v[80:83], a[156:159], a[16:19], v[80:83]
    ds_read_b128 a[140:143], v9 offset:51200
    v_mfma_f32_16x16x32_bf16 v[116:119], a[156:159], a[20:23], v[116:119]
    s_waitcnt lgkmcnt(3)
    v_mfma_f32_16x16x32_bf16 v[84:87], a[160:163], a[16:19], v[84:87]
    ds_read_b128 a[144:147], v10 offset:49152
    v_mfma_f32_16x16x32_bf16 v[120:123], a[160:163], a[20:23], v[120:123]
    v_mfma_f32_16x16x32_bf16 v[76:79], a[164:167], a[24:27], v[76:79]
    ds_read_b128 a[148:151], v10 offset:51200
    v_mfma_f32_16x16x32_bf16 v[112:115], a[164:167], a[28:31], v[112:115]
    v_mfma_f32_16x16x32_bf16 v[80:83], a[168:171], a[24:27], v[80:83]
    ds_read_b128 a[152:155], v11 offset:49152
    v_mfma_f32_16x16x32_bf16 v[116:119], a[168:171], a[28:31], v[116:119]
    v_mfma_f32_16x16x32_bf16 v[84:87], a[172:175], a[24:27], v[84:87]
    ds_read_b128 a[156:159], v11 offset:51200
    v_mfma_f32_16x16x32_bf16 v[120:123], a[172:175], a[28:31], v[120:123]
    v_cvt_pk_bf16_f32 v76, v76, v77
    v_cvt_pk_bf16_f32 v77, v78, v79
    v_mfma_f32_16x16x32_bf16 v[88:91], a[128:131], a[96:99], v[88:91]
    ds_read_b128 a[160:163], v12 offset:12288
    v_mfma_f32_16x16x32_bf16 v[124:127], a[128:131], a[100:103], v[124:127]
    s_waitcnt lgkmcnt(3)
    v_cvt_pk_bf16_f32 v78, v80, v81
    v_mov_b32 v79, -1
    v_mfma_f32_16x16x32_bf16 v[92:95], a[132:135], a[96:99], v[92:95]
    buffer_store_dwordx4 v[76:79], v5, s[20:23], s33 offen offset:0 sc1
    v_cvt_pk_bf16_f32 v112, v112, v113
    v_mfma_f32_16x16x32_bf16 v[128:131], a[132:135], a[100:103], v[128:131]
    ds_read_b128 a[164:167], v12 offset:14336
    v_cvt_pk_bf16_f32 v113, v114, v115
    v_cvt_pk_bf16_f32 v114, v116, v117
    v_mfma_f32_16x16x32_bf16 v[88:91], a[136:139], a[104:107], v[88:91]
    ds_read_b128 a[168:171], v13 offset:12288
    v_mov_b32 v115, -1
    v_mfma_f32_16x16x32_bf16 v[124:127], a[136:139], a[108:111], v[124:127]
    v_mfma_f32_16x16x32_bf16 v[92:95], a[140:143], a[104:107], v[92:95]
    buffer_store_dwordx4 v[112:115], v5, s[20:23], s33 offen offset:2048 sc1
    v_cvt_pk_bf16_f32 v80, v82, v83
    v_mfma_f32_16x16x32_bf16 v[128:131], a[140:143], a[108:111], v[128:131]
    ds_read_b128 a[172:175], v13 offset:14336
    v_cvt_pk_bf16_f32 v81, v84, v85
    v_cvt_pk_bf16_f32 v82, v86, v87
    v_mfma_f32_16x16x32_bf16 v[88:91], a[144:147], a[112:115], v[88:91]
    ds_read_b128 a[128:131], v14 offset:12288
    v_mov_b32 v83, -1
    v_mfma_f32_16x16x32_bf16 v[124:127], a[144:147], a[116:119], v[124:127]
    v_mfma_f32_16x16x32_bf16 v[92:95], a[148:151], a[112:115], v[92:95]
    buffer_store_dwordx4 v[80:83], v5, s[20:23], s33 offen offset:1024 sc1
    v_cvt_pk_bf16_f32 v116, v118, v119
    v_mfma_f32_16x16x32_bf16 v[128:131], a[148:151], a[116:119], v[128:131]
    s_waitcnt lgkmcnt(2)
    ds_read_b128 a[132:135], v14 offset:14336
    v_cvt_pk_bf16_f32 v117, v120, v121
    v_cvt_pk_bf16_f32 v118, v122, v123
    v_mfma_f32_16x16x32_bf16 v[88:91], a[152:155], a[120:123], v[88:91]
    ds_read_b128 a[136:139], v15 offset:12288
    v_mov_b32 v119, -1
    v_mfma_f32_16x16x32_bf16 v[124:127], a[152:155], a[124:127], v[124:127]
    v_mfma_f32_16x16x32_bf16 v[92:95], a[156:159], a[120:123], v[92:95]
    buffer_store_dwordx4 v[116:119], v5, s[20:23], s33 offen offset:3072 sc1
    v_mfma_f32_16x16x32_bf16 v[128:131], a[156:159], a[124:127], v[128:131]
    ds_read_b128 a[140:143], v15 offset:14336
    v_mfma_f32_16x16x32_bf16 v[88:91], a[160:163], a[0:3], v[88:91]
    ds_read_b128 a[144:147], v8 offset:53248
    v_mfma_f32_16x16x32_bf16 v[124:127], a[160:163], a[4:7], v[124:127]
    v_mfma_f32_16x16x32_bf16 v[92:95], a[164:167], a[0:3], v[92:95]
    ds_read_b128 a[148:151], v9 offset:53248
    v_mfma_f32_16x16x32_bf16 v[128:131], a[164:167], a[4:7], v[128:131]
    v_mfma_f32_16x16x32_bf16 v[88:91], a[168:171], a[8:11], v[88:91]
    ds_read_b128 a[152:155], v10 offset:53248
    v_mfma_f32_16x16x32_bf16 v[124:127], a[168:171], a[12:15], v[124:127]
    s_waitcnt lgkmcnt(3)
    v_mfma_f32_16x16x32_bf16 v[92:95], a[172:175], a[8:11], v[92:95]
    ds_read_b128 a[156:159], v11 offset:53248
    v_mfma_f32_16x16x32_bf16 v[128:131], a[172:175], a[12:15], v[128:131]
    v_mfma_f32_16x16x32_bf16 v[88:91], a[128:131], a[16:19], v[88:91]
    ds_read_b128 a[160:163], v12 offset:16384
    v_mfma_f32_16x16x32_bf16 v[124:127], a[128:131], a[20:23], v[124:127]
    v_mfma_f32_16x16x32_bf16 v[92:95], a[132:135], a[16:19], v[92:95]
    ds_read_b128 a[164:167], v13 offset:16384
    v_mfma_f32_16x16x32_bf16 v[128:131], a[132:135], a[20:23], v[128:131]
    v_mfma_f32_16x16x32_bf16 v[88:91], a[136:139], a[24:27], v[88:91]
    ds_read_b128 a[168:171], v14 offset:16384
    v_mfma_f32_16x16x32_bf16 v[124:127], a[136:139], a[28:31], v[124:127]
    v_mfma_f32_16x16x32_bf16 v[92:95], a[140:143], a[24:27], v[92:95]
    ds_read_b128 a[172:175], v15 offset:16384
    v_mfma_f32_16x16x32_bf16 v[128:131], a[140:143], a[28:31], v[128:131]
    s_waitcnt lgkmcnt(3)
    v_mfma_f32_16x16x32_bf16 v[96:99], a[144:147], a[96:99], v[96:99]
    v_mfma_f32_16x16x32_bf16 v[132:135], a[144:147], a[100:103], v[132:135]
    v_cvt_pk_bf16_f32 v88, v88, v89
    v_cvt_pk_bf16_f32 v89, v90, v91
    v_mfma_f32_16x16x32_bf16 v[96:99], a[148:151], a[104:107], v[96:99]
    v_mfma_f32_16x16x32_bf16 v[132:135], a[148:151], a[108:111], v[132:135]
    v_cvt_pk_bf16_f32 v90, v92, v93
    v_mov_b32 v91, -1
    v_mfma_f32_16x16x32_bf16 v[96:99], a[152:155], a[112:115], v[96:99]
    buffer_store_dwordx4 v[88:91], v5, s[20:23], s34 offen offset:0 sc1
    v_cvt_pk_bf16_f32 v124, v124, v125
    v_mfma_f32_16x16x32_bf16 v[132:135], a[152:155], a[116:119], v[132:135]
    v_cvt_pk_bf16_f32 v125, v126, v127
    v_cvt_pk_bf16_f32 v126, v128, v129
    v_mov_b32 v127, -1
    v_mfma_f32_16x16x32_bf16 v[96:99], a[156:159], a[120:123], v[96:99]
    v_mfma_f32_16x16x32_bf16 v[132:135], a[156:159], a[124:127], v[132:135]
    v_mfma_f32_16x16x32_bf16 v[96:99], a[160:163], a[0:3], v[96:99]
    buffer_store_dwordx4 v[124:127], v5, s[20:23], s34 offen offset:2048 sc1
    v_cvt_pk_bf16_f32 v92, v94, v95
    v_mfma_f32_16x16x32_bf16 v[132:135], a[160:163], a[4:7], v[132:135]
    s_waitcnt lgkmcnt(0)
    v_mfma_f32_16x16x32_bf16 v[96:99], a[164:167], a[8:11], v[96:99]
    v_mfma_f32_16x16x32_bf16 v[132:135], a[164:167], a[12:15], v[132:135]
    v_mfma_f32_16x16x32_bf16 v[96:99], a[168:171], a[16:19], v[96:99]
    v_mfma_f32_16x16x32_bf16 v[132:135], a[168:171], a[20:23], v[132:135]
    v_mfma_f32_16x16x32_bf16 v[96:99], a[172:175], a[24:27], v[96:99]
    v_mfma_f32_16x16x32_bf16 v[132:135], a[172:175], a[28:31], v[132:135]
    s_nop 6
    v_cvt_pk_bf16_f32 v93, v96, v97
    v_cvt_pk_bf16_f32 v94, v98, v99
    v_mov_b32 v95, -1
    buffer_store_dwordx4 v[92:95], v5, s[20:23], s34 offen offset:1024 sc1
    v_cvt_pk_bf16_f32 v128, v130, v131
    v_cvt_pk_bf16_f32 v129, v132, v133
    v_cvt_pk_bf16_f32 v130, v134, v135
    v_mov_b32 v131, -1
    buffer_store_dwordx4 v[128:131], v5, s[20:23], s34 offen offset:3072 sc1
    s_endpgm
gated_mix__ssm_conv_s5__swiglu_ffn__prompt_kernel_B_pg0_10:
    s_branch gated_mix__ssm_conv_s5__swiglu_ffn__prompt_kernel_B_pr0
gated_mix__ssm_conv_s5__swiglu_ffn__prompt_kernel_tails:
gated_mix__ssm_conv_s5__swiglu_ffn__prompt_kernel_A_rd_s:
    s_mov_b32 s50, 0
gated_mix__ssm_conv_s5__swiglu_ffn__prompt_kernel_A_rd_l:
    s_sleep 1
    buffer_load_dword v28, v29, s[52:55], 0 offen sc1
    s_waitcnt vmcnt(0)
    v_cmp_eq_u32 s[76:77], 0, v28
    s_nop 1
    s_cmp_eq_u64 s[76:77], 0
    s_cbranch_scc1 gated_mix__ssm_conv_s5__swiglu_ffn__prompt_kernel_A_rd
    s_add_u32 s50, s50, 1
    s_cmp_lt_u32 s50, 32768
    s_cbranch_scc1 gated_mix__ssm_conv_s5__swiglu_ffn__prompt_kernel_A_rd_l
    s_branch gated_mix__ssm_conv_s5__swiglu_ffn__prompt_kernel_A_rd
gated_mix__ssm_conv_s5__swiglu_ffn__prompt_kernel_A_eS_s:
    s_mov_b32 s50, 0
gated_mix__ssm_conv_s5__swiglu_ffn__prompt_kernel_A_eS_l:
    s_sleep 1
    buffer_load_dwordx3 v[28:30], v7, s[32:35], 0 offen offset:256 sc1
    buffer_load_dwordx3 v[32:34], v7, s[32:35], 0 offen offset:512 sc1
    s_waitcnt vmcnt(0)
    v_max3_u32 v31, v28, v29, v30
    v_max3_u32 v31, v31, v32, v33
    v_max_u32 v31, v31, v34
    v_cmp_eq_u32 s[78:79], -1, v31
    s_nop 1
    s_cmp_eq_u64 s[78:79], 0
    s_cbranch_scc1 gated_mix__ssm_conv_s5__swiglu_ffn__prompt_kernel_A_eS
    s_add_u32 s50, s50, 1
    s_cmp_lt_u32 s50, 32768
    s_cbranch_scc1 gated_mix__ssm_conv_s5__swiglu_ffn__prompt_kernel_A_eS_l
    s_branch gated_mix__ssm_conv_s5__swiglu_ffn__prompt_kernel_A_eS
gated_mix__ssm_conv_s5__swiglu_ffn__prompt_kernel_hp0_s:
    s_mov_b32 s50, 0
gated_mix__ssm_conv_s5__swiglu_ffn__prompt_kernel_hp0_l:
    s_sleep 1
    buffer_load_dword v21, v20, s[20:23], s69 offen offset:0 sc1
    s_waitcnt vmcnt(0)
    v_cmp_eq_u32 s[76:77], 0, v21
    s_nop 1
    s_cmp_eq_u64 s[76:77], 0
    s_cbranch_scc1 gated_mix__ssm_conv_s5__swiglu_ffn__prompt_kernel_hp0
    s_add_u32 s50, s50, 1
    s_cmp_lt_u32 s50, 32768
    s_cbranch_scc1 gated_mix__ssm_conv_s5__swiglu_ffn__prompt_kernel_hp0_l
    s_branch gated_mix__ssm_conv_s5__swiglu_ffn__prompt_kernel_hp0
gated_mix__ssm_conv_s5__swiglu_ffn__prompt_kernel_hp1_s:
    s_mov_b32 s50, 0
gated_mix__ssm_conv_s5__swiglu_ffn__prompt_kernel_hp1_l:
    s_sleep 1
    buffer_load_dword v21, v20, s[20:23], s69 offen offset:128 sc1
    s_waitcnt vmcnt(0)
    v_cmp_eq_u32 s[76:77], 0, v21
    s_nop 1
    s_cmp_eq_u64 s[76:77], 0
    s_cbranch_scc1 gated_mix__ssm_conv_s5__swiglu_ffn__prompt_kernel_hp1
    s_add_u32 s50, s50, 1
    s_cmp_lt_u32 s50, 32768
    s_cbranch_scc1 gated_mix__ssm_conv_s5__swiglu_ffn__prompt_kernel_hp1_l
    s_branch gated_mix__ssm_conv_s5__swiglu_ffn__prompt_kernel_hp1
gated_mix__ssm_conv_s5__swiglu_ffn__prompt_kernel_hp2_s:
    s_mov_b32 s50, 0
gated_mix__ssm_conv_s5__swiglu_ffn__prompt_kernel_hp2_l:
    s_sleep 1
    buffer_load_dword v21, v20, s[20:23], s69 offen offset:256 sc1
    s_waitcnt vmcnt(0)
    v_cmp_eq_u32 s[76:77], 0, v21
    s_nop 1
    s_cmp_eq_u64 s[76:77], 0
    s_cbranch_scc1 gated_mix__ssm_conv_s5__swiglu_ffn__prompt_kernel_hp2
    s_add_u32 s50, s50, 1
    s_cmp_lt_u32 s50, 32768
    s_cbranch_scc1 gated_mix__ssm_conv_s5__swiglu_ffn__prompt_kernel_hp2_l
    s_branch gated_mix__ssm_conv_s5__swiglu_ffn__prompt_kernel_hp2
gated_mix__ssm_conv_s5__swiglu_ffn__prompt_kernel_hp3_s:
    s_mov_b32 s50, 0
gated_mix__ssm_conv_s5__swiglu_ffn__prompt_kernel_hp3_l:
    s_sleep 1
    buffer_load_dword v21, v20, s[20:23], s69 offen offset:384 sc1
    s_waitcnt vmcnt(0)
    v_cmp_eq_u32 s[76:77], 0, v21
    s_nop 1
    s_cmp_eq_u64 s[76:77], 0
    s_cbranch_scc1 gated_mix__ssm_conv_s5__swiglu_ffn__prompt_kernel_hp3
    s_add_u32 s50, s50, 1
    s_cmp_lt_u32 s50, 32768
    s_cbranch_scc1 gated_mix__ssm_conv_s5__swiglu_ffn__prompt_kernel_hp3_l
    s_branch gated_mix__ssm_conv_s5__swiglu_ffn__prompt_kernel_hp3
gated_mix__ssm_conv_s5__swiglu_ffn__prompt_kernel_hp4_s:
    s_mov_b32 s50, 0
gated_mix__ssm_conv_s5__swiglu_ffn__prompt_kernel_hp4_l:
    s_sleep 1
    buffer_load_dword v21, v20, s[20:23], s69 offen offset:560 sc1
    s_waitcnt vmcnt(0)
    v_cmp_eq_u32 s[76:77], 0, v21
    s_nop 1
    s_cmp_eq_u64 s[76:77], 0
    s_cbranch_scc1 gated_mix__ssm_conv_s5__swiglu_ffn__prompt_kernel_hp4
    s_add_u32 s50, s50, 1
    s_cmp_lt_u32 s50, 32768
    s_cbranch_scc1 gated_mix__ssm_conv_s5__swiglu_ffn__prompt_kernel_hp4_l
    s_branch gated_mix__ssm_conv_s5__swiglu_ffn__prompt_kernel_hp4
gated_mix__ssm_conv_s5__swiglu_ffn__prompt_kernel_lk_s:
    s_mov_b32 s50, 0
gated_mix__ssm_conv_s5__swiglu_ffn__prompt_kernel_lk_l:
    s_sleep 1
    buffer_load_dword v59, v58, s[20:23], s54 offen sc1
    s_waitcnt vmcnt(0)
    v_cmp_eq_u32 s[78:79], 0, v59
    s_nop 1
    s_cmp_eq_u64 s[78:79], 0
    s_cbranch_scc1 gated_mix__ssm_conv_s5__swiglu_ffn__prompt_kernel_lk
    s_add_u32 s50, s50, 1
    s_cmp_lt_u32 s50, 32768
    s_cbranch_scc1 gated_mix__ssm_conv_s5__swiglu_ffn__prompt_kernel_lk_l
    s_branch gated_mix__ssm_conv_s5__swiglu_ffn__prompt_kernel_lk
gated_mix__ssm_conv_s5__swiglu_ffn__prompt_kernel_gp_s:
    s_mov_b32 s50, 0
gated_mix__ssm_conv_s5__swiglu_ffn__prompt_kernel_gp_l:
    s_sleep 1
    buffer_load_dword v32, v33, s[20:23], s86 offen sc1
    s_waitcnt vmcnt(0)
    v_cmp_eq_u32 s[78:79], 0, v32
    s_nop 1
    s_cmp_eq_u64 s[78:79], 0
    s_cbranch_scc1 gated_mix__ssm_conv_s5__swiglu_ffn__prompt_kernel_gp
    s_add_u32 s50, s50, 1
    s_cmp_lt_u32 s50, 32768
    s_cbranch_scc1 gated_mix__ssm_conv_s5__swiglu_ffn__prompt_kernel_gp_l
    s_branch gated_mix__ssm_conv_s5__swiglu_ffn__prompt_kernel_gp
gated_mix__ssm_conv_s5__swiglu_ffn__prompt_kernel_B_rd_s:
    s_mov_b32 s50, 0
gated_mix__ssm_conv_s5__swiglu_ffn__prompt_kernel_B_rd_l:
    s_sleep 1
    buffer_load_dword v28, v29, s[52:55], 0 offen sc1
    s_waitcnt vmcnt(0)
    v_cmp_eq_u32 s[76:77], 0, v28
    s_nop 1
    s_cmp_eq_u64 s[76:77], 0
    s_cbranch_scc1 gated_mix__ssm_conv_s5__swiglu_ffn__prompt_kernel_B_rd
    s_add_u32 s50, s50, 1
    s_cmp_lt_u32 s50, 32768
    s_cbranch_scc1 gated_mix__ssm_conv_s5__swiglu_ffn__prompt_kernel_B_rd_l
    s_branch gated_mix__ssm_conv_s5__swiglu_ffn__prompt_kernel_B_rd
gated_mix__ssm_conv_s5__swiglu_ffn__prompt_kernel_sp_s:
    s_mov_b32 s50, 0
gated_mix__ssm_conv_s5__swiglu_ffn__prompt_kernel_sp_l:
    s_sleep 1
    buffer_load_dword v23, v22, s[20:23], s73 offen sc1
    s_waitcnt vmcnt(0)
    v_cmp_eq_u32 s[76:77], 0, v23
    s_nop 1
    s_cmp_eq_u64 s[76:77], 0
    s_cbranch_scc1 gated_mix__ssm_conv_s5__swiglu_ffn__prompt_kernel_sp
    s_add_u32 s50, s50, 1
    s_cmp_lt_u32 s50, 32768
    s_cbranch_scc1 gated_mix__ssm_conv_s5__swiglu_ffn__prompt_kernel_sp_l
    s_branch gated_mix__ssm_conv_s5__swiglu_ffn__prompt_kernel_sp
gated_mix__ssm_conv_s5__swiglu_ffn__prompt_kernel_lkb_s:
    s_mov_b32 s50, 0
gated_mix__ssm_conv_s5__swiglu_ffn__prompt_kernel_lkb_l:
    s_sleep 1
    buffer_load_dword v29, v28, s[20:23], s35 offen sc1
    s_waitcnt vmcnt(0)
    v_cmp_eq_u32 s[76:77], 0, v29
    s_nop 1
    s_cmp_eq_u64 s[76:77], 0
    s_cbranch_scc1 gated_mix__ssm_conv_s5__swiglu_ffn__prompt_kernel_lkb
    s_add_u32 s50, s50, 1
    s_cmp_lt_u32 s50, 32768
    s_cbranch_scc1 gated_mix__ssm_conv_s5__swiglu_ffn__prompt_kernel_lkb_l
    s_branch gated_mix__ssm_conv_s5__swiglu_ffn__prompt_kernel_lkb
gated_mix__ssm_conv_s5__swiglu_ffn__prompt_kernel_done:
    s_endpgm
.section .rodata,"a"
.p2align 6
.amdhsa_kernel gated_mix__ssm_conv_s5__swiglu_ffn__prompt_kernel
  .amdhsa_next_free_vgpr 512
  .amdhsa_next_free_sgpr 102
  .amdhsa_accum_offset 256
  .amdhsa_group_segment_fixed_size 0
  .amdhsa_kernarg_size 136
  .amdhsa_user_sgpr_count 2
  .amdhsa_user_sgpr_kernarg_segment_ptr 1
  .amdhsa_system_sgpr_workgroup_id_x 1
.end_amdhsa_kernel
```
